```python
import torch

def _softmax(x, axis=-1):
    return torch.softmax(x, dim=axis)
def _gelu(x):
    return torch.nn.functional.gelu(x, approximate="tanh")
def _silu(x):
    return torch.nn.functional.silu(x)
def _sigmoid(x):
    return torch.sigmoid(x)
def _layernorm(x, axis=-1, eps=1e-5):
    m = x.mean(dim=axis, keepdim=True)
    v = x.var(dim=axis, keepdim=True, unbiased=False)
    return (x - m) / torch.sqrt(v + eps)
def _scatter_add(tgt, idx, src, axis=0):
    return tgt.clone().index_add_(axis, idx, src)
def _segment_sum(src, seg, n):
    out = torch.zeros((n,) + src.shape[1:], dtype=src.dtype)
    return out.index_add_(0, seg, src)
def _pad(x, pw):
    flat = tuple(v for pair in reversed(pw) for v in pair)
    return torch.nn.functional.pad(x, flat)

kernel_name = 'interleave_layers__ssm_conv_h3__mixer_channel_mlp__prompt'

def setup_inputs():

    _w = (lambda a: (lambda t: t.to(torch.bfloat16) if t.is_floating_point() else t)(torch.as_tensor(a)))
    def _A_setup():
        B, S, D = 1, 2048, 448
        ks = 4
        return {
            "q": _w((lambda *s: torch.randn(*s, dtype=torch.bfloat16) * 0.05)(B, S, D)),
            "k": _w((lambda *s: torch.randn(*s, dtype=torch.bfloat16) * 0.4)(B, S, D)),
            "v": _w((lambda *s: torch.randn(*s, dtype=torch.bfloat16) * 0.4)(B, S, D)),
            "shift_k": _w((lambda *s: torch.randn(*s, dtype=torch.bfloat16) * 0.4)(D, ks) * 0.5),
            "ssm_k": _w((lambda *s: torch.randn(*s, dtype=torch.bfloat16) * 0.4)(D, S) * (1.0 / S ** 0.5)),
            "ssm_D": _w((lambda *s: torch.randn(*s, dtype=torch.bfloat16) * 0.4)(D)),
        }
    _A_in = _A_setup()

    def _B_setup():
        B, S, D, F = 1, 2048, 448, 1792
        return {
            "x": _w((lambda *s: torch.randn(*s, dtype=torch.bfloat16) * 0.05)(B, S, D)),
            "w1": _w((lambda *s: torch.randn(*s, dtype=torch.bfloat16) * 0.8)(D, F) * (D ** -0.5)),
            "b1": _w((lambda *s: torch.randn(*s, dtype=torch.bfloat16) * 0.8)(F)),
            "w2": _w((lambda *s: torch.randn(*s, dtype=torch.bfloat16) * 0.8)(F, D) * (F ** -0.5)),
            "b2": _w((lambda *s: torch.randn(*s, dtype=torch.bfloat16) * 0.2)(D)),
        }
    _B_in = _B_setup()

    return {
        "A_q": _A_in["q"],
        "A_k": _A_in["k"],
        "A_v": _A_in["v"],
        "A_shift_k": _A_in["shift_k"],
        "A_ssm_k": _A_in["ssm_k"],
        "A_ssm_D": _A_in["ssm_D"],
        "B_x": _B_in["x"],
        "B_w1": _B_in["w1"],
        "B_b1": _B_in["b1"],
        "B_w2": _B_in["w2"],
        "B_b2": _B_in["b2"],
    }

def reference(A_q, A_k, A_v, A_shift_k, A_ssm_k, A_ssm_D, B_x, B_w1, B_b1, B_w2, B_b2):
    def _A_ref(q, k, v, shift_k, ssm_k, ssm_D):
        B, S, D = q.shape
        ks = shift_k.shape[-1]
        k_pad = _pad(k, ((0, 0), (ks - 1, 0), (0, 0)))
        k_shift = torch.zeros_like(k)
        for t in range(ks):
            k_shift = k_shift + k_pad[:, t:t + S, :] * shift_k[:, ks - 1 - t][None, None, :]
        kv = k_shift * v
        L = 2 * S
        kv_pad = _pad(kv, ((0, 0), (0, S), (0, 0)))
        kf_pad = _pad(ssm_k, ((0, 0), (0, S)))
        kv_f = (lambda x, axes=(-2,-1): torch.fft.rfft2(x.float(), dim=axes))(kv_pad[:, None, :, :], axes=(1, 2))
        kf_f = (lambda x, axes=(-2,-1): torch.fft.rfft2(x.float(), dim=axes))(kf_pad[:, None, :], axes=(1, 2))
        kf_f = (lambda x, *d: x.permute(*d))(kf_f, 1, 2, 0)
        y_f = kv_f * kf_f[None, :, :, :]
        y = (lambda x, s, axes=(-2,-1): torch.fft.irfft2(x, s=s, dim=axes).to(torch.bfloat16))(y_f, (1, L), axes=(1, 2))[:, 0, :S, :]
        y = y + kv * ssm_D[None, None, :]
        return q * y

    def _B_ref(x, w1, b1, w2, b2):
        y = _layernorm(x, axis=-1)
        h = _gelu(torch.einsum("bsd,df->bsf", y, w1) + b1)
        return torch.einsum("bsf,fd->bsd", h, w2) + b2

    x = A_q
    x = x + _A_ref(_layernorm(x, axis=-1), A_k, A_v, A_shift_k, A_ssm_k, A_ssm_D)
    x = x + _B_ref(_layernorm(x, axis=-1), B_w1, B_b1, B_w2, B_b2)
    x = x + _A_ref(_layernorm(x, axis=-1), A_k, A_v, A_shift_k, A_ssm_k, A_ssm_D)
    x = x + _B_ref(_layernorm(x, axis=-1), B_w1, B_b1, B_w2, B_b2)
    return x
```

```asm
; @launch grid=(256,1,1) block=(256,1,1) lds=163840
.amdgcn_target "amdgcn-amd-amdhsa--gfx950"
.text
.globl interleave_layers__ssm_conv_h3__mixer_channel_mlp__prompt_kernel
.p2align 12
.fill 0, 4, 0xbf810000
.p2align 8
.type interleave_layers__ssm_conv_h3__mixer_channel_mlp__prompt_kernel,@function
interleave_layers__ssm_conv_h3__mixer_channel_mlp__prompt_kernel:
    s_cmp_ge_u32 s2, 256
    s_cbranch_scc1 L_exit
    s_load_dwordx2 s[20:21], s[0:1], 104
    s_load_dwordx2 s[4:5], s[0:1], 8
    s_load_dwordx2 s[8:9], s[0:1], 16
    s_load_dwordx2 s[12:13], s[0:1], 24
    s_load_dwordx2 s[16:17], s[0:1], 32
    s_load_dwordx2 s[28:29], s[0:1], 56
    s_load_dwordx2 s[32:33], s[0:1], 72
    s_load_dwordx2 s[44:45], s[0:1], 40
    s_load_dwordx2 s[24:25], s[0:1], 0
    s_load_dwordx2 s[36:37], s[0:1], 64
    s_load_dwordx2 s[40:41], s[0:1], 80
    s_load_dwordx2 s[48:49], s[0:1], 88
    s_getpc_b64 s[60:61]
L_pc:
    s_lshr_b32 s52, s2, 3
    v_lshrrev_b32 v45, 6, v0
    v_bfe_u32 v46, v0, 4, 2
    v_lshl_add_u32 v46, v45, 2, v46
    v_lshl_add_u32 v46, s52, 4, v46
    v_lshlrev_b32 v46, 7, v46
    v_min_u32 v46, L_pf_end-L_pc-4, v46
    global_load_dword v4, v46, s[60:61]
    s_mov_b32 s22, 268435456
    s_mov_b32 s23, 0x20000
    s_mov_b32 s6, 1835008
    s_mov_b32 s7, 0x20000
    s_mov_b32 s10, 1835008
    s_mov_b32 s11, 0x20000
    s_mov_b32 s14, 3584
    s_mov_b32 s15, 0x20000
    s_mov_b32 s18, 1835008
    s_mov_b32 s19, 0x20000
    s_mov_b32 s30, 1605632
    s_mov_b32 s31, 0x20000
    s_mov_b32 s34, 1605632
    s_mov_b32 s35, 0x20000
    s_mov_b32 s46, 896
    s_mov_b32 s47, 0x20000
    s_mov_b32 s26, 1835008
    s_mov_b32 s27, 0x20000
    s_mov_b32 s38, 3584
    s_mov_b32 s39, 0x20000
    s_mov_b32 s42, 896
    s_mov_b32 s43, 0x20000
    s_mov_b32 s50, 1835008
    s_mov_b32 s51, 0x20000
    s_and_b32 s3, s2, 7
    v_and_b32 v44, 63, v0
    v_readfirstlane_b32 s53, v45
    v_lshlrev_b32 v1, 4, v44
    s_mov_b32 s58, 131072
    s_cmp_eq_u32 s3, 7
    s_cbranch_scc1 L_x7
    v_and_b32 v51, 31, v0
    v_lshrrev_b32 v75, 5, v0
    s_mul_i32 s56, s52, 57344
    s_lshl_b32 s57, s3, 7
    s_add_u32 s56, s56, s57
    v_mul_u32_u24 v45, 7168, v75
    v_lshl_add_u32 v45, v51, 2, v45
    v_add_u32 v45, s56, v45
    v_subrev_u32 v50, 2688, v45
    s_movk_i32 s89, 4480
    v_lshlrev_b32 v51, 4, v51
    s_lshl_b32 s57, s3, 9
    s_waitcnt lgkmcnt(0)
    buffer_load_dword v2, off, s[20:23], 0 sc0 sc1
    buffer_load_dwordx4 v[46:49], v51, s[12:15], s57 offen
    buffer_load_dword v64, v50, s[4:7], 0 offen offset:0
    buffer_load_dword v65, v50, s[4:7], 0 offen offset:896
    buffer_load_dword v66, v50, s[4:7], 0 offen offset:1792
    buffer_load_dword v67, v45, s[4:7], 0 offen offset:0
    buffer_load_dword v76, v45, s[8:11], 0 offen offset:0
    buffer_load_dword v68, v45, s[4:7], 0 offen offset:896
    buffer_load_dword v77, v45, s[8:11], 0 offen offset:896
    buffer_load_dword v69, v45, s[4:7], 0 offen offset:1792
    buffer_load_dword v78, v45, s[8:11], 0 offen offset:1792
    buffer_load_dword v70, v45, s[4:7], 0 offen offset:2688
    buffer_load_dword v79, v45, s[8:11], 0 offen offset:2688
    buffer_load_dword v71, v45, s[4:7], 0 offen offset:3584
    buffer_load_dword v80, v45, s[8:11], 0 offen offset:3584
    buffer_load_dword v72, v45, s[4:7], s89 offen offset:0
    buffer_load_dword v81, v45, s[8:11], s89 offen offset:0
    buffer_load_dword v73, v45, s[4:7], s89 offen offset:896
    buffer_load_dword v82, v45, s[8:11], s89 offen offset:896
    buffer_load_dword v74, v45, s[4:7], s89 offen offset:1792
    buffer_load_dword v83, v45, s[8:11], s89 offen offset:1792
    s_lshl_b32 s84, s3, 5
    s_add_u32 s84, s84, s52
    s_lshl_b32 s84, s84, 1
    v_bfe_u32 v75, v44, 2, 1
    v_lshrrev_b32 v84, 1, v0
    v_lshlrev_b32 v75, 12, v75
    v_lshlrev_b32 v84, 7, v84
    s_lshl_b32 s56, s84, 13
    s_add_u32 s56, s56, 65536
    s_lshl_b32 s56, s84, 12
    buffer_load_dwordx2 v[50:51], v75, s[16:19], s56 offen
    s_lshr_b32 s57, s53, 1
    s_add_u32 s57, s57, s84
    s_lshl_b32 s57, s57, 1
    buffer_load_ushort v45, off, s[44:47], s57
    s_mov_b32 s60, 0xffff0000
    s_mov_b32 s83, 152064
    s_mul_i32 s56, s52, 37
    s_lshr_b32 s56, s56, 8
    s_mul_i32 s57, s56, 7
    s_sub_u32 s54, s52, s57
    s_lshl2_add_u32 s55, s3, s56
    s_lshl2_add_u32 s86, s52, s53
    s_lshl3_add_u32 s96, s52, s53
    v_lshrrev_b32 v75, 3, v44
    v_lshrrev_b32 v84, 2, v44
    v_and_b32 v84, 4, v84
    v_and_b32 v85, 7, v44
    v_xor_b32 v84, v84, v85
    v_lshlrev_b32 v84, 4, v84
    v_mul_u32_u24 v85, 896, v75
    v_add_u32 v38, v85, v84
    v_lshl_add_u32 v40, v85, 2, v84
    v_add_u32 v39, 6144, v38
    v_add_u32 v41, 27648, v40
    v_min_u32 v75, 6, v44
    v_lshlrev_b32 v3, 2, v75
    s_lshl2_add_u32 s56, s54, s53
    s_lshl_b32 s61, s56, 7
    s_mul_i32 s62, s53, 24576
    s_and_b32 s68, s55, 3
    s_mul_i32 s68, s68, 6
    s_add_u32 s68, s68, 2
    s_lshr_b32 s68, s68, 2
    s_add_u32 s68, s68, s3
    s_sub_u32 s67, s68, 6
    s_min_u32 s68, s68, s67
    s_sub_u32 s67, s68, 6
    s_min_u32 s68, s68, s67
    s_add_u32 s56, s68, s54
    s_add_u32 s67, s56, 1
    s_sub_u32 s56, s56, 6
    s_min_u32 s67, s67, s56
    s_mul_i32 s67, s67, 229376
    s_add_u32 s73, s67, s61
    s_lshl_b32 s57, s3, 5
    s_add_u32 s57, s57, s52
    s_sub_u32 s57, s57, s54
    s_lshl2_add_u32 s57, s57, s53
    s_lshl2_add_u32 s57, s54, s57
    s_lshl_b32 s57, s57, 12
    s_add_u32 s65, s57, 4718592
    v_bfe_u32 v225, v44, 3, 1
    v_lshrrev_b32 v224, 4, v44
    v_lshl_add_u32 v224, v224, 3, v225
    v_and_b32 v225, 7, v44
    v_mul_u32_u24 v224, 1792, v224
    v_lshl_add_u32 v224, v225, 4, v224
    s_lshl4_add_u32 s56, s55, s53
    s_mul_i32 s94, s56, 3584
    s_lshl_b32 s57, s54, 7
    s_add_u32 s94, s94, s57
    s_lshl2_add_u32 s56, s54, s53
    s_lshl_b32 s56, s56, 7
    v_lshl_add_u32 v225, v44, 1, s56
    v_lshl_add_u32 v226, v44, 1, s57
    s_mul_i32 s57, s54, 5
    s_lshl2_add_u32 s56, s55, s53
    v_min_u32 v227, 4, v44
    s_mul_i32 s56, s56, 4608
    v_add_u32 v227, s57, v227
    s_add_u32 s56, s56, 8912896
    v_min_u32 v227, 35, v227
    v_lshl_add_u32 v227, v227, 7, s56
    s_add_u32 s57, s65, 4290316288
    v_add_u32 v228, s57, v1
    v_lshrrev_b32 v229, 2, v1
    v_and_b32 v229, 124, v229
    v_mov_b32 v231, -1
    v_lshrrev_b32 v235, 3, v0
    v_and_b32 v230, 7, v0
    v_lshlrev_b32 v235, 9, v235
    v_lshl_add_u32 v235, v230, 4, v235
    s_lshl_b32 s97, s84, 13
    s_add_u32 s97, s97, 65536
    v_lshlrev_b32 v230, 4, v0
    v_sub_u32 v230, 152048, v230
    v_and_b32 v116, 31, v0
    v_lshrrev_b32 v117, 5, v0
    v_mul_u32_u24 v116, 272, v116
    v_lshl_add_u32 v116, v117, 4, v116
    v_add_u32 v116, 131584, v116
    v_lshrrev_b32 v75, 3, v0
    v_and_b32 v114, 7, v0
    v_mul_u32_u24 v117, 272, v75
    v_lshlrev_b32 v75, 14, v75
    v_lshl_add_u32 v117, v114, 4, v117
    v_lshl_add_u32 v75, v114, 4, v75
    v_add_u32 v117, 131584, v117
    s_lshl_b32 s79, s3, 19
    s_lshl_b32 s57, s52, 9
    s_add_u32 s79, s79, s57
    s_add_u32 s79, s79, 65536
    s_lshl_b32 s56, s84, 12
    s_lshl_b32 s82, s53, 10
    s_add_u32 s56, s56, s82
    s_add_u32 m0, s82, 98336
    s_add_u32 s57, s56, 0
    buffer_load_dwordx4 v1, s[16:19], s57 offen lds
    s_add_u32 m0, s82, 114976
    s_add_u32 s57, s56, 4096
    buffer_load_dwordx4 v1, s[16:19], s57 offen lds
    s_add_u32 m0, s82, 106656
    s_add_u32 s57, s56, 4
    buffer_load_dwordx4 v1, s[16:19], s57 offen lds
    s_add_u32 m0, s82, 123296
    s_add_u32 s57, s56, 4100
    buffer_load_dwordx4 v1, s[16:19], s57 offen lds
    s_add_u32 m0, s82, 102496
    s_add_u32 s57, s56, 2
    buffer_load_dwordx4 v1, s[16:19], s57 offen lds
    s_add_u32 m0, s82, 119136
    s_add_u32 s57, s56, 4098
    buffer_load_dwordx4 v1, s[16:19], s57 offen lds
    s_add_u32 m0, s82, 110816
    s_add_u32 s57, s56, 6
    buffer_load_dwordx4 v1, s[16:19], s57 offen lds
    s_add_u32 m0, s82, 127456
    s_add_u32 s57, s56, 4102
    buffer_load_dwordx4 v1, s[16:19], s57 offen lds
    s_waitcnt vmcnt(30)
    v_add_u32 v2, 1, v2
    s_nop 0
    v_readfirstlane_b32 s59, v2
    s_lshl_b32 s90, s3, 7
    s_add_u32 s90, s90, 4096
    s_getreg_b32 s92, hwreg(HW_REG_XCC_ID, 0, 4)
    s_lshl_b32 s92, s92, 28
    s_xor_b32 s92, s92, s59
    s_cmp_lg_u32 s53, 0
    s_cbranch_scc1 Lxp_1
    v_mov_b32 v118, s92
    s_lshl2_add_u32 s57, s52, s90
    buffer_store_dword v118, off, s[20:23], s57 sc1
Lxp_1:
    s_waitcnt vmcnt(29)
    v_lshlrev_b32 v106, 16, v46
    v_lshlrev_b32 v107, 16, v48
    v_and_b32 v108, s60, v46
    v_and_b32 v109, s60, v48
    v_lshlrev_b32 v110, 16, v47
    v_lshlrev_b32 v111, 16, v49
    v_and_b32 v112, s60, v47
    v_and_b32 v113, s60, v49
    s_waitcnt vmcnt(28)
    v_lshlrev_b32 v84, 16, v64
    v_and_b32 v85, s60, v64
    s_waitcnt vmcnt(27)
    v_lshlrev_b32 v86, 16, v65
    v_and_b32 v87, s60, v65
    s_waitcnt vmcnt(26)
    v_lshlrev_b32 v88, 16, v66
    v_and_b32 v89, s60, v66
    s_waitcnt vmcnt(25)
    v_lshlrev_b32 v90, 16, v67
    v_and_b32 v91, s60, v67
    v_pk_mul_f32 v[124:125], v[84:85], v[112:113]
    s_waitcnt vmcnt(24)
    v_lshlrev_b32 v114, 16, v76
    v_pk_fma_f32 v[124:125], v[86:87], v[110:111], v[124:125]
    v_and_b32 v115, s60, v76
    v_pk_fma_f32 v[124:125], v[88:89], v[108:109], v[124:125]
    v_pk_fma_f32 v[124:125], v[90:91], v[106:107], v[124:125]
    v_pk_mul_f32 v[124:125], v[124:125], v[114:115]
    s_waitcnt vmcnt(23)
    v_lshlrev_b32 v92, 16, v68
    v_and_b32 v93, s60, v68
    v_pk_mul_f32 v[126:127], v[86:87], v[112:113]
    s_waitcnt vmcnt(22)
    v_lshlrev_b32 v114, 16, v77
    v_pk_fma_f32 v[126:127], v[88:89], v[110:111], v[126:127]
    v_and_b32 v115, s60, v77
    v_pk_fma_f32 v[126:127], v[90:91], v[108:109], v[126:127]
    v_pk_fma_f32 v[126:127], v[92:93], v[106:107], v[126:127]
    v_pk_mul_f32 v[126:127], v[126:127], v[114:115]
    s_waitcnt vmcnt(21)
    v_lshlrev_b32 v94, 16, v69
    v_and_b32 v95, s60, v69
    v_pk_mul_f32 v[128:129], v[88:89], v[112:113]
    s_waitcnt vmcnt(20)
    v_lshlrev_b32 v114, 16, v78
    v_pk_fma_f32 v[128:129], v[90:91], v[110:111], v[128:129]
    v_and_b32 v115, s60, v78
    v_pk_fma_f32 v[128:129], v[92:93], v[108:109], v[128:129]
    v_pk_fma_f32 v[128:129], v[94:95], v[106:107], v[128:129]
    v_pk_mul_f32 v[128:129], v[128:129], v[114:115]
    s_waitcnt vmcnt(19)
    v_lshlrev_b32 v96, 16, v70
    v_and_b32 v97, s60, v70
    v_pk_mul_f32 v[130:131], v[90:91], v[112:113]
    s_waitcnt vmcnt(18)
    v_lshlrev_b32 v114, 16, v79
    v_pk_fma_f32 v[130:131], v[92:93], v[110:111], v[130:131]
    v_and_b32 v115, s60, v79
    v_pk_fma_f32 v[130:131], v[94:95], v[108:109], v[130:131]
    v_pk_fma_f32 v[130:131], v[96:97], v[106:107], v[130:131]
    v_pk_mul_f32 v[130:131], v[130:131], v[114:115]
    s_waitcnt vmcnt(17)
    v_lshlrev_b32 v98, 16, v71
    v_and_b32 v99, s60, v71
    v_pk_mul_f32 v[132:133], v[92:93], v[112:113]
    s_waitcnt vmcnt(16)
    v_lshlrev_b32 v114, 16, v80
    v_pk_fma_f32 v[132:133], v[94:95], v[110:111], v[132:133]
    v_and_b32 v115, s60, v80
    v_pk_fma_f32 v[132:133], v[96:97], v[108:109], v[132:133]
    v_pk_fma_f32 v[132:133], v[98:99], v[106:107], v[132:133]
    v_pk_mul_f32 v[132:133], v[132:133], v[114:115]
    s_waitcnt vmcnt(15)
    v_lshlrev_b32 v100, 16, v72
    v_and_b32 v101, s60, v72
    v_pk_mul_f32 v[134:135], v[94:95], v[112:113]
    s_waitcnt vmcnt(14)
    v_lshlrev_b32 v114, 16, v81
    v_pk_fma_f32 v[134:135], v[96:97], v[110:111], v[134:135]
    v_and_b32 v115, s60, v81
    v_pk_fma_f32 v[134:135], v[98:99], v[108:109], v[134:135]
    v_pk_fma_f32 v[134:135], v[100:101], v[106:107], v[134:135]
    v_pk_mul_f32 v[134:135], v[134:135], v[114:115]
    s_waitcnt vmcnt(13)
    v_lshlrev_b32 v102, 16, v73
    v_and_b32 v103, s60, v73
    v_pk_mul_f32 v[136:137], v[96:97], v[112:113]
    s_waitcnt vmcnt(12)
    v_lshlrev_b32 v114, 16, v82
    v_pk_fma_f32 v[136:137], v[98:99], v[110:111], v[136:137]
    v_and_b32 v115, s60, v82
    v_pk_fma_f32 v[136:137], v[100:101], v[108:109], v[136:137]
    v_pk_fma_f32 v[136:137], v[102:103], v[106:107], v[136:137]
    v_pk_mul_f32 v[136:137], v[136:137], v[114:115]
    s_waitcnt vmcnt(11)
    v_lshlrev_b32 v104, 16, v74
    v_and_b32 v105, s60, v74
    v_pk_mul_f32 v[138:139], v[98:99], v[112:113]
    s_waitcnt vmcnt(10)
    v_lshlrev_b32 v114, 16, v83
    v_pk_fma_f32 v[138:139], v[100:101], v[110:111], v[138:139]
    v_and_b32 v115, s60, v83
    v_pk_fma_f32 v[138:139], v[102:103], v[108:109], v[138:139]
    v_pk_fma_f32 v[138:139], v[104:105], v[106:107], v[138:139]
    v_pk_mul_f32 v[138:139], v[138:139], v[114:115]
    v_cvt_pk_bf16_f32 v140, v138, v136
    v_cvt_pk_bf16_f32 v141, v134, v132
    v_cvt_pk_bf16_f32 v142, v130, v128
    v_cvt_pk_bf16_f32 v143, v126, v124
    ds_write_b128 v116, v[140:143] offset:0
    v_cvt_pk_bf16_f32 v144, v139, v137
    v_cvt_pk_bf16_f32 v145, v135, v133
    v_cvt_pk_bf16_f32 v146, v131, v129
    v_cvt_pk_bf16_f32 v147, v127, v125
    ds_write_b128 v116, v[144:147] offset:128
    s_waitcnt lgkmcnt(0)
    s_barrier
    ds_read_b128 v[140:143], v117 offset:0
    ds_read_b128 v[144:147], v117 offset:128
    v_mov_b32 v11, v2
    v_mov_b32 v13, v2
    v_mov_b32 v15, v2
    v_mov_b32 v17, v2
    v_mov_b32 v19, v2
    v_mov_b32 v21, v2
    v_mov_b32 v23, v2
    v_mov_b32 v25, v2
    s_waitcnt lgkmcnt(1)
    v_mov_b32 v10, v140
    v_mov_b32 v12, v141
    v_mov_b32 v14, v142
    v_mov_b32 v16, v143
    buffer_store_dwordx4 v[10:13], v75, s[20:23], s79 offen offset:0
    buffer_store_dwordx4 v[14:17], v75, s[20:23], s79 offen offset:128
    s_waitcnt lgkmcnt(0)
    v_mov_b32 v18, v144
    v_mov_b32 v20, v145
    v_mov_b32 v22, v146
    v_mov_b32 v24, v147
    buffer_store_dwordx4 v[18:21], v75, s[20:23], s79 offen offset:256
    buffer_store_dwordx4 v[22:25], v75, s[20:23], s79 offen offset:384
    s_cmp_ge_u32 s52, 28
    s_cbranch_scc1 L_help
    buffer_load_dwordx4 v[76:79], v235, s[20:23], s97 offen offset:0 sc1
    buffer_load_dwordx4 v[80:83], v235, s[20:23], s97 offen offset:128 sc1
    buffer_load_dwordx4 v[84:87], v235, s[20:23], s97 offen offset:256 sc1
    buffer_load_dwordx4 v[88:91], v235, s[20:23], s97 offen offset:384 sc1
    v_mov_b32 v92, 0
    v_mov_b32 v93, 0
    v_mov_b32 v94, 0
    v_mov_b32 v95, 0
    v_and_b32 v49, 7, v44
    v_mul_u32_u24 v49, 4160, v49
    v_add_u32 v49, 98304, v49
    v_and_b32 v65, 31, v44
    v_min_u32 v65, 29, v65
    v_lshlrev_b32 v65, 4, v65
    v_lshrrev_b32 v64, 5, v44
    v_mul_u32_u24 v64, 4608, v64
    v_add3_u32 v64, v64, v65, s83
    ds_write_b128 v49, v[92:95]
    ds_write_b128 v64, v[92:95]
    v_and_b32 v65, 3, v44
    v_lshlrev_b32 v65, 4, v65
    v_sub_u32 v65, 48, v65
    s_waitcnt vmcnt(17)
    v_lshlrev_b64 v[94:95], v65, v[50:51]
    v_lshlrev_b64 v[94:95], 16, v[94:95]
    ds_write_b128 v49, v[92:95] offset:16
    s_and_b32 s85, s53, 1
    s_lshr_b32 s56, s53, 1
    v_not_b32 v64, v44
    v_bfe_u32 v49, v64, 3, 1
    v_lshrrev_b32 v65, 4, v44
    v_lshl_add_u32 v65, s85, 2, v65
    v_cmp_eq_u32 vcc, v49, v65
    v_bfe_u32 v49, v64, 1, 2
    v_and_b32 v64, 1, v64
    v_lshlrev_b32 v64, 4, v64
    v_cndmask_b32 v49, 7, v49, vcc
    s_waitcnt vmcnt(16)
    v_lshlrev_b32 v45, v64, v45
    v_cmp_eq_u32 vcc, 0, v49
    s_nop 1
    v_cndmask_b32 v68, 0, v45, vcc
    v_cmp_eq_u32 vcc, 1, v49
    s_nop 1
    v_cndmask_b32 v69, 0, v45, vcc
    v_cmp_eq_u32 vcc, 2, v49
    s_nop 1
    v_cndmask_b32 v70, 0, v45, vcc
    v_cmp_eq_u32 vcc, 3, v49
    s_nop 1
    v_cndmask_b32 v71, 0, v45, vcc
    v_and_b32 v49, 15, v44
    v_add_u32 v64, 1, v49
    v_and_b32 v65, 3, v64
    v_mul_u32_u24 v67, 4160, v65
    v_lshrrev_b32 v64, 2, v64
    v_lshl_add_u32 v67, v64, 3, v67
    v_lshrrev_b32 v65, 4, v44
    v_lshl_add_u32 v67, v65, 4, v67
    s_mul_i32 s57, s56, 16640
    s_lshl_b32 s82, s85, 8
    s_add_u32 s57, s57, s82
    s_add_u32 s57, s57, 98304
    v_add_u32 v67, s57, v67
    v_lshlrev_b32 v49, 5, v49
    v_lshlrev_b32 v65, 4, v65
    v_sub_u32 v72, v65, v49
    s_mul_i32 s57, s56, 4608
    s_add_u32 s57, s57, s82
    s_add_u32 s57, s57, 148448
    v_add_u32 v72, s57, v72
    s_mov_b64 exec, 0
    s_cmp_eq_u32 s53, 1
    s_cbranch_scc1 L_i1007
    s_cmp_eq_u32 s53, 2
    s_cbranch_scc1 L_i1165
    s_cmp_eq_u32 s53, 3
    s_cbranch_scc1 L_i1505
    s_branch L_i556
L_backM:
    s_cmp_eq_u32 s3, 7
    s_cbranch_scc1 L_backX
    s_mov_b64 exec, -1
    s_waitcnt vmcnt(0)
    v_bitop3_b32 v47, v77, v79, s59 bitop3:0x7e
    v_bitop3_b32 v48, v81, v83, s59 bitop3:0x7e
    v_bitop3_b32 v47, v85, v47, s59 bitop3:0xde
    v_bitop3_b32 v48, v87, v48, s59 bitop3:0xde
    v_bitop3_b32 v47, v89, v47, s59 bitop3:0xde
    v_bitop3_b32 v48, v91, v48, s59 bitop3:0xde
    v_or_b32 v47, v47, v48
    v_cmp_ne_u32 vcc, 0, v47
    s_cbranch_vccnz Lrt_14
Lck_13:
    v_mov_b32 v77, v78
    v_mov_b32 v78, v80
    v_mov_b32 v79, v82
    ds_write_b128 v230, v[76:79] offset:0
    v_mov_b32 v85, v86
    v_mov_b32 v86, v88
    v_mov_b32 v87, v90
    ds_write_b128 v230, v[84:87] offset:4608
    buffer_store_dword v231, v228, s[20:23], 0 offen offset:0
    buffer_store_dword v231, v228, s[20:23], 0 offen offset:1024
    buffer_load_dword v37, v229, s[20:23], s90 offen sc1
    buffer_load_dwordx4 v[26:29], v224, s[24:27], s94 offen offset:0
    buffer_load_dwordx4 v[30:33], v224, s[24:27], s94 offen offset:896
    buffer_load_ushort v34, v225, s[36:39], 0 offen
    buffer_load_ushort v35, v226, s[40:43], 0 offen
    buffer_load_dword v36, v227, s[20:23], 0 offen
    s_add_u32 m0, s62, 0
    s_add_u32 s63, s73, 0
    buffer_load_dwordx4 v40, s[28:31], s63 offen offset:0 lds
    buffer_load_dwordx4 v41, s[28:31], s63 offen offset:1024 lds
    s_add_u32 m0, s62, 2048
    s_add_u32 s63, s73, 57344
    buffer_load_dwordx4 v40, s[28:31], s63 offen offset:0 lds
    buffer_load_dwordx4 v41, s[28:31], s63 offen offset:1024 lds
    s_waitcnt lgkmcnt(0)
    s_barrier
    ds_read_b128 a[32:35], v72 offset:3584
    ds_read_b128 a[36:39], v72 offset:3072
    ds_read_b128 a[40:43], v72 offset:2560
    ds_read_b128 a[44:47], v72 offset:2048
    ds_read_b64 a[0:1], v67 offset:0
    ds_read_b64 a[2:3], v67 offset:8
    ds_read_b64 a[4:5], v67 offset:512
    ds_read_b64 a[6:7], v67 offset:520
    ds_read_b64 a[8:9], v67 offset:1024
    ds_read_b64 a[10:11], v67 offset:1032
    ds_read_b64 a[12:13], v67 offset:1536
    ds_read_b64 a[14:15], v67 offset:1544
    s_cmp_eq_u32 s85, 1
    s_cbranch_scc1 Lh_17
    s_waitcnt lgkmcnt(10)
    v_mfma_f32_16x16x32_bf16 v[128:131], v[68:71], a[36:39], 0
    s_add_u32 m0, s62, 4096
    s_add_u32 s63, s73, 114688
    ds_read_b128 a[96:99], v72 offset:3648
    s_waitcnt lgkmcnt(10)
    v_mfma_f32_16x16x32_bf16 v[132:135], v[68:71], a[40:43], 0
    s_mov_b32 s0, 0x06543210
    ds_read_b64 a[64:65], v67 offset:64
    buffer_load_dwordx4 v40, s[28:31], s63 offen offset:0 lds
    s_waitcnt lgkmcnt(8)
    v_mfma_f32_16x16x32_bf16 v[128:131], a[0:3], a[36:39], v[128:131]
    s_mov_b32 s1, 0x10654321
    ds_read_b64 a[66:67], v67 offset:72
    buffer_load_dwordx4 v41, s[28:31], s63 offen offset:1024 lds
    v_mfma_f32_16x16x32_bf16 v[132:135], a[0:3], a[40:43], v[132:135]
    s_lshl2_add_u32 s66, s54, 4
    ds_read_b128 a[100:103], v72 offset:3136
    s_lshr_b64 s[0:1], s[0:1], s66
    s_waitcnt lgkmcnt(8)
    v_mfma_f32_16x16x32_bf16 v[128:131], a[4:7], a[32:35], v[128:131]
    s_and_b32 s0, s0, 0xffffff
    ds_read_b64 a[68:69], v67 offset:576
    v_mfma_f32_16x16x32_bf16 v[132:135], a[4:7], a[36:39], v[132:135]
    ds_read_b64 a[70:71], v67 offset:584
    s_waitcnt lgkmcnt(8)
    v_mfma_f32_16x16x32_bf16 v[132:135], a[8:11], a[32:35], v[132:135]
    s_lshr_b32 s1, s0, 8
    ds_read_b128 a[104:107], v72 offset:2624
    v_mfma_f32_16x16x32_bf16 v[124:127], v[68:71], a[32:35], 0
    s_lshl_b32 s66, s0, 24
    ds_read_b64 a[72:73], v67 offset:1088
    s_waitcnt lgkmcnt(4)
    v_mfma_f32_16x16x32_bf16 v[128:131], a[64:67], a[100:103], v[128:131]
    s_or_b32 s0, s0, s66
    ds_read_b64 a[74:75], v67 offset:1096
    v_mfma_f32_16x16x32_bf16 v[136:139], v[68:71], a[44:47], 0
    s_lshl_b32 s68, s68, 2
    ds_read_b128 a[108:111], v72 offset:2112
    s_waitcnt lgkmcnt(4)
    v_mfma_f32_16x16x32_bf16 v[128:131], a[68:71], a[96:99], v[128:131]
    s_lshr_b64 s[0:1], s[0:1], s68
    ds_read_b64 a[76:77], v67 offset:1600
    v_mfma_f32_16x16x32_bf16 v[132:135], a[68:71], a[100:103], v[132:135]
    ds_read_b64 a[78:79], v67 offset:1608
L_i556:
    s_cbranch_execz L_i1786
    s_waitcnt lgkmcnt(5)
    v_mfma_f32_16x16x32_bf16 v[132:135], a[64:67], a[104:107], v[132:135]
    s_lshl_b32 s57, s53, 10
    s_add_u32 s57, s57, 131584
    ds_read_b128 a[160:163], v72 offset:3712
    s_waitcnt lgkmcnt(4)
    v_mfma_f32_16x16x32_bf16 v[132:135], a[72:75], a[96:99], v[132:135]
    s_bfe_u32 s74, s0, 0x40004
    ds_read_b64 a[128:129], v67 offset:128
    v_add_u32 v45, s57, v1
    v_mfma_f32_16x16x32_bf16 v[124:127], a[0:3], a[32:35], v[124:127]
    s_add_u32 m0, s62, 6144
    s_add_u32 s63, s73, 172032
    ds_read_b64 a[130:131], v67 offset:136
    v_mfma_f32_16x16x32_bf16 v[136:139], a[0:3], a[44:47], v[136:139]
    s_lshl_b32 s67, s74, 14
    ds_read_b128 a[164:167], v72 offset:3200
    buffer_load_dwordx4 v40, s[28:31], s63 offen offset:0 lds
    v_mfma_f32_16x16x32_bf16 v[136:139], a[4:7], a[40:43], v[136:139]
    s_mul_i32 s74, s74, 229376
    ds_read_b64 a[132:133], v67 offset:640
    buffer_load_dwordx4 v41, s[28:31], s63 offen offset:1024 lds
    v_mfma_f32_16x16x32_bf16 v[136:139], a[8:11], a[36:39], v[136:139]
    s_add_u32 s74, s74, s61
    ds_read_b64 a[134:135], v67 offset:648
    v_bfe_u32 v47, v44, 2, 2
    v_mfma_f32_16x16x32_bf16 v[136:139], a[12:15], a[32:35], v[136:139]
    s_mul_i32 s72, s54, 229376
    ds_read_b128 a[168:171], v72 offset:2688
    v_lshrrev_b32 v48, 4, v44
    v_mfma_f32_16x16x32_bf16 v[124:127], a[64:67], a[96:99], v[124:127]
    s_add_u32 s72, s72, s61
    ds_read_b64 a[136:137], v67 offset:1152
    v_mul_u32_u24 v46, 114688, v47
    s_waitcnt lgkmcnt(4)
    v_mfma_f32_16x16x32_bf16 v[128:131], a[128:131], a[164:167], v[128:131]
    s_mul_i32 s87, s53, 15360
    ds_read_b64 a[138:139], v67 offset:1160
    v_lshl_add_u32 v46, v48, 12, v46
    v_mfma_f32_16x16x32_bf16 v[136:139], a[68:71], a[104:107], v[136:139]
    s_add_u32 s87, s87, 98304
    ds_read_b128 a[172:175], v72 offset:2176
    v_and_b32 v48, 3, v44
    s_waitcnt lgkmcnt(4)
    v_mfma_f32_16x16x32_bf16 v[128:131], a[132:135], a[160:163], v[128:131]
    s_xor_b32 s57, s57, 1024
    ds_read_b64 a[140:141], v67 offset:1664
    v_lshl_add_u32 v46, v48, 4, v46
    v_mfma_f32_16x16x32_bf16 v[132:135], a[132:135], a[164:167], v[132:135]
    s_mov_b32 s93, 160768
    ds_read_b64 a[142:143], v67 offset:1672
    v_add_u32 v47, s57, v1
    s_waitcnt lgkmcnt(5)
    v_mfma_f32_16x16x32_bf16 v[132:135], a[128:131], a[168:171], v[132:135]
    s_and_b32 s56, s52, 3
    s_lshr_b32 s57, s53, 1
    ds_read_b128 a[224:227], v72 offset:3776
    s_waitcnt lgkmcnt(4)
    v_mfma_f32_16x16x32_bf16 v[132:135], a[136:139], a[160:163], v[132:135]
    s_lshl1_add_u32 s56, s56, s57
    s_lshr_b32 s57, s52, 2
    ds_read_b64 a[192:193], v67 offset:192
    v_mfma_f32_16x16x32_bf16 v[136:139], a[72:75], a[100:103], v[136:139]
    s_lshl3_add_u32 s56, s56, s57
    s_lshl_b32 s56, s56, 6
    ds_read_b64 a[194:195], v67 offset:200
    v_mfma_f32_16x16x32_bf16 v[136:139], a[64:67], a[108:111], v[136:139]
    s_lshl_b32 s57, s3, 14
    s_add_u32 s56, s56, s57
    ds_read_b128 a[228:231], v72 offset:3264
    v_mfma_f32_16x16x32_bf16 v[136:139], a[76:79], a[96:99], v[136:139]
    s_add_u32 s82, s56, 4718592
    s_add_u32 m0, s62, 8192
    ds_read_b64 a[196:197], v67 offset:704
    v_mfma_f32_16x16x32_bf16 v[124:127], a[128:131], a[160:163], v[124:127]
    s_add_u32 s63, s74, 0
    ds_read_b64 a[198:199], v67 offset:712
    buffer_load_dwordx4 v40, s[28:31], s63 offen offset:0 lds
    v_mfma_f32_16x16x32_bf16 v[136:139], a[132:135], a[168:171], v[136:139]
    s_lshl_b32 s1, s54, 14
    ds_read_b128 a[232:235], v72 offset:2752
    buffer_load_dwordx4 v41, s[28:31], s63 offen offset:1024 lds
    v_mfma_f32_16x16x32_bf16 v[136:139], a[136:139], a[164:167], v[136:139]
    s_sub_u32 s1, s65, s1
    ds_read_b64 a[200:201], v67 offset:1216
    v_mov_b32 v77, v2
    s_waitcnt lgkmcnt(4)
    v_mfma_f32_16x16x32_bf16 v[128:131], a[192:195], a[228:231], v[128:131]
    s_add_u32 s67, s67, s1
    ds_read_b64 a[202:203], v67 offset:1224
    v_mov_b32 v79, v2
    v_mfma_f32_16x16x32_bf16 v[136:139], a[128:131], a[172:175], v[136:139]
    s_bfe_u32 s66, s0, 0x40000
    ds_read_b128 a[236:239], v72 offset:2240
    v_mov_b32 v81, v2
    s_waitcnt lgkmcnt(4)
    v_mfma_f32_16x16x32_bf16 v[128:131], a[196:199], a[224:227], v[128:131]
    s_lshl_b32 s66, s66, 14
    ds_read_b64 a[204:205], v67 offset:1728
    v_mov_b32 v83, v2
    v_mfma_f32_16x16x32_bf16 v[132:135], a[196:199], a[228:231], v[132:135]
    s_add_u32 s66, s66, s1
    ds_read_b64 a[206:207], v67 offset:1736
    v_mov_b32 v85, v2
    s_waitcnt lgkmcnt(5)
    v_mfma_f32_16x16x32_bf16 v[132:135], a[192:195], a[232:235], v[132:135]
    s_bfe_u32 s75, s0, 0x40008
    v_mov_b32 v87, v2
    v_mov_b32 v89, v2
    s_waitcnt lgkmcnt(3)
    v_mfma_f32_16x16x32_bf16 v[132:135], a[200:203], a[224:227], v[132:135]
    s_lshl_b32 s68, s75, 14
    v_mov_b32 v91, v2
    s_mul_i32 s75, s75, 229376
    v_mfma_f32_16x16x32_bf16 v[136:139], a[140:143], a[160:163], v[136:139]
    s_add_u32 s68, s68, s1
    ds_read_b128 a[48:51], v72 offset:1536
    ds_write_b128 v45, v[128:131] offset:0
    v_mfma_f32_16x16x32_bf16 v[124:127], a[192:195], a[224:227], v[124:127]
    s_add_u32 s75, s75, s61
    ds_read_b64 a[16:17], v67 offset:2048
    ds_write_b128 v45, v[132:135] offset:4096
    v_mfma_f32_16x16x32_bf16 v[136:139], a[196:199], a[232:235], v[136:139]
    s_bfe_u32 s76, s0, 0x4000c
    ds_read_b64 a[18:19], v67 offset:2056
    s_lshl_b32 s69, s76, 14
    v_mfma_f32_16x16x32_bf16 v[136:139], a[200:203], a[228:231], v[136:139]
    s_mul_i32 s76, s76, 229376
    ds_read_b128 a[52:55], v72 offset:1024
    s_add_u32 s69, s69, s1
    s_waitcnt lgkmcnt(8)
    v_mfma_f32_16x16x32_bf16 v[136:139], a[192:195], a[236:239], v[136:139]
    s_add_u32 s76, s76, s61
    s_bfe_u32 s77, s0, 0x40010
    s_waitcnt lgkmcnt(6)
    v_mfma_f32_16x16x32_bf16 v[136:139], a[204:207], a[224:227], v[136:139]
    s_lshl_b32 s70, s77, 14
    ds_read_b64 a[20:21], v67 offset:2560
    v_mfma_f32_16x16x32_bf16 v[144:147], a[8:11], a[44:47], 0
    s_mul_i32 s77, s77, 229376
    ds_read_b64 a[22:23], v67 offset:2568
    v_mfma_f32_16x16x32_bf16 v[144:147], a[12:15], a[40:43], v[144:147]
    s_add_u32 s70, s70, s1
    ds_read_b128 a[112:115], v72 offset:1600
    v_mfma_f32_16x16x32_bf16 v[144:147], a[72:75], a[108:111], v[144:147]
    s_waitcnt lgkmcnt(5)
    s_barrier
    ds_read_b128 v[92:95], v47 offset:0
    ds_read_b128 v[96:99], v47 offset:4096
    v_mfma_f32_16x16x32_bf16 v[144:147], a[76:79], a[104:107], v[144:147]
    s_add_u32 s57, s82, 0
    ds_read_b64 a[80:81], v67 offset:2112
    s_add_u32 s77, s77, s61
    v_mfma_f32_16x16x32_bf16 v[144:147], a[136:139], a[172:175], v[144:147]
    s_bfe_u32 s78, s0, 0x40014
    ds_read_b64 a[82:83], v67 offset:2120
    v_mfma_f32_16x16x32_bf16 v[144:147], a[140:143], a[168:171], v[144:147]
    s_lshl_b32 s71, s78, 14
    ds_read_b128 a[116:119], v72 offset:1088
    v_mfma_f32_16x16x32_bf16 v[144:147], a[200:203], a[236:239], v[144:147]
    s_mul_i32 s78, s78, 229376
    ds_read_b64 a[84:85], v67 offset:2624
    v_bfe_u32 v232, v44, 2, 2
    v_mfma_f32_16x16x32_bf16 v[144:147], a[204:207], a[232:235], v[144:147]
    s_add_u32 s71, s71, s1
    ds_read_b64 a[86:87], v67 offset:2632
    v_mfma_f32_16x16x32_bf16 v[144:147], a[4:7], a[48:51], v[144:147]
    s_waitcnt lgkmcnt(6)
    s_add_u32 m0, s62, 10240
    s_add_u32 s63, s74, 57344
    v_mfma_f32_16x16x32_bf16 v[144:147], a[16:19], a[36:39], v[144:147]
    s_add_u32 s78, s78, s61
    ds_read_b128 a[176:179], v72 offset:1664
    buffer_load_dwordx4 v40, s[28:31], s63 offen offset:0 lds
    v_mfma_f32_16x16x32_bf16 v[144:147], v[68:71], a[52:55], v[144:147]
    s_mul_i32 s0, s53, 57344
    ds_read_b64 a[144:145], v67 offset:2176
    buffer_load_dwordx4 v41, s[28:31], s63 offen offset:1024 lds
    v_mfma_f32_16x16x32_bf16 v[144:147], a[0:3], a[52:55], v[144:147]
    s_sub_u32 s61, s0, s61
    ds_read_b64 a[146:147], v67 offset:2184
    v_add_f32 v124, v124, v92
    v_mfma_f32_16x16x32_bf16 v[144:147], a[20:23], a[32:35], v[144:147]
    s_lshl_b32 s99, s54, 7
    ds_read_b128 a[180:183], v72 offset:1152
    v_add_f32 v125, v125, v93
    v_mfma_f32_16x16x32_bf16 v[144:147], a[68:71], a[112:115], v[144:147]
    s_add_u32 s61, s61, s99
    v_add_f32 v126, v126, v94
    v_add_f32 v127, v127, v95
    s_waitcnt lgkmcnt(7)
    v_mfma_f32_16x16x32_bf16 v[144:147], a[80:83], a[100:103], v[144:147]
    s_lshl2_add_u32 s0, s55, s53
    ds_read_b64 a[148:149], v67 offset:2688
    v_cvt_pk_bf16_f32 v76, v124, v125
    s_waitcnt lgkmcnt(7)
    v_mfma_f32_16x16x32_bf16 v[144:147], a[64:67], a[116:119], v[144:147]
    ds_read_b64 a[150:151], v67 offset:2696
    v_cvt_pk_bf16_f32 v78, v126, v127
    s_waitcnt lgkmcnt(6)
    v_mfma_f32_16x16x32_bf16 v[144:147], a[84:87], a[96:99], v[144:147]
    s_mul_i32 s1, s0, 4608
    ds_read_b128 a[240:243], v72 offset:1728
    buffer_store_dwordx4 v[76:79], v46, s[20:23], s57 offen sc1
    s_waitcnt lgkmcnt(6)
    v_mfma_f32_16x16x32_bf16 v[144:147], a[132:135], a[176:179], v[144:147]
    s_add_u32 s57, s82, 1572864
    ds_read_b64 a[208:209], v67 offset:2240
    s_waitcnt lgkmcnt(5)
    v_mfma_f32_16x16x32_bf16 v[144:147], a[144:147], a[164:167], v[144:147]
    s_add_u32 s98, s1, 8912896
    v_add_f32 v136, v136, v96
    v_add_f32 v137, v137, v97
    s_waitcnt lgkmcnt(4)
    v_mfma_f32_16x16x32_bf16 v[144:147], a[128:131], a[180:183], v[144:147]
    s_lshr_b32 s0, s54, 2
    ds_read_b64 a[210:211], v67 offset:2248
    v_add_f32 v138, v138, v98
    s_waitcnt lgkmcnt(3)
    v_mfma_f32_16x16x32_bf16 v[144:147], a[148:151], a[160:163], v[144:147]
    s_lshl_b32 s0, s0, 9
    ds_read_b128 a[244:247], v72 offset:1216
    v_add_f32 v139, v139, v99
    s_waitcnt lgkmcnt(3)
    v_mfma_f32_16x16x32_bf16 v[144:147], a[196:199], a[240:243], v[144:147]
    s_add_u32 s0, s0, s98
    ds_read_b64 a[212:213], v67 offset:2752
    v_cvt_pk_bf16_f32 v80, v136, v137
    v_mfma_f32_16x16x32_bf16 v[140:143], a[4:7], a[44:47], 0
    s_add_u32 s99, s99, s0
    ds_read_b64 a[214:215], v67 offset:2760
    v_cvt_pk_bf16_f32 v82, v138, v139
    v_mfma_f32_16x16x32_bf16 v[140:143], a[8:11], a[40:43], v[140:143]
    s_add_u32 s0, s54, 2
    buffer_store_dwordx4 v[80:83], v46, s[20:23], s57 offen sc1
    v_lshlrev_b32 v232, 7, v232
    s_waitcnt lgkmcnt(3)
    v_mfma_f32_16x16x32_bf16 v[144:147], a[208:211], a[228:231], v[144:147]
    s_and_b32 s0, s0, 8
    v_bfe_u32 v233, v44, 3, 1
    v_lshl_add_u32 v232, v233, 6, v232
    s_waitcnt lgkmcnt(2)
    v_mfma_f32_16x16x32_bf16 v[144:147], a[192:195], a[244:247], v[144:147]
    s_lshl4_add_u32 s86, s0, 0x270
    v_add_u32 v232, s62, v232
    v_lshrrev_b32 v233, 5, v44
    v_mfma_f32_16x16x32_bf16 v[140:143], a[12:15], a[36:39], v[140:143]
    s_add_u32 s88, s1, 8916992
    v_bfe_u32 v234, v44, 4, 1
    v_lshl_add_u32 v42, v233, 10, v232
    s_waitcnt lgkmcnt(0)
    v_mfma_f32_16x16x32_bf16 v[144:147], a[212:215], a[224:227], v[144:147]
    v_lshl_add_u32 v8, v233, 9, v232
    v_lshl_add_u32 v42, v234, 5, v42
    v_mfma_f32_16x16x32_bf16 v[140:143], a[72:75], a[104:107], v[140:143]
    s_lshl2_add_u32 s89, s54, s88
    ds_read_b128 a[56:59], v72 offset:512
    v_lshl_add_u32 v8, v234, 4, v8
    v_mfma_f32_16x16x32_bf16 v[140:143], a[68:71], a[108:111], v[140:143]
    s_xor_b32 s83, s59, 2147483648
    ds_read_b64 a[24:25], v67 offset:3072
    ds_write_b128 v45, v[144:147] offset:12288
    v_mfma_f32_16x16x32_bf16 v[140:143], a[76:79], a[100:103], v[140:143]
    s_mov_b32 s91, 0x409d30fc
    ds_read_b64 a[26:27], v67 offset:3080
    v_xor_b32 v4, v233, v234
    v_mfma_f32_16x16x32_bf16 v[140:143], a[136:139], a[168:171], v[140:143]
    s_mov_b32 s80, 0xc0088e99
    v_lshlrev_b32 v6, 8, v233
    v_mfma_f32_16x16x32_bf16 v[140:143], a[132:135], a[172:175], v[140:143]
    s_waitcnt lgkmcnt(1)
    s_barrier
    ds_read_b128 v[92:95], v47 offset:12288
    v_mfma_f32_16x16x32_bf16 v[140:143], a[140:143], a[164:167], v[140:143]
    s_add_u32 s57, s82, 2097152
    ds_read_b128 a[60:63], v72 offset:0
    ds_read_b64 a[28:29], v67 offset:3584
    v_mfma_f32_16x16x32_bf16 v[140:143], a[200:203], a[232:235], v[140:143]
    s_lshl_b32 s0, s53, 7
    s_add_u32 s95, s0, 161792
    v_bfe_u32 v233, v44, 1, 1
    v_mfma_f32_16x16x32_bf16 v[140:143], a[196:199], a[236:239], v[140:143]
    ds_read_b64 a[30:31], v67 offset:3592
    v_and_b32 v234, 1, v44
    v_mfma_f32_16x16x32_bf16 v[140:143], a[204:207], a[228:231], v[140:143]
    ds_read_b128 a[120:123], v72 offset:576
    v_lshl_add_u32 v42, v233, 4, v42
    v_mfma_f32_16x16x32_bf16 v[140:143], v[68:71], a[48:51], v[140:143]
    ds_read_b64 a[88:89], v67 offset:3136
    v_mfma_f32_16x16x32_bf16 v[140:143], a[0:3], a[48:51], v[140:143]
    v_lshl_add_u32 v8, v233, 3, v8
    v_mfma_f32_16x16x32_bf16 v[140:143], a[16:19], a[32:35], v[140:143]
    ds_read_b64 a[90:91], v67 offset:3144
    v_mfma_f32_16x16x32_bf16 v[140:143], a[64:67], a[112:115], v[140:143]
    ds_read_b128 a[124:127], v72 offset:64
    v_lshl_add_u32 v42, v234, 3, v42
    v_mfma_f32_16x16x32_bf16 v[140:143], a[80:83], a[96:99], v[140:143]
    v_mfma_f32_16x16x32_bf16 v[140:143], a[128:131], a[176:179], v[140:143]
    ds_read_b64 a[92:93], v67 offset:3648
    v_lshl_add_u32 v8, v234, 5, v8
    v_mfma_f32_16x16x32_bf16 v[140:143], a[144:147], a[160:163], v[140:143]
    ds_read_b64 a[94:95], v67 offset:3656
    v_mfma_f32_16x16x32_bf16 v[140:143], a[192:195], a[240:243], v[140:143]
    ds_read_b128 a[184:187], v72 offset:640
    v_xor_b32 v43, 64, v42
    v_mfma_f32_16x16x32_bf16 v[140:143], a[208:211], a[224:227], v[140:143]
    v_mfma_f32_16x16x32_bf16 v[148:151], a[12:15], a[44:47], 0
    s_and_b32 s64, s55, 3
    s_waitcnt vmcnt(14)
    v_and_b32 v36, 15, v44
    s_mul_i32 s64, s64, 57344
    v_mul_u32_u24 v36, 3584, v36
    s_add_u32 s64, s64, s72
    buffer_load_dword v36, v36, s[28:31], s64 offen
    v_mfma_f32_16x16x32_bf16 v[148:151], a[76:79], a[108:111], v[148:151]
    s_waitcnt lgkmcnt(10)
    ds_read_b64 a[152:153], v67 offset:3200
    ds_read_b64 a[154:155], v67 offset:3208
    v_mfma_f32_16x16x32_bf16 v[148:151], a[140:143], a[172:175], v[148:151]
    s_add_u32 m0, s62, 12288
    s_add_u32 s63, s74, 114688
    buffer_load_dwordx4 v40, s[28:31], s63 offen offset:0 lds
    v_mfma_f32_16x16x32_bf16 v[148:151], a[204:207], a[236:239], v[148:151]
    ds_read_b128 a[188:191], v72 offset:128
    buffer_load_dwordx4 v41, s[28:31], s63 offen offset:1024 lds
    v_mfma_f32_16x16x32_bf16 v[148:151], a[8:11], a[48:51], v[148:151]
    ds_read_b64 a[156:157], v67 offset:3712
    v_add_f32 v140, v140, v92
    v_mfma_f32_16x16x32_bf16 v[148:151], a[16:19], a[40:43], v[148:151]
    ds_read_b64 a[158:159], v67 offset:3720
    v_add_f32 v141, v141, v93
    v_mfma_f32_16x16x32_bf16 v[148:151], a[4:7], a[52:55], v[148:151]
    v_add_f32 v142, v142, v94
    v_add_f32 v143, v143, v95
    v_mfma_f32_16x16x32_bf16 v[148:151], a[20:23], a[36:39], v[148:151]
    ds_read_b128 a[248:251], v72 offset:704
    v_cvt_pk_bf16_f32 v84, v140, v141
    v_mfma_f32_16x16x32_bf16 v[148:151], a[72:75], a[112:115], v[148:151]
    ds_read_b64 a[216:217], v67 offset:3264
    v_cvt_pk_bf16_f32 v86, v142, v143
    v_mfma_f32_16x16x32_bf16 v[148:151], a[80:83], a[104:107], v[148:151]
    buffer_store_dwordx4 v[84:87], v46, s[20:23], s57 offen sc1
    v_xor_b32 v9, 64, v8
    v_mfma_f32_16x16x32_bf16 v[148:151], a[68:71], a[116:119], v[148:151]
    ds_read_b64 a[218:219], v67 offset:3272
    v_bfe_u32 v232, v44, 3, 2
    v_mfma_f32_16x16x32_bf16 v[148:151], a[84:87], a[100:103], v[148:151]
    ds_read_b128 a[252:255], v72 offset:192
    v_and_b32 v234, 7, v44
    v_mfma_f32_16x16x32_bf16 v[148:151], a[136:139], a[176:179], v[148:151]
    ds_read_b64 a[220:221], v67 offset:3776
    v_mul_u32_u24 v232, 15360, v232
    v_mfma_f32_16x16x32_bf16 v[148:151], a[144:147], a[168:171], v[148:151]
    v_lshl_add_u32 v233, v234, 4, v232
    v_add_u32 v233, 98304, v233
    v_mfma_f32_16x16x32_bf16 v[148:151], a[132:135], a[180:183], v[148:151]
    ds_read_b64 a[222:223], v67 offset:3784
    v_lshl_add_u32 v6, s53, 10, v6
    v_mfma_f32_16x16x32_bf16 v[148:151], a[148:151], a[164:167], v[148:151]
    v_lshl_add_u32 v4, v4, 7, v233
    v_mfma_f32_16x16x32_bf16 v[148:151], a[200:203], a[240:243], v[148:151]
    v_add_u32 v6, v6, v233
    v_mfma_f32_16x16x32_bf16 v[148:151], a[208:211], a[232:235], v[148:151]
    v_mfma_f32_16x16x32_bf16 v[148:151], a[196:199], a[244:247], v[148:151]
    v_add_u32 v52, s87, v1
    v_mfma_f32_16x16x32_bf16 v[148:151], a[212:215], a[228:231], v[148:151]
    v_mfma_f32_16x16x32_bf16 v[148:151], v[68:71], a[56:59], v[148:151]
    v_lshl_add_u32 v55, v44, 2, s93
    v_mfma_f32_16x16x32_bf16 v[148:151], a[0:3], a[56:59], v[148:151]
    v_mfma_f32_16x16x32_bf16 v[148:151], a[24:27], a[32:35], v[148:151]
    v_lshrrev_b32 v233, 3, v44
    s_waitcnt lgkmcnt(15)
    v_mfma_f32_16x16x32_bf16 v[148:151], a[64:67], a[120:123], v[148:151]
    v_mfma_f32_16x16x32_bf16 v[148:151], a[88:91], a[96:99], v[148:151]
    v_lshlrev_b32 v232, 7, v234
    s_waitcnt lgkmcnt(11)
    v_mfma_f32_16x16x32_bf16 v[148:151], a[128:131], a[184:187], v[148:151]
    s_waitcnt lgkmcnt(9)
    v_mfma_f32_16x16x32_bf16 v[148:151], a[152:155], a[160:163], v[148:151]
    v_lshl_add_u32 v232, v233, 4, v232
    s_waitcnt lgkmcnt(5)
    v_mfma_f32_16x16x32_bf16 v[148:151], a[192:195], a[248:251], v[148:151]
    s_waitcnt lgkmcnt(3)
    v_mfma_f32_16x16x32_bf16 v[148:151], a[216:219], a[224:227], v[148:151]
    v_add_u32 v60, s87, v232
    v_mfma_f32_16x16x32_bf16 v[152:155], a[12:15], a[48:51], 0
    v_mfma_f32_16x16x32_bf16 v[152:155], a[16:19], a[44:47], v[152:155]
    s_nop 4
    ds_write_b128 v45, v[148:151] offset:8192
    v_lshrrev_b32 v232, 2, v44
    v_mfma_f32_16x16x32_bf16 v[152:155], a[8:11], a[52:55], v[152:155]
    v_mfma_f32_16x16x32_bf16 v[152:155], a[20:23], a[40:43], v[152:155]
    v_lshrrev_b32 v233, 4, v44
    v_mfma_f32_16x16x32_bf16 v[152:155], a[76:79], a[112:115], v[152:155]
    v_mfma_f32_16x16x32_bf16 v[152:155], a[80:83], a[108:111], v[152:155]
    v_xor_b32 v232, v232, v233
    v_mfma_f32_16x16x32_bf16 v[152:155], a[72:75], a[116:119], v[152:155]
    v_mfma_f32_16x16x32_bf16 v[152:155], a[84:87], a[104:107], v[152:155]
    v_and_b32 v232, 1, v232
    v_mfma_f32_16x16x32_bf16 v[152:155], a[140:143], a[176:179], v[152:155]
    s_waitcnt lgkmcnt(0)
    s_barrier
    ds_read_b128 v[92:95], v47 offset:8192
    v_mfma_f32_16x16x32_bf16 v[152:155], a[144:147], a[172:175], v[152:155]
    s_add_u32 s57, s82, 3670016
    v_and_or_b32 v232, v44, 3, v232
    v_mfma_f32_16x16x32_bf16 v[152:155], a[136:139], a[180:183], v[152:155]
    v_mfma_f32_16x16x32_bf16 v[152:155], a[148:151], a[168:171], v[152:155]
    v_add_u32 v232, -1, v232
    v_mfma_f32_16x16x32_bf16 v[152:155], a[204:207], a[240:243], v[152:155]
    v_mfma_f32_16x16x32_bf16 v[152:155], a[208:211], a[236:239], v[152:155]
    s_add_u32 m0, s62, 14336
    s_add_u32 s63, s74, 172032
    buffer_load_dwordx4 v40, s[28:31], s63 offen offset:0 lds
    v_mfma_f32_16x16x32_bf16 v[152:155], a[200:203], a[244:247], v[152:155]
    buffer_load_dwordx4 v41, s[28:31], s63 offen offset:1024 lds
    v_ashrrev_i32 v232, 31, v232
    v_mfma_f32_16x16x32_bf16 v[152:155], a[212:215], a[232:235], v[152:155]
    v_and_b32 v120, 0x3f803f80, v232
    v_mfma_f32_16x16x32_bf16 v[152:155], a[4:7], a[56:59], v[152:155]
    v_mfma_f32_16x16x32_bf16 v[152:155], a[24:27], a[36:39], v[152:155]
    v_mov_b32 v62, 0
    v_mfma_f32_16x16x32_bf16 v[152:155], v[68:71], a[60:63], v[152:155]
    v_mfma_f32_16x16x32_bf16 v[152:155], a[0:3], a[60:63], v[152:155]
    v_mov_b32 v63, 0
    v_mfma_f32_16x16x32_bf16 v[152:155], a[28:31], a[32:35], v[152:155]
    v_mfma_f32_16x16x32_bf16 v[152:155], a[68:71], a[120:123], v[152:155]
    v_mov_b32 v121, v120
    v_mfma_f32_16x16x32_bf16 v[152:155], a[88:91], a[100:103], v[152:155]
    v_mfma_f32_16x16x32_bf16 v[152:155], a[64:67], a[124:127], v[152:155]
    v_mov_b32 v122, v120
    v_mfma_f32_16x16x32_bf16 v[152:155], a[92:95], a[96:99], v[152:155]
    v_mfma_f32_16x16x32_bf16 v[152:155], a[132:135], a[184:187], v[152:155]
    v_mov_b32 v123, v120
    v_mfma_f32_16x16x32_bf16 v[152:155], a[152:155], a[164:167], v[152:155]
    v_mfma_f32_16x16x32_bf16 v[152:155], a[128:131], a[188:191], v[152:155]
    v_mfma_f32_16x16x32_bf16 v[152:155], a[156:159], a[160:163], v[152:155]
    v_mfma_f32_16x16x32_bf16 v[152:155], a[196:199], a[248:251], v[152:155]
    v_mfma_f32_16x16x32_bf16 v[152:155], a[216:219], a[228:231], v[152:155]
    v_mfma_f32_16x16x32_bf16 v[152:155], a[192:195], a[252:255], v[152:155]
    v_mfma_f32_16x16x32_bf16 v[152:155], a[220:223], a[224:227], v[152:155]
    s_waitcnt lgkmcnt(0)
    s_nop 6
    v_pk_add_f32 v[152:153], v[152:153], v[92:93]
    v_pk_add_f32 v[154:155], v[154:155], v[94:95]
    v_cvt_pk_bf16_f32 v88, v152, v153
    v_cvt_pk_bf16_f32 v90, v154, v155
    buffer_store_dwordx4 v[88:91], v46, s[20:23], s57 offen sc1
    s_branch Lh_18
Lh_17:
L_i1007:
    s_cbranch_execz L_i2389
    s_waitcnt lgkmcnt(11)
    v_mfma_f32_16x16x32_bf16 v[124:127], v[68:71], a[32:35], 0
    s_add_u32 m0, s62, 4096
    s_add_u32 s63, s73, 114688
    ds_read_b128 a[96:99], v72 offset:3648
    s_waitcnt lgkmcnt(9)
    v_mfma_f32_16x16x32_bf16 v[136:139], v[68:71], a[44:47], 0
    s_mov_b32 s0, 0x06543210
    ds_read_b64 a[64:65], v67 offset:64
    buffer_load_dwordx4 v40, s[28:31], s63 offen offset:0 lds
    s_waitcnt lgkmcnt(8)
    v_mfma_f32_16x16x32_bf16 v[124:127], a[0:3], a[32:35], v[124:127]
    s_mov_b32 s1, 0x10654321
    ds_read_b64 a[66:67], v67 offset:72
    buffer_load_dwordx4 v41, s[28:31], s63 offen offset:1024 lds
    v_mfma_f32_16x16x32_bf16 v[136:139], a[0:3], a[44:47], v[136:139]
    s_lshl2_add_u32 s66, s54, 4
    ds_read_b128 a[100:103], v72 offset:3136
    s_lshr_b64 s[0:1], s[0:1], s66
    s_waitcnt lgkmcnt(8)
    v_mfma_f32_16x16x32_bf16 v[136:139], a[4:7], a[40:43], v[136:139]
    s_and_b32 s0, s0, 0xffffff
    ds_read_b64 a[68:69], v67 offset:576
    s_waitcnt lgkmcnt(7)
    v_mfma_f32_16x16x32_bf16 v[136:139], a[8:11], a[36:39], v[136:139]
    ds_read_b64 a[70:71], v67 offset:584
    s_waitcnt lgkmcnt(6)
    v_mfma_f32_16x16x32_bf16 v[136:139], a[12:15], a[32:35], v[136:139]
    s_lshr_b32 s1, s0, 8
    ds_read_b128 a[104:107], v72 offset:2624
    s_waitcnt lgkmcnt(4)
    v_mfma_f32_16x16x32_bf16 v[124:127], a[64:67], a[96:99], v[124:127]
    s_lshl_b32 s66, s0, 24
    ds_read_b64 a[72:73], v67 offset:1088
    v_mfma_f32_16x16x32_bf16 v[128:131], v[68:71], a[36:39], 0
    s_or_b32 s0, s0, s66
    ds_read_b64 a[74:75], v67 offset:1096
    v_mfma_f32_16x16x32_bf16 v[132:135], v[68:71], a[40:43], 0
    s_lshl_b32 s68, s68, 2
    ds_read_b128 a[108:111], v72 offset:2112
    v_mfma_f32_16x16x32_bf16 v[128:131], a[0:3], a[36:39], v[128:131]
    s_lshr_b64 s[0:1], s[0:1], s68
    ds_read_b64 a[76:77], v67 offset:1600
    s_waitcnt lgkmcnt(4)
    v_mfma_f32_16x16x32_bf16 v[136:139], a[68:71], a[104:107], v[136:139]
    ds_read_b64 a[78:79], v67 offset:1608
    v_mfma_f32_16x16x32_bf16 v[132:135], a[0:3], a[40:43], v[132:135]
    s_lshl_b32 s57, s53, 10
    s_add_u32 s57, s57, 131584
    ds_read_b128 a[160:163], v72 offset:3712
    s_waitcnt lgkmcnt(4)
    v_mfma_f32_16x16x32_bf16 v[136:139], a[72:75], a[100:103], v[136:139]
    s_bfe_u32 s74, s0, 0x40004
    ds_read_b64 a[128:129], v67 offset:128
    v_add_u32 v45, s57, v1
    s_waitcnt lgkmcnt(4)
    v_mfma_f32_16x16x32_bf16 v[136:139], a[64:67], a[108:111], v[136:139]
    s_add_u32 m0, s62, 6144
    s_add_u32 s63, s73, 172032
    ds_read_b64 a[130:131], v67 offset:136
    v_mfma_f32_16x16x32_bf16 v[128:131], a[4:7], a[32:35], v[128:131]
    s_lshl_b32 s67, s74, 14
    ds_read_b128 a[164:167], v72 offset:3200
    buffer_load_dwordx4 v40, s[28:31], s63 offen offset:0 lds
    s_waitcnt lgkmcnt(4)
    v_mfma_f32_16x16x32_bf16 v[136:139], a[76:79], a[96:99], v[136:139]
    s_mul_i32 s74, s74, 229376
    ds_read_b64 a[132:133], v67 offset:640
    buffer_load_dwordx4 v41, s[28:31], s63 offen offset:1024 lds
    v_mfma_f32_16x16x32_bf16 v[132:135], a[4:7], a[36:39], v[132:135]
    s_add_u32 s74, s74, s61
    ds_read_b64 a[134:135], v67 offset:648
    v_bfe_u32 v47, v44, 2, 2
    v_mfma_f32_16x16x32_bf16 v[132:135], a[8:11], a[32:35], v[132:135]
    s_mul_i32 s72, s54, 229376
    ds_read_b128 a[168:171], v72 offset:2688
    v_lshrrev_b32 v48, 4, v44
    s_waitcnt lgkmcnt(4)
    v_mfma_f32_16x16x32_bf16 v[124:127], a[128:131], a[160:163], v[124:127]
    s_add_u32 s72, s72, s61
    ds_read_b64 a[136:137], v67 offset:1152
    v_mul_u32_u24 v46, 114688, v47
    v_mfma_f32_16x16x32_bf16 v[128:131], a[64:67], a[100:103], v[128:131]
    s_mul_i32 s87, s53, 15360
    ds_read_b64 a[138:139], v67 offset:1160
    v_lshl_add_u32 v46, v48, 12, v46
    v_mfma_f32_16x16x32_bf16 v[128:131], a[68:71], a[96:99], v[128:131]
    s_add_u32 s87, s87, 98304
    ds_read_b128 a[172:175], v72 offset:2176
    v_and_b32 v48, 3, v44
    v_mfma_f32_16x16x32_bf16 v[132:135], a[68:71], a[100:103], v[132:135]
    s_xor_b32 s57, s57, 1024
    ds_read_b64 a[140:141], v67 offset:1664
    v_lshl_add_u32 v46, v48, 4, v46
    s_waitcnt lgkmcnt(4)
    v_mfma_f32_16x16x32_bf16 v[136:139], a[132:135], a[168:171], v[136:139]
    s_mov_b32 s93, 160768
    ds_read_b64 a[142:143], v67 offset:1672
    v_add_u32 v47, s57, v1
    v_mfma_f32_16x16x32_bf16 v[132:135], a[64:67], a[104:107], v[132:135]
    s_and_b32 s56, s52, 3
    s_lshr_b32 s57, s53, 1
    ds_read_b128 a[224:227], v72 offset:3776
    s_waitcnt lgkmcnt(4)
    v_mfma_f32_16x16x32_bf16 v[136:139], a[136:139], a[164:167], v[136:139]
    s_lshl1_add_u32 s56, s56, s57
    s_lshr_b32 s57, s52, 2
    ds_read_b64 a[192:193], v67 offset:192
    s_waitcnt lgkmcnt(4)
    v_mfma_f32_16x16x32_bf16 v[136:139], a[128:131], a[172:175], v[136:139]
    s_lshl3_add_u32 s56, s56, s57
    s_lshl_b32 s56, s56, 6
    ds_read_b64 a[194:195], v67 offset:200
    v_mfma_f32_16x16x32_bf16 v[132:135], a[72:75], a[96:99], v[132:135]
    s_lshl_b32 s57, s3, 14
    s_add_u32 s56, s56, s57
    ds_read_b128 a[228:231], v72 offset:3264
    s_waitcnt lgkmcnt(4)
    v_mfma_f32_16x16x32_bf16 v[136:139], a[140:143], a[160:163], v[136:139]
    s_add_u32 s82, s56, 4718592
    s_add_u32 m0, s62, 8192
    ds_read_b64 a[196:197], v67 offset:704
    v_mfma_f32_16x16x32_bf16 v[128:131], a[128:131], a[164:167], v[128:131]
    s_add_u32 s63, s74, 0
    ds_read_b64 a[198:199], v67 offset:712
    buffer_load_dwordx4 v40, s[28:31], s63 offen offset:0 lds
    v_mfma_f32_16x16x32_bf16 v[128:131], a[132:135], a[160:163], v[128:131]
    s_lshl_b32 s1, s54, 14
    ds_read_b128 a[232:235], v72 offset:2752
    buffer_load_dwordx4 v41, s[28:31], s63 offen offset:1024 lds
    s_waitcnt lgkmcnt(4)
    v_mfma_f32_16x16x32_bf16 v[124:127], a[192:195], a[224:227], v[124:127]
    s_sub_u32 s1, s65, s1
    ds_read_b64 a[200:201], v67 offset:1216
    v_mov_b32 v77, v2
    v_mfma_f32_16x16x32_bf16 v[132:135], a[132:135], a[164:167], v[132:135]
    s_add_u32 s67, s67, s1
    ds_read_b64 a[202:203], v67 offset:1224
    v_mov_b32 v79, v2
    v_mfma_f32_16x16x32_bf16 v[132:135], a[128:131], a[168:171], v[132:135]
    s_bfe_u32 s66, s0, 0x40000
    ds_read_b128 a[236:239], v72 offset:2240
    v_mov_b32 v81, v2
    v_mfma_f32_16x16x32_bf16 v[132:135], a[136:139], a[160:163], v[132:135]
    s_lshl_b32 s66, s66, 14
    ds_read_b64 a[204:205], v67 offset:1728
    v_mov_b32 v83, v2
    s_waitcnt lgkmcnt(4)
    v_mfma_f32_16x16x32_bf16 v[136:139], a[196:199], a[232:235], v[136:139]
    s_add_u32 s66, s66, s1
    ds_read_b64 a[206:207], v67 offset:1736
    v_mov_b32 v85, v2
    v_mfma_f32_16x16x32_bf16 v[128:131], a[192:195], a[228:231], v[128:131]
    s_bfe_u32 s75, s0, 0x40008
    v_mov_b32 v87, v2
    v_mov_b32 v89, v2
    s_waitcnt lgkmcnt(3)
L_i1165:
    s_cbranch_execz L_i3050
    v_mfma_f32_16x16x32_bf16 v[136:139], a[200:203], a[228:231], v[136:139]
    s_lshl_b32 s68, s75, 14
    v_mov_b32 v91, v2
    s_mul_i32 s75, s75, 229376
    s_waitcnt lgkmcnt(2)
    v_mfma_f32_16x16x32_bf16 v[136:139], a[192:195], a[236:239], v[136:139]
    s_add_u32 s68, s68, s1
    ds_read_b128 a[48:51], v72 offset:1536
    ds_write_b128 v45, v[124:127] offset:0
    v_mfma_f32_16x16x32_bf16 v[128:131], a[196:199], a[224:227], v[128:131]
    s_add_u32 s75, s75, s61
    ds_read_b64 a[16:17], v67 offset:2048
    s_bfe_u32 s76, s0, 0x4000c
    s_waitcnt lgkmcnt(3)
    v_mfma_f32_16x16x32_bf16 v[136:139], a[204:207], a[224:227], v[136:139]
    s_lshl_b32 s69, s76, 14
    ds_read_b64 a[18:19], v67 offset:2056
    s_mul_i32 s76, s76, 229376
    v_mfma_f32_16x16x32_bf16 v[132:135], a[196:199], a[228:231], v[132:135]
    s_add_u32 s69, s69, s1
    ds_read_b128 a[52:55], v72 offset:1024
    s_add_u32 s76, s76, s61
    v_mfma_f32_16x16x32_bf16 v[132:135], a[192:195], a[232:235], v[132:135]
    s_bfe_u32 s77, s0, 0x40010
    ds_write_b128 v45, v[136:139] offset:4096
    v_mfma_f32_16x16x32_bf16 v[132:135], a[200:203], a[224:227], v[132:135]
    s_lshl_b32 s70, s77, 14
    ds_read_b64 a[20:21], v67 offset:2560
    v_mfma_f32_16x16x32_bf16 v[140:143], a[4:7], a[44:47], 0
    s_mul_i32 s77, s77, 229376
    ds_read_b64 a[22:23], v67 offset:2568
    v_mfma_f32_16x16x32_bf16 v[140:143], a[8:11], a[40:43], v[140:143]
    s_add_u32 s70, s70, s1
    ds_read_b128 a[112:115], v72 offset:1600
    v_mfma_f32_16x16x32_bf16 v[140:143], a[12:15], a[36:39], v[140:143]
    s_waitcnt lgkmcnt(3)
    s_barrier
    ds_read_b128 v[92:95], v47 offset:0
    ds_read_b128 v[96:99], v47 offset:4096
    v_mfma_f32_16x16x32_bf16 v[140:143], a[72:75], a[104:107], v[140:143]
    s_add_u32 s57, s82, 524288
    ds_read_b64 a[80:81], v67 offset:2112
    s_add_u32 s77, s77, s61
    v_mfma_f32_16x16x32_bf16 v[140:143], a[68:71], a[108:111], v[140:143]
    s_bfe_u32 s78, s0, 0x40014
    ds_read_b64 a[82:83], v67 offset:2120
    v_mfma_f32_16x16x32_bf16 v[140:143], a[76:79], a[100:103], v[140:143]
    s_lshl_b32 s71, s78, 14
    ds_read_b128 a[116:119], v72 offset:1088
    v_mfma_f32_16x16x32_bf16 v[140:143], a[136:139], a[168:171], v[140:143]
    s_mul_i32 s78, s78, 229376
    ds_read_b64 a[84:85], v67 offset:2624
    v_bfe_u32 v232, v44, 2, 2
    v_mfma_f32_16x16x32_bf16 v[140:143], a[132:135], a[172:175], v[140:143]
    s_add_u32 s71, s71, s1
    ds_read_b64 a[86:87], v67 offset:2632
    v_mfma_f32_16x16x32_bf16 v[140:143], a[140:143], a[164:167], v[140:143]
    s_waitcnt lgkmcnt(6)
    s_add_u32 m0, s62, 10240
    s_add_u32 s63, s74, 57344
    v_mfma_f32_16x16x32_bf16 v[140:143], a[200:203], a[232:235], v[140:143]
    s_add_u32 s78, s78, s61
    ds_read_b128 a[176:179], v72 offset:1664
    buffer_load_dwordx4 v40, s[28:31], s63 offen offset:0 lds
    v_mfma_f32_16x16x32_bf16 v[140:143], a[196:199], a[236:239], v[140:143]
    s_mul_i32 s0, s53, 57344
    ds_read_b64 a[144:145], v67 offset:2176
    buffer_load_dwordx4 v41, s[28:31], s63 offen offset:1024 lds
    v_mfma_f32_16x16x32_bf16 v[140:143], a[204:207], a[228:231], v[140:143]
    s_sub_u32 s61, s0, s61
    ds_read_b64 a[146:147], v67 offset:2184
    v_add_f32 v128, v128, v92
    v_mfma_f32_16x16x32_bf16 v[140:143], v[68:71], a[48:51], v[140:143]
    s_lshl_b32 s99, s54, 7
    ds_read_b128 a[180:183], v72 offset:1152
    v_add_f32 v129, v129, v93
    v_mfma_f32_16x16x32_bf16 v[140:143], a[0:3], a[48:51], v[140:143]
    s_add_u32 s61, s61, s99
    v_add_f32 v130, v130, v94
    v_add_f32 v131, v131, v95
    v_mfma_f32_16x16x32_bf16 v[140:143], a[16:19], a[32:35], v[140:143]
    s_lshl2_add_u32 s0, s55, s53
    ds_read_b64 a[148:149], v67 offset:2688
    v_cvt_pk_bf16_f32 v76, v128, v129
    v_mfma_f32_16x16x32_bf16 v[140:143], a[64:67], a[112:115], v[140:143]
    ds_read_b64 a[150:151], v67 offset:2696
    v_cvt_pk_bf16_f32 v78, v130, v131
    s_waitcnt lgkmcnt(9)
    v_mfma_f32_16x16x32_bf16 v[140:143], a[80:83], a[96:99], v[140:143]
    s_mul_i32 s1, s0, 4608
    ds_read_b128 a[240:243], v72 offset:1728
    buffer_store_dwordx4 v[76:79], v46, s[20:23], s57 offen sc1
    s_waitcnt lgkmcnt(6)
    v_mfma_f32_16x16x32_bf16 v[140:143], a[128:131], a[176:179], v[140:143]
    s_add_u32 s57, s82, 1048576
    ds_read_b64 a[208:209], v67 offset:2240
    s_waitcnt lgkmcnt(5)
    v_mfma_f32_16x16x32_bf16 v[140:143], a[144:147], a[160:163], v[140:143]
    s_add_u32 s98, s1, 8912896
    v_add_f32 v132, v132, v96
    v_add_f32 v133, v133, v97
    v_mfma_f32_16x16x32_bf16 v[144:147], a[8:11], a[44:47], 0
    s_lshr_b32 s0, s54, 2
    ds_read_b64 a[210:211], v67 offset:2248
    v_add_f32 v134, v134, v98
    v_mfma_f32_16x16x32_bf16 v[144:147], a[12:15], a[40:43], v[144:147]
    s_lshl_b32 s0, s0, 9
    ds_read_b128 a[244:247], v72 offset:1216
    v_add_f32 v135, v135, v99
    s_waitcnt lgkmcnt(3)
    v_mfma_f32_16x16x32_bf16 v[140:143], a[192:195], a[240:243], v[140:143]
    s_add_u32 s0, s0, s98
    ds_read_b64 a[212:213], v67 offset:2752
    v_cvt_pk_bf16_f32 v80, v132, v133
    v_mfma_f32_16x16x32_bf16 v[144:147], a[72:75], a[108:111], v[144:147]
    s_add_u32 s99, s99, s0
    ds_read_b64 a[214:215], v67 offset:2760
    v_cvt_pk_bf16_f32 v82, v134, v135
    v_mfma_f32_16x16x32_bf16 v[144:147], a[76:79], a[104:107], v[144:147]
    s_add_u32 s0, s54, 2
    buffer_store_dwordx4 v[80:83], v46, s[20:23], s57 offen sc1
    v_lshlrev_b32 v232, 7, v232
    s_waitcnt lgkmcnt(3)
    v_mfma_f32_16x16x32_bf16 v[140:143], a[208:211], a[224:227], v[140:143]
    s_and_b32 s0, s0, 8
    v_bfe_u32 v233, v44, 3, 1
    v_lshl_add_u32 v232, v233, 6, v232
    v_mfma_f32_16x16x32_bf16 v[144:147], a[136:139], a[172:175], v[144:147]
    s_lshl4_add_u32 s86, s0, 0x270
    v_add_u32 v232, s62, v232
    v_lshrrev_b32 v233, 5, v44
    v_mfma_f32_16x16x32_bf16 v[144:147], a[140:143], a[168:171], v[144:147]
    s_add_u32 s88, s1, 8916992
    ds_write_b128 v45, v[140:143] offset:12288
    v_bfe_u32 v234, v44, 4, 1
    v_mfma_f32_16x16x32_bf16 v[144:147], a[200:203], a[236:239], v[144:147]
    v_lshl_add_u32 v42, v233, 10, v232
    v_lshl_add_u32 v8, v233, 9, v232
    v_mfma_f32_16x16x32_bf16 v[144:147], a[204:207], a[232:235], v[144:147]
    s_lshl2_add_u32 s89, s54, s88
    ds_read_b128 a[56:59], v72 offset:512
    v_lshl_add_u32 v42, v234, 5, v42
    v_mfma_f32_16x16x32_bf16 v[144:147], a[4:7], a[48:51], v[144:147]
    s_xor_b32 s83, s59, 2147483648
    ds_read_b64 a[24:25], v67 offset:3072
    v_lshl_add_u32 v8, v234, 4, v8
    v_mfma_f32_16x16x32_bf16 v[144:147], a[16:19], a[36:39], v[144:147]
    s_mov_b32 s91, 0x409d30fc
    ds_read_b64 a[26:27], v67 offset:3080
    v_xor_b32 v4, v233, v234
    v_mfma_f32_16x16x32_bf16 v[144:147], v[68:71], a[52:55], v[144:147]
    s_mov_b32 s80, 0xc0088e99
    v_lshlrev_b32 v6, 8, v233
    v_mfma_f32_16x16x32_bf16 v[144:147], a[0:3], a[52:55], v[144:147]
    s_waitcnt lgkmcnt(3)
    s_barrier
    ds_read_b128 v[92:95], v47 offset:12288
    v_mfma_f32_16x16x32_bf16 v[144:147], a[20:23], a[32:35], v[144:147]
    s_add_u32 s57, s82, 2621440
    ds_read_b128 a[60:63], v72 offset:0
    ds_read_b64 a[28:29], v67 offset:3584
    v_mfma_f32_16x16x32_bf16 v[144:147], a[68:71], a[112:115], v[144:147]
    s_lshl_b32 s0, s53, 7
    s_add_u32 s95, s0, 161792
    v_bfe_u32 v233, v44, 1, 1
    v_mfma_f32_16x16x32_bf16 v[144:147], a[80:83], a[100:103], v[144:147]
    ds_read_b64 a[30:31], v67 offset:3592
    v_and_b32 v234, 1, v44
    v_mfma_f32_16x16x32_bf16 v[144:147], a[64:67], a[116:119], v[144:147]
    ds_read_b128 a[120:123], v72 offset:576
    v_lshl_add_u32 v42, v233, 4, v42
    v_mfma_f32_16x16x32_bf16 v[144:147], a[84:87], a[96:99], v[144:147]
    ds_read_b64 a[88:89], v67 offset:3136
    v_mfma_f32_16x16x32_bf16 v[144:147], a[132:135], a[176:179], v[144:147]
    v_lshl_add_u32 v8, v233, 3, v8
    v_mfma_f32_16x16x32_bf16 v[144:147], a[144:147], a[164:167], v[144:147]
    ds_read_b64 a[90:91], v67 offset:3144
    v_mfma_f32_16x16x32_bf16 v[144:147], a[128:131], a[180:183], v[144:147]
    ds_read_b128 a[124:127], v72 offset:64
    v_lshl_add_u32 v42, v234, 3, v42
    v_mfma_f32_16x16x32_bf16 v[144:147], a[148:151], a[160:163], v[144:147]
    v_mfma_f32_16x16x32_bf16 v[144:147], a[196:199], a[240:243], v[144:147]
    ds_read_b64 a[92:93], v67 offset:3648
    v_lshl_add_u32 v8, v234, 5, v8
    v_mfma_f32_16x16x32_bf16 v[144:147], a[208:211], a[228:231], v[144:147]
    ds_read_b64 a[94:95], v67 offset:3656
    v_mfma_f32_16x16x32_bf16 v[144:147], a[192:195], a[244:247], v[144:147]
    ds_read_b128 a[184:187], v72 offset:640
    v_xor_b32 v43, 64, v42
    v_mfma_f32_16x16x32_bf16 v[144:147], a[212:215], a[224:227], v[144:147]
    v_mfma_f32_16x16x32_bf16 v[152:155], a[12:15], a[48:51], 0
    s_and_b32 s64, s55, 3
    s_waitcnt vmcnt(14)
    v_and_b32 v36, 15, v44
    s_mul_i32 s64, s64, 57344
    v_mul_u32_u24 v36, 3584, v36
    s_add_u32 s64, s64, s72
    buffer_load_dword v36, v36, s[28:31], s64 offen
    v_mfma_f32_16x16x32_bf16 v[152:155], a[16:19], a[44:47], v[152:155]
    s_waitcnt lgkmcnt(10)
    ds_read_b64 a[152:153], v67 offset:3200
    ds_read_b64 a[154:155], v67 offset:3208
    v_mfma_f32_16x16x32_bf16 v[152:155], a[8:11], a[52:55], v[152:155]
    s_add_u32 m0, s62, 12288
    s_add_u32 s63, s74, 114688
    buffer_load_dwordx4 v40, s[28:31], s63 offen offset:0 lds
    v_mfma_f32_16x16x32_bf16 v[152:155], a[20:23], a[40:43], v[152:155]
    ds_read_b128 a[188:191], v72 offset:128
    buffer_load_dwordx4 v41, s[28:31], s63 offen offset:1024 lds
    v_mfma_f32_16x16x32_bf16 v[152:155], a[76:79], a[112:115], v[152:155]
    ds_read_b64 a[156:157], v67 offset:3712
    v_add_f32 v144, v144, v92
    v_mfma_f32_16x16x32_bf16 v[152:155], a[80:83], a[108:111], v[152:155]
    ds_read_b64 a[158:159], v67 offset:3720
    v_add_f32 v145, v145, v93
    v_mfma_f32_16x16x32_bf16 v[152:155], a[72:75], a[116:119], v[152:155]
    v_add_f32 v146, v146, v94
    v_add_f32 v147, v147, v95
    v_mfma_f32_16x16x32_bf16 v[152:155], a[84:87], a[104:107], v[152:155]
    ds_read_b128 a[248:251], v72 offset:704
    v_cvt_pk_bf16_f32 v84, v144, v145
    v_mfma_f32_16x16x32_bf16 v[152:155], a[140:143], a[176:179], v[152:155]
    ds_read_b64 a[216:217], v67 offset:3264
    v_cvt_pk_bf16_f32 v86, v146, v147
    v_mfma_f32_16x16x32_bf16 v[152:155], a[144:147], a[172:175], v[152:155]
    buffer_store_dwordx4 v[84:87], v46, s[20:23], s57 offen sc1
    v_xor_b32 v9, 64, v8
    v_mfma_f32_16x16x32_bf16 v[152:155], a[136:139], a[180:183], v[152:155]
    ds_read_b64 a[218:219], v67 offset:3272
    v_bfe_u32 v232, v44, 3, 2
    v_mfma_f32_16x16x32_bf16 v[152:155], a[148:151], a[168:171], v[152:155]
    ds_read_b128 a[252:255], v72 offset:192
    v_and_b32 v234, 7, v44
    v_mfma_f32_16x16x32_bf16 v[152:155], a[204:207], a[240:243], v[152:155]
    ds_read_b64 a[220:221], v67 offset:3776
    v_mul_u32_u24 v232, 15360, v232
    v_mfma_f32_16x16x32_bf16 v[152:155], a[208:211], a[236:239], v[152:155]
    v_lshl_add_u32 v233, v234, 4, v232
    v_add_u32 v233, 98304, v233
    v_mfma_f32_16x16x32_bf16 v[152:155], a[200:203], a[244:247], v[152:155]
    ds_read_b64 a[222:223], v67 offset:3784
    v_lshl_add_u32 v6, s53, 10, v6
    v_mfma_f32_16x16x32_bf16 v[152:155], a[212:215], a[232:235], v[152:155]
    v_lshl_add_u32 v4, v4, 7, v233
    v_mfma_f32_16x16x32_bf16 v[152:155], a[4:7], a[56:59], v[152:155]
    v_add_u32 v6, v6, v233
    v_mfma_f32_16x16x32_bf16 v[152:155], a[24:27], a[36:39], v[152:155]
    s_waitcnt lgkmcnt(15)
    v_mfma_f32_16x16x32_bf16 v[152:155], v[68:71], a[60:63], v[152:155]
    v_add_u32 v52, s87, v1
    v_mfma_f32_16x16x32_bf16 v[152:155], a[0:3], a[60:63], v[152:155]
    v_mfma_f32_16x16x32_bf16 v[152:155], a[28:31], a[32:35], v[152:155]
    v_lshl_add_u32 v55, v44, 2, s93
    v_mfma_f32_16x16x32_bf16 v[152:155], a[68:71], a[120:123], v[152:155]
    v_mfma_f32_16x16x32_bf16 v[152:155], a[88:91], a[100:103], v[152:155]
    v_lshrrev_b32 v233, 3, v44
    s_waitcnt lgkmcnt(14)
    v_mfma_f32_16x16x32_bf16 v[152:155], a[64:67], a[124:127], v[152:155]
    s_waitcnt lgkmcnt(12)
    v_mfma_f32_16x16x32_bf16 v[152:155], a[92:95], a[96:99], v[152:155]
    v_lshlrev_b32 v232, 7, v234
    s_waitcnt lgkmcnt(11)
    v_mfma_f32_16x16x32_bf16 v[152:155], a[132:135], a[184:187], v[152:155]
    s_waitcnt lgkmcnt(9)
    v_mfma_f32_16x16x32_bf16 v[152:155], a[152:155], a[164:167], v[152:155]
    v_lshl_add_u32 v232, v233, 4, v232
    s_waitcnt lgkmcnt(8)
    v_mfma_f32_16x16x32_bf16 v[152:155], a[128:131], a[188:191], v[152:155]
    s_waitcnt lgkmcnt(6)
    v_mfma_f32_16x16x32_bf16 v[152:155], a[156:159], a[160:163], v[152:155]
    v_add_u32 v60, s87, v232
    s_waitcnt lgkmcnt(5)
    v_mfma_f32_16x16x32_bf16 v[152:155], a[196:199], a[248:251], v[152:155]
    s_waitcnt lgkmcnt(3)
    v_mfma_f32_16x16x32_bf16 v[152:155], a[216:219], a[228:231], v[152:155]
    v_lshrrev_b32 v232, 2, v44
    s_waitcnt lgkmcnt(2)
    v_mfma_f32_16x16x32_bf16 v[152:155], a[192:195], a[252:255], v[152:155]
    s_waitcnt lgkmcnt(0)
    v_mfma_f32_16x16x32_bf16 v[152:155], a[220:223], a[224:227], v[152:155]
    v_lshrrev_b32 v233, 4, v44
    v_mfma_f32_16x16x32_bf16 v[148:151], a[12:15], a[44:47], 0
    v_mfma_f32_16x16x32_bf16 v[148:151], a[76:79], a[108:111], v[148:151]
    s_nop 4
    ds_write_b128 v45, v[152:155] offset:8192
    v_xor_b32 v232, v232, v233
    v_mfma_f32_16x16x32_bf16 v[148:151], a[140:143], a[172:175], v[148:151]
    v_mfma_f32_16x16x32_bf16 v[148:151], a[204:207], a[236:239], v[148:151]
    v_and_b32 v232, 1, v232
    v_mfma_f32_16x16x32_bf16 v[148:151], a[8:11], a[48:51], v[148:151]
    s_waitcnt lgkmcnt(0)
    s_barrier
    ds_read_b128 v[92:95], v47 offset:8192
    v_mfma_f32_16x16x32_bf16 v[148:151], a[16:19], a[40:43], v[148:151]
    s_add_u32 s57, s82, 3145728
    v_and_or_b32 v232, v44, 3, v232
    v_mfma_f32_16x16x32_bf16 v[148:151], a[4:7], a[52:55], v[148:151]
    v_mfma_f32_16x16x32_bf16 v[148:151], a[20:23], a[36:39], v[148:151]
    v_add_u32 v232, -1, v232
    v_mfma_f32_16x16x32_bf16 v[148:151], a[72:75], a[112:115], v[148:151]
    v_mfma_f32_16x16x32_bf16 v[148:151], a[80:83], a[104:107], v[148:151]
    s_add_u32 m0, s62, 14336
    s_add_u32 s63, s74, 172032
    buffer_load_dwordx4 v40, s[28:31], s63 offen offset:0 lds
    v_mfma_f32_16x16x32_bf16 v[148:151], a[68:71], a[116:119], v[148:151]
    buffer_load_dwordx4 v41, s[28:31], s63 offen offset:1024 lds
    v_ashrrev_i32 v232, 31, v232
    v_mfma_f32_16x16x32_bf16 v[148:151], a[84:87], a[100:103], v[148:151]
    v_and_b32 v120, 0x3f803f80, v232
    v_mfma_f32_16x16x32_bf16 v[148:151], a[136:139], a[176:179], v[148:151]
    v_mfma_f32_16x16x32_bf16 v[148:151], a[144:147], a[168:171], v[148:151]
    v_mov_b32 v62, 0
    v_mfma_f32_16x16x32_bf16 v[148:151], a[132:135], a[180:183], v[148:151]
    v_mfma_f32_16x16x32_bf16 v[148:151], a[148:151], a[164:167], v[148:151]
    v_mov_b32 v63, 0
    v_mfma_f32_16x16x32_bf16 v[148:151], a[200:203], a[240:243], v[148:151]
    v_mfma_f32_16x16x32_bf16 v[148:151], a[208:211], a[232:235], v[148:151]
    v_mov_b32 v121, v120
    v_mfma_f32_16x16x32_bf16 v[148:151], a[196:199], a[244:247], v[148:151]
    v_mfma_f32_16x16x32_bf16 v[148:151], a[212:215], a[228:231], v[148:151]
    v_mov_b32 v122, v120
    v_mfma_f32_16x16x32_bf16 v[148:151], v[68:71], a[56:59], v[148:151]
    v_mfma_f32_16x16x32_bf16 v[148:151], a[0:3], a[56:59], v[148:151]
    v_mov_b32 v123, v120
    v_mfma_f32_16x16x32_bf16 v[148:151], a[24:27], a[32:35], v[148:151]
    v_mfma_f32_16x16x32_bf16 v[148:151], a[64:67], a[120:123], v[148:151]
    v_mfma_f32_16x16x32_bf16 v[148:151], a[88:91], a[96:99], v[148:151]
    v_mfma_f32_16x16x32_bf16 v[148:151], a[128:131], a[184:187], v[148:151]
    v_mfma_f32_16x16x32_bf16 v[148:151], a[152:155], a[160:163], v[148:151]
    v_mfma_f32_16x16x32_bf16 v[148:151], a[192:195], a[248:251], v[148:151]
    v_mfma_f32_16x16x32_bf16 v[148:151], a[216:219], a[224:227], v[148:151]
    s_waitcnt lgkmcnt(0)
    s_nop 6
    v_pk_add_f32 v[148:149], v[148:149], v[92:93]
    v_pk_add_f32 v[150:151], v[150:151], v[94:95]
    v_cvt_pk_bf16_f32 v88, v148, v149
    v_cvt_pk_bf16_f32 v90, v150, v151
    buffer_store_dwordx4 v[88:91], v46, s[20:23], s57 offen sc1
Lh_18:
L_i1505:
    s_cbranch_execz L_i3693
    s_mov_b32 s97, 0
Lxc_19:
    v_cmp_ne_u32 vcc, s92, v37
    s_cbranch_vccz Lxs_20
    v_xor_b32 v37, s59, v37
    v_and_b32 v37, 0x0fffffff, v37
    v_cmp_ne_u32 vcc, 0, v37
    s_cbranch_vccnz Lxq_21
    s_mov_b32 s97, 1
    buffer_store_dwordx4 v[10:13], v75, s[20:23], s79 offen offset:0 sc1
    buffer_store_dwordx4 v[14:17], v75, s[20:23], s79 offen offset:128 sc1
    buffer_store_dwordx4 v[18:21], v75, s[20:23], s79 offen offset:256 sc1
    buffer_store_dwordx4 v[22:25], v75, s[20:23], s79 offen offset:384 sc1
Lxs_20:
L_join:
    s_cmp_lg_u32 s97, 0
    s_cbranch_scc1 L_mlpS
L_mlpF:
    s_add_u32 m0, s62, 16384
    s_add_u32 s63, s72, 0
    buffer_load_dwordx4 v40, s[28:31], s63 offen offset:0 lds
    ds_write_b128 v52, v[26:29] offset:0
    ds_write_b128 v52, v[30:33] offset:1024
    ds_read_b128 v[80:83], v60 offset:0
    ds_read_b128 v[84:87], v60 offset:1024
    s_waitcnt vmcnt(20)
    ds_read_b64_tr_b16 a[32:33], v42 offset:0
    ds_read_b64_tr_b16 a[34:35], v42 offset:512
    ds_read_b64_tr_b16 a[36:37], v43 offset:0
    ds_read_b64_tr_b16 a[38:39], v43 offset:512
    s_waitcnt vmcnt(18)
    ds_read_b64_tr_b16 a[40:41], v42 offset:2048
    ds_read_b64_tr_b16 a[42:43], v42 offset:2560
    s_waitcnt lgkmcnt(4)
    v_mfma_f32_16x16x32_bf16 v[112:115], v[120:123], a[32:35], 0
    buffer_load_dwordx4 v41, s[28:31], s63 offen offset:1024 lds
    ds_read_b64_tr_b16 a[44:45], v43 offset:2048
    ds_read_b64_tr_b16 a[46:47], v43 offset:2560
    s_waitcnt lgkmcnt(4)
    v_mfma_f32_16x16x32_bf16 v[116:119], v[120:123], a[36:39], 0
    v_lshlrev_b32 v34, 16, v34
    v_lshlrev_b32 v35, 16, v35
    v_mul_f32 v34, 0x3f80002a, v34
    s_lshr_b32 s56, s53, 1
    s_lshl_b32 s90, s56, 7
    ds_write_b32 v55, v35
    v_lshlrev_b32 v10, 16, v80
    v_and_b32 v11, s60, v80
    v_lshlrev_b32 v12, 16, v81
    v_and_b32 v13, s60, v81
    v_lshlrev_b32 v14, 16, v82
    v_and_b32 v15, s60, v82
    v_lshlrev_b32 v16, 16, v83
    v_and_b32 v17, s60, v83
    v_lshlrev_b32 v18, 16, v84
    v_and_b32 v19, s60, v84
    v_lshlrev_b32 v20, 16, v85
    v_and_b32 v21, s60, v85
    v_lshlrev_b32 v22, 16, v86
    v_and_b32 v23, s60, v86
    v_lshlrev_b32 v24, 16, v87
    v_and_b32 v25, s60, v87
    v_pk_add_f32 v[64:65], v[10:11], v[12:13]
    v_pk_mul_f32 v[68:69], v[10:11], v[10:11]
    v_pk_add_f32 v[66:67], v[18:19], v[20:21]
    v_pk_mul_f32 v[70:71], v[18:19], v[18:19]
    v_pk_fma_f32 v[68:69], v[12:13], v[12:13], v[68:69]
    v_pk_fma_f32 v[70:71], v[20:21], v[20:21], v[70:71]
    v_pk_add_f32 v[64:65], v[64:65], v[14:15]
    v_pk_fma_f32 v[68:69], v[14:15], v[14:15], v[68:69]
    v_pk_add_f32 v[66:67], v[66:67], v[22:23]
    v_pk_fma_f32 v[70:71], v[22:23], v[22:23], v[70:71]
    v_pk_add_f32 v[64:65], v[64:65], v[16:17]
    v_pk_fma_f32 v[68:69], v[16:17], v[16:17], v[68:69]
    v_pk_add_f32 v[66:67], v[66:67], v[24:25]
    v_pk_fma_f32 v[70:71], v[24:25], v[24:25], v[70:71]
    v_add_f32 v72, v64, v65
    v_add_f32 v73, v66, v67
    v_add_f32 v76, v68, v69
    v_add_f32 v77, v70, v71
    v_and_b32 v78, s86, v1
    v_mov_b32 v74, v2
    v_mov_b32 v75, v2
    v_permlane32_swap_b32 v72, v76
    v_permlane32_swap_b32 v73, v77
    v_pk_add_f32 v[72:73], v[72:73], v[76:77]
    v_mov_b32 v76, v72
    v_mov_b32 v77, v73
    s_nop 0
    v_permlane16_swap_b32 v72, v76
    v_permlane16_swap_b32 v73, v77
    v_pk_add_f32 v[72:73], v[72:73], v[76:77]
    s_nop 1
    v_add_f32_dpp v72, v72, v72 row_ror:8 row_mask:0xf bank_mask:0xf
    v_add_f32_dpp v73, v73, v73 row_ror:8 row_mask:0xf bank_mask:0xf
    buffer_store_dwordx4 v[72:75], v78, s[20:23], s99 offen offset:0
    s_waitcnt vmcnt(18)
    ds_read_b64_tr_b16 a[48:49], v42 offset:4096
    ds_read_b64_tr_b16 a[50:51], v42 offset:4608
    s_waitcnt lgkmcnt(5)
    v_mfma_f32_16x16x32_bf16 v[112:115], v[120:123], a[40:43], v[112:115]
    s_add_u32 m0, s62, 18432
    s_add_u32 s63, s72, 57344
    buffer_load_dwordx4 v40, s[28:31], s63 offen offset:0 lds
    ds_read_b64_tr_b16 a[52:53], v43 offset:4096
    ds_read_b64_tr_b16 a[54:55], v43 offset:4608
    s_waitcnt lgkmcnt(5)
    v_mfma_f32_16x16x32_bf16 v[116:119], v[120:123], a[44:47], v[116:119]
    s_waitcnt vmcnt(17)
    ds_read_b64_tr_b16 a[56:57], v42 offset:6144
    ds_read_b64_tr_b16 a[58:59], v42 offset:6656
    s_waitcnt lgkmcnt(4)
    v_mfma_f32_16x16x32_bf16 v[112:115], v[120:123], a[48:51], v[112:115]
    ds_read_b64_tr_b16 a[60:61], v43 offset:6144
    ds_read_b64_tr_b16 a[62:63], v43 offset:6656
    s_waitcnt lgkmcnt(4)
    v_mfma_f32_16x16x32_bf16 v[116:119], v[120:123], a[52:55], v[116:119]
    s_waitcnt vmcnt(15)
    ds_read_b64_tr_b16 a[64:65], v42 offset:8192
    ds_read_b64_tr_b16 a[66:67], v42 offset:8704
    buffer_load_dwordx4 v41, s[28:31], s63 offen offset:1024 lds
    s_waitcnt lgkmcnt(4)
    v_mfma_f32_16x16x32_bf16 v[112:115], v[120:123], a[56:59], v[112:115]
    ds_read_b64_tr_b16 a[68:69], v43 offset:8192
    ds_read_b64_tr_b16 a[70:71], v43 offset:8704
    s_waitcnt lgkmcnt(4)
    v_mfma_f32_16x16x32_bf16 v[116:119], v[120:123], a[60:63], v[116:119]
    s_waitcnt vmcnt(14)
    ds_read_b64_tr_b16 a[72:73], v42 offset:10240
    ds_read_b64_tr_b16 a[74:75], v42 offset:10752
    s_waitcnt lgkmcnt(4)
    v_mfma_f32_16x16x32_bf16 v[112:115], v[120:123], a[64:67], v[112:115]
    ds_read_b64_tr_b16 a[76:77], v43 offset:10240
    ds_read_b64_tr_b16 a[78:79], v43 offset:10752
    s_waitcnt lgkmcnt(4)
    v_mfma_f32_16x16x32_bf16 v[116:119], v[120:123], a[68:71], v[116:119]
    s_waitcnt vmcnt(9)
    ds_read_b64_tr_b16 a[80:81], v42 offset:12288
    s_add_u32 m0, s62, 20480
    s_add_u32 s63, s72, 114688
    buffer_load_dwordx4 v40, s[28:31], s63 offen offset:0 lds
    ds_read_b64_tr_b16 a[82:83], v42 offset:12800
    s_waitcnt lgkmcnt(4)
    v_mfma_f32_16x16x32_bf16 v[112:115], v[120:123], a[72:75], v[112:115]
    ds_read_b64_tr_b16 a[84:85], v43 offset:12288
    ds_read_b64_tr_b16 a[86:87], v43 offset:12800
    s_waitcnt lgkmcnt(4)
    v_mfma_f32_16x16x32_bf16 v[116:119], v[120:123], a[76:79], v[116:119]
    s_waitcnt vmcnt(7)
    ds_read_b64_tr_b16 a[88:89], v42 offset:14336
    ds_read_b64_tr_b16 a[90:91], v42 offset:14848
    s_waitcnt lgkmcnt(4)
    v_mfma_f32_16x16x32_bf16 v[112:115], v[120:123], a[80:83], v[112:115]
    ds_read_b64_tr_b16 a[92:93], v43 offset:14336
    ds_read_b64_tr_b16 a[94:95], v43 offset:14848
    s_waitcnt lgkmcnt(4)
    v_mfma_f32_16x16x32_bf16 v[116:119], v[120:123], a[84:87], v[116:119]
    buffer_load_dwordx4 v41, s[28:31], s63 offen offset:1024 lds
    v_lshrrev_b32 v128, 1, v1
    v_bfe_u32 v129, v1, 4, 1
    v_and_b32 v128, 0x1f0, v128
    v_lshl_add_u32 v128, v129, 9, v128
    s_add_u32 m0, s62, 22528
    s_add_u32 s63, s72, 172032
    buffer_load_dwordx4 v40, s[28:31], s63 offen offset:0 lds
    buffer_load_dwordx4 v41, s[28:31], s63 offen offset:1024 lds
    s_add_u32 m0, s62, 0
    s_add_u32 s63, s75, 0
    buffer_load_dwordx4 v40, s[28:31], s63 offen offset:0 lds
    buffer_load_dwordx4 v41, s[28:31], s63 offen offset:1024 lds
    s_add_u32 m0, s62, 2048
    s_add_u32 s63, s75, 57344
    buffer_load_dwordx4 v40, s[28:31], s63 offen offset:0 lds
    buffer_load_dwordx4 v41, s[28:31], s63 offen offset:1024 lds
    s_add_u32 m0, s62, 4096
    s_add_u32 s63, s75, 114688
    buffer_load_dwordx4 v40, s[28:31], s63 offen offset:0 lds
    buffer_load_dwordx4 v41, s[28:31], s63 offen offset:1024 lds
    s_add_u32 m0, s62, 6144
    s_add_u32 s63, s75, 172032
    buffer_load_dwordx4 v40, s[28:31], s63 offen offset:0 lds
    buffer_load_dwordx4 v41, s[28:31], s63 offen offset:1024 lds
    buffer_load_dwordx4 v[144:147], v1, s[20:23], s98 offen offset:0 sc1
    buffer_load_dwordx4 v[148:151], v1, s[20:23], s98 offen offset:1024 sc1
    buffer_load_dwordx4 v[80:83], v128, s[20:23], s65 offen offset:0 sc1
    buffer_load_dwordx4 v[84:87], v128, s[20:23], s65 offen offset:1024 sc1
    buffer_load_dwordx4 v[88:91], v128, s[20:23], s65 offen offset:2048 sc1
    buffer_load_dwordx4 v[92:95], v128, s[20:23], s65 offen offset:3072 sc1
    buffer_store_dword v2, off, s[20:23], s89 offset:0
    s_barrier
    s_add_u32 m0, s62, 8192
    s_add_u32 s63, s76, 0
    buffer_load_dwordx4 v40, s[28:31], s63 offen offset:0 lds
    v_xor_b32 v131, s90, v1
    v_xor_b32 v133, s90, v52
    buffer_load_dwordx4 v41, s[28:31], s63 offen offset:1024 lds
    v_mov_b32 v50, v52
    v_lshrrev_b32 v132, 7, v1
    s_add_u32 m0, s62, 10240
    s_add_u32 s63, s76, 57344
    buffer_load_dwordx4 v40, s[28:31], s63 offen offset:0 lds
    v_lshl_add_u32 v132, v132, 5, s93
    buffer_load_dwordx4 v41, s[28:31], s63 offen offset:1024 lds
    ds_read_b128 v[136:139], v132 offset:0
    ds_read_b128 v[140:143], v132 offset:16
    s_waitcnt vmcnt(9)
    v_bitop3_b32 v152, v146, v150, s59 bitop3:0x7e
    v_bitop3_b32 v152, v147, v152, s59 bitop3:0xde
    v_bitop3_b32 v152, v151, v152, s59 bitop3:0xde
    v_cmp_ne_u32 vcc, 0, v152
    s_cbranch_vccnz Lrt_30
Lck_29:
    v_add_f32_dpp v144, v148, v144 quad_perm:[0,1,2,3] row_mask:0xf bank_mask:0x3
    v_add_f32_dpp v145, v149, v145 quad_perm:[0,1,2,3] row_mask:0xf bank_mask:0x3
    s_nop 0
    v_add_f32_dpp v144, v148, v144 quad_perm:[0,1,2,3] row_mask:0x5 bank_mask:0xc
    v_add_f32_dpp v145, v149, v145 quad_perm:[0,1,2,3] row_mask:0x5 bank_mask:0xc
    s_nop 0
    v_add_f32_dpp v144, v144, v144 row_ror:8 row_mask:0xf bank_mask:0xf
    v_add_f32_dpp v145, v145, v145 row_ror:8 row_mask:0xf bank_mask:0xf
    v_mov_b32 v146, v144
    v_mov_b32 v147, v145
    s_nop 0
    v_permlane16_swap_b32 v144, v146
    v_permlane16_swap_b32 v145, v147
    v_add_f32 v144, v144, v146
    v_add_f32 v145, v145, v147
    v_mov_b32 v146, v144
    v_mov_b32 v147, v145
    s_nop 0
    v_permlane32_swap_b32 v144, v146
    v_permlane32_swap_b32 v145, v147
    v_mul_f32 v152, 0xbb124925, v144
    v_mul_f32 v156, 0xbb124925, v145
    v_fmaak_f32 v153, v152, v152, 0xb727c5ac
    v_fmaak_f32 v157, v156, v156, 0xb727c5ac
    v_fmac_f32 v153, 0xbb124925, v146
    v_fmac_f32 v157, 0xbb124925, v147
    v_rsq_f32_e64 v153, |v153|
    v_rsq_f32_e64 v157, |v157|
    v_mul_f32 v152, v152, v153
    v_mul_f32 v156, v156, v157
    v_pk_fma_f32 v[96:97], v[10:11], v[152:153], v[152:153] op_sel:[0,1,0] op_sel_hi:[1,1,0]
    v_pk_fma_f32 v[98:99], v[12:13], v[152:153], v[152:153] op_sel:[0,1,0] op_sel_hi:[1,1,0]
    v_pk_fma_f32 v[100:101], v[14:15], v[152:153], v[152:153] op_sel:[0,1,0] op_sel_hi:[1,1,0]
    v_pk_fma_f32 v[102:103], v[16:17], v[152:153], v[152:153] op_sel:[0,1,0] op_sel_hi:[1,1,0]
    v_pk_fma_f32 v[104:105], v[18:19], v[156:157], v[156:157] op_sel:[0,1,0] op_sel_hi:[1,1,0]
    v_pk_fma_f32 v[106:107], v[20:21], v[156:157], v[156:157] op_sel:[0,1,0] op_sel_hi:[1,1,0]
    v_pk_fma_f32 v[108:109], v[22:23], v[156:157], v[156:157] op_sel:[0,1,0] op_sel_hi:[1,1,0]
    v_pk_fma_f32 v[110:111], v[24:25], v[156:157], v[156:157] op_sel:[0,1,0] op_sel_hi:[1,1,0]
    s_add_u32 s56, s65, 4290316288
    s_waitcnt vmcnt(5)
    v_bitop3_b32 v129, v81, v83, s59 bitop3:0x7e
    v_bitop3_b32 v130, v85, v87, s59 bitop3:0x7e
    v_bitop3_b32 v129, v89, v129, s59 bitop3:0xde
    v_bitop3_b32 v130, v91, v130, s59 bitop3:0xde
    v_bitop3_b32 v129, v93, v129, s59 bitop3:0xde
    v_bitop3_b32 v130, v95, v130, s59 bitop3:0xde
    v_or_b32 v129, v129, v130
    v_cmp_ne_u32 vcc, 0, v129
    s_cbranch_vccnz Lrt_32
Lck_31:
    s_mov_b32 vcc_lo, 0x55555555
    s_mov_b32 vcc_hi, 0x55555555
    v_cndmask_b32_dpp v26, v82, v80, vcc quad_perm:[1,0,3,2] row_mask:0xf bank_mask:0xf
    v_cndmask_b32_dpp v28, v86, v84, vcc quad_perm:[1,0,3,2] row_mask:0xf bank_mask:0xf
    v_cndmask_b32_dpp v30, v90, v88, vcc quad_perm:[1,0,3,2] row_mask:0xf bank_mask:0xf
    v_cndmask_b32_dpp v32, v94, v92, vcc quad_perm:[1,0,3,2] row_mask:0xf bank_mask:0xf
    s_not_b64 vcc, vcc
    v_cndmask_b32_dpp v27, v80, v82, vcc quad_perm:[1,0,3,2] row_mask:0xf bank_mask:0xf
    v_cndmask_b32_dpp v29, v84, v86, vcc quad_perm:[1,0,3,2] row_mask:0xf bank_mask:0xf
    v_cndmask_b32_dpp v31, v88, v90, vcc quad_perm:[1,0,3,2] row_mask:0xf bank_mask:0xf
    v_cndmask_b32_dpp v33, v92, v94, vcc quad_perm:[1,0,3,2] row_mask:0xf bank_mask:0xf
    v_lshlrev_b32 v64, 16, v26
    v_lshlrev_b32 v65, 16, v27
    v_lshlrev_b32 v66, 16, v28
    v_lshlrev_b32 v67, 16, v29
    v_lshlrev_b32 v68, 16, v30
    v_lshlrev_b32 v69, 16, v31
    v_lshlrev_b32 v70, 16, v32
L_i1786:
    s_cbranch_execz L_i4371
    v_lshlrev_b32 v71, 16, v33
    v_pk_fma_f32 v[10:11], v[96:97], v[64:65], v[10:11]
    v_pk_fma_f32 v[12:13], v[98:99], v[66:67], v[12:13]
    v_pk_fma_f32 v[14:15], v[100:101], v[68:69], v[14:15]
    v_pk_fma_f32 v[16:17], v[102:103], v[70:71], v[16:17]
    v_cvt_pk_bf16_f32 v144, v10, v11
    v_cvt_pk_bf16_f32 v145, v12, v13
    v_cvt_pk_bf16_f32 v146, v14, v15
    v_cvt_pk_bf16_f32 v147, v16, v17
    buffer_store_dwordx4 v[144:147], v131, s[20:23], s56 offen offset:0
    ds_write_b128 v133, v[144:147] offset:0
    v_and_b32 v72, s60, v26
    v_and_b32 v73, s60, v27
    v_and_b32 v74, s60, v28
    v_and_b32 v75, s60, v29
    v_and_b32 v76, s60, v30
    v_and_b32 v77, s60, v31
    v_and_b32 v78, s60, v32
    v_and_b32 v79, s60, v33
    v_pk_fma_f32 v[18:19], v[104:105], v[72:73], v[18:19]
    v_pk_fma_f32 v[20:21], v[106:107], v[74:75], v[20:21]
    v_pk_fma_f32 v[22:23], v[108:109], v[76:77], v[22:23]
    v_pk_fma_f32 v[24:25], v[110:111], v[78:79], v[24:25]
    v_cvt_pk_bf16_f32 v148, v18, v19
    v_cvt_pk_bf16_f32 v149, v20, v21
    v_cvt_pk_bf16_f32 v150, v22, v23
    v_cvt_pk_bf16_f32 v151, v24, v25
    buffer_store_dwordx4 v[148:151], v131, s[20:23], s56 offen offset:1024
    ds_write_b128 v133, v[148:151] offset:8192
    v_pk_add_f32 v[64:65], v[10:11], v[12:13]
    v_pk_mul_f32 v[68:69], v[10:11], v[10:11]
    v_pk_add_f32 v[66:67], v[18:19], v[20:21]
    v_pk_mul_f32 v[70:71], v[18:19], v[18:19]
    v_pk_fma_f32 v[68:69], v[12:13], v[12:13], v[68:69]
    v_pk_fma_f32 v[70:71], v[20:21], v[20:21], v[70:71]
    v_pk_add_f32 v[64:65], v[64:65], v[14:15]
    v_pk_fma_f32 v[68:69], v[14:15], v[14:15], v[68:69]
    v_pk_add_f32 v[66:67], v[66:67], v[22:23]
    v_pk_fma_f32 v[70:71], v[22:23], v[22:23], v[70:71]
    v_pk_add_f32 v[64:65], v[64:65], v[16:17]
    v_pk_fma_f32 v[68:69], v[16:17], v[16:17], v[68:69]
    v_pk_add_f32 v[66:67], v[66:67], v[24:25]
    v_pk_fma_f32 v[70:71], v[24:25], v[24:25], v[70:71]
    v_add_f32 v72, v64, v65
    v_add_f32 v73, v66, v67
    v_add_f32 v76, v68, v69
    v_add_f32 v77, v70, v71
    v_and_b32 v78, s86, v1
    v_mov_b32 v74, v2
    v_mov_b32 v75, v2
    v_permlane32_swap_b32 v72, v76
    v_permlane32_swap_b32 v73, v77
    v_pk_add_f32 v[72:73], v[72:73], v[76:77]
    v_mov_b32 v76, v72
    v_mov_b32 v77, v73
    s_nop 0
    v_permlane16_swap_b32 v72, v76
    v_permlane16_swap_b32 v73, v77
    v_pk_add_f32 v[72:73], v[72:73], v[76:77]
    s_nop 1
    v_add_f32_dpp v72, v72, v72 row_ror:8 row_mask:0xf bank_mask:0xf
    v_add_f32_dpp v73, v73, v73 row_ror:8 row_mask:0xf bank_mask:0xf
    buffer_store_dwordx4 v[72:75], v78, s[20:23], s99 offen offset:2048
    buffer_load_dwordx4 v[96:99], v1, s[20:23], s98 offen offset:2048 sc1
    buffer_load_dwordx4 v[100:103], v1, s[20:23], s98 offen offset:3072 sc1
    s_waitcnt lgkmcnt(3)
    v_pk_add_f32 v[10:11], v[10:11], v[136:137]
    v_pk_add_f32 v[12:13], v[12:13], v[138:139]
    s_waitcnt lgkmcnt(2)
    v_pk_add_f32 v[14:15], v[14:15], v[140:141]
    v_pk_add_f32 v[16:17], v[16:17], v[142:143]
    v_pk_add_f32 v[18:19], v[18:19], v[136:137]
    v_pk_add_f32 v[20:21], v[20:21], v[138:139]
    v_pk_add_f32 v[22:23], v[22:23], v[140:141]
    v_pk_add_f32 v[24:25], v[24:25], v[142:143]
    ds_read_b64_tr_b16 a[0:1], v42 offset:16384
    ds_read_b64_tr_b16 a[2:3], v42 offset:16896
    v_mfma_f32_16x16x32_bf16 v[112:115], v[120:123], a[88:91], v[112:115]
    ds_read_b64_tr_b16 a[4:5], v43 offset:16384
    ds_read_b64_tr_b16 a[6:7], v43 offset:16896
    v_mfma_f32_16x16x32_bf16 v[116:119], v[120:123], a[92:95], v[116:119]
    ds_read_b64_tr_b16 a[8:9], v42 offset:18432
    ds_read_b64_tr_b16 a[10:11], v42 offset:18944
    s_add_u32 m0, s62, 12288
    s_add_u32 s63, s76, 114688
    buffer_load_dwordx4 v40, s[28:31], s63 offen offset:0 lds
    s_waitcnt lgkmcnt(4)
    v_mfma_f32_16x16x32_bf16 v[112:115], v[120:123], a[0:3], v[112:115]
    ds_read_b64_tr_b16 a[12:13], v43 offset:18432
    ds_read_b64_tr_b16 a[14:15], v43 offset:18944
    s_waitcnt lgkmcnt(4)
    v_mfma_f32_16x16x32_bf16 v[116:119], v[120:123], a[4:7], v[116:119]
    ds_read_b64_tr_b16 a[16:17], v42 offset:20480
    ds_read_b64_tr_b16 a[18:19], v42 offset:20992
    s_waitcnt lgkmcnt(4)
    v_mfma_f32_16x16x32_bf16 v[112:115], v[120:123], a[8:11], v[112:115]
    ds_read_b64_tr_b16 a[20:21], v43 offset:20480
    buffer_load_dwordx4 v41, s[28:31], s63 offen offset:1024 lds
    ds_read_b64_tr_b16 a[22:23], v43 offset:20992
    s_waitcnt lgkmcnt(4)
    v_mfma_f32_16x16x32_bf16 v[116:119], v[120:123], a[12:15], v[116:119]
    ds_read_b64_tr_b16 a[24:25], v42 offset:22528
    ds_read_b64_tr_b16 a[26:27], v42 offset:23040
    s_waitcnt lgkmcnt(4)
    v_mfma_f32_16x16x32_bf16 v[112:115], v[120:123], a[16:19], v[112:115]
    ds_read_b64_tr_b16 a[28:29], v43 offset:22528
    ds_read_b64_tr_b16 a[30:31], v43 offset:23040
    s_waitcnt lgkmcnt(4)
    v_mfma_f32_16x16x32_bf16 v[116:119], v[120:123], a[20:23], v[116:119]
    s_add_u32 m0, s62, 14336
    s_add_u32 s63, s76, 172032
    buffer_load_dwordx4 v40, s[28:31], s63 offen offset:0 lds
    ds_read_b64_tr_b16 a[96:97], v42 offset:0
    ds_read_b64_tr_b16 a[98:99], v42 offset:512
    s_waitcnt lgkmcnt(4)
    v_mfma_f32_16x16x32_bf16 v[112:115], v[120:123], a[24:27], v[112:115]
    ds_read_b64_tr_b16 a[100:101], v43 offset:0
    ds_read_b64_tr_b16 a[102:103], v43 offset:512
    s_waitcnt lgkmcnt(4)
    v_mfma_f32_16x16x32_bf16 v[116:119], v[120:123], a[28:31], v[116:119]
    ds_read_b64_tr_b16 a[104:105], v42 offset:2048
    ds_read_b64_tr_b16 a[106:107], v42 offset:2560
    buffer_load_dwordx4 v41, s[28:31], s63 offen offset:1024 lds
    s_waitcnt lgkmcnt(4)
    v_mfma_f32_16x16x32_bf16 v[112:115], v[120:123], a[96:99], v[112:115]
    ds_read_b64_tr_b16 a[108:109], v43 offset:2048
    ds_read_b64_tr_b16 a[110:111], v43 offset:2560
    s_waitcnt lgkmcnt(4)
    v_mfma_f32_16x16x32_bf16 v[116:119], v[120:123], a[100:103], v[116:119]
    ds_read_b64_tr_b16 a[112:113], v42 offset:4096
    ds_read_b64_tr_b16 a[114:115], v42 offset:4608
    s_waitcnt lgkmcnt(4)
    v_mfma_f32_16x16x32_bf16 v[112:115], v[120:123], a[104:107], v[112:115]
    ds_read_b64_tr_b16 a[116:117], v43 offset:4096
    s_add_u32 m0, s62, 16384
    s_add_u32 s63, s77, 0
    buffer_load_dwordx4 v40, s[28:31], s63 offen offset:0 lds
    ds_read_b64_tr_b16 a[118:119], v43 offset:4608
    s_waitcnt lgkmcnt(4)
    v_mfma_f32_16x16x32_bf16 v[116:119], v[120:123], a[108:111], v[116:119]
    ds_read_b64_tr_b16 a[120:121], v42 offset:6144
    ds_read_b64_tr_b16 a[122:123], v42 offset:6656
    s_waitcnt lgkmcnt(4)
    v_mfma_f32_16x16x32_bf16 v[112:115], v[120:123], a[112:115], v[112:115]
    ds_read_b64_tr_b16 a[124:125], v43 offset:6144
    ds_read_b64_tr_b16 a[126:127], v43 offset:6656
    s_waitcnt lgkmcnt(4)
    v_mfma_f32_16x16x32_bf16 v[116:119], v[120:123], a[116:119], v[116:119]
    buffer_load_dwordx4 v41, s[28:31], s63 offen offset:1024 lds
    s_add_u32 m0, s62, 18432
    s_add_u32 s63, s77, 57344
    buffer_load_dwordx4 v40, s[28:31], s63 offen offset:0 lds
    buffer_load_dwordx4 v41, s[28:31], s63 offen offset:1024 lds
    s_waitcnt vmcnt(8)
    v_bitop3_b32 v104, v98, v102, s59 bitop3:0x7e
    v_bitop3_b32 v104, v99, v104, s59 bitop3:0xde
    v_bitop3_b32 v104, v103, v104, s59 bitop3:0xde
    v_cmp_ne_u32 vcc, 0, v104
    s_cbranch_vccnz Lrt_34
Lck_33:
    s_add_u32 m0, s87, 1024
    s_add_u32 s57, s66, 4290316288
    buffer_load_dwordx4 v1, s[20:23], s57 offen sc1 lds
    ds_read_b64_tr_b16 a[128:129], v42 offset:8192
    ds_read_b64_tr_b16 a[130:131], v42 offset:8704
    s_waitcnt lgkmcnt(4)
    v_mfma_f32_16x16x32_bf16 v[112:115], v[120:123], a[120:123], v[112:115]
    s_add_u32 m0, s87, 2048
    s_add_u32 s57, s67, 4290316288
    buffer_load_dwordx4 v1, s[20:23], s57 offen sc1 lds
    ds_read_b64_tr_b16 a[132:133], v43 offset:8192
    ds_read_b64_tr_b16 a[134:135], v43 offset:8704
    s_waitcnt lgkmcnt(4)
    v_mfma_f32_16x16x32_bf16 v[116:119], v[120:123], a[124:127], v[116:119]
    s_add_u32 m0, s87, 3072
    s_add_u32 s57, s68, 4290316288
    buffer_load_dwordx4 v1, s[20:23], s57 offen sc1 lds
    ds_read_b64_tr_b16 a[136:137], v42 offset:10240
    ds_read_b64_tr_b16 a[138:139], v42 offset:10752
    s_waitcnt lgkmcnt(4)
    v_mfma_f32_16x16x32_bf16 v[112:115], v[120:123], a[128:131], v[112:115]
    s_add_u32 m0, s87, 4096
    s_add_u32 s57, s69, 4290316288
    buffer_load_dwordx4 v1, s[20:23], s57 offen sc1 lds
    ds_read_b64_tr_b16 a[140:141], v43 offset:10240
    ds_read_b64_tr_b16 a[142:143], v43 offset:10752
    s_waitcnt lgkmcnt(4)
    v_mfma_f32_16x16x32_bf16 v[116:119], v[120:123], a[132:135], v[116:119]
    s_add_u32 m0, s87, 5120
    s_add_u32 s57, s70, 4290316288
    buffer_load_dwordx4 v1, s[20:23], s57 offen sc1 lds
    s_add_u32 m0, s87, 6144
    s_add_u32 s57, s71, 4290316288
    buffer_load_dwordx4 v1, s[20:23], s57 offen sc1 lds
    s_add_u32 m0, s62, 20480
    s_add_u32 s63, s77, 114688
    buffer_load_dwordx4 v40, s[28:31], s63 offen offset:0 lds
    buffer_load_dwordx4 v41, s[28:31], s63 offen offset:1024 lds
    s_add_u32 m0, s62, 22528
    s_add_u32 s63, s77, 172032
    buffer_load_dwordx4 v40, s[28:31], s63 offen offset:0 lds
    buffer_load_dwordx4 v41, s[28:31], s63 offen offset:1024 lds
    s_waitcnt vmcnt(8)
    ds_read2st64_b32 v[46:47], v50 offset0:4 offset1:8
    s_waitcnt lgkmcnt(0)
    v_max_u32 v46, v46, v47
    v_cmp_eq_u32 vcc, -1, v46
    s_cbranch_vccnz Lzr_68
Lzc_67:
    s_barrier
    ds_read_b128 v[128:131], v4 offset:0
    ds_read_b128 v[132:135], v4 offset:256
    ds_read_b128 v[136:139], v4 offset:512
    ds_read_b128 v[140:143], v4 offset:768
    ds_read_b128 v[144:147], v4 offset:1024
    ds_read_b128 v[148:151], v4 offset:1280
    ds_read_b128 v[152:155], v4 offset:1536
    s_waitcnt lgkmcnt(6)
    v_mfma_f32_32x32x16_bf16 v[64:79], a[0:3], v[128:131], 0
    s_waitcnt lgkmcnt(5)
    ds_read_b128 v[156:159], v4 offset:1792
    ds_read_b64_tr_b16 a[144:145], v42 offset:12288
    ds_read_b64_tr_b16 a[146:147], v42 offset:12800
    ds_read_b64_tr_b16 a[148:149], v43 offset:12288
    ds_read_b64_tr_b16 a[150:151], v43 offset:12800
    v_mfma_f32_16x16x32_bf16 v[112:115], v[120:123], a[136:139], v[112:115]
    s_add_u32 m0, s62, 0
    s_add_u32 s63, s78, 0
    buffer_load_dwordx4 v40, s[28:31], s63 offen offset:0 lds
    buffer_load_dwordx4 v41, s[28:31], s63 offen offset:1024 lds
    v_mfma_f32_16x16x32_bf16 v[116:119], v[120:123], a[140:143], v[116:119]
    v_mfma_f32_32x32x16_bf16 v[64:79], a[8:11], v[132:135], v[64:79]
    s_waitcnt vmcnt(6) lgkmcnt(8)
    ds_read_b128 v[128:131], v4 offset:2048
    ds_read2st64_b32 v[46:47], v50 offset0:12 offset1:16
    ds_read2st64_b32 v[48:49], v50 offset0:20 offset1:24
    v_mfma_f32_32x32x16_bf16 v[64:79], a[16:19], v[136:139], v[64:79]
    s_add_u32 m0, s62, 2048
    s_add_u32 s63, s78, 57344
    ds_read_b128 v[132:135], v4 offset:2304
    buffer_load_dwordx4 v40, s[28:31], s63 offen offset:0 lds
    buffer_load_dwordx4 v41, s[28:31], s63 offen offset:1024 lds
    ds_read_b64_tr_b16 a[152:153], v42 offset:14336
    v_mfma_f32_32x32x16_bf16 v[64:79], a[24:27], v[140:143], v[64:79]
    s_waitcnt lgkmcnt(2)
    ds_read_b128 v[136:139], v4 offset:2560
    ds_read_b64_tr_b16 a[154:155], v42 offset:14848
    ds_read_b64_tr_b16 a[156:157], v43 offset:14336
    v_max3_u32 v47, v47, v48, v49
    v_max_u32 v46, v46, v47
    v_cmp_eq_u32 vcc, -1, v46
    v_mfma_f32_16x16x32_bf16 v[112:115], v[120:123], a[144:147], v[112:115]
    ds_read_b64_tr_b16 a[158:159], v43 offset:14848
    v_mfma_f32_16x16x32_bf16 v[116:119], v[120:123], a[148:151], v[116:119]
    s_add_u32 m0, s62, 4096
    s_add_u32 s63, s78, 114688
    buffer_load_dwordx4 v40, s[28:31], s63 offen offset:0 lds
    buffer_load_dwordx4 v41, s[28:31], s63 offen offset:1024 lds
    v_mfma_f32_32x32x16_bf16 v[64:79], a[32:35], v[144:147], v[64:79]
    ds_read_b128 v[140:143], v4 offset:2816
    s_cbranch_vccnz Lzr_70
Lzc_69:
    s_barrier
    v_mfma_f32_32x32x16_bf16 v[64:79], a[40:43], v[148:151], v[64:79]
    s_waitcnt lgkmcnt(1)
    s_add_u32 m0, s62, 6144
    s_add_u32 s63, s78, 172032
    ds_read_b128 v[144:147], v4 offset:3072
    buffer_load_dwordx4 v40, s[28:31], s63 offen offset:0 lds
    buffer_load_dwordx4 v41, s[28:31], s63 offen offset:1024 lds
    ds_read_b64_tr_b16 a[160:161], v42 offset:16384
    v_mfma_f32_16x16x32_bf16 v[112:115], v[120:123], a[152:155], v[112:115]
    ds_read_b64_tr_b16 a[162:163], v42 offset:16896
    ds_read_b64_tr_b16 a[164:165], v43 offset:16384
    v_mfma_f32_16x16x32_bf16 v[116:119], v[120:123], a[156:159], v[116:119]
    ds_read_b64_tr_b16 a[166:167], v43 offset:16896
    v_mfma_f32_32x32x16_bf16 v[64:79], a[48:51], v[152:155], v[64:79]
    s_add_u32 m0, s87, 9216
    s_add_u32 s57, s66, 4290317312
    ds_read_b128 v[148:151], v4 offset:3328
    buffer_load_dwordx4 v1, s[20:23], s57 offen sc1 lds
    ds_read_b64_tr_b16 a[168:169], v42 offset:18432
    ds_read_b64_tr_b16 a[170:171], v42 offset:18944
    v_mfma_f32_32x32x16_bf16 v[64:79], a[56:59], v[156:159], v[64:79]
    s_waitcnt lgkmcnt(3)
    ds_read_b128 v[152:155], v4 offset:3584
    ds_read_b64_tr_b16 a[172:173], v43 offset:18432
    ds_read_b64_tr_b16 a[174:175], v43 offset:18944
    v_mfma_f32_16x16x32_bf16 v[112:115], v[120:123], a[160:163], v[112:115]
    v_mfma_f32_16x16x32_bf16 v[116:119], v[120:123], a[164:167], v[116:119]
    v_mfma_f32_32x32x16_bf16 v[64:79], a[64:67], v[128:131], v[64:79]
    s_waitcnt vmcnt(11)
    ds_read_b128 v[156:159], v4 offset:3840
    ds_read_b64_tr_b16 a[176:177], v42 offset:20480
    ds_read_b64_tr_b16 a[178:179], v42 offset:20992
    ds_read_b64_tr_b16 a[180:181], v43 offset:20480
    ds_read_b64_tr_b16 a[182:183], v43 offset:20992
    v_add_f32_dpp v96, v100, v96 quad_perm:[0,1,2,3] row_mask:0xf bank_mask:0x3
    v_mfma_f32_32x32x16_bf16 v[64:79], a[72:75], v[132:135], v[64:79]
    s_waitcnt lgkmcnt(5)
    s_add_u32 m0, s87, 10240
    s_add_u32 s57, s67, 4290317312
    ds_read_b128 v[128:131], v4 offset:4096
    buffer_load_dwordx4 v1, s[20:23], s57 offen sc1 lds
    v_add_f32_dpp v97, v101, v97 quad_perm:[0,1,2,3] row_mask:0xf bank_mask:0x3
    v_add_f32_dpp v96, v100, v96 quad_perm:[0,1,2,3] row_mask:0x5 bank_mask:0xc
    v_mfma_f32_16x16x32_bf16 v[112:115], v[120:123], a[168:171], v[112:115]
    v_add_f32_dpp v97, v101, v97 quad_perm:[0,1,2,3] row_mask:0x5 bank_mask:0xc
    v_add_f32_dpp v96, v96, v96 row_ror:8 row_mask:0xf bank_mask:0xf
    v_mfma_f32_16x16x32_bf16 v[116:119], v[120:123], a[172:175], v[116:119]
    v_add_f32_dpp v97, v97, v97 row_ror:8 row_mask:0xf bank_mask:0xf
    v_mov_b32 v98, v96
    v_mfma_f32_32x32x16_bf16 v[64:79], a[80:83], v[136:139], v[64:79]
    s_waitcnt vmcnt(10)
    ds_read_b128 v[132:135], v4 offset:4352
    ds_read_b64_tr_b16 a[184:185], v42 offset:22528
    ds_read_b64_tr_b16 a[186:187], v42 offset:23040
    ds_read_b64_tr_b16 a[188:189], v43 offset:22528
    ds_read_b64_tr_b16 a[190:191], v43 offset:23040
    v_mov_b32 v99, v97
    v_mfma_f32_32x32x16_bf16 v[64:79], a[88:91], v[140:143], v[64:79]
    s_waitcnt lgkmcnt(6)
    ds_read_b128 v[136:139], v4 offset:4608
    v_permlane16_swap_b32 v96, v98
    v_permlane16_swap_b32 v97, v99
    v_add_f32 v96, v96, v98
    v_mfma_f32_16x16x32_bf16 v[112:115], v[120:123], a[176:179], v[112:115]
    v_add_f32 v97, v97, v99
    v_mov_b32 v98, v96
    v_mfma_f32_16x16x32_bf16 v[116:119], v[120:123], a[180:183], v[116:119]
    v_mov_b32 v99, v97
    v_mfma_f32_32x32x16_bf16 v[64:79], a[96:99], v[144:147], v[64:79]
    s_add_u32 m0, s87, 11264
    s_add_u32 s57, s68, 4290317312
    ds_read_b128 v[140:143], v4 offset:4864
    buffer_load_dwordx4 v1, s[20:23], s57 offen sc1 lds
    v_permlane32_swap_b32 v96, v98
    v_mfma_f32_32x32x16_bf16 v[64:79], a[104:107], v[148:151], v[64:79]
    s_waitcnt lgkmcnt(2)
    ds_read_b128 v[144:147], v4 offset:5120
    v_permlane32_swap_b32 v97, v99
    v_and_b32 v110, 0x270, v1
    v_add_u32 v110, s95, v110
    v_mul_f32 v104, 0xbb124925, v96
    v_mfma_f32_16x16x32_bf16 v[112:115], v[120:123], a[184:187], v[112:115]
    v_mul_f32 v105, 0xbb124925, v97
    v_fmaak_f32 v106, v104, v104, 0xaedbe66f
    v_mfma_f32_16x16x32_bf16 v[116:119], v[120:123], a[188:191], v[116:119]
    v_fmaak_f32 v107, v105, v105, 0xaedbe66f
    v_fmac_f32 v106, 0xbb124925, v98
    v_mfma_f32_32x32x16_bf16 v[64:79], a[112:115], v[152:155], v[64:79]
    s_waitcnt vmcnt(9)
    ds_read_b128 v[148:151], v4 offset:5376
    ds_read_b64_tr_b16 a[192:193], v42 offset:0
    ds_read_b64_tr_b16 a[194:195], v42 offset:512
    ds_read_b64_tr_b16 a[196:197], v43 offset:0
    ds_read_b64_tr_b16 a[198:199], v43 offset:512
    v_fmac_f32 v107, 0xbb124925, v99
    v_mfma_f32_32x32x16_bf16 v[64:79], a[120:123], v[156:159], v[64:79]
    s_add_u32 m0, s87, 12288
    s_add_u32 s57, s69, 4290317312
    ds_read_b128 v[152:155], v4 offset:5632
    buffer_load_dwordx4 v1, s[20:23], s57 offen sc1 lds
    v_rsq_f32_e64 v108, |v106|
    v_mfma_f32_32x32x16_bf16 v[64:79], a[128:131], v[128:131], v[64:79]
    s_waitcnt vmcnt(8)
    ds_read_b128 v[156:159], v4 offset:5888
    ds_read_b64_tr_b16 a[200:201], v42 offset:2048
    ds_read_b64_tr_b16 a[202:203], v42 offset:2560
    ds_read_b64_tr_b16 a[204:205], v43 offset:2048
    ds_read_b64_tr_b16 a[206:207], v43 offset:2560
    v_mfma_f32_32x32x16_bf16 v[64:79], a[136:139], v[132:135], v[64:79]
    s_waitcnt lgkmcnt(6)
    ds_read_b128 v[128:131], v4 offset:6144
    v_rsq_f32_e64 v109, |v107|
    v_mul_f32_e64 v106, |v106|, v108
    v_mul_f32_e64 v107, |v107|, v109
    v_mul_f32 v100, 0xbeeff509, v108
    v_mfma_f32_16x16x32_bf16 v[112:115], v[120:123], a[192:195], v[112:115]
    v_mul_f32 v102, 0xbeeff509, v109
    v_mov_b32_dpp v106, v104 quad_perm:[0,1,2,3] row_mask:0x3 bank_mask:0xf
    v_mfma_f32_16x16x32_bf16 v[116:119], v[120:123], a[196:199], v[116:119]
    v_mov_b32_dpp v107, v105 quad_perm:[0,1,2,3] row_mask:0x3 bank_mask:0xf
    v_cvt_pk_bf16_f32 v108, v106, v106
    v_mfma_f32_32x32x16_bf16 v[64:79], a[144:147], v[136:139], v[64:79]
    s_waitcnt vmcnt(6)
    s_add_u32 m0, s87, 13312
    s_add_u32 s57, s70, 4290317312
    ds_read_b128 v[132:135], v4 offset:6400
    buffer_load_dwordx4 v1, s[20:23], s57 offen sc1 lds
    ds_read_b64_tr_b16 a[208:209], v42 offset:4096
    ds_read_b64_tr_b16 a[210:211], v42 offset:4608
    v_mfma_f32_32x32x16_bf16 v[64:79], a[152:155], v[140:143], v[64:79]
    s_waitcnt lgkmcnt(4)
    ds_read_b128 v[136:139], v4 offset:6656
    ds_read_b64_tr_b16 a[212:213], v43 offset:4096
    ds_read_b64_tr_b16 a[214:215], v43 offset:4608
    v_cvt_pk_bf16_f32 v109, v107, v107
    v_lshlrev_b32 v108, 16, v108
    v_lshlrev_b32 v109, 16, v109
    v_mfma_f32_16x16x32_bf16 v[112:115], v[120:123], a[200:203], v[112:115]
    v_sub_f32 v108, v106, v108
    v_sub_f32 v109, v107, v109
    v_mfma_f32_16x16x32_bf16 v[116:119], v[120:123], a[204:207], v[116:119]
    v_cvt_pk_bf16_f32 v101, v106, v108
    v_cvt_pk_bf16_f32 v103, v107, v109
    v_mfma_f32_32x32x16_bf16 v[64:79], a[160:163], v[144:147], v[64:79]
    s_waitcnt vmcnt(5)
    ds_read_b128 v[140:143], v4 offset:6912
    ds_write_b128 v110, v[100:103]
    ds_read_b64_tr_b16 a[216:217], v42 offset:6144
    ds_read_b64_tr_b16 a[218:219], v42 offset:6656
    ds_read_b64_tr_b16 a[220:221], v43 offset:6144
    ds_read_b64_tr_b16 a[222:223], v43 offset:6656
    v_mfma_f32_32x32x16_bf16 v[64:79], a[168:171], v[148:151], v[64:79]
    s_waitcnt lgkmcnt(6)
    s_add_u32 m0, s87, 14336
    s_add_u32 s57, s71, 4290317312
    s_add_u32 s72, s72, s61
    s_add_u32 s73, s73, s61
    ds_read_b128 v[144:147], v4 offset:0
    buffer_load_dwordx4 v1, s[20:23], s57 offen sc1 lds
    v_mfma_f32_16x16x32_bf16 v[112:115], v[120:123], a[208:211], v[112:115]
    s_add_u32 s74, s74, s61
    s_add_u32 s75, s75, s61
    s_add_u32 s76, s76, s61
    v_mfma_f32_16x16x32_bf16 v[116:119], v[120:123], a[212:215], v[116:119]
    s_add_u32 s77, s77, s61
    s_add_u32 s78, s78, s61
    v_mfma_f32_32x32x16_bf16 v[64:79], a[176:179], v[152:155], v[64:79]
    s_add_u32 m0, s62, 8192
    s_add_u32 s63, s72, 0
    ds_read_b128 v[148:151], v4 offset:256
    buffer_load_dwordx4 v38, s[32:35], s63 offen offset:0 lds
    buffer_load_dwordx4 v39, s[32:35], s63 offen offset:1024 lds
    v_mfma_f32_32x32x16_bf16 v[64:79], a[184:187], v[156:159], v[64:79]
    s_waitcnt lgkmcnt(2)
    s_add_u32 m0, s62, 10240
    s_add_u32 s63, s72, 14336
    ds_read_b128 v[152:155], v4 offset:512
    buffer_load_dwordx4 v38, s[32:35], s63 offen offset:0 lds
    buffer_load_dwordx4 v39, s[32:35], s63 offen offset:1024 lds
    v_add_u32 v96, 161792, v1
    v_mfma_f32_16x16x32_bf16 v[112:115], v[120:123], a[216:219], v[112:115]
    v_mfma_f32_16x16x32_bf16 v[116:119], v[120:123], a[220:223], v[116:119]
    v_mfma_f32_32x32x16_bf16 v[64:79], a[192:195], v[128:131], v[64:79]
    ds_read_b128 v[156:159], v4 offset:768
    s_barrier
    ds_read_b128 v[52:55], v96
    s_nop 2
    v_permlane32_swap_b32 v112, v34
    s_nop 1
    v_mov_b32_dpp v34, v116 quad_perm:[0,1,2,3] row_mask:0x3 bank_mask:0xf
    v_cvt_pk_bf16_f32 v56, v112, v112
    v_cvt_pk_bf16_f32 v58, v34, v34
    v_mfma_f32_32x32x16_bf16 v[64:79], a[200:203], v[132:135], v[64:79]
    ds_read_b128 v[128:131], v4 offset:1024
    v_lshlrev_b32 v113, 16, v56
    v_lshlrev_b32 v117, 16, v58
    v_sub_f32 v113, v112, v113
    v_sub_f32 v117, v34, v117
    v_mfma_f32_32x32x16_bf16 v[64:79], a[208:211], v[136:139], v[64:79]
    s_waitcnt lgkmcnt(1)
    ds_read_b128 v[132:135], v4 offset:1280
    v_cvt_pk_bf16_f32 v57, v113, 0
    v_cvt_pk_bf16_f32 v59, v117, 0
    v_cvt_pk_bf16_f32 v5, v112, v113
    v_cvt_pk_bf16_f32 v7, v34, v117
    v_mfma_f32_32x32x16_bf16 v[64:79], a[216:219], v[140:143], v[64:79]
    ds_read_b128 v[136:139], v4 offset:1536
    v_mov_b32 v60, v53
    v_mov_b32 v61, v53
    s_nop 1
    v_mfma_f32_32x32x16_bf16 v[64:79], v[56:59], v[60:63], v[64:79]
    s_add_u32 m0, s62, 12288
    s_add_u32 s63, s73, 0
    buffer_load_dwordx4 v38, s[32:35], s63 offen offset:0 lds
    buffer_load_dwordx4 v39, s[32:35], s63 offen offset:1024 lds
    v_mfma_f32_32x32x16_bf16 v[80:95], a[4:7], v[144:147], 0
    ds_read_b128 v[140:143], v4 offset:1792
    v_mfma_f32_32x32x16_bf16 v[80:95], a[12:15], v[148:151], v[80:95]
    s_add_u32 m0, s62, 14336
    s_add_u32 s63, s73, 14336
    ds_read_b128 v[144:147], v4 offset:2048
    buffer_load_dwordx4 v38, s[32:35], s63 offen offset:0 lds
    buffer_load_dwordx4 v39, s[32:35], s63 offen offset:1024 lds
    v_mfma_f32_32x32x16_bf16 v[80:95], a[20:23], v[152:155], v[80:95]
    s_add_u32 s92, s65, 0
    ds_read_b128 v[148:151], v4 offset:2304
    v_mul_f32 v64, v52, v64
    v_mul_f32 v65, v52, v65
    v_fma_f32 v34, v64, v64, s91
    v_fma_f32 v35, v65, v65, s91
    v_mul_f32 v34, v34, v64
    v_mul_f32 v35, v35, v65
    v_mfma_f32_32x32x16_bf16 v[80:95], a[28:31], v[156:159], v[80:95]
    s_waitcnt lgkmcnt(4)
    ds_read_b128 v[152:155], v4 offset:2560
    v_mul_f32 v66, v52, v66
    v_exp_f32 v34, v34
    v_mul_f32 v67, v52, v67
    v_exp_f32 v35, v35
    v_fma_f32 v36, v66, v66, s91
    v_mfma_f32_32x32x16_bf16 v[80:95], a[36:39], v[128:131], v[80:95]
    s_add_u32 m0, s62, 16384
    s_add_u32 s63, s74, 0
    ds_read_b128 v[156:159], v4 offset:2816
    buffer_load_dwordx4 v38, s[32:35], s63 offen offset:0 lds
    buffer_load_dwordx4 v39, s[32:35], s63 offen offset:1024 lds
    v_add_f32 v34, 1.0, v34
    v_fma_f32 v37, v67, v67, s91
    v_add_f32 v35, 1.0, v35
    v_mfma_f32_32x32x16_bf16 v[80:95], a[44:47], v[132:135], v[80:95]
    s_waitcnt lgkmcnt(4)
    ds_read_b128 v[128:131], v4 offset:3072
    v_mul_f32 v36, v36, v66
    v_rcp_f32 v34, v34
    v_mul_f32 v37, v37, v67
    v_rcp_f32 v35, v35
    v_mul_f32 v34, v34, v64
    v_mfma_f32_32x32x16_bf16 v[80:95], a[52:55], v[136:139], v[80:95]
    ds_read_b128 v[132:135], v4 offset:3328
    v_exp_f32 v36, v36
    v_exp_f32 v37, v37
    v_mul_f32 v35, v35, v65
    v_add_f32 v36, 1.0, v36
    v_cvt_pk_bf16_f32 v64, v34, v35
    v_mfma_f32_32x32x16_bf16 v[80:95], a[60:63], v[140:143], v[80:95]
    s_waitcnt lgkmcnt(4)
    s_add_u32 m0, s62, 18432
    s_add_u32 s63, s74, 14336
    ds_read_b128 v[136:139], v4 offset:3584
    buffer_load_dwordx4 v38, s[32:35], s63 offen offset:0 lds
    buffer_load_dwordx4 v39, s[32:35], s63 offen offset:1024 lds
    v_add_f32 v37, 1.0, v37
    v_mul_f32 v68, v52, v68
    v_mfma_f32_32x32x16_bf16 v[80:95], a[68:71], v[144:147], v[80:95]
    ds_read_b128 v[140:143], v4 offset:3840
    v_rcp_f32 v36, v36
    v_mul_f32 v69, v52, v69
    v_rcp_f32 v37, v37
    v_fma_f32 v34, v68, v68, s91
    v_mul_f32 v36, v36, v66
    v_mfma_f32_32x32x16_bf16 v[80:95], a[76:79], v[148:151], v[80:95]
    s_waitcnt lgkmcnt(4)
    ds_read_b128 v[144:147], v4 offset:4096
    v_fma_f32 v35, v69, v69, s91
    v_mul_f32 v37, v37, v67
    v_mul_f32 v34, v34, v68
    v_cvt_pk_bf16_f32 v65, v36, v37
    v_mul_f32 v35, v35, v69
    v_mul_f32 v70, v52, v70
    v_mul_f32 v71, v52, v71
    v_mfma_f32_32x32x16_bf16 v[80:95], a[84:87], v[152:155], v[80:95]
    s_add_u32 m0, s62, 20480
    s_add_u32 s63, s75, 0
    ds_read_b128 v[148:151], v4 offset:4352
    buffer_load_dwordx4 v38, s[32:35], s63 offen offset:0 lds
    buffer_load_dwordx4 v39, s[32:35], s63 offen offset:1024 lds
    v_exp_f32 v34, v34
    v_fma_f32 v36, v70, v70, s91
    v_mfma_f32_32x32x16_bf16 v[80:95], a[92:95], v[156:159], v[80:95]
    s_waitcnt lgkmcnt(4)
    ds_read_b128 v[152:155], v4 offset:4608
    v_exp_f32 v35, v35
    v_add_f32 v34, 1.0, v34
    v_fma_f32 v37, v71, v71, s91
    v_add_f32 v35, 1.0, v35
    v_mul_f32 v36, v36, v70
    v_mul_f32 v37, v37, v71
    v_mfma_f32_32x32x16_bf16 v[80:95], a[100:103], v[128:131], v[80:95]
    ds_read_b128 v[156:159], v4 offset:4864
    v_rcp_f32 v34, v34
    v_rcp_f32 v35, v35
    v_exp_f32 v36, v36
    v_mfma_f32_32x32x16_bf16 v[80:95], a[108:111], v[132:135], v[80:95]
    s_waitcnt lgkmcnt(4)
    s_add_u32 m0, s62, 22528
    s_add_u32 s63, s75, 14336
    ds_read_b128 v[128:131], v4 offset:5120
    buffer_load_dwordx4 v38, s[32:35], s63 offen offset:0 lds
    buffer_load_dwordx4 v39, s[32:35], s63 offen offset:1024 lds
    v_mul_f32 v34, v34, v68
    v_exp_f32 v37, v37
    v_mfma_f32_32x32x16_bf16 v[80:95], a[116:119], v[136:139], v[80:95]
    ds_read_b128 v[132:135], v4 offset:5376
    v_mul_f32 v35, v35, v69
    v_add_f32 v36, 1.0, v36
    v_cvt_pk_bf16_f32 v66, v34, v35
    v_add_f32 v37, 1.0, v37
    v_mul_f32 v72, v52, v72
    v_rcp_f32 v36, v36
    v_mfma_f32_32x32x16_bf16 v[80:95], a[124:127], v[140:143], v[80:95]
    s_waitcnt lgkmcnt(4)
    ds_read_b128 v[136:139], v4 offset:5632
    v_mul_f32 v73, v52, v73
    v_rcp_f32 v37, v37
    v_fma_f32 v34, v72, v72, s91
    v_mul_f32 v36, v36, v70
    v_fma_f32 v35, v73, v73, s91
    v_mul_f32 v37, v37, v71
    v_mfma_f32_32x32x16_bf16 v[80:95], a[132:135], v[144:147], v[80:95]
L_i2389:
    s_cbranch_execz L_i5038
    s_add_u32 m0, s62, 0
    s_add_u32 s63, s76, 0
    ds_read_b128 v[140:143], v4 offset:5888
    buffer_load_dwordx4 v38, s[32:35], s63 offen offset:0 lds
    buffer_load_dwordx4 v39, s[32:35], s63 offen offset:1024 lds
    v_mul_f32 v34, v34, v72
    v_cvt_pk_bf16_f32 v67, v36, v37
    v_mul_f32 v35, v35, v73
    v_mfma_f32_32x32x16_bf16 v[80:95], a[140:143], v[148:151], v[80:95]
    s_waitcnt lgkmcnt(4)
    ds_read_b128 v[144:147], v4 offset:6144
    buffer_store_dwordx4 v[64:67], v1, s[20:23], s92 offen offset:0
    v_mul_f32 v74, v52, v74
    v_exp_f32 v34, v34
    v_mul_f32 v75, v52, v75
    v_fma_f32 v36, v74, v74, s91
    v_mfma_f32_32x32x16_bf16 v[80:95], a[148:151], v[152:155], v[80:95]
    ds_read_b128 v[148:151], v4 offset:6400
    v_exp_f32 v35, v35
    v_add_f32 v34, 1.0, v34
    v_fma_f32 v37, v75, v75, s91
    v_add_f32 v35, 1.0, v35
    v_mul_f32 v36, v36, v74
    v_mul_f32 v37, v37, v75
    v_mfma_f32_32x32x16_bf16 v[80:95], a[156:159], v[156:159], v[80:95]
    s_waitcnt lgkmcnt(4)
    ds_read_b128 v[152:155], v4 offset:6656
    v_rcp_f32 v34, v34
    v_rcp_f32 v35, v35
    v_exp_f32 v36, v36
    v_mul_f32 v34, v34, v72
    v_mfma_f32_32x32x16_bf16 v[80:95], a[164:167], v[128:131], v[80:95]
    s_waitcnt vmcnt(17)
    ds_read_b128 v[156:159], v4 offset:6912
    ds_read_b64_tr_b16 a[224:225], v8 offset:8192
    ds_read_b64_tr_b16 a[226:227], v8 offset:9216
    ds_read_b64_tr_b16 a[228:229], v9 offset:8192
    ds_read_b64_tr_b16 a[230:231], v9 offset:9216
    v_exp_f32 v37, v37
    v_mul_f32 v35, v35, v73
    v_mfma_f32_32x32x16_bf16 v[80:95], a[172:175], v[132:135], v[80:95]
    s_waitcnt vmcnt(15) lgkmcnt(8)
    s_add_u32 m0, s62, 2048
    s_add_u32 s63, s76, 14336
    buffer_load_dwordx4 v38, s[32:35], s63 offen offset:0 lds
    buffer_load_dwordx4 v39, s[32:35], s63 offen offset:1024 lds
    ds_read_b64_tr_b16 a[232:233], v8 offset:10240
    ds_read_b64_tr_b16 a[234:235], v8 offset:11264
    ds_read_b64_tr_b16 a[236:237], v9 offset:10240
    ds_read_b64_tr_b16 a[238:239], v9 offset:11264
    v_mfma_f32_32x32x16_bf16 v[80:95], a[180:183], v[136:139], v[80:95]
    s_add_u32 m0, s62, 4096
    s_add_u32 s63, s77, 0
    ds_read2st64_b32 v[40:41], v50 offset0:36 offset1:40
    ds_read2st64_b32 v[42:43], v50 offset0:44 offset1:48
    ds_read2st64_b32 v[44:45], v50 offset0:52 offset1:56
    buffer_load_dwordx4 v38, s[32:35], s63 offen offset:0 lds
    buffer_load_dwordx4 v39, s[32:35], s63 offen offset:1024 lds
    v_mfma_f32_32x32x16_bf16 v[80:95], a[188:191], v[140:143], v[80:95]
    s_waitcnt lgkmcnt(13)
    v_add_f32 v36, 1.0, v36
    v_cvt_pk_bf16_f32 v68, v34, v35
    v_add_f32 v37, 1.0, v37
    v_mul_f32 v76, v52, v76
    v_rcp_f32 v36, v36
    v_mul_f32 v77, v52, v77
    v_fma_f32 v34, v76, v76, s91
    v_mfma_f32_32x32x16_bf16 v[80:95], a[196:199], v[144:147], v[80:95]
    s_waitcnt lgkmcnt(0)
    v_max3_u32 v41, v41, v42, v43
    v_max3_u32 v40, v40, v44, v45
    v_max_u32 v40, v40, v41
    v_cmp_eq_u32 vcc, -1, v40
    v_rcp_f32 v37, v37
    v_mul_f32 v36, v36, v74
    v_fma_f32 v35, v77, v77, s91
    v_mfma_f32_32x32x16_bf16 v[80:95], a[204:207], v[148:151], v[80:95]
    s_waitcnt vmcnt(17)
    ds_read_b64_tr_b16 v[160:161], v8 offset:12288
    ds_read_b64_tr_b16 v[162:163], v8 offset:13312
    ds_read_b64_tr_b16 v[164:165], v9 offset:12288
    ds_read_b64_tr_b16 v[166:167], v9 offset:13312
    s_cbranch_vccnz Lzr_72
Lzc_71:
    s_barrier
    v_mul_f32 v37, v37, v75
    v_mfma_f32_32x32x16_bf16 v[80:95], a[212:215], v[152:155], v[80:95]
    s_add_u32 m0, s62, 6144
    s_add_u32 s63, s77, 14336
    ds_read_b128 v[128:131], v4 offset:8192
    ds_read_b128 v[132:135], v4 offset:8448
    ds_read_b128 v[136:139], v4 offset:8704
    ds_read_b128 v[140:143], v4 offset:8960
    buffer_load_dwordx4 v38, s[32:35], s63 offen offset:0 lds
    buffer_load_dwordx4 v39, s[32:35], s63 offen offset:1024 lds
    v_mfma_f32_32x32x16_bf16 v[80:95], a[220:223], v[156:159], v[80:95]
    s_waitcnt vmcnt(17) lgkmcnt(2)
    ds_read_b128 v[144:147], v4 offset:9216
    ds_read_b128 v[148:151], v4 offset:9472
    ds_read_b128 v[152:155], v4 offset:9728
    ds_read_b64_tr_b16 v[168:169], v8 offset:14336
    ds_read_b64_tr_b16 v[170:171], v8 offset:15360
    ds_read_b64_tr_b16 v[172:173], v9 offset:14336
    ds_read_b64_tr_b16 v[174:175], v9 offset:15360
    v_mfma_f32_32x32x16_bf16 v[80:95], v[58:61], v[60:63], v[80:95]
    v_mul_f32 v34, v34, v76
    v_cvt_pk_bf16_f32 v69, v36, v37
    v_mul_f32 v35, v35, v77
    v_mul_f32 v78, v52, v78
    v_exp_f32 v34, v34
    v_mfma_f32_32x32x16_bf16 v[96:111], a[0:3], v[128:131], 0
    s_add_u32 m0, s62, 8192
    s_add_u32 s63, s78, 0
    ds_read_b128 v[156:159], v4 offset:9984
    buffer_load_dwordx4 v38, s[32:35], s63 offen offset:0 lds
    buffer_load_dwordx4 v39, s[32:35], s63 offen offset:1024 lds
    v_mul_f32 v79, v52, v79
    v_exp_f32 v35, v35
    v_mfma_f32_32x32x16_bf16 v[96:111], a[8:11], v[132:135], v[96:111]
    s_waitcnt lgkmcnt(8)
    ds_read_b128 v[128:131], v4 offset:10240
    v_mov_b32 v60, v55
    v_mov_b32 v61, v55
    v_fma_f32 v36, v78, v78, s91
    v_add_f32 v34, 1.0, v34
    v_fma_f32 v37, v79, v79, s91
    v_add_f32 v35, 1.0, v35
    v_mul_f32 v36, v36, v78
    v_mfma_f32_32x32x16_bf16 v[96:111], a[16:19], v[136:139], v[96:111]
    s_waitcnt vmcnt(17)
    ds_read_b128 v[132:135], v4 offset:10496
    ds_read_b64_tr_b16 v[176:177], v8 offset:16384
    ds_read_b64_tr_b16 v[178:179], v8 offset:17408
    ds_read_b64_tr_b16 v[180:181], v9 offset:16384
    ds_read_b64_tr_b16 v[182:183], v9 offset:17408
    v_rcp_f32 v34, v34
    v_mul_f32 v37, v37, v79
    v_mfma_f32_32x32x16_bf16 v[96:111], a[24:27], v[140:143], v[96:111]
    s_waitcnt lgkmcnt(12)
    s_add_u32 m0, s62, 10240
    s_add_u32 s63, s78, 14336
    ds_read_b128 v[136:139], v4 offset:10752
    buffer_load_dwordx4 v38, s[32:35], s63 offen offset:0 lds
    buffer_load_dwordx4 v39, s[32:35], s63 offen offset:1024 lds
    v_rcp_f32 v35, v35
    v_mul_f32 v34, v34, v76
    v_mfma_f32_32x32x16_bf16 v[96:111], a[32:35], v[144:147], v[96:111]
    ds_read_b128 v[140:143], v4 offset:11008
    v_exp_f32 v36, v36
    v_exp_f32 v37, v37
    v_mul_f32 v35, v35, v77
    v_add_f32 v36, 1.0, v36
    v_mfma_f32_32x32x16_bf16 v[96:111], a[40:43], v[148:151], v[96:111]
    s_waitcnt vmcnt(17) lgkmcnt(8)
    ds_read_b128 v[144:147], v4 offset:11264
    ds_read_b64_tr_b16 v[184:185], v8 offset:18432
    ds_read_b64_tr_b16 v[186:187], v8 offset:19456
    ds_read_b64_tr_b16 v[188:189], v9 offset:18432
    ds_read_b64_tr_b16 v[190:191], v9 offset:19456
    v_cvt_pk_bf16_f32 v70, v34, v35
    v_add_f32 v37, 1.0, v37
    v_mul_f32 v80, v52, v80
    v_mfma_f32_32x32x16_bf16 v[96:111], a[48:51], v[152:155], v[96:111]
    s_add_u32 m0, s62, 12288
    s_add_u32 s63, s72, 28672
    ds_read_b128 v[148:151], v4 offset:11520
    buffer_load_dwordx4 v38, s[32:35], s63 offen offset:0 lds
    buffer_load_dwordx4 v39, s[32:35], s63 offen offset:1024 lds
    v_rcp_f32 v36, v36
    v_mul_f32 v81, v52, v81
    v_mfma_f32_32x32x16_bf16 v[96:111], a[56:59], v[156:159], v[96:111]
    s_waitcnt lgkmcnt(12)
    ds_read_b128 v[152:155], v4 offset:11776
    v_rcp_f32 v37, v37
    v_fma_f32 v34, v80, v80, s91
    v_mul_f32 v36, v36, v78
    v_fma_f32 v35, v81, v81, s91
    v_mul_f32 v37, v37, v79
    v_mul_f32 v34, v34, v80
    v_mfma_f32_32x32x16_bf16 v[96:111], a[64:67], v[128:131], v[96:111]
    s_waitcnt vmcnt(17)
    ds_read_b128 v[156:159], v4 offset:12032
    ds_read_b64_tr_b16 v[192:193], v8 offset:20480
    ds_read_b64_tr_b16 v[194:195], v8 offset:21504
    ds_read_b64_tr_b16 v[196:197], v9 offset:20480
    ds_read_b64_tr_b16 v[198:199], v9 offset:21504
    v_cvt_pk_bf16_f32 v71, v36, v37
    v_mul_f32 v35, v35, v81
    v_mul_f32 v82, v52, v82
    v_mfma_f32_32x32x16_bf16 v[96:111], a[72:75], v[132:135], v[96:111]
    s_waitcnt lgkmcnt(12)
    s_add_u32 m0, s62, 14336
    s_add_u32 s63, s72, 43008
    ds_read_b128 v[128:131], v4 offset:12288
    buffer_store_dwordx4 v[68:71], v1, s[20:23], s92 offen offset:1024
    buffer_load_dwordx4 v38, s[32:35], s63 offen offset:0 lds
    buffer_load_dwordx4 v39, s[32:35], s63 offen offset:1024 lds
    v_mul_f32 v83, v52, v83
    v_mfma_f32_32x32x16_bf16 v[96:111], a[80:83], v[136:139], v[96:111]
    ds_read_b128 v[132:135], v4 offset:12544
    v_exp_f32 v34, v34
    v_exp_f32 v35, v35
    v_fma_f32 v36, v82, v82, s91
    v_add_f32 v34, 1.0, v34
    v_fma_f32 v37, v83, v83, s91
    v_mfma_f32_32x32x16_bf16 v[96:111], a[88:91], v[140:143], v[96:111]
    s_waitcnt vmcnt(18) lgkmcnt(8)
    ds_read_b128 v[136:139], v4 offset:12800
    ds_read_b64_tr_b16 v[200:201], v8 offset:22528
    ds_read_b64_tr_b16 v[202:203], v8 offset:23552
    ds_read_b64_tr_b16 v[204:205], v9 offset:22528
    ds_read_b64_tr_b16 v[206:207], v9 offset:23552
    v_add_f32 v35, 1.0, v35
    v_mul_f32 v36, v36, v82
    v_mul_f32 v37, v37, v83
    v_mfma_f32_32x32x16_bf16 v[96:111], a[96:99], v[144:147], v[96:111]
    s_add_u32 m0, s62, 16384
    s_add_u32 s63, s73, 28672
    ds_read_b128 v[140:143], v4 offset:13056
    buffer_load_dwordx4 v38, s[32:35], s63 offen offset:0 lds
    buffer_load_dwordx4 v39, s[32:35], s63 offen offset:1024 lds
    v_rcp_f32 v34, v34
    v_mfma_f32_32x32x16_bf16 v[96:111], a[104:107], v[148:151], v[96:111]
    s_waitcnt lgkmcnt(12)
    ds_read_b128 v[144:147], v4 offset:13312
    v_rcp_f32 v35, v35
    v_exp_f32 v36, v36
    v_mul_f32 v34, v34, v80
    v_exp_f32 v37, v37
    v_mfma_f32_32x32x16_bf16 v[96:111], a[112:115], v[152:155], v[96:111]
    s_waitcnt vmcnt(18)
    ds_read_b128 v[148:151], v4 offset:13568
    ds_read_b64_tr_b16 v[208:209], v8 offset:0
    ds_read_b64_tr_b16 v[210:211], v8 offset:1024
    ds_read_b64_tr_b16 v[212:213], v9 offset:0
    ds_read_b64_tr_b16 v[214:215], v9 offset:1024
    v_mul_f32 v35, v35, v81
    v_add_f32 v36, 1.0, v36
    v_cvt_pk_bf16_f32 v80, v34, v35
    v_mfma_f32_32x32x16_bf16 v[96:111], a[120:123], v[156:159], v[96:111]
    s_waitcnt lgkmcnt(12)
    s_add_u32 m0, s62, 18432
    s_add_u32 s63, s73, 43008
    ds_read_b128 v[152:155], v4 offset:13824
    buffer_load_dwordx4 v38, s[32:35], s63 offen offset:0 lds
    buffer_load_dwordx4 v39, s[32:35], s63 offen offset:1024 lds
    v_add_f32 v37, 1.0, v37
    v_mul_f32 v84, v52, v84
    v_mul_f32 v85, v52, v85
    v_mfma_f32_32x32x16_bf16 v[96:111], a[128:131], v[128:131], v[96:111]
    ds_read_b128 v[156:159], v4 offset:14080
    v_rcp_f32 v36, v36
    v_rcp_f32 v37, v37
    v_fma_f32 v34, v84, v84, s91
    v_mul_f32 v36, v36, v82
    v_fma_f32 v35, v85, v85, s91
    v_mfma_f32_32x32x16_bf16 v[96:111], a[136:139], v[132:135], v[96:111]
    s_waitcnt lgkmcnt(8)
    ds_read_b128 v[128:131], v4 offset:14336
    v_mul_f32 v37, v37, v83
    v_mul_f32 v34, v34, v84
    v_cvt_pk_bf16_f32 v81, v36, v37
    v_mul_f32 v35, v35, v85
    v_mul_f32 v86, v52, v86
    v_exp_f32 v34, v34
    v_mfma_f32_32x32x16_bf16 v[96:111], a[144:147], v[136:139], v[96:111]
    ds_read_b128 v[132:135], v4 offset:14592
    v_mul_f32 v87, v52, v87
    v_exp_f32 v35, v35
    v_fma_f32 v36, v86, v86, s91
    v_add_f32 v34, 1.0, v34
    v_fma_f32 v37, v87, v87, s91
    v_add_f32 v35, 1.0, v35
    v_mfma_f32_32x32x16_bf16 v[96:111], a[152:155], v[140:143], v[96:111]
    s_waitcnt vmcnt(6) lgkmcnt(8)
    ds_read_b128 v[136:139], v4 offset:14848
    buffer_store_dword v2, off, s[20:23], s89 offset:64
    ds_read_b64_tr_b16 v[216:217], v8 offset:2048
    ds_read_b64_tr_b16 v[218:219], v8 offset:3072
    ds_read_b64_tr_b16 v[220:221], v9 offset:2048
    ds_read_b64_tr_b16 v[222:223], v9 offset:3072
    v_mul_f32 v36, v36, v86
    v_mul_f32 v37, v37, v87
    v_mfma_f32_32x32x16_bf16 v[96:111], a[160:163], v[144:147], v[96:111]
    s_add_u32 m0, s62, 20480
    s_add_u32 s63, s74, 28672
    ds_read_b128 v[140:143], v4 offset:15104
    buffer_load_dwordx4 v38, s[32:35], s63 offen offset:0 lds
    buffer_load_dwordx4 v39, s[32:35], s63 offen offset:1024 lds
    ds_read_b64_tr_b16 v[224:225], v8 offset:4096
    ds_read_b64_tr_b16 v[226:227], v8 offset:5120
    ds_read_b64_tr_b16 v[228:229], v9 offset:4096
    v_mfma_f32_32x32x16_bf16 v[96:111], a[168:171], v[148:151], v[96:111]
    s_waitcnt lgkmcnt(11)
    s_add_u32 m0, s62, 22528
    s_add_u32 s63, s74, 43008
    ds_read_b128 v[144:147], v4 offset:8192
    ds_read_b64_tr_b16 v[230:231], v9 offset:5120
    buffer_load_dwordx4 v38, s[32:35], s63 offen offset:0 lds
    buffer_load_dwordx4 v39, s[32:35], s63 offen offset:1024 lds
    v_rcp_f32 v34, v34
    v_mfma_f32_32x32x16_bf16 v[96:111], a[176:179], v[152:155], v[96:111]
    ds_read_b128 v[148:151], v4 offset:8448
    v_rcp_f32 v35, v35
    v_exp_f32 v36, v36
    v_mul_f32 v34, v34, v84
    v_exp_f32 v37, v37
    v_mfma_f32_32x32x16_bf16 v[96:111], a[184:187], v[156:159], v[96:111]
    s_waitcnt lgkmcnt(12)
    ds_read_b128 v[152:155], v4 offset:8704
    v_mul_f32 v35, v35, v85
    v_add_f32 v36, 1.0, v36
    v_cvt_pk_bf16_f32 v82, v34, v35
    v_add_f32 v37, 1.0, v37
    v_mul_f32 v88, v52, v88
    v_rcp_f32 v36, v36
    v_mul_f32 v89, v52, v89
    v_mfma_f32_32x32x16_bf16 v[96:111], a[192:195], v[128:131], v[96:111]
    ds_read_b128 v[156:159], v4 offset:8960
    ds_read_b64_tr_b16 v[232:233], v8 offset:6144
    ds_read_b64_tr_b16 v[234:235], v8 offset:7168
    ds_read_b64_tr_b16 v[236:237], v9 offset:6144
    ds_read_b64_tr_b16 v[238:239], v9 offset:7168
    v_rcp_f32 v37, v37
    v_fma_f32 v34, v88, v88, s91
    v_mfma_f32_32x32x16_bf16 v[96:111], a[200:203], v[132:135], v[96:111]
    s_waitcnt lgkmcnt(12)
    s_add_u32 m0, s62, 0
    s_add_u32 s63, s75, 28672
    ds_read_b128 v[128:131], v4 offset:9216
    buffer_load_dwordx4 v38, s[32:35], s63 offen offset:0 lds
    buffer_load_dwordx4 v39, s[32:35], s63 offen offset:1024 lds
    v_mul_f32 v36, v36, v86
    v_fma_f32 v35, v89, v89, s91
    v_mul_f32 v37, v37, v87
    v_mfma_f32_32x32x16_bf16 v[96:111], a[208:211], v[136:139], v[96:111]
    ds_read_b128 v[132:135], v4 offset:9472
    ds_read_b64_tr_b16 v[240:241], v8 offset:8192
    ds_read_b64_tr_b16 v[242:243], v8 offset:9216
    ds_read_b64_tr_b16 v[244:245], v9 offset:8192
    ds_read_b64_tr_b16 v[246:247], v9 offset:9216
    v_mul_f32 v34, v34, v88
    v_cvt_pk_bf16_f32 v83, v36, v37
    v_mul_f32 v35, v35, v89
    v_mfma_f32_32x32x16_bf16 v[96:111], a[216:219], v[140:143], v[96:111]
    s_waitcnt lgkmcnt(12)
    s_add_u32 m0, s62, 2048
    s_add_u32 s63, s75, 43008
    ds_read_b128 v[136:139], v4 offset:9728
    buffer_store_dwordx4 v[80:83], v1, s[20:23], s92 offen offset:2048
    buffer_load_dwordx4 v38, s[32:35], s63 offen offset:0 lds
    buffer_load_dwordx4 v39, s[32:35], s63 offen offset:1024 lds
    v_mul_f32 v90, v52, v90
    v_mul_f32 v91, v52, v91
    v_mfma_f32_32x32x16_bf16 v[96:111], v[56:59], v[60:63], v[96:111]
    v_exp_f32 v34, v34
    v_exp_f32 v35, v35
    v_fma_f32 v36, v90, v90, s91
    v_add_f32 v34, 1.0, v34
    v_mfma_f32_32x32x16_bf16 v[112:127], a[4:7], v[144:147], 0
    ds_read_b128 v[140:143], v4 offset:9984
    v_fma_f32 v37, v91, v91, s91
    v_add_f32 v35, 1.0, v35
    v_mul_f32 v36, v36, v90
    v_rcp_f32 v34, v34
    v_mul_f32 v37, v37, v91
    v_mfma_f32_32x32x16_bf16 v[112:127], a[12:15], v[148:151], v[112:127]
    s_waitcnt lgkmcnt(12)
    ds_read_b128 v[144:147], v4 offset:10240
    ds_read_b64_tr_b16 v[248:249], v8 offset:10240
    ds_read_b64_tr_b16 v[250:251], v8 offset:11264
    ds_read_b64_tr_b16 v[252:253], v9 offset:10240
    ds_read_b64_tr_b16 v[254:255], v9 offset:11264
    v_rcp_f32 v35, v35
    v_mfma_f32_32x32x16_bf16 v[112:127], a[20:23], v[152:155], v[112:127]
    s_add_u32 m0, s62, 4096
    s_add_u32 s63, s76, 28672
    ds_read_b128 v[148:151], v4 offset:10496
    buffer_load_dwordx4 v38, s[32:35], s63 offen offset:0 lds
    buffer_load_dwordx4 v39, s[32:35], s63 offen offset:1024 lds
    v_exp_f32 v36, v36
    v_mul_f32 v34, v34, v88
    v_mfma_f32_32x32x16_bf16 v[112:127], a[28:31], v[156:159], v[112:127]
    s_waitcnt lgkmcnt(12)
    ds_read_b128 v[152:155], v4 offset:10752
    buffer_load_dword v0, v3, s[20:23], s88 offen offset:64 sc1
    v_exp_f32 v37, v37
    v_mul_f32 v35, v35, v89
    v_add_f32 v36, 1.0, v36
    v_cvt_pk_bf16_f32 v84, v34, v35
    v_add_f32 v37, 1.0, v37
    v_mfma_f32_32x32x16_bf16 v[112:127], a[36:39], v[128:131], v[112:127]
    ds_read_b128 v[156:159], v4 offset:11008
    ds_read_b64_tr_b16 a[240:241], v8 offset:12288
    ds_read_b64_tr_b16 a[242:243], v8 offset:13312
    ds_read_b64_tr_b16 a[244:245], v9 offset:12288
    ds_read_b64_tr_b16 a[246:247], v9 offset:13312
    v_mul_f32 v92, v52, v92
    v_rcp_f32 v36, v36
    v_mfma_f32_32x32x16_bf16 v[112:127], a[44:47], v[132:135], v[112:127]
    s_waitcnt lgkmcnt(12)
    s_add_u32 m0, s62, 6144
    s_add_u32 s63, s76, 43008
    ds_read_b128 v[128:131], v4 offset:11264
    buffer_load_dwordx4 v38, s[32:35], s63 offen offset:0 lds
    buffer_load_dwordx4 v39, s[32:35], s63 offen offset:1024 lds
    v_mul_f32 v93, v52, v93
    v_rcp_f32 v37, v37
    v_mfma_f32_32x32x16_bf16 v[112:127], a[52:55], v[136:139], v[112:127]
    ds_read_b128 v[132:135], v4 offset:11520
    v_fma_f32 v34, v92, v92, s91
    v_mul_f32 v36, v36, v90
    v_fma_f32 v35, v93, v93, s91
    v_mul_f32 v37, v37, v91
    v_mul_f32 v34, v34, v92
    v_cvt_pk_bf16_f32 v85, v36, v37
    v_mfma_f32_32x32x16_bf16 v[112:127], a[60:63], v[140:143], v[112:127]
    s_waitcnt vmcnt(19) lgkmcnt(8)
    ds_read_b128 v[136:139], v4 offset:11776
    ds_read_b64_tr_b16 a[248:249], v8 offset:14336
    ds_read_b64_tr_b16 a[250:251], v8 offset:15360
    ds_read_b64_tr_b16 a[252:253], v9 offset:14336
    ds_read_b64_tr_b16 a[254:255], v9 offset:15360
    v_mul_f32 v35, v35, v93
    v_mul_f32 v94, v52, v94
    v_mul_f32 v95, v52, v95
    v_mfma_f32_32x32x16_bf16 v[112:127], a[68:71], v[144:147], v[112:127]
    s_add_u32 m0, s62, 8192
    s_add_u32 s63, s77, 28672
    ds_read_b128 v[140:143], v4 offset:12032
    buffer_load_dwordx4 v38, s[32:35], s63 offen offset:0 lds
    buffer_load_dwordx4 v39, s[32:35], s63 offen offset:1024 lds
    v_exp_f32 v34, v34
    v_fma_f32 v36, v94, v94, s91
    v_mfma_f32_32x32x16_bf16 v[112:127], a[76:79], v[148:151], v[112:127]
    s_waitcnt lgkmcnt(12)
    ds_read_b128 v[144:147], v4 offset:12288
    v_exp_f32 v35, v35
    v_add_f32 v34, 1.0, v34
    v_fma_f32 v37, v95, v95, s91
    v_add_f32 v35, 1.0, v35
    v_mul_f32 v36, v36, v94
    v_mul_f32 v37, v37, v95
    v_mfma_f32_32x32x16_bf16 v[112:127], a[84:87], v[152:155], v[112:127]
    ds_read_b128 v[148:151], v4 offset:12544
    v_rcp_f32 v34, v34
    v_rcp_f32 v35, v35
    v_exp_f32 v36, v36
    v_mul_f32 v34, v34, v92
    v_mfma_f32_32x32x16_bf16 v[112:127], a[92:95], v[156:159], v[112:127]
    s_waitcnt lgkmcnt(8)
    s_add_u32 m0, s62, 10240
    s_add_u32 s63, s77, 43008
    ds_read_b128 v[152:155], v4 offset:12800
    buffer_load_dwordx4 v38, s[32:35], s63 offen offset:0 lds
    buffer_load_dwordx4 v39, s[32:35], s63 offen offset:1024 lds
    v_exp_f32 v37, v37
    v_mfma_f32_32x32x16_bf16 v[112:127], a[100:103], v[128:131], v[112:127]
    ds_read_b128 v[156:159], v4 offset:13056
    v_mul_f32 v35, v35, v93
    v_add_f32 v36, 1.0, v36
    v_cvt_pk_bf16_f32 v86, v34, v35
    v_add_f32 v37, 1.0, v37
    v_mul_f32 v96, v54, v96
    v_rcp_f32 v36, v36
    v_mfma_f32_32x32x16_bf16 v[112:127], a[108:111], v[132:135], v[112:127]
    s_waitcnt lgkmcnt(4)
    ds_read_b128 v[128:131], v4 offset:13312
    v_mul_f32 v97, v54, v97
    v_rcp_f32 v37, v37
    v_fma_f32 v34, v96, v96, s91
    v_mul_f32 v36, v36, v94
    v_fma_f32 v35, v97, v97, s91
    v_mul_f32 v37, v37, v95
    v_mfma_f32_32x32x16_bf16 v[112:127], a[116:119], v[136:139], v[112:127]
    s_add_u32 m0, s62, 12288
    s_add_u32 s63, s78, 28672
    ds_read_b128 v[132:135], v4 offset:13568
    buffer_load_dwordx4 v38, s[32:35], s63 offen offset:0 lds
    buffer_load_dwordx4 v39, s[32:35], s63 offen offset:1024 lds
    v_mul_f32 v34, v34, v96
    v_cvt_pk_bf16_f32 v87, v36, v37
    v_mul_f32 v35, v35, v97
    v_mfma_f32_32x32x16_bf16 v[112:127], a[124:127], v[140:143], v[112:127]
    s_waitcnt vmcnt(8) lgkmcnt(4)
    ds_read_b128 v[136:139], v4 offset:13824
    buffer_store_dwordx4 v[84:87], v1, s[20:23], s92 offen offset:3072
    v_cmp_ne_u32 vcc, s59, v0
    s_add_u32 s92, s65, 4290314240
    v_mul_f32 v98, v54, v98
    v_exp_f32 v34, v34
    v_mul_f32 v99, v54, v99
    v_mfma_f32_32x32x16_bf16 v[112:127], a[132:135], v[144:147], v[112:127]
    ds_read_b128 v[140:143], v4 offset:14080
    s_cbranch_vccnz Lrt_74
Lck_73:
    v_exp_f32 v35, v35
    v_fma_f32 v36, v98, v98, s91
    v_add_f32 v34, 1.0, v34
    v_fma_f32 v37, v99, v99, s91
    v_mfma_f32_32x32x16_bf16 v[112:127], a[140:143], v[148:151], v[112:127]
    s_waitcnt lgkmcnt(4)
    s_add_u32 m0, s62, 14336
    s_add_u32 s63, s78, 43008
    ds_read_b128 v[144:147], v4 offset:14336
    buffer_load_dwordx4 v[40:43], v1, s[20:23], s66 offen offset:0 sc1
    buffer_load_dwordx4 v38, s[32:35], s63 offen offset:0 lds
    buffer_load_dwordx4 v39, s[32:35], s63 offen offset:1024 lds
    v_add_f32 v35, 1.0, v35
    v_mul_f32 v36, v36, v98
    v_mfma_f32_32x32x16_bf16 v[112:127], a[148:151], v[152:155], v[112:127]
    ds_read_b128 v[148:151], v4 offset:14592
    v_rcp_f32 v34, v34
    v_mul_f32 v37, v37, v99
    v_rcp_f32 v35, v35
    v_exp_f32 v36, v36
    v_mfma_f32_32x32x16_bf16 v[112:127], a[156:159], v[156:159], v[112:127]
    s_waitcnt lgkmcnt(4)
    ds_read_b128 v[152:155], v4 offset:14848
    buffer_load_dwordx4 v[44:47], v1, s[20:23], s66 offen offset:1024 sc1
    v_mul_f32 v34, v34, v96
    v_exp_f32 v37, v37
    v_mul_f32 v35, v35, v97
    v_add_f32 v36, 1.0, v36
    v_cvt_pk_bf16_f32 v96, v34, v35
    v_mfma_f32_32x32x16_bf16 v[112:127], a[164:167], v[128:131], v[112:127]
    ds_read_b128 v[156:159], v4 offset:15104
    v_add_f32 v37, 1.0, v37
    v_mul_f32 v100, v54, v100
    v_rcp_f32 v36, v36
    v_mul_f32 v101, v54, v101
    v_rcp_f32 v37, v37
    v_mfma_f32_32x32x16_bf16 v[112:127], a[172:175], v[132:135], v[112:127]
    s_waitcnt lgkmcnt(4)
    buffer_load_dwordx4 v[48:51], v1, s[20:23], s67 offen offset:0 sc1
    v_fma_f32 v34, v100, v100, s91
    v_mul_f32 v36, v36, v98
    v_fma_f32 v35, v101, v101, s91
    v_mul_f32 v37, v37, v99
    v_mul_f32 v34, v34, v100
    v_cvt_pk_bf16_f32 v97, v36, v37
    v_mfma_f32_32x32x16_bf16 v[112:127], a[180:183], v[136:139], v[112:127]
    v_mul_f32 v35, v35, v101
    v_mul_f32 v102, v54, v102
    v_exp_f32 v34, v34
    v_mul_f32 v103, v54, v103
    v_exp_f32 v35, v35
    v_fma_f32 v36, v102, v102, s91
    v_mfma_f32_32x32x16_bf16 v[112:127], a[188:191], v[140:143], v[112:127]
    s_waitcnt lgkmcnt(2)
    buffer_load_dwordx4 v[72:75], v1, s[20:23], s67 offen offset:1024 sc1
    v_add_f32 v34, 1.0, v34
    v_fma_f32 v37, v103, v103, s91
    v_add_f32 v35, 1.0, v35
    v_mul_f32 v36, v36, v102
    v_rcp_f32 v34, v34
    v_mul_f32 v37, v37, v103
    v_mfma_f32_32x32x16_bf16 v[112:127], a[196:199], v[144:147], v[112:127]
    v_rcp_f32 v35, v35
    v_exp_f32 v36, v36
    v_mul_f32 v34, v34, v100
    v_exp_f32 v37, v37
    v_mul_f32 v35, v35, v101
    v_mfma_f32_32x32x16_bf16 v[112:127], a[204:207], v[148:151], v[112:127]
    s_waitcnt lgkmcnt(0)
    buffer_load_dwordx4 v[76:79], v1, s[20:23], s68 offen offset:0 sc1
    v_add_f32 v36, 1.0, v36
    v_cvt_pk_bf16_f32 v98, v34, v35
    v_add_f32 v37, 1.0, v37
    v_mul_f32 v104, v54, v104
    v_rcp_f32 v36, v36
    v_mul_f32 v105, v54, v105
    v_mfma_f32_32x32x16_bf16 v[112:127], a[212:215], v[152:155], v[112:127]
    s_waitcnt vmcnt(7)
    buffer_store_dword v2, off, s[20:23], s89 offset:96
    v_rcp_f32 v37, v37
    v_fma_f32 v34, v104, v104, s91
    v_mul_f32 v36, v36, v102
    v_fma_f32 v35, v105, v105, s91
    v_mul_f32 v37, v37, v103
    v_mfma_f32_32x32x16_bf16 v[112:127], a[220:223], v[156:159], v[112:127]
    buffer_load_dwordx4 v[88:91], v1, s[20:23], s68 offen offset:1024 sc1
    v_mul_f32 v34, v34, v104
    v_cvt_pk_bf16_f32 v99, v36, v37
    v_mul_f32 v35, v35, v105
    v_mul_f32 v106, v54, v106
    v_exp_f32 v34, v34
    v_mul_f32 v107, v54, v107
    v_mfma_f32_32x32x16_bf16 v[112:127], v[58:61], v[60:63], v[112:127]
    v_exp_f32 v35, v35
    v_fma_f32 v36, v106, v106, s91
    v_add_f32 v34, 1.0, v34
    v_fma_f32 v37, v107, v107, s91
    v_add_f32 v35, 1.0, v35
    v_mfma_f32_32x32x16_bf16 v[128:143], a[224:227], v[64:67], 0
    buffer_store_dwordx4 v[96:99], v1, s[20:23], s92 offen offset:0
    v_mul_f32 v36, v36, v106
    v_rcp_f32 v34, v34
    v_mul_f32 v37, v37, v107
    v_rcp_f32 v35, v35
    v_mfma_f32_32x32x16_bf16 v[144:159], a[228:231], v[64:67], 0
    buffer_load_dwordx4 v[56:59], v1, s[20:23], s69 offen offset:0 sc1
    v_exp_f32 v36, v36
    v_mul_f32 v34, v34, v104
    v_exp_f32 v37, v37
    v_mul_f32 v35, v35, v105
    v_mfma_f32_32x32x16_bf16 v[128:143], a[232:235], v[68:71], v[128:143]
    v_add_f32 v36, 1.0, v36
    v_cvt_pk_bf16_f32 v100, v34, v35
    v_add_f32 v37, 1.0, v37
    v_mul_f32 v108, v54, v108
    v_rcp_f32 v36, v36
    v_mul_f32 v109, v54, v109
    v_mfma_f32_32x32x16_bf16 v[144:159], a[236:239], v[68:71], v[144:159]
    buffer_load_dwordx4 v[60:63], v1, s[20:23], s69 offen offset:1024 sc1
    v_rcp_f32 v37, v37
    v_fma_f32 v34, v108, v108, s91
    v_mul_f32 v36, v36, v106
    v_fma_f32 v35, v109, v109, s91
    v_mul_f32 v37, v37, v107
    v_mfma_f32_32x32x16_bf16 v[128:143], a[240:243], v[80:83], v[128:143]
    v_mul_f32 v34, v34, v108
    v_cvt_pk_bf16_f32 v101, v36, v37
    v_mul_f32 v35, v35, v109
    v_mul_f32 v110, v54, v110
    v_exp_f32 v34, v34
    v_mul_f32 v111, v54, v111
    v_mfma_f32_32x32x16_bf16 v[144:159], a[244:247], v[80:83], v[144:159]
    buffer_load_dwordx4 v[92:95], v1, s[20:23], s70 offen offset:0 sc1
    v_exp_f32 v35, v35
    v_fma_f32 v36, v110, v110, s91
    v_add_f32 v34, 1.0, v34
    v_fma_f32 v37, v111, v111, s91
    v_add_f32 v35, 1.0, v35
    v_mfma_f32_32x32x16_bf16 v[128:143], a[248:251], v[84:87], v[128:143]
    v_mul_f32 v36, v36, v110
    v_rcp_f32 v34, v34
    v_mul_f32 v37, v37, v111
    v_rcp_f32 v35, v35
    v_mul_f32 v34, v34, v108
    v_mfma_f32_32x32x16_bf16 v[144:159], a[252:255], v[84:87], v[144:159]
    s_waitcnt vmcnt(12)
    v_exp_f32 v36, v36
    v_exp_f32 v37, v37
    v_mul_f32 v35, v35, v109
    v_add_f32 v36, 1.0, v36
    v_cvt_pk_bf16_f32 v102, v34, v35
    v_mfma_f32_32x32x16_bf16 v[128:143], v[160:163], v[40:43], v[128:143]
    buffer_load_dword v0, v3, s[20:23], s88 offen offset:96 sc1
    v_add_f32 v37, 1.0, v37
    v_mul_f32 v112, v54, v112
    v_rcp_f32 v36, v36
    v_mul_f32 v113, v54, v113
    v_fma_f32 v34, v112, v112, s91
    v_mfma_f32_32x32x16_bf16 v[144:159], v[164:167], v[40:43], v[144:159]
    s_waitcnt vmcnt(10)
    buffer_load_dwordx4 v[40:43], v1, s[20:23], s70 offen offset:1024 sc1
    v_rcp_f32 v37, v37
    v_mul_f32 v36, v36, v110
    v_fma_f32 v35, v113, v113, s91
L_i3050:
    s_cbranch_execz L_backM
    v_mul_f32 v37, v37, v111
    v_mul_f32 v34, v34, v112
    v_mfma_f32_32x32x16_bf16 v[128:143], v[168:171], v[44:47], v[128:143]
    v_cvt_pk_bf16_f32 v103, v36, v37
    v_mul_f32 v35, v35, v113
    v_mul_f32 v114, v54, v114
    v_exp_f32 v34, v34
    v_mul_f32 v115, v54, v115
    v_fma_f32 v36, v114, v114, s91
    v_mfma_f32_32x32x16_bf16 v[144:159], v[172:175], v[44:47], v[144:159]
    s_waitcnt vmcnt(10)
    buffer_load_dwordx4 v[44:47], v1, s[20:23], s71 offen offset:0 sc1
    buffer_store_dwordx4 v[100:103], v1, s[20:23], s92 offen offset:1024
    v_exp_f32 v35, v35
    v_add_f32 v34, 1.0, v34
    v_fma_f32 v37, v115, v115, s91
    v_add_f32 v35, 1.0, v35
    v_mfma_f32_32x32x16_bf16 v[128:143], v[176:179], v[48:51], v[128:143]
    v_mul_f32 v36, v36, v114
    v_rcp_f32 v34, v34
    v_mul_f32 v37, v37, v115
    v_rcp_f32 v35, v35
    v_mul_f32 v34, v34, v112
    v_mfma_f32_32x32x16_bf16 v[144:159], v[180:183], v[48:51], v[144:159]
    s_waitcnt vmcnt(11)
    buffer_load_dwordx4 v[48:51], v1, s[20:23], s71 offen offset:1024 sc1
    v_exp_f32 v36, v36
    v_exp_f32 v37, v37
    v_mul_f32 v35, v35, v113
    v_add_f32 v36, 1.0, v36
    v_mfma_f32_32x32x16_bf16 v[128:143], v[184:187], v[72:75], v[128:143]
    v_cvt_pk_bf16_f32 v112, v34, v35
    v_add_f32 v37, 1.0, v37
    v_mul_f32 v116, v54, v116
    v_rcp_f32 v36, v36
    v_mul_f32 v117, v54, v117
    v_fma_f32 v34, v116, v116, s91
    v_mfma_f32_32x32x16_bf16 v[144:159], v[188:191], v[72:75], v[144:159]
    s_waitcnt vmcnt(11)
    v_rcp_f32 v37, v37
    v_mul_f32 v36, v36, v114
    v_fma_f32 v35, v117, v117, s91
    v_mul_f32 v37, v37, v115
    v_mul_f32 v34, v34, v116
    v_cvt_pk_bf16_f32 v113, v36, v37
    v_mfma_f32_32x32x16_bf16 v[128:143], v[192:195], v[76:79], v[128:143]
    v_mul_f32 v35, v35, v117
    v_mul_f32 v118, v54, v118
    v_exp_f32 v34, v34
    v_mul_f32 v119, v54, v119
    v_exp_f32 v35, v35
    v_mfma_f32_32x32x16_bf16 v[144:159], v[196:199], v[76:79], v[144:159]
    s_waitcnt vmcnt(9)
    v_fma_f32 v36, v118, v118, s91
    v_add_f32 v34, 1.0, v34
    v_fma_f32 v37, v119, v119, s91
    v_add_f32 v35, 1.0, v35
    v_mul_f32 v36, v36, v118
    v_rcp_f32 v34, v34
    v_mfma_f32_32x32x16_bf16 v[128:143], v[200:203], v[88:91], v[128:143]
    v_mul_f32 v37, v37, v119
    v_rcp_f32 v35, v35
    v_exp_f32 v36, v36
    v_mul_f32 v34, v34, v116
    v_mul_f32 v35, v35, v117
    v_mfma_f32_32x32x16_bf16 v[144:159], v[204:207], v[88:91], v[144:159]
    s_waitcnt vmcnt(4)
    v_cmp_ne_u32 vcc, s59, v0
    v_exp_f32 v37, v37
    v_add_f32 v36, 1.0, v36
    v_cvt_pk_bf16_f32 v114, v34, v35
    v_add_f32 v37, 1.0, v37
    v_mul_f32 v120, v54, v120
    v_mfma_f32_32x32x16_bf16 v[128:143], v[208:211], v[56:59], v[128:143]
    s_cbranch_vccnz Lrt_76
Lck_75:
    v_rcp_f32 v36, v36
    v_mul_f32 v121, v54, v121
    v_rcp_f32 v37, v37
    v_fma_f32 v34, v120, v120, s91
    v_mfma_f32_32x32x16_bf16 v[144:159], v[212:215], v[56:59], v[144:159]
    s_waitcnt vmcnt(0)
    buffer_load_dwordx4 v[56:59], v1, s[20:23], s66 offen offset:2048 sc1
    buffer_store_dword v2, off, s[20:23], s89 offset:128
    v_mul_f32 v36, v36, v118
    v_fma_f32 v35, v121, v121, s91
    v_mul_f32 v37, v37, v119
    v_mul_f32 v34, v34, v120
    v_cvt_pk_bf16_f32 v115, v36, v37
    v_mfma_f32_32x32x16_bf16 v[128:143], v[216:219], v[60:63], v[128:143]
    buffer_load_dwordx4 v[72:75], v1, s[20:23], s66 offen offset:3072 sc1
    buffer_store_dwordx4 v[112:115], v1, s[20:23], s92 offen offset:2048
    v_mul_f32 v35, v35, v121
    v_mul_f32 v122, v54, v122
    v_exp_f32 v34, v34
    v_mul_f32 v123, v54, v123
    v_mfma_f32_32x32x16_bf16 v[144:159], v[220:223], v[60:63], v[144:159]
    v_exp_f32 v35, v35
    v_fma_f32 v36, v122, v122, s91
    v_add_f32 v34, 1.0, v34
    v_fma_f32 v37, v123, v123, s91
    v_add_f32 v35, 1.0, v35
    v_mul_f32 v36, v36, v122
    v_mfma_f32_32x32x16_bf16 v[128:143], v[224:227], v[92:95], v[128:143]
    buffer_load_dwordx4 v[60:63], v1, s[20:23], s67 offen offset:2048 sc1
    v_rcp_f32 v34, v34
    v_mul_f32 v37, v37, v123
    v_rcp_f32 v35, v35
    v_mul_f32 v34, v34, v120
    v_mfma_f32_32x32x16_bf16 v[144:159], v[228:231], v[92:95], v[144:159]
    v_exp_f32 v36, v36
    v_exp_f32 v37, v37
    v_mul_f32 v35, v35, v121
    v_add_f32 v36, 1.0, v36
    v_cvt_pk_bf16_f32 v116, v34, v35
    v_mfma_f32_32x32x16_bf16 v[128:143], v[232:235], v[40:43], v[128:143]
    buffer_load_dwordx4 v[76:79], v1, s[20:23], s67 offen offset:3072 sc1
    v_add_f32 v37, 1.0, v37
    v_mul_f32 v124, v54, v124
    v_rcp_f32 v36, v36
    v_mul_f32 v125, v54, v125
    v_fma_f32 v34, v124, v124, s91
    v_mfma_f32_32x32x16_bf16 v[144:159], v[236:239], v[40:43], v[144:159]
    v_rcp_f32 v37, v37
    v_mul_f32 v36, v36, v122
    v_fma_f32 v35, v125, v125, s91
    v_mul_f32 v37, v37, v123
    v_mul_f32 v34, v34, v124
    v_cvt_pk_bf16_f32 v117, v36, v37
    v_mfma_f32_32x32x16_bf16 v[128:143], v[240:243], v[44:47], v[128:143]
    buffer_load_dwordx4 v[40:43], v1, s[20:23], s68 offen offset:2048 sc1
    ds_read_b64_tr_b16 v[64:65], v8 offset:16384
    ds_read_b64_tr_b16 v[66:67], v8 offset:17408
    v_mul_f32 v35, v35, v125
    v_mul_f32 v126, v54, v126
    v_exp_f32 v34, v34
    v_mfma_f32_32x32x16_bf16 v[144:159], v[244:247], v[44:47], v[144:159]
    ds_read_b64_tr_b16 v[68:69], v9 offset:16384
    ds_read_b64_tr_b16 v[70:71], v9 offset:17408
    v_mul_f32 v127, v54, v127
    v_exp_f32 v35, v35
    v_fma_f32 v36, v126, v126, s91
    v_add_f32 v34, 1.0, v34
    v_mfma_f32_32x32x16_bf16 v[128:143], v[248:251], v[48:51], v[128:143]
    buffer_load_dwordx4 v[44:47], v1, s[20:23], s68 offen offset:3072 sc1
    ds_read_b64_tr_b16 v[80:81], v8 offset:18432
    ds_read_b64_tr_b16 v[82:83], v8 offset:19456
    v_fma_f32 v37, v127, v127, s91
    v_add_f32 v35, 1.0, v35
    v_mul_f32 v36, v36, v126
    v_mul_f32 v37, v37, v127
    v_mfma_f32_32x32x16_bf16 v[144:159], v[252:255], v[48:51], v[144:159]
    s_waitcnt vmcnt(7) lgkmcnt(4)
    ds_read_b64_tr_b16 v[84:85], v9 offset:18432
    ds_read_b64_tr_b16 v[86:87], v9 offset:19456
    v_rcp_f32 v34, v34
    v_rcp_f32 v35, v35
    v_mul_f32 v34, v34, v124
    v_mfma_f32_32x32x16_bf16 v[128:143], v[64:67], v[56:59], v[128:143]
    s_waitcnt lgkmcnt(4)
    buffer_load_dwordx4 v[48:51], v1, s[20:23], s69 offen offset:2048 sc1
    ds_read_b64_tr_b16 v[64:65], v8 offset:20480
    ds_read_b64_tr_b16 v[66:67], v8 offset:21504
    v_exp_f32 v36, v36
    v_mul_f32 v35, v35, v125
    v_mfma_f32_32x32x16_bf16 v[144:159], v[68:71], v[56:59], v[144:159]
    s_waitcnt vmcnt(6) lgkmcnt(4)
    ds_read_b64_tr_b16 v[68:69], v9 offset:20480
    ds_read_b64_tr_b16 v[70:71], v9 offset:21504
    v_exp_f32 v37, v37
    v_add_f32 v36, 1.0, v36
    v_cvt_pk_bf16_f32 v118, v34, v35
    v_mfma_f32_32x32x16_bf16 v[128:143], v[80:83], v[72:75], v[128:143]
    s_waitcnt lgkmcnt(4)
    buffer_load_dwordx4 v[56:59], v1, s[20:23], s69 offen offset:3072 sc1
    ds_read_b64_tr_b16 v[80:81], v8 offset:22528
    ds_read_b64_tr_b16 v[82:83], v8 offset:23552
    buffer_load_dword v0, v3, s[20:23], s88 offen offset:128 sc1
    v_add_f32 v37, 1.0, v37
    v_mfma_f32_32x32x16_bf16 v[144:159], v[84:87], v[72:75], v[144:159]
    s_waitcnt vmcnt(6) lgkmcnt(4)
    ds_read_b64_tr_b16 v[84:85], v9 offset:22528
    ds_read_b64_tr_b16 v[86:87], v9 offset:23552
    v_rcp_f32 v36, v36
    v_rcp_f32 v37, v37
    v_mfma_f32_32x32x16_bf16 v[128:143], v[64:67], v[60:63], v[128:143]
    s_waitcnt lgkmcnt(4)
    buffer_load_dwordx4 v[72:75], v1, s[20:23], s70 offen offset:2048 sc1
    ds_read_b64_tr_b16 v[64:65], v8 offset:0
    ds_read_b64_tr_b16 v[66:67], v8 offset:1024
    v_mul_f32 v36, v36, v126
    v_mul_f32 v37, v37, v127
    v_cvt_pk_bf16_f32 v119, v36, v37
    v_mfma_f32_32x32x16_bf16 v[144:159], v[68:71], v[60:63], v[144:159]
    s_waitcnt vmcnt(6) lgkmcnt(4)
    ds_read_b64_tr_b16 v[68:69], v9 offset:0
    ds_read_b64_tr_b16 v[70:71], v9 offset:1024
    buffer_store_dwordx4 v[116:119], v1, s[20:23], s92 offen offset:3072
    v_mfma_f32_32x32x16_bf16 v[128:143], v[80:83], v[76:79], v[128:143]
    s_waitcnt lgkmcnt(4)
    buffer_load_dwordx4 v[60:63], v1, s[20:23], s70 offen offset:3072 sc1
    ds_read_b64_tr_b16 v[80:81], v8 offset:2048
    ds_read_b64_tr_b16 v[82:83], v8 offset:3072
    v_mfma_f32_32x32x16_bf16 v[144:159], v[84:87], v[76:79], v[144:159]
    s_waitcnt vmcnt(7) lgkmcnt(4)
    buffer_load_dwordx4 v[76:79], v1, s[20:23], s71 offen offset:2048 sc1
    ds_read_b64_tr_b16 v[84:85], v9 offset:2048
    ds_read_b64_tr_b16 v[86:87], v9 offset:3072
    v_mfma_f32_32x32x16_bf16 v[128:143], v[64:67], v[40:43], v[128:143]
    s_waitcnt lgkmcnt(4)
    buffer_load_dwordx4 v[88:91], v1, s[20:23], s71 offen offset:3072 sc1
    ds_read_b64_tr_b16 v[64:65], v8 offset:4096
    ds_read_b64_tr_b16 v[66:67], v8 offset:5120
    v_mfma_f32_32x32x16_bf16 v[144:159], v[68:71], v[40:43], v[144:159]
    s_waitcnt vmcnt(8) lgkmcnt(4)
    s_add_u32 s66, s66, 4290314240
    s_add_u32 s67, s67, 4290314240
    ds_read_b64_tr_b16 v[68:69], v9 offset:4096
    ds_read_b64_tr_b16 v[70:71], v9 offset:5120
    v_mfma_f32_32x32x16_bf16 v[128:143], v[80:83], v[44:47], v[128:143]
    s_waitcnt lgkmcnt(4)
    s_add_u32 s68, s68, 4290314240
    s_add_u32 s69, s69, 4290314240
    ds_read_b64_tr_b16 v[80:81], v8 offset:6144
    ds_read_b64_tr_b16 v[82:83], v8 offset:7168
    v_mfma_f32_32x32x16_bf16 v[144:159], v[84:87], v[44:47], v[144:159]
    s_waitcnt vmcnt(7) lgkmcnt(4)
    s_add_u32 s70, s70, 4290314240
    s_add_u32 s71, s71, 4290314240
    ds_read_b64_tr_b16 v[84:85], v9 offset:6144
    ds_read_b64_tr_b16 v[86:87], v9 offset:7168
    v_mfma_f32_32x32x16_bf16 v[128:143], v[64:67], v[48:51], v[128:143]
    s_waitcnt lgkmcnt(4)
    ds_read_b64_tr_b16 v[64:65], v8 offset:8192
    ds_read_b64_tr_b16 v[66:67], v8 offset:9216
    v_mfma_f32_32x32x16_bf16 v[144:159], v[68:71], v[48:51], v[144:159]
    s_waitcnt vmcnt(5) lgkmcnt(4)
    ds_read_b64_tr_b16 v[68:69], v9 offset:8192
    ds_read_b64_tr_b16 v[70:71], v9 offset:9216
    v_cmp_ne_u32 vcc, s59, v0
    v_mfma_f32_32x32x16_bf16 v[128:143], v[80:83], v[56:59], v[128:143]
    s_waitcnt lgkmcnt(4)
    ds_read_b64_tr_b16 v[80:81], v8 offset:10240
    ds_read_b64_tr_b16 v[82:83], v8 offset:11264
    s_cbranch_vccnz Lrt_78
Lck_77:
    v_mfma_f32_32x32x16_bf16 v[144:159], v[84:87], v[56:59], v[144:159]
    s_waitcnt vmcnt(4) lgkmcnt(4)
    buffer_load_dwordx4 v[40:43], v1, s[20:23], s66 offen offset:0 sc1
    ds_read_b64_tr_b16 v[84:85], v8 offset:12288
    ds_read_b64_tr_b16 v[86:87], v8 offset:13312
    v_mov_b32 v0, -1
    v_mfma_f32_32x32x16_bf16 v[128:143], v[64:67], v[72:75], v[128:143]
    s_waitcnt lgkmcnt(4)
    buffer_store_dword v0, v1, s[20:23], s65 offen offset:0
    ds_read_b64_tr_b16 v[64:65], v8 offset:14336
    ds_read_b64_tr_b16 v[66:67], v8 offset:15360
    v_mfma_f32_32x32x16_bf16 v[144:159], v[68:71], v[72:75], v[144:159]
    s_waitcnt vmcnt(4) lgkmcnt(4)
    buffer_load_dwordx4 v[44:47], v1, s[20:23], s66 offen offset:1024 sc1
    buffer_store_dword v0, v1, s[20:23], s65 offen offset:1024
    ds_read_b64_tr_b16 v[68:69], v9 offset:10240
    ds_read_b64_tr_b16 v[70:71], v9 offset:11264
    buffer_store_dword v2, off, s[20:23], s89 offset:160
    v_mfma_f32_32x32x16_bf16 v[128:143], v[80:83], v[60:63], v[128:143]
    s_waitcnt vmcnt(6) lgkmcnt(4)
    ds_read_b64_tr_b16 v[80:81], v9 offset:12288
    ds_read_b64_tr_b16 v[82:83], v9 offset:13312
    v_mfma_f32_32x32x16_bf16 v[128:143], v[84:87], v[76:79], v[128:143]
    s_waitcnt vmcnt(5) lgkmcnt(4)
    buffer_load_dwordx4 v[48:51], v1, s[20:23], s67 offen offset:0 sc1
    ds_read_b64_tr_b16 v[84:85], v9 offset:14336
    ds_read_b64_tr_b16 v[86:87], v9 offset:15360
    v_mfma_f32_32x32x16_bf16 v[128:143], v[64:67], v[88:91], v[128:143]
    s_waitcnt lgkmcnt(4)
    v_mfma_f32_32x32x16_bf16 v[144:159], v[68:71], v[60:63], v[144:159]
    s_waitcnt lgkmcnt(2)
    buffer_load_dwordx4 v[52:55], v1, s[20:23], s67 offen offset:1024 sc1
    v_mfma_f32_32x32x16_bf16 v[144:159], v[80:83], v[76:79], v[144:159]
    s_waitcnt lgkmcnt(0)
    v_add_u32 v38, s87, v1
    v_mfma_f32_32x32x16_bf16 v[144:159], v[84:87], v[88:91], v[144:159]
    buffer_load_dwordx4 v[56:59], v1, s[20:23], s68 offen offset:0 sc1
    s_nop 2
    v_cvt_pk_f16_f32 v128, v128, v129
    v_cvt_pk_f16_f32 v129, v130, v131
    v_cvt_pk_f16_f32 v130, v132, v133
    v_cvt_pk_f16_f32 v131, v134, v135
    v_cvt_pk_f16_f32 v136, v136, v137
    v_mfma_f32_32x32x16_bf16 v[64:79], a[224:227], v[96:99], 0
    v_cvt_pk_f16_f32 v137, v138, v139
    v_mfma_f32_32x32x16_bf16 v[80:95], a[228:231], v[96:99], 0
    buffer_load_dwordx4 v[60:63], v1, s[20:23], s68 offen offset:1024 sc1
    ds_write_b128 v6, v[128:131] offset:0
    v_cvt_pk_f16_f32 v138, v140, v141
    v_cvt_pk_f16_f32 v139, v142, v143
    v_mfma_f32_32x32x16_bf16 v[64:79], a[232:235], v[100:103], v[64:79]
    ds_write_b128 v6, v[136:139] offset:128
    v_cvt_pk_f16_f32 v144, v144, v145
    v_cvt_pk_f16_f32 v145, v146, v147
    v_cvt_pk_f16_f32 v146, v148, v149
    v_cvt_pk_f16_f32 v147, v150, v151
    v_cvt_pk_f16_f32 v152, v152, v153
    v_mfma_f32_32x32x16_bf16 v[80:95], a[236:239], v[100:103], v[80:95]
    buffer_load_dwordx4 v[104:107], v1, s[20:23], s69 offen offset:0 sc1
    v_cvt_pk_f16_f32 v153, v154, v155
    v_mfma_f32_32x32x16_bf16 v[64:79], a[240:243], v[112:115], v[64:79]
    ds_write_b128 v6, v[144:147] offset:512
    v_cvt_pk_f16_f32 v154, v156, v157
    v_cvt_pk_f16_f32 v155, v158, v159
    v_mfma_f32_32x32x16_bf16 v[80:95], a[244:247], v[112:115], v[80:95]
    buffer_load_dwordx4 v[108:111], v1, s[20:23], s69 offen offset:1024 sc1
    ds_write_b128 v6, v[152:155] offset:640
    v_mfma_f32_32x32x16_bf16 v[64:79], a[248:251], v[116:119], v[64:79]
    v_mfma_f32_32x32x16_bf16 v[80:95], a[252:255], v[116:119], v[80:95]
    s_waitcnt vmcnt(10) lgkmcnt(0)
    buffer_load_dwordx4 v[120:123], v1, s[20:23], s70 offen offset:0 sc1
    s_barrier
    ds_read_b128 v[144:147], v38 offset:0
    ds_read_b128 v[148:151], v38 offset:1024
    ds_read_b128 v[152:155], v38 offset:2048
    ds_read_b128 v[156:159], v38 offset:3072
    v_mfma_f32_32x32x16_bf16 v[64:79], v[160:163], v[40:43], v[64:79]
    buffer_load_dword v0, v3, s[20:23], s88 offen offset:160 sc1
    v_mfma_f32_32x32x16_bf16 v[80:95], v[164:167], v[40:43], v[80:95]
    s_waitcnt vmcnt(10)
    buffer_load_dwordx4 v[40:43], v1, s[20:23], s70 offen offset:1024 sc1
    v_mfma_f32_32x32x16_bf16 v[64:79], v[168:171], v[44:47], v[64:79]
    s_waitcnt lgkmcnt(2)
    v_pk_add_f16 v144, v144, v148
    v_pk_add_f16 v145, v145, v149
    v_pk_add_f16 v146, v146, v150
    v_pk_add_f16 v147, v147, v151
    v_mfma_f32_32x32x16_bf16 v[80:95], v[172:175], v[44:47], v[80:95]
    s_waitcnt vmcnt(8) lgkmcnt(0)
    buffer_load_dwordx4 v[44:47], v1, s[20:23], s71 offen offset:0 sc1
    v_pk_add_f16 v152, v152, v156
    v_pk_add_f16 v153, v153, v157
    v_pk_add_f16 v154, v154, v158
    v_pk_add_f16 v155, v155, v159
    v_pk_add_f16 v144, v144, v152
    v_pk_add_f16 v145, v145, v153
    v_mfma_f32_32x32x16_bf16 v[64:79], v[176:179], v[48:51], v[64:79]
    v_pk_add_f16 v146, v146, v154
    v_pk_add_f16 v147, v147, v155
    v_fma_mix_f32 v10, v144, s80, v10 op_sel:[0,0,0] op_sel_hi:[1,0,0]
    v_fma_mix_f32 v11, v144, s80, v11 op_sel:[1,0,0] op_sel_hi:[1,0,0]
    v_fma_mix_f32 v12, v145, s80, v12 op_sel:[0,0,0] op_sel_hi:[1,0,0]
    v_fma_mix_f32 v13, v145, s80, v13 op_sel:[1,0,0] op_sel_hi:[1,0,0]
    v_mfma_f32_32x32x16_bf16 v[80:95], v[180:183], v[48:51], v[80:95]
    s_waitcnt vmcnt(8)
    buffer_load_dwordx4 v[48:51], v1, s[20:23], s71 offen offset:1024 sc1
    v_fma_mix_f32 v14, v146, s80, v14 op_sel:[0,0,0] op_sel_hi:[1,0,0]
    v_fma_mix_f32 v15, v146, s80, v15 op_sel:[1,0,0] op_sel_hi:[1,0,0]
    v_fma_mix_f32 v16, v147, s80, v16 op_sel:[0,0,0] op_sel_hi:[1,0,0]
    v_fma_mix_f32 v17, v147, s80, v17 op_sel:[1,0,0] op_sel_hi:[1,0,0]
    v_mul_f32 v138, v10, v10
    v_mfma_f32_32x32x16_bf16 v[64:79], v[184:187], v[52:55], v[64:79]
    v_add_f32 v136, v10, v11
    v_fmac_f32 v138, v11, v11
    v_add_f32 v136, v136, v12
    v_fmac_f32 v138, v12, v12
    v_add_f32 v136, v136, v13
    v_fmac_f32 v138, v13, v13
    v_add_f32 v136, v136, v14
    v_mfma_f32_32x32x16_bf16 v[80:95], v[188:191], v[52:55], v[80:95]
    s_waitcnt vmcnt(8)
    v_fmac_f32 v138, v14, v14
    v_add_f32 v136, v136, v15
    v_fmac_f32 v138, v15, v15
    v_add_f32 v136, v136, v16
    v_fmac_f32 v138, v16, v16
    v_add_f32 v136, v136, v17
    v_fmac_f32 v138, v17, v17
    v_mfma_f32_32x32x16_bf16 v[64:79], v[192:195], v[56:59], v[64:79]
    v_and_b32 v140, s86, v1
    v_xor_b32 v137, 2147483648, v2
    v_permlane32_swap_b32 v136, v138
    v_add_f32 v136, v136, v138
    v_mov_b32 v139, v136
    v_lshlrev_b32 v128, 16, v26
    v_mfma_f32_32x32x16_bf16 v[80:95], v[196:199], v[56:59], v[80:95]
    s_waitcnt vmcnt(7)
    v_lshlrev_b32 v129, 16, v27
    v_permlane16_swap_b32 v136, v139
    v_add_f32 v136, v136, v139
    v_lshlrev_b32 v130, 16, v28
    v_lshlrev_b32 v131, 16, v29
    v_add_f32_dpp v136, v136, v136 row_ror:8 row_mask:0xf bank_mask:0xf
    v_mfma_f32_32x32x16_bf16 v[64:79], v[200:203], v[60:63], v[64:79]
    buffer_store_dwordx2 v[136:137], v140, s[20:23], s99 offen offset:0
    v_mfma_f32_32x32x16_bf16 v[80:95], v[204:207], v[60:63], v[80:95]
    s_waitcnt vmcnt(4)
    v_cmp_ne_u32 vcc, s59, v0
    v_mfma_f32_32x32x16_bf16 v[64:79], v[208:211], v[104:107], v[64:79]
    s_cbranch_vccnz Lrt_80
Lck_79:
    v_mfma_f32_32x32x16_bf16 v[80:95], v[212:215], v[104:107], v[80:95]
    buffer_load_dwordx4 v[52:55], v1, s[20:23], s66 offen offset:2048 sc1
    v_mfma_f32_32x32x16_bf16 v[64:79], v[216:219], v[108:111], v[64:79]
    buffer_load_dwordx4 v[56:59], v1, s[20:23], s66 offen offset:3072 sc1
    v_mfma_f32_32x32x16_bf16 v[80:95], v[220:223], v[108:111], v[80:95]
    v_mfma_f32_32x32x16_bf16 v[64:79], v[224:227], v[120:123], v[64:79]
    buffer_load_dwordx4 v[60:63], v1, s[20:23], s67 offen offset:2048 sc1
    v_mfma_f32_32x32x16_bf16 v[80:95], v[228:231], v[120:123], v[80:95]
    s_waitcnt vmcnt(6)
    v_mfma_f32_32x32x16_bf16 v[64:79], v[232:235], v[40:43], v[64:79]
    buffer_load_dwordx4 v[104:107], v1, s[20:23], s67 offen offset:3072 sc1
    v_mfma_f32_32x32x16_bf16 v[80:95], v[236:239], v[40:43], v[80:95]
    s_waitcnt vmcnt(6)
    buffer_load_dwordx2 v[144:145], v1, s[20:23], s98 offen offset:0 sc1
    buffer_load_dwordx2 v[146:147], v1, s[20:23], s98 offen offset:1024 sc1
    v_mfma_f32_32x32x16_bf16 v[64:79], v[240:243], v[44:47], v[64:79]
    buffer_load_dwordx4 v[40:43], v1, s[20:23], s68 offen offset:2048 sc1
    ds_read_b64_tr_b16 v[96:97], v8 offset:16384
    ds_read_b64_tr_b16 v[98:99], v8 offset:17408
    v_mfma_f32_32x32x16_bf16 v[80:95], v[244:247], v[44:47], v[80:95]
    s_waitcnt vmcnt(8)
    ds_read_b64_tr_b16 v[100:101], v9 offset:16384
    ds_read_b64_tr_b16 v[102:103], v9 offset:17408
    v_mfma_f32_32x32x16_bf16 v[64:79], v[248:251], v[48:51], v[64:79]
    buffer_load_dwordx4 v[44:47], v1, s[20:23], s68 offen offset:3072 sc1
    ds_read_b64_tr_b16 v[112:113], v8 offset:18432
    ds_read_b64_tr_b16 v[114:115], v8 offset:19456
    v_mfma_f32_32x32x16_bf16 v[80:95], v[252:255], v[48:51], v[80:95]
    s_waitcnt vmcnt(7) lgkmcnt(4)
    ds_read_b64_tr_b16 v[116:117], v9 offset:18432
    ds_read_b64_tr_b16 v[118:119], v9 offset:19456
    v_mfma_f32_32x32x16_bf16 v[64:79], v[96:99], v[52:55], v[64:79]
    s_waitcnt lgkmcnt(4)
    buffer_load_dwordx4 v[48:51], v1, s[20:23], s69 offen offset:2048 sc1
    ds_read_b64_tr_b16 v[96:97], v8 offset:20480
    ds_read_b64_tr_b16 v[98:99], v8 offset:21504
    v_mfma_f32_32x32x16_bf16 v[80:95], v[100:103], v[52:55], v[80:95]
    s_waitcnt vmcnt(7) lgkmcnt(4)
    ds_read_b64_tr_b16 v[100:101], v9 offset:20480
    ds_read_b64_tr_b16 v[102:103], v9 offset:21504
    v_mfma_f32_32x32x16_bf16 v[64:79], v[112:115], v[56:59], v[64:79]
    s_waitcnt lgkmcnt(4)
    buffer_load_dwordx4 v[52:55], v1, s[20:23], s69 offen offset:3072 sc1
    ds_read_b64_tr_b16 v[112:113], v8 offset:22528
    ds_read_b64_tr_b16 v[114:115], v8 offset:23552
    v_mfma_f32_32x32x16_bf16 v[80:95], v[116:119], v[56:59], v[80:95]
    s_waitcnt vmcnt(7) lgkmcnt(4)
    ds_read_b64_tr_b16 v[116:117], v9 offset:22528
    ds_read_b64_tr_b16 v[118:119], v9 offset:23552
    v_mfma_f32_32x32x16_bf16 v[64:79], v[96:99], v[60:63], v[64:79]
    s_waitcnt vmcnt(4) lgkmcnt(4)
    buffer_load_dwordx4 v[56:59], v1, s[20:23], s70 offen offset:2048 sc1
    ds_read_b64_tr_b16 v[96:97], v8 offset:0
    ds_read_b64_tr_b16 v[98:99], v8 offset:1024
    v_bitop3_b32 v148, v145, v147, s83 bitop3:0x7e
    v_cmp_ne_u32 vcc, 0, v148
    v_mfma_f32_32x32x16_bf16 v[80:95], v[100:103], v[60:63], v[80:95]
    s_waitcnt lgkmcnt(4)
    ds_read_b64_tr_b16 v[100:101], v9 offset:0
    ds_read_b64_tr_b16 v[102:103], v9 offset:1024
    s_cbranch_vccnz Lrt_82
Lck_81:
    v_add_f32_dpp v144, v146, v144 quad_perm:[0,1,2,3] row_mask:0xf bank_mask:0x3
    v_lshlrev_b32 v132, 16, v30
    v_lshlrev_b32 v133, 16, v31
    v_add_f32_dpp v144, v146, v144 quad_perm:[0,1,2,3] row_mask:0x5 bank_mask:0xc
    v_mfma_f32_32x32x16_bf16 v[64:79], v[112:115], v[104:107], v[64:79]
    s_waitcnt lgkmcnt(4)
    buffer_load_dwordx4 v[60:63], v1, s[20:23], s70 offen offset:3072 sc1
    ds_read_b64_tr_b16 v[112:113], v8 offset:2048
    ds_read_b64_tr_b16 v[114:115], v8 offset:3072
    v_lshlrev_b32 v134, 16, v32
    v_lshlrev_b32 v135, 16, v33
    v_add_f32_dpp v144, v144, v144 row_ror:8 row_mask:0xf bank_mask:0xf
    v_mov_b32 v148, v144
    v_mfma_f32_32x32x16_bf16 v[80:95], v[116:119], v[104:107], v[80:95]
    s_waitcnt vmcnt(5) lgkmcnt(4)
    buffer_load_dwordx4 v[104:107], v1, s[20:23], s71 offen offset:2048 sc1
    ds_read_b64_tr_b16 v[116:117], v9 offset:2048
    ds_read_b64_tr_b16 v[118:119], v9 offset:3072
    v_xor_b32 v141, s90, v1
    v_xor_b32 v143, s90, v38
    v_permlane16_swap_b32 v144, v148
    v_mfma_f32_32x32x16_bf16 v[64:79], v[96:99], v[40:43], v[64:79]
    s_waitcnt lgkmcnt(4)
    buffer_load_dwordx4 v[108:111], v1, s[20:23], s71 offen offset:3072 sc1
    ds_read_b64_tr_b16 v[96:97], v8 offset:4096
    ds_read_b64_tr_b16 v[98:99], v8 offset:5120
    v_add_f32 v144, v144, v148
    v_mov_b32 v148, v144
    v_lshrrev_b32 v142, 7, v1
    v_lshl_add_u32 v142, v142, 5, s93
    v_mfma_f32_32x32x16_bf16 v[80:95], v[100:103], v[40:43], v[80:95]
    s_waitcnt vmcnt(6) lgkmcnt(4)
    ds_read_b64_tr_b16 v[100:101], v9 offset:4096
    ds_read_b64_tr_b16 v[102:103], v9 offset:5120
    v_permlane32_swap_b32 v144, v148
    v_mul_f32 v149, 0xbb124925, v144
    v_fmaak_f32 v150, v149, v149, 0xb727c5ac
    v_fmac_f32 v150, 0xbb124925, v148
    v_mfma_f32_32x32x16_bf16 v[64:79], v[112:115], v[44:47], v[64:79]
    s_waitcnt lgkmcnt(4)
    ds_read_b64_tr_b16 v[112:113], v8 offset:6144
    ds_read_b64_tr_b16 v[114:115], v8 offset:7168
    v_rsq_f32_e64 v150, |v150|
    s_add_u32 s64, s65, 0
    v_mul_f32 v149, v149, v150
    v_fma_f32 v152, v10, v150, v149
    v_mfma_f32_32x32x16_bf16 v[80:95], v[116:119], v[44:47], v[80:95]
    s_waitcnt vmcnt(5) lgkmcnt(4)
    ds_read_b64_tr_b16 v[116:117], v9 offset:6144
    ds_read_b64_tr_b16 v[118:119], v9 offset:7168
    v_fma_f32 v153, v11, v150, v149
    v_fmac_f32 v10, v152, v128
    v_fmac_f32 v11, v153, v129
    v_fma_f32 v152, v12, v150, v149
    v_fma_f32 v153, v13, v150, v149
    v_mfma_f32_32x32x16_bf16 v[64:79], v[96:99], v[48:51], v[64:79]
    s_waitcnt lgkmcnt(4)
    ds_read_b64_tr_b16 v[96:97], v8 offset:8192
    ds_read_b64_tr_b16 v[98:99], v8 offset:9216
    v_cvt_pk_bf16_f32 v156, v10, v11
    v_fmac_f32 v12, v152, v130
    v_fmac_f32 v13, v153, v131
    v_fma_f32 v152, v14, v150, v149
    v_fma_f32 v153, v15, v150, v149
    v_mfma_f32_32x32x16_bf16 v[80:95], v[100:103], v[48:51], v[80:95]
    s_waitcnt vmcnt(4) lgkmcnt(4)
    ds_read_b64_tr_b16 v[100:101], v9 offset:8192
    ds_read_b64_tr_b16 v[102:103], v9 offset:9216
    v_cvt_pk_bf16_f32 v157, v12, v13
    v_fmac_f32 v14, v152, v132
    v_fmac_f32 v15, v153, v133
    v_fma_f32 v152, v16, v150, v149
    v_fma_f32 v153, v17, v150, v149
    v_mfma_f32_32x32x16_bf16 v[64:79], v[112:115], v[52:55], v[64:79]
    s_waitcnt lgkmcnt(4)
    ds_read_b64_tr_b16 v[112:113], v8 offset:10240
    ds_read_b64_tr_b16 v[114:115], v8 offset:11264
    v_cvt_pk_bf16_f32 v158, v14, v15
    v_fmac_f32 v16, v152, v134
    v_fmac_f32 v17, v153, v135
    v_cvt_pk_bf16_f32 v159, v16, v17
    v_mfma_f32_32x32x16_bf16 v[80:95], v[116:119], v[52:55], v[80:95]
    s_waitcnt vmcnt(3) lgkmcnt(4)
    ds_read_b64_tr_b16 v[116:117], v8 offset:12288
    ds_read_b64_tr_b16 v[118:119], v8 offset:13312
    buffer_store_dwordx4 v[156:159], v141, s[20:23], s64 offen
    ds_write_b128 v143, v[156:159] offset:0
    ds_read_b128 v[144:147], v142 offset:0
    ds_read_b128 v[148:151], v142 offset:16
    v_mul_f32 v138, v10, v10
    v_mfma_f32_32x32x16_bf16 v[64:79], v[96:99], v[56:59], v[64:79]
    s_waitcnt lgkmcnt(7)
    ds_read_b64_tr_b16 v[96:97], v8 offset:14336
    ds_read_b64_tr_b16 v[98:99], v8 offset:15360
    v_add_f32 v136, v10, v11
    v_fmac_f32 v138, v11, v11
    v_add_f32 v136, v136, v12
    v_fmac_f32 v138, v12, v12
    v_add_f32 v136, v136, v13
    v_mfma_f32_32x32x16_bf16 v[80:95], v[100:103], v[56:59], v[80:95]
    s_waitcnt vmcnt(3) lgkmcnt(7)
    ds_read_b64_tr_b16 v[100:101], v9 offset:10240
    ds_read_b64_tr_b16 v[102:103], v9 offset:11264
    v_fmac_f32 v138, v13, v13
    v_add_f32 v136, v136, v14
    v_fmac_f32 v138, v14, v14
    v_add_f32 v136, v136, v15
    v_fmac_f32 v138, v15, v15
    v_mfma_f32_32x32x16_bf16 v[64:79], v[112:115], v[60:63], v[64:79]
    s_waitcnt vmcnt(2) lgkmcnt(7)
    ds_read_b64_tr_b16 v[112:113], v9 offset:12288
    ds_read_b64_tr_b16 v[114:115], v9 offset:13312
    v_add_f32 v136, v136, v16
    v_fmac_f32 v138, v16, v16
    v_add_f32 v136, v136, v17
    v_fmac_f32 v138, v17, v17
    v_mfma_f32_32x32x16_bf16 v[64:79], v[116:119], v[104:107], v[64:79]
    s_waitcnt vmcnt(1) lgkmcnt(4)
    ds_read_b64_tr_b16 v[116:117], v9 offset:14336
    ds_read_b64_tr_b16 v[118:119], v9 offset:15360
    v_permlane32_swap_b32 v136, v138
    v_add_f32 v136, v136, v138
    v_mov_b32 v139, v136
    v_mfma_f32_32x32x16_bf16 v[64:79], v[96:99], v[108:111], v[64:79]
    s_waitcnt lgkmcnt(4)
    v_permlane16_swap_b32 v136, v139
    v_add_f32 v136, v136, v139
    s_nop 1
    v_add_f32_dpp v136, v136, v136 row_ror:8 row_mask:0xf bank_mask:0xf
    v_mfma_f32_32x32x16_bf16 v[80:95], v[100:103], v[60:63], v[80:95]
    s_waitcnt lgkmcnt(2)
    buffer_store_dwordx2 v[136:137], v140, s[20:23], s99 offen offset:2048
    v_add_f32 v10, v10, v144
    v_add_f32 v11, v11, v145
    v_add_f32 v12, v12, v146
    v_add_f32 v13, v13, v147
    v_add_f32 v14, v14, v148
    v_add_f32 v15, v15, v149
    v_mfma_f32_32x32x16_bf16 v[80:95], v[112:115], v[104:107], v[80:95]
    s_waitcnt lgkmcnt(0)
    v_add_f32 v16, v16, v150
    v_add_f32 v17, v17, v151
    v_mfma_f32_32x32x16_bf16 v[80:95], v[116:119], v[108:111], v[80:95]
    v_cvt_pk_f16_f32 v64, v64, v65
    v_cvt_pk_f16_f32 v65, v66, v67
    v_cvt_pk_f16_f32 v66, v68, v69
    v_cvt_pk_f16_f32 v67, v70, v71
    v_cvt_pk_f16_f32 v72, v72, v73
    v_cvt_pk_f16_f32 v73, v74, v75
    ds_write_b128 v6, v[64:67] offset:8192
    v_cvt_pk_f16_f32 v74, v76, v77
    v_cvt_pk_f16_f32 v75, v78, v79
    ds_write_b128 v6, v[72:75] offset:8320
    s_nop 1
    v_cvt_pk_f16_f32 v80, v80, v81
    v_cvt_pk_f16_f32 v81, v82, v83
    v_cvt_pk_f16_f32 v82, v84, v85
    v_cvt_pk_f16_f32 v83, v86, v87
    v_cvt_pk_f16_f32 v88, v88, v89
    v_cvt_pk_f16_f32 v89, v90, v91
    ds_write_b128 v6, v[80:83] offset:8704
    v_cvt_pk_f16_f32 v90, v92, v93
    v_cvt_pk_f16_f32 v91, v94, v95
    ds_write_b128 v6, v[88:91] offset:8832
    s_waitcnt lgkmcnt(0)
    s_barrier
    ds_read_b128 v[80:83], v38 offset:8192
    ds_read_b128 v[84:87], v38 offset:9216
    ds_read_b128 v[88:91], v38 offset:10240
    ds_read_b128 v[92:95], v38 offset:11264
    s_waitcnt lgkmcnt(2)
    v_pk_add_f16 v80, v80, v84
    v_pk_add_f16 v81, v81, v85
    v_pk_add_f16 v82, v82, v86
    v_pk_add_f16 v83, v83, v87
    s_waitcnt lgkmcnt(0)
    v_pk_add_f16 v88, v88, v92
    v_pk_add_f16 v89, v89, v93
    v_pk_add_f16 v90, v90, v94
    v_pk_add_f16 v91, v91, v95
    v_pk_add_f16 v80, v80, v88
    v_pk_add_f16 v81, v81, v89
    v_pk_add_f16 v82, v82, v90
L_i3693:
    s_cbranch_execz L_backM
    v_pk_add_f16 v83, v83, v91
    v_fma_mix_f32 v18, v80, s80, v18 op_sel:[0,0,0] op_sel_hi:[1,0,0]
    v_fma_mix_f32 v19, v80, s80, v19 op_sel:[1,0,0] op_sel_hi:[1,0,0]
    v_fma_mix_f32 v20, v81, s80, v20 op_sel:[0,0,0] op_sel_hi:[1,0,0]
    v_fma_mix_f32 v21, v81, s80, v21 op_sel:[1,0,0] op_sel_hi:[1,0,0]
    v_fma_mix_f32 v22, v82, s80, v22 op_sel:[0,0,0] op_sel_hi:[1,0,0]
    v_fma_mix_f32 v23, v82, s80, v23 op_sel:[1,0,0] op_sel_hi:[1,0,0]
    v_fma_mix_f32 v24, v83, s80, v24 op_sel:[0,0,0] op_sel_hi:[1,0,0]
    v_fma_mix_f32 v25, v83, s80, v25 op_sel:[1,0,0] op_sel_hi:[1,0,0]
    v_pk_add_f32 v[88:89], v[18:19], v[20:21]
    v_pk_mul_f32 v[90:91], v[18:19], v[18:19]
    v_pk_fma_f32 v[90:91], v[20:21], v[20:21], v[90:91]
    v_pk_add_f32 v[88:89], v[88:89], v[22:23]
    v_pk_fma_f32 v[90:91], v[22:23], v[22:23], v[90:91]
    v_pk_add_f32 v[88:89], v[88:89], v[24:25]
    v_pk_fma_f32 v[90:91], v[24:25], v[24:25], v[90:91]
    v_add_f32 v72, v88, v89
    v_add_f32 v74, v90, v91
    v_and_b32 v76, s86, v1
    v_xor_b32 v73, 2147483648, v2
    v_permlane32_swap_b32 v72, v74
    v_add_f32 v72, v72, v74
    v_mov_b32 v75, v72
    v_and_b32 v64, s60, v26
    v_and_b32 v65, s60, v27
    v_permlane16_swap_b32 v72, v75
    v_add_f32 v72, v72, v75
    v_and_b32 v66, s60, v28
    v_and_b32 v67, s60, v29
    v_add_f32_dpp v72, v72, v72 row_ror:8 row_mask:0xf bank_mask:0xf
    buffer_store_dwordx2 v[72:73], v76, s[20:23], s99 offen offset:8
    s_add_u32 m0, s87, 1024
    s_add_u32 s57, s66, 4653056
    buffer_load_dwordx4 v1, s[20:23], s57 offen sc1 lds
    s_add_u32 m0, s87, 2048
    s_add_u32 s57, s67, 4653056
    buffer_load_dwordx4 v1, s[20:23], s57 offen sc1 lds
    s_add_u32 m0, s87, 3072
    s_add_u32 s57, s68, 4653056
    buffer_load_dwordx4 v1, s[20:23], s57 offen sc1 lds
    s_add_u32 m0, s87, 4096
    s_add_u32 s57, s69, 4653056
    buffer_load_dwordx4 v1, s[20:23], s57 offen sc1 lds
    s_add_u32 m0, s87, 5120
    s_add_u32 s57, s70, 4653056
    buffer_load_dwordx4 v1, s[20:23], s57 offen sc1 lds
    s_add_u32 m0, s87, 6144
    s_add_u32 s57, s71, 4653056
    buffer_load_dwordx4 v1, s[20:23], s57 offen sc1 lds
    buffer_load_dwordx2 v[80:81], v1, s[20:23], s98 offen offset:8 sc1
    buffer_load_dwordx2 v[82:83], v1, s[20:23], s98 offen offset:1032 sc1
    buffer_load_dwordx2 v[112:113], v1, s[20:23], s98 offen offset:2048 sc1
    buffer_load_dwordx2 v[114:115], v1, s[20:23], s98 offen offset:3072 sc1
    v_pk_add_u16 v56, v5, 0 op_sel_hi:[0,0]
    v_lshrrev_b32 v57, 16, v5
    v_mov_b32 v62, 0
    v_pk_add_u16 v58, v7, 0 op_sel_hi:[0,0]
    v_lshrrev_b32 v59, 16, v7
    v_mov_b32 v63, 0
    s_waitcnt vmcnt(8)
    ds_read2st64_b32 v[46:47], v38 offset0:4 offset1:8
    s_waitcnt lgkmcnt(0)
    v_max_u32 v46, v46, v47
    v_cmp_eq_u32 vcc, -1, v46
    s_cbranch_vccnz Lzr_153
Lzc_152:
    s_barrier
    ds_read_b128 v[128:131], v4 offset:0
    ds_read_b128 v[132:135], v4 offset:256
    ds_read_b128 v[136:139], v4 offset:512
    ds_read_b128 v[140:143], v4 offset:768
    ds_read_b128 v[144:147], v4 offset:1024
    ds_read_b128 v[148:151], v4 offset:1280
    ds_read_b128 v[152:155], v4 offset:1536
    s_waitcnt lgkmcnt(6)
    v_mfma_f32_32x32x16_bf16 v[96:111], a[0:3], v[128:131], 0
    s_waitcnt lgkmcnt(5)
    ds_read_b128 v[156:159], v4 offset:1792
    v_mfma_f32_32x32x16_bf16 v[96:111], a[8:11], v[132:135], v[96:111]
    s_waitcnt lgkmcnt(4)
    ds_read_b128 v[128:131], v4 offset:2048
    v_mfma_f32_32x32x16_bf16 v[96:111], a[16:19], v[136:139], v[96:111]
    s_waitcnt vmcnt(4)
    ds_read_b128 v[132:135], v4 offset:2304
    ds_read2st64_b32 v[46:47], v38 offset0:12 offset1:16
    ds_read2st64_b32 v[48:49], v38 offset0:20 offset1:24
    v_mfma_f32_32x32x16_bf16 v[96:111], a[24:27], v[140:143], v[96:111]
    s_waitcnt lgkmcnt(6)
    ds_read_b128 v[136:139], v4 offset:2560
    v_mfma_f32_32x32x16_bf16 v[96:111], a[32:35], v[144:147], v[96:111]
    ds_read_b128 v[140:143], v4 offset:2816
    v_mfma_f32_32x32x16_bf16 v[96:111], a[40:43], v[148:151], v[96:111]
    s_waitcnt vmcnt(2) lgkmcnt(6)
    v_bitop3_b32 v84, v81, v83, s83 bitop3:0x7e
    v_cmp_ne_u32 vcc, 0, v84
    v_mfma_f32_32x32x16_bf16 v[96:111], a[48:51], v[152:155], v[96:111]
    s_cbranch_vccnz Lrt_155
Lck_154:
    v_add_f32_dpp v80, v82, v80 quad_perm:[0,1,2,3] row_mask:0xf bank_mask:0x3
    v_and_b32 v68, s60, v30
    v_and_b32 v69, s60, v31
    v_add_f32_dpp v80, v82, v80 quad_perm:[0,1,2,3] row_mask:0x5 bank_mask:0xc
    v_and_b32 v70, s60, v32
    v_and_b32 v71, s60, v33
    v_mfma_f32_32x32x16_bf16 v[96:111], a[56:59], v[156:159], v[96:111]
    s_waitcnt lgkmcnt(2)
    v_max3_u32 v47, v47, v48, v49
    v_max_u32 v46, v46, v47
    v_cmp_eq_u32 vcc, -1, v46
    v_add_f32_dpp v80, v80, v80 row_ror:8 row_mask:0xf bank_mask:0xf
    v_mov_b32 v84, v80
    v_xor_b32 v77, s90, v1
    v_mfma_f32_32x32x16_bf16 v[96:111], a[64:67], v[128:131], v[96:111]
    s_cbranch_vccnz Lzr_161
Lzc_160:
    s_barrier
    v_xor_b32 v79, s90, v38
    v_permlane16_swap_b32 v80, v84
    v_mfma_f32_32x32x16_bf16 v[96:111], a[72:75], v[132:135], v[96:111]
    s_waitcnt lgkmcnt(0)
    ds_read_b128 v[144:147], v4 offset:3072
    ds_read_b128 v[148:151], v4 offset:3328
    ds_read_b128 v[152:155], v4 offset:3584
    v_add_f32 v80, v80, v84
    v_mov_b32 v84, v80
    v_lshrrev_b32 v78, 7, v1
    v_lshl_add_u32 v78, v78, 5, s93
    v_mfma_f32_32x32x16_bf16 v[96:111], a[80:83], v[136:139], v[96:111]
    ds_read_b128 v[156:159], v4 offset:3840
    ds_read_b128 v[128:131], v4 offset:4096
    v_permlane32_swap_b32 v80, v84
    v_mul_f32 v85, 0xbb124925, v80
    v_fmaak_f32 v86, v85, v85, 0xb727c5ac
    v_mfma_f32_32x32x16_bf16 v[96:111], a[88:91], v[140:143], v[96:111]
    s_waitcnt lgkmcnt(3)
    ds_read_b128 v[132:135], v4 offset:4352
    ds_read_b128 v[136:139], v4 offset:4608
    v_fmac_f32 v86, 0xbb124925, v84
    v_rsq_f32_e64 v86, |v86|
    s_add_u32 s64, s65, 1024
    v_mfma_f32_32x32x16_bf16 v[96:111], a[96:99], v[144:147], v[96:111]
    s_waitcnt vmcnt(0)
    ds_read_b128 v[140:143], v4 offset:4864
    v_bitop3_b32 v116, v113, v115, s83 bitop3:0x7e
    v_cmp_ne_u32 vcc, 0, v116
    v_mul_f32 v85, v85, v86
    v_fma_f32 v88, v18, v86, v85
    v_fma_f32 v89, v19, v86, v85
    v_mfma_f32_32x32x16_bf16 v[96:111], a[104:107], v[148:151], v[96:111]
    s_waitcnt lgkmcnt(4)
    ds_read_b128 v[144:147], v4 offset:5120
    s_cbranch_vccnz Lrt_157
Lck_156:
    v_fmac_f32 v18, v88, v64
    v_fmac_f32 v19, v89, v65
    v_fma_f32 v88, v20, v86, v85
    v_fma_f32 v89, v21, v86, v85
    v_cvt_pk_bf16_f32 v92, v18, v19
    v_mfma_f32_32x32x16_bf16 v[96:111], a[112:115], v[152:155], v[96:111]
    ds_read_b128 v[148:151], v4 offset:5376
    v_fmac_f32 v20, v88, v66
    v_fmac_f32 v21, v89, v67
    v_fma_f32 v88, v22, v86, v85
    v_fma_f32 v89, v23, v86, v85
    v_cvt_pk_bf16_f32 v93, v20, v21
    v_mfma_f32_32x32x16_bf16 v[96:111], a[120:123], v[156:159], v[96:111]
    s_waitcnt lgkmcnt(4)
    ds_read_b128 v[152:155], v4 offset:5632
    v_fmac_f32 v22, v88, v68
    v_fmac_f32 v23, v89, v69
    v_fma_f32 v88, v24, v86, v85
    v_fma_f32 v89, v25, v86, v85
    v_cvt_pk_bf16_f32 v94, v22, v23
    v_mfma_f32_32x32x16_bf16 v[96:111], a[128:131], v[128:131], v[96:111]
    ds_read_b128 v[156:159], v4 offset:5888
    v_fmac_f32 v24, v88, v70
    v_fmac_f32 v25, v89, v71
    v_cvt_pk_bf16_f32 v95, v24, v25
    v_add_f32_dpp v112, v114, v112 quad_perm:[0,1,2,3] row_mask:0xf bank_mask:0x3
    v_and_b32 v113, 0x270, v1
    v_add_u32 v113, s95, v113
    v_mfma_f32_32x32x16_bf16 v[96:111], a[136:139], v[132:135], v[96:111]
    s_waitcnt lgkmcnt(4)
    ds_read_b128 v[128:131], v4 offset:6144
    buffer_store_dwordx4 v[92:95], v77, s[20:23], s64 offen
    ds_write_b128 v79, v[92:95] offset:8192
    ds_read_b128 v[80:83], v78 offset:0
    ds_read_b128 v[84:87], v78 offset:16
    v_add_f32_dpp v112, v114, v112 quad_perm:[0,1,2,3] row_mask:0x5 bank_mask:0xc
    v_mfma_f32_32x32x16_bf16 v[96:111], a[144:147], v[136:139], v[96:111]
    ds_read_b128 v[132:135], v4 offset:6400
    v_add_f32_dpp v112, v112, v112 row_ror:8 row_mask:0xf bank_mask:0xf
    v_mov_b32 v116, v112
    s_nop 1
    v_permlane16_swap_b32 v112, v116
    v_add_f32 v112, v112, v116
    v_mfma_f32_32x32x16_bf16 v[96:111], a[152:155], v[140:143], v[96:111]
    s_waitcnt lgkmcnt(7)
    ds_read_b128 v[136:139], v4 offset:6656
    v_mov_b32 v116, v112
    s_nop 1
    v_permlane32_swap_b32 v112, v116
    v_mul_f32 v117, 0xbb124925, v112
    v_fmaak_f32 v118, v117, v117, 0xaedbe66f
    v_fmac_f32 v118, 0xbb124925, v116
    v_mfma_f32_32x32x16_bf16 v[96:111], a[160:163], v[144:147], v[96:111]
    ds_read_b128 v[140:143], v4 offset:6912
    v_rsq_f32_e64 v119, |v118|
    v_mul_f32 v74, v18, v18
    v_mul_f32_e64 v118, |v118|, v119
    v_mul_f32 v114, 0xbeeff509, v119
    v_mfma_f32_32x32x16_bf16 v[96:111], a[168:171], v[148:151], v[96:111]
    s_waitcnt lgkmcnt(7)
    ds_read_b128 v[144:147], v4 offset:0
    v_mov_b32_dpp v118, v117 quad_perm:[0,1,2,3] row_mask:0x3 bank_mask:0xf
    v_cvt_pk_bf16_f32 v119, v118, v118
    v_lshlrev_b32 v119, 16, v119
    v_sub_f32 v119, v118, v119
    v_cvt_pk_bf16_f32 v115, v118, v119
    v_mfma_f32_32x32x16_bf16 v[96:111], a[176:179], v[152:155], v[96:111]
    ds_read_b128 v[148:151], v4 offset:256
    ds_write_b64 v113, v[114:115] offset:0
    v_add_f32 v72, v18, v19
    v_fmac_f32 v74, v19, v19
    v_add_f32 v72, v72, v20
    v_fmac_f32 v74, v20, v20
    v_mfma_f32_32x32x16_bf16 v[96:111], a[184:187], v[156:159], v[96:111]
    s_waitcnt lgkmcnt(5)
    ds_read_b128 v[152:155], v4 offset:512
    v_add_u32 v112, 161792, v1
    v_add_f32 v72, v72, v21
    v_fmac_f32 v74, v21, v21
    v_add_f32 v72, v72, v22
    v_fmac_f32 v74, v22, v22
    v_add_f32 v72, v72, v23
    v_mfma_f32_32x32x16_bf16 v[96:111], a[192:195], v[128:131], v[96:111]
    s_waitcnt lgkmcnt(1)
    ds_read_b128 v[156:159], v4 offset:768
    s_barrier
    ds_read_b64 v[52:53], v112 offset:0
    v_fmac_f32 v74, v23, v23
    v_add_f32 v72, v72, v24
    v_mfma_f32_32x32x16_bf16 v[96:111], a[200:203], v[132:135], v[96:111]
    ds_read_b128 v[128:131], v4 offset:1024
    v_fmac_f32 v74, v24, v24
    v_add_f32 v72, v72, v25
    v_fmac_f32 v74, v25, v25
    s_nop 1
    v_permlane32_swap_b32 v72, v74
    v_mfma_f32_32x32x16_bf16 v[96:111], a[208:211], v[136:139], v[96:111]
    s_waitcnt lgkmcnt(1)
    ds_read_b128 v[132:135], v4 offset:1280
    v_add_f32 v72, v72, v74
    v_mov_b32 v75, v72
    s_nop 1
    v_permlane16_swap_b32 v72, v75
    v_add_f32 v72, v72, v75
    s_nop 1
    v_add_f32_dpp v72, v72, v72 row_ror:8 row_mask:0xf bank_mask:0xf
    v_mfma_f32_32x32x16_bf16 v[96:111], a[216:219], v[140:143], v[96:111]
    ds_read_b128 v[136:139], v4 offset:1536
    buffer_store_dwordx2 v[72:73], v76, s[20:23], s99 offen offset:2056
    v_mov_b32 v60, v53
    v_mov_b32 v61, v53
    v_add_f32 v18, v18, v80
    v_add_f32 v19, v19, v81
    v_mfma_f32_32x32x16_bf16 v[96:111], v[56:59], v[60:63], v[96:111]
    v_add_f32 v20, v20, v82
    v_add_f32 v21, v21, v83
    v_add_f32 v22, v22, v84
    v_add_f32 v23, v23, v85
    v_add_f32 v24, v24, v86
    v_add_f32 v25, v25, v87
    v_mfma_f32_32x32x16_bf16 v[112:127], a[4:7], v[144:147], 0
    s_add_u32 m0, s87, 9216
    s_add_u32 s57, s66, 4654080
    ds_read_b128 v[140:143], v4 offset:1792
    buffer_load_dwordx4 v1, s[20:23], s57 offen sc1 lds
    v_mfma_f32_32x32x16_bf16 v[112:127], a[12:15], v[148:151], v[112:127]
    s_add_u32 m0, s87, 10240
    s_add_u32 s57, s67, 4654080
    ds_read_b128 v[144:147], v4 offset:2048
    buffer_load_dwordx4 v1, s[20:23], s57 offen sc1 lds
    v_mfma_f32_32x32x16_bf16 v[112:127], a[20:23], v[152:155], v[112:127]
    s_add_u32 s92, s65, 4290314240
    s_add_u32 m0, s87, 11264
    s_add_u32 s57, s68, 4654080
    ds_read_b128 v[148:151], v4 offset:2304
    buffer_load_dwordx4 v1, s[20:23], s57 offen sc1 lds
    v_mul_f32 v96, v52, v96
    v_mul_f32 v97, v52, v97
    v_mfma_f32_32x32x16_bf16 v[112:127], a[28:31], v[156:159], v[112:127]
    s_waitcnt lgkmcnt(4)
    s_add_u32 m0, s87, 12288
    s_add_u32 s57, s69, 4654080
    ds_read_b128 v[152:155], v4 offset:2560
    buffer_load_dwordx4 v1, s[20:23], s57 offen sc1 lds
    v_fma_f32 v34, v96, v96, s91
    v_fma_f32 v35, v97, v97, s91
    v_mul_f32 v34, v34, v96
    v_mfma_f32_32x32x16_bf16 v[112:127], a[36:39], v[128:131], v[112:127]
    s_add_u32 m0, s87, 13312
    s_add_u32 s57, s70, 4654080
    ds_read_b128 v[156:159], v4 offset:2816
    buffer_load_dwordx4 v1, s[20:23], s57 offen sc1 lds
    v_mul_f32 v35, v35, v97
    v_exp_f32 v34, v34
    v_mul_f32 v98, v52, v98
    v_mfma_f32_32x32x16_bf16 v[112:127], a[44:47], v[132:135], v[112:127]
    s_waitcnt lgkmcnt(4)
    s_add_u32 m0, s87, 14336
    s_add_u32 s57, s71, 4654080
    ds_read_b128 v[128:131], v4 offset:3072
    buffer_load_dwordx4 v1, s[20:23], s57 offen sc1 lds
    v_exp_f32 v35, v35
    v_mfma_f32_32x32x16_bf16 v[112:127], a[52:55], v[136:139], v[112:127]
    ds_read_b128 v[132:135], v4 offset:3328
    v_add_f32 v34, 1.0, v34
    v_mul_f32 v99, v52, v99
    v_add_f32 v35, 1.0, v35
    v_fma_f32 v36, v98, v98, s91
    v_rcp_f32 v34, v34
    v_mfma_f32_32x32x16_bf16 v[112:127], a[60:63], v[140:143], v[112:127]
    s_waitcnt lgkmcnt(4)
    ds_read_b128 v[136:139], v4 offset:3584
    v_fma_f32 v37, v99, v99, s91
    v_rcp_f32 v35, v35
    v_mul_f32 v36, v36, v98
    v_mul_f32 v34, v34, v96
    v_mul_f32 v37, v37, v99
    v_mfma_f32_32x32x16_bf16 v[112:127], a[68:71], v[144:147], v[112:127]
    ds_read_b128 v[140:143], v4 offset:3840
    v_mul_f32 v35, v35, v97
    v_exp_f32 v36, v36
    v_cvt_pk_bf16_f32 v96, v34, v35
    v_mul_f32 v100, v52, v100
    v_mfma_f32_32x32x16_bf16 v[112:127], a[76:79], v[148:151], v[112:127]
    s_waitcnt lgkmcnt(4)
    ds_read_b128 v[144:147], v4 offset:4096
    v_exp_f32 v37, v37
    v_add_f32 v36, 1.0, v36
    v_mul_f32 v101, v52, v101
    v_add_f32 v37, 1.0, v37
    v_fma_f32 v34, v100, v100, s91
    v_mfma_f32_32x32x16_bf16 v[112:127], a[84:87], v[152:155], v[112:127]
    ds_read_b128 v[148:151], v4 offset:4352
    v_rcp_f32 v36, v36
    v_fma_f32 v35, v101, v101, s91
    v_rcp_f32 v37, v37
    v_mul_f32 v34, v34, v100
    v_mfma_f32_32x32x16_bf16 v[112:127], a[92:95], v[156:159], v[112:127]
    s_waitcnt lgkmcnt(4)
    ds_read_b128 v[152:155], v4 offset:4608
    v_mul_f32 v36, v36, v98
    v_mul_f32 v35, v35, v101
    v_mul_f32 v37, v37, v99
    v_exp_f32 v34, v34
    v_cvt_pk_bf16_f32 v97, v36, v37
    v_mfma_f32_32x32x16_bf16 v[112:127], a[100:103], v[128:131], v[112:127]
    ds_read_b128 v[156:159], v4 offset:4864
    v_exp_f32 v35, v35
    v_mul_f32 v102, v52, v102
    v_add_f32 v34, 1.0, v34
    v_mul_f32 v103, v52, v103
    v_mfma_f32_32x32x16_bf16 v[112:127], a[108:111], v[132:135], v[112:127]
    s_waitcnt lgkmcnt(4)
    ds_read_b128 v[128:131], v4 offset:5120
    v_add_f32 v35, 1.0, v35
    v_fma_f32 v36, v102, v102, s91
    v_rcp_f32 v34, v34
    v_fma_f32 v37, v103, v103, s91
    v_mul_f32 v36, v36, v102
    v_mfma_f32_32x32x16_bf16 v[112:127], a[116:119], v[136:139], v[112:127]
    ds_read_b128 v[132:135], v4 offset:5376
    v_rcp_f32 v35, v35
    v_mul_f32 v34, v34, v100
    v_mul_f32 v37, v37, v103
    v_mul_f32 v35, v35, v101
    v_cvt_pk_bf16_f32 v98, v34, v35
    v_mfma_f32_32x32x16_bf16 v[112:127], a[124:127], v[140:143], v[112:127]
    s_waitcnt lgkmcnt(4)
    ds_read_b128 v[136:139], v4 offset:5632
    v_exp_f32 v36, v36
    v_exp_f32 v37, v37
    v_mul_f32 v104, v52, v104
    v_mfma_f32_32x32x16_bf16 v[112:127], a[132:135], v[144:147], v[112:127]
    s_waitcnt vmcnt(4)
    buffer_load_dwordx2 v[80:81], v1, s[20:23], s98 offen offset:2056 sc1
    buffer_load_dwordx2 v[82:83], v1, s[20:23], s98 offen offset:3080 sc1
    ds_read_b128 v[140:143], v4 offset:5888
    ds_read2st64_b32 v[46:47], v38 offset0:36 offset1:40
    v_add_f32 v36, 1.0, v36
    v_mul_f32 v105, v52, v105
    v_add_f32 v37, 1.0, v37
    v_mfma_f32_32x32x16_bf16 v[112:127], a[140:143], v[148:151], v[112:127]
    s_waitcnt lgkmcnt(5)
    ds_read_b128 v[144:147], v4 offset:6144
    v_fma_f32 v34, v104, v104, s91
    v_rcp_f32 v36, v36
    v_fma_f32 v35, v105, v105, s91
    v_rcp_f32 v37, v37
    v_mfma_f32_32x32x16_bf16 v[112:127], a[148:151], v[152:155], v[112:127]
    ds_read_b128 v[148:151], v4 offset:6400
    v_mul_f32 v34, v34, v104
    v_mul_f32 v36, v36, v102
    v_mul_f32 v35, v35, v105
    v_mul_f32 v37, v37, v103
    v_cvt_pk_bf16_f32 v99, v36, v37
    v_mfma_f32_32x32x16_bf16 v[112:127], a[156:159], v[156:159], v[112:127]
    s_waitcnt lgkmcnt(5)
    ds_read_b128 v[152:155], v4 offset:6656
    buffer_store_dwordx4 v[96:99], v1, s[20:23], s92 offen offset:0
    v_exp_f32 v34, v34
    v_exp_f32 v35, v35
    v_mul_f32 v106, v52, v106
    v_mfma_f32_32x32x16_bf16 v[112:127], a[164:167], v[128:131], v[112:127]
    ds_read_b128 v[156:159], v4 offset:6912
    v_add_f32 v34, 1.0, v34
    v_mul_f32 v107, v52, v107
    v_add_f32 v35, 1.0, v35
    v_fma_f32 v36, v106, v106, s91
    v_rcp_f32 v34, v34
    v_mfma_f32_32x32x16_bf16 v[112:127], a[172:175], v[132:135], v[112:127]
    s_waitcnt lgkmcnt(4)
    v_max_u32 v46, v46, v47
    v_cmp_eq_u32 vcc, -1, v46
    v_fma_f32 v37, v107, v107, s91
    v_rcp_f32 v35, v35
    v_mul_f32 v36, v36, v106
    v_mul_f32 v34, v34, v104
    v_mfma_f32_32x32x16_bf16 v[112:127], a[180:183], v[136:139], v[112:127]
    s_cbranch_vccnz Lzr_163
Lzc_162:
    s_barrier
    v_mul_f32 v37, v37, v107
    v_mul_f32 v35, v35, v105
    v_cvt_pk_bf16_f32 v100, v34, v35
    v_mfma_f32_32x32x16_bf16 v[112:127], a[188:191], v[140:143], v[112:127]
    s_waitcnt lgkmcnt(2)
    ds_read_b128 v[128:131], v4 offset:8192
    ds_read_b128 v[132:135], v4 offset:8448
    v_exp_f32 v36, v36
    v_exp_f32 v37, v37
    v_mul_f32 v108, v52, v108
    v_mfma_f32_32x32x16_bf16 v[112:127], a[196:199], v[144:147], v[112:127]
    ds_read_b128 v[136:139], v4 offset:8704
    v_add_f32 v36, 1.0, v36
    v_mul_f32 v109, v52, v109
    v_add_f32 v37, 1.0, v37
    v_fma_f32 v34, v108, v108, s91
    v_rcp_f32 v36, v36
    v_mfma_f32_32x32x16_bf16 v[112:127], a[204:207], v[148:151], v[112:127]
    s_waitcnt lgkmcnt(3)
    ds_read_b128 v[140:143], v4 offset:8960
    ds_read_b128 v[144:147], v4 offset:9216
    v_fma_f32 v35, v109, v109, s91
    v_rcp_f32 v37, v37
    v_mul_f32 v34, v34, v108
    v_mfma_f32_32x32x16_bf16 v[112:127], a[212:215], v[152:155], v[112:127]
    ds_read_b128 v[148:151], v4 offset:9472
    v_mul_f32 v36, v36, v106
    v_mul_f32 v35, v35, v109
    v_mul_f32 v37, v37, v107
    v_exp_f32 v34, v34
    v_cvt_pk_bf16_f32 v101, v36, v37
    v_mfma_f32_32x32x16_bf16 v[112:127], a[220:223], v[156:159], v[112:127]
    s_waitcnt vmcnt(1) lgkmcnt(4)
    ds_read_b128 v[152:155], v4 offset:9728
    v_bitop3_b32 v84, v81, v83, s83 bitop3:0x7e
    v_cmp_ne_u32 vcc, 0, v84
    v_exp_f32 v35, v35
    v_mul_f32 v110, v52, v110
    v_add_f32 v34, 1.0, v34
    v_mfma_f32_32x32x16_bf16 v[112:127], v[58:61], v[60:63], v[112:127]
    v_mul_f32 v111, v52, v111
    v_add_f32 v35, 1.0, v35
    v_fma_f32 v36, v110, v110, s91
    v_rcp_f32 v34, v34
    v_fma_f32 v37, v111, v111, s91
    v_mfma_f32_32x32x16_bf16 v[64:79], a[0:3], v[128:131], 0
    ds_read_b128 v[156:159], v4 offset:9984
    s_cbranch_vccnz Lrt_159
Lck_158:
    v_add_f32_dpp v80, v82, v80 quad_perm:[0,1,2,3] row_mask:0xf bank_mask:0x3
    v_and_b32 v81, 0x270, v1
    v_add_u32 v81, s95, v81
    v_add_f32_dpp v80, v82, v80 quad_perm:[0,1,2,3] row_mask:0x5 bank_mask:0xc
    v_mfma_f32_32x32x16_bf16 v[64:79], a[8:11], v[132:135], v[64:79]
    s_waitcnt lgkmcnt(4)
    ds_read_b128 v[128:131], v4 offset:10240
    v_add_f32_dpp v80, v80, v80 row_ror:8 row_mask:0xf bank_mask:0xf
    v_mov_b32 v84, v80
    s_nop 1
    v_permlane16_swap_b32 v80, v84
    v_add_f32 v80, v80, v84
    v_mov_b32 v84, v80
    v_mfma_f32_32x32x16_bf16 v[64:79], a[16:19], v[136:139], v[64:79]
    ds_read_b128 v[132:135], v4 offset:10496
    ds_read2st64_b32 v[46:47], v38 offset0:44 offset1:48
    ds_read2st64_b32 v[48:49], v38 offset0:52 offset1:56
    v_permlane32_swap_b32 v80, v84
    v_mul_f32 v85, 0xbb124925, v80
    v_fmaak_f32 v86, v85, v85, 0xaedbe66f
    v_mfma_f32_32x32x16_bf16 v[64:79], a[24:27], v[140:143], v[64:79]
    s_waitcnt lgkmcnt(6)
    ds_read_b128 v[136:139], v4 offset:10752
    v_fmac_f32 v86, 0xbb124925, v84
    v_rsq_f32_e64 v87, |v86|
    v_rcp_f32 v35, v35
    v_mul_f32_e64 v86, |v86|, v87
    v_mfma_f32_32x32x16_bf16 v[64:79], a[32:35], v[144:147], v[64:79]
    ds_read_b128 v[140:143], v4 offset:11008
    v_mul_f32 v82, 0xbeeff509, v87
    v_mov_b32_dpp v86, v85 quad_perm:[0,1,2,3] row_mask:0x3 bank_mask:0xf
    v_cvt_pk_bf16_f32 v87, v86, v86
    v_lshlrev_b32 v87, 16, v87
    v_sub_f32 v87, v86, v87
    v_mfma_f32_32x32x16_bf16 v[64:79], a[40:43], v[148:151], v[64:79]
    s_waitcnt lgkmcnt(6)
    v_cvt_pk_bf16_f32 v83, v86, v87
    v_mul_f32 v36, v36, v110
    v_mul_f32 v34, v34, v108
    v_mul_f32 v37, v37, v111
    v_mul_f32 v35, v35, v109
    v_exp_f32 v36, v36
    v_mfma_f32_32x32x16_bf16 v[64:79], a[48:51], v[152:155], v[64:79]
    ds_write_b64 v81, v[82:83] offset:8
    v_cvt_pk_bf16_f32 v102, v34, v35
    v_exp_f32 v37, v37
    v_mul_f32 v112, v52, v112
    v_add_f32 v36, 1.0, v36
    v_mul_f32 v113, v52, v113
    v_mfma_f32_32x32x16_bf16 v[64:79], a[56:59], v[156:159], v[64:79]
    s_waitcnt lgkmcnt(3)
    v_max3_u32 v47, v47, v48, v49
    v_max_u32 v46, v46, v47
    v_cmp_eq_u32 vcc, -1, v46
    v_add_u32 v80, 161792, v1
    v_add_f32 v37, 1.0, v37
    v_fma_f32 v34, v112, v112, s91
    v_mfma_f32_32x32x16_bf16 v[64:79], a[64:67], v[128:131], v[64:79]
    s_cbranch_vccnz Lzr_165
Lzc_164:
    s_barrier
    s_waitcnt lgkmcnt(0)
    s_barrier
    ds_read_b64 v[54:55], v80 offset:8
    v_mfma_f32_32x32x16_bf16 v[64:79], a[72:75], v[132:135], v[64:79]
    ds_read_b128 v[144:147], v4 offset:11264
    ds_read_b128 v[148:151], v4 offset:11520
    ds_read_b128 v[152:155], v4 offset:11776
    v_rcp_f32 v36, v36
    v_fma_f32 v35, v113, v113, s91
    v_mul_f32 v34, v34, v112
    v_mfma_f32_32x32x16_bf16 v[64:79], a[80:83], v[136:139], v[64:79]
    ds_read_b128 v[156:159], v4 offset:12032
    ds_read_b128 v[128:131], v4 offset:12288
    v_rcp_f32 v37, v37
    v_mul_f32 v36, v36, v110
    v_mul_f32 v35, v35, v113
    v_mfma_f32_32x32x16_bf16 v[64:79], a[88:91], v[140:143], v[64:79]
    s_waitcnt lgkmcnt(3)
    ds_read_b128 v[132:135], v4 offset:12544
    ds_read_b128 v[136:139], v4 offset:12800
    v_mul_f32 v37, v37, v111
    v_exp_f32 v34, v34
    v_cvt_pk_bf16_f32 v103, v36, v37
    v_mul_f32 v114, v52, v114
    v_mfma_f32_32x32x16_bf16 v[64:79], a[96:99], v[144:147], v[64:79]
    ds_read_b128 v[140:143], v4 offset:13056
    buffer_store_dwordx4 v[100:103], v1, s[20:23], s92 offen offset:1024
    v_mov_b32 v60, v55
    v_mov_b32 v61, v55
    v_exp_f32 v35, v35
    v_add_f32 v34, 1.0, v34
    v_mfma_f32_32x32x16_bf16 v[64:79], a[104:107], v[148:151], v[64:79]
    s_waitcnt lgkmcnt(4)
    ds_read_b128 v[144:147], v4 offset:13312
    v_mul_f32 v115, v52, v115
    v_add_f32 v35, 1.0, v35
    v_fma_f32 v36, v114, v114, s91
    v_rcp_f32 v34, v34
    v_fma_f32 v37, v115, v115, s91
    v_mfma_f32_32x32x16_bf16 v[64:79], a[112:115], v[152:155], v[64:79]
    ds_read_b128 v[148:151], v4 offset:13568
    v_rcp_f32 v35, v35
    v_mul_f32 v36, v36, v114
    v_mul_f32 v34, v34, v112
    v_mul_f32 v37, v37, v115
    v_mfma_f32_32x32x16_bf16 v[64:79], a[120:123], v[156:159], v[64:79]
    s_waitcnt lgkmcnt(4)
    ds_read_b128 v[152:155], v4 offset:13824
    v_mul_f32 v35, v35, v113
    v_exp_f32 v36, v36
    v_cvt_pk_bf16_f32 v112, v34, v35
    v_exp_f32 v37, v37
    v_mfma_f32_32x32x16_bf16 v[64:79], a[128:131], v[128:131], v[64:79]
    ds_read_b128 v[156:159], v4 offset:14080
    v_mul_f32 v116, v52, v116
    v_add_f32 v36, 1.0, v36
    v_mul_f32 v117, v52, v117
    v_add_f32 v37, 1.0, v37
    v_fma_f32 v34, v116, v116, s91
    v_fma_f32 v35, v117, v117, s91
    v_mfma_f32_32x32x16_bf16 v[64:79], a[136:139], v[132:135], v[64:79]
    s_waitcnt lgkmcnt(4)
    ds_read_b128 v[128:131], v4 offset:14336
    v_rcp_f32 v36, v36
    v_rcp_f32 v37, v37
    v_mul_f32 v34, v34, v116
    v_mfma_f32_32x32x16_bf16 v[64:79], a[144:147], v[136:139], v[64:79]
    ds_read_b128 v[132:135], v4 offset:14592
    v_mul_f32 v36, v36, v114
    v_mul_f32 v35, v35, v117
    v_mul_f32 v37, v37, v115
    v_exp_f32 v34, v34
    v_cvt_pk_bf16_f32 v113, v36, v37
    v_mfma_f32_32x32x16_bf16 v[64:79], a[152:155], v[140:143], v[64:79]
    s_waitcnt lgkmcnt(4)
    ds_read_b128 v[136:139], v4 offset:14848
    v_exp_f32 v35, v35
    v_mul_f32 v118, v52, v118
    v_add_f32 v34, 1.0, v34
    v_mul_f32 v119, v52, v119
    v_add_f32 v35, 1.0, v35
    v_mfma_f32_32x32x16_bf16 v[64:79], a[160:163], v[144:147], v[64:79]
    ds_read_b128 v[140:143], v4 offset:15104
    v_fma_f32 v36, v118, v118, s91
    v_rcp_f32 v34, v34
    v_fma_f32 v37, v119, v119, s91
    v_mul_f32 v36, v36, v118
    v_mfma_f32_32x32x16_bf16 v[64:79], a[168:171], v[148:151], v[64:79]
    s_waitcnt vmcnt(0) lgkmcnt(4)
    ds_read_b128 v[144:147], v4 offset:8192
    buffer_store_dword v2, off, s[20:23], s89 offset:256
    v_rcp_f32 v35, v35
    v_mul_f32 v34, v34, v116
    v_mul_f32 v37, v37, v119
    v_mul_f32 v35, v35, v117
    v_mfma_f32_32x32x16_bf16 v[64:79], a[176:179], v[152:155], v[64:79]
    ds_read_b128 v[148:151], v4 offset:8448
    v_exp_f32 v36, v36
    v_cvt_pk_bf16_f32 v114, v34, v35
    v_exp_f32 v37, v37
    v_mul_f32 v120, v52, v120
    v_mfma_f32_32x32x16_bf16 v[64:79], a[184:187], v[156:159], v[64:79]
    s_waitcnt lgkmcnt(4)
    ds_read_b128 v[152:155], v4 offset:8704
    v_add_f32 v36, 1.0, v36
    v_mul_f32 v121, v52, v121
    v_add_f32 v37, 1.0, v37
    v_fma_f32 v34, v120, v120, s91
    v_rcp_f32 v36, v36
    v_mfma_f32_32x32x16_bf16 v[64:79], a[192:195], v[128:131], v[64:79]
    ds_read_b128 v[156:159], v4 offset:8960
    v_fma_f32 v35, v121, v121, s91
    v_rcp_f32 v37, v37
    v_mul_f32 v34, v34, v120
    v_mul_f32 v36, v36, v118
    v_mfma_f32_32x32x16_bf16 v[64:79], a[200:203], v[132:135], v[64:79]
    s_waitcnt lgkmcnt(4)
    ds_read_b128 v[128:131], v4 offset:9216
    v_mul_f32 v35, v35, v121
    v_mul_f32 v37, v37, v119
    v_exp_f32 v34, v34
    v_cvt_pk_bf16_f32 v115, v36, v37
    v_mul_f32 v122, v52, v122
    v_mfma_f32_32x32x16_bf16 v[64:79], a[208:211], v[136:139], v[64:79]
    ds_read_b128 v[132:135], v4 offset:9472
    buffer_store_dwordx4 v[112:115], v1, s[20:23], s92 offen offset:2048
    v_exp_f32 v35, v35
    v_add_f32 v34, 1.0, v34
    v_mul_f32 v123, v52, v123
    v_add_f32 v35, 1.0, v35
    v_mfma_f32_32x32x16_bf16 v[64:79], a[216:219], v[140:143], v[64:79]
    s_waitcnt lgkmcnt(4)
    ds_read_b128 v[136:139], v4 offset:9728
L_i4371:
    s_cbranch_execz L_backM
    v_fma_f32 v36, v122, v122, s91
    v_rcp_f32 v34, v34
    v_fma_f32 v37, v123, v123, s91
    v_mul_f32 v36, v36, v122
    v_mfma_f32_32x32x16_bf16 v[64:79], v[56:59], v[60:63], v[64:79]
    v_rcp_f32 v35, v35
    v_mul_f32 v34, v34, v120
    v_mul_f32 v37, v37, v123
    v_mul_f32 v35, v35, v121
    v_cvt_pk_bf16_f32 v116, v34, v35
    v_mfma_f32_32x32x16_bf16 v[80:95], a[4:7], v[144:147], 0
    ds_read_b128 v[140:143], v4 offset:9984
    v_exp_f32 v36, v36
    v_exp_f32 v37, v37
    v_mul_f32 v124, v52, v124
    v_add_f32 v36, 1.0, v36
    v_mfma_f32_32x32x16_bf16 v[80:95], a[12:15], v[148:151], v[80:95]
    s_waitcnt lgkmcnt(4)
    ds_read_b128 v[144:147], v4 offset:10240
    v_mul_f32 v125, v52, v125
    v_add_f32 v37, 1.0, v37
    v_fma_f32 v34, v124, v124, s91
    v_rcp_f32 v36, v36
    v_fma_f32 v35, v125, v125, s91
    v_mfma_f32_32x32x16_bf16 v[80:95], a[20:23], v[152:155], v[80:95]
    ds_read_b128 v[148:151], v4 offset:10496
    v_rcp_f32 v37, v37
    v_mul_f32 v34, v34, v124
    v_mul_f32 v36, v36, v122
    v_mul_f32 v35, v35, v125
    v_mfma_f32_32x32x16_bf16 v[80:95], a[28:31], v[156:159], v[80:95]
    s_waitcnt lgkmcnt(4)
    ds_read_b128 v[152:155], v4 offset:10752
    v_mul_f32 v37, v37, v123
    v_exp_f32 v34, v34
    v_cvt_pk_bf16_f32 v117, v36, v37
    v_exp_f32 v35, v35
    v_mfma_f32_32x32x16_bf16 v[80:95], a[36:39], v[128:131], v[80:95]
    ds_read_b128 v[156:159], v4 offset:11008
    v_mul_f32 v126, v52, v126
    v_add_f32 v34, 1.0, v34
    v_mul_f32 v127, v52, v127
    v_add_f32 v35, 1.0, v35
    v_fma_f32 v36, v126, v126, s91
    v_fma_f32 v37, v127, v127, s91
    v_mfma_f32_32x32x16_bf16 v[80:95], a[44:47], v[132:135], v[80:95]
    s_waitcnt lgkmcnt(4)
    ds_read_b128 v[128:131], v4 offset:11264
    v_rcp_f32 v34, v34
    v_rcp_f32 v35, v35
    v_mul_f32 v36, v36, v126
    v_mul_f32 v34, v34, v124
    v_mfma_f32_32x32x16_bf16 v[80:95], a[52:55], v[136:139], v[80:95]
    ds_read_b128 v[132:135], v4 offset:11520
    v_mul_f32 v37, v37, v127
    v_mul_f32 v35, v35, v125
    v_exp_f32 v36, v36
    v_cvt_pk_bf16_f32 v118, v34, v35
    v_mfma_f32_32x32x16_bf16 v[80:95], a[60:63], v[140:143], v[80:95]
    s_waitcnt lgkmcnt(4)
    ds_read_b128 v[136:139], v4 offset:11776
    v_exp_f32 v37, v37
    v_mul_f32 v64, v54, v64
    v_add_f32 v36, 1.0, v36
    v_mul_f32 v65, v54, v65
    v_add_f32 v37, 1.0, v37
    v_mfma_f32_32x32x16_bf16 v[80:95], a[68:71], v[144:147], v[80:95]
    ds_read_b128 v[140:143], v4 offset:12032
    v_fma_f32 v34, v64, v64, s91
    v_rcp_f32 v36, v36
    v_fma_f32 v35, v65, v65, s91
    v_rcp_f32 v37, v37
    v_mfma_f32_32x32x16_bf16 v[80:95], a[76:79], v[148:151], v[80:95]
    s_waitcnt lgkmcnt(4)
    ds_read_b128 v[144:147], v4 offset:12288
    v_mul_f32 v34, v34, v64
    v_mul_f32 v36, v36, v126
    v_mul_f32 v35, v35, v65
    v_mul_f32 v37, v37, v127
    v_cvt_pk_bf16_f32 v119, v36, v37
    v_mfma_f32_32x32x16_bf16 v[80:95], a[84:87], v[152:155], v[80:95]
    ds_read_b128 v[148:151], v4 offset:12544
    buffer_store_dwordx4 v[116:119], v1, s[20:23], s92 offen offset:3072
    buffer_load_dword v0, v3, s[20:23], s88 offen offset:256 sc1
    s_add_u32 s92, s65, 0
    v_exp_f32 v34, v34
    v_mul_f32 v66, v54, v66
    v_mfma_f32_32x32x16_bf16 v[80:95], a[92:95], v[156:159], v[80:95]
    s_waitcnt lgkmcnt(4)
    ds_read_b128 v[152:155], v4 offset:12800
    v_exp_f32 v35, v35
    v_add_f32 v34, 1.0, v34
    v_mul_f32 v67, v54, v67
    v_add_f32 v35, 1.0, v35
    v_fma_f32 v36, v66, v66, s91
    v_mfma_f32_32x32x16_bf16 v[80:95], a[100:103], v[128:131], v[80:95]
    ds_read_b128 v[156:159], v4 offset:13056
    v_rcp_f32 v34, v34
    v_fma_f32 v37, v67, v67, s91
    v_rcp_f32 v35, v35
    v_mfma_f32_32x32x16_bf16 v[80:95], a[108:111], v[132:135], v[80:95]
    s_waitcnt lgkmcnt(4)
    ds_read_b128 v[128:131], v4 offset:13312
    v_mul_f32 v36, v36, v66
    v_mul_f32 v34, v34, v64
    v_mul_f32 v37, v37, v67
    v_mul_f32 v35, v35, v65
    v_exp_f32 v36, v36
    v_mfma_f32_32x32x16_bf16 v[80:95], a[116:119], v[136:139], v[80:95]
    ds_read_b128 v[132:135], v4 offset:13568
    v_cvt_pk_bf16_f32 v64, v34, v35
    v_exp_f32 v37, v37
    v_mul_f32 v68, v54, v68
    v_add_f32 v36, 1.0, v36
    v_mul_f32 v69, v54, v69
    v_mfma_f32_32x32x16_bf16 v[80:95], a[124:127], v[140:143], v[80:95]
    s_waitcnt lgkmcnt(4)
    ds_read_b128 v[136:139], v4 offset:13824
    v_add_f32 v37, 1.0, v37
    v_fma_f32 v34, v68, v68, s91
    v_rcp_f32 v36, v36
    v_fma_f32 v35, v69, v69, s91
    v_mul_f32 v34, v34, v68
    v_mfma_f32_32x32x16_bf16 v[80:95], a[132:135], v[144:147], v[80:95]
    ds_read_b128 v[140:143], v4 offset:14080
    v_rcp_f32 v37, v37
    v_mul_f32 v36, v36, v66
    v_mul_f32 v35, v35, v69
    v_mul_f32 v37, v37, v67
    v_mfma_f32_32x32x16_bf16 v[80:95], a[140:143], v[148:151], v[80:95]
    s_waitcnt lgkmcnt(4)
    ds_read_b128 v[144:147], v4 offset:14336
    v_exp_f32 v34, v34
    v_cvt_pk_bf16_f32 v65, v36, v37
    v_exp_f32 v35, v35
    v_mul_f32 v70, v54, v70
    v_mfma_f32_32x32x16_bf16 v[80:95], a[148:151], v[152:155], v[80:95]
    ds_read_b128 v[148:151], v4 offset:14592
    v_add_f32 v34, 1.0, v34
    v_mul_f32 v71, v54, v71
    v_add_f32 v35, 1.0, v35
    v_fma_f32 v36, v70, v70, s91
    v_rcp_f32 v34, v34
    v_mfma_f32_32x32x16_bf16 v[80:95], a[156:159], v[156:159], v[80:95]
    s_waitcnt lgkmcnt(4)
    ds_read_b128 v[152:155], v4 offset:14848
    v_fma_f32 v37, v71, v71, s91
    v_rcp_f32 v35, v35
    v_mul_f32 v36, v36, v70
    v_mul_f32 v34, v34, v68
    v_mfma_f32_32x32x16_bf16 v[80:95], a[164:167], v[128:131], v[80:95]
    s_waitcnt vmcnt(0)
    ds_read_b128 v[156:159], v4 offset:15104
    v_cmp_ne_u32 vcc, s59, v0
    v_mul_f32 v37, v37, v71
    v_mul_f32 v35, v35, v69
    v_exp_f32 v36, v36
    v_cvt_pk_bf16_f32 v66, v34, v35
    v_mfma_f32_32x32x16_bf16 v[80:95], a[172:175], v[132:135], v[80:95]
    s_waitcnt lgkmcnt(4)
    buffer_store_dword v2, off, s[20:23], s89 offset:288
    s_cbranch_vccnz Lrt_167
Lck_166:
    v_exp_f32 v37, v37
    v_mul_f32 v72, v54, v72
    v_add_f32 v36, 1.0, v36
    v_mul_f32 v73, v54, v73
    v_mfma_f32_32x32x16_bf16 v[80:95], a[180:183], v[136:139], v[80:95]
    buffer_load_dwordx4 v[40:43], v1, s[20:23], s66 offen offset:0 sc1
    v_add_f32 v37, 1.0, v37
    v_fma_f32 v34, v72, v72, s91
    v_rcp_f32 v36, v36
    v_fma_f32 v35, v73, v73, s91
    v_mfma_f32_32x32x16_bf16 v[80:95], a[188:191], v[140:143], v[80:95]
    s_waitcnt lgkmcnt(2)
    v_rcp_f32 v37, v37
    v_mul_f32 v34, v34, v72
    v_mul_f32 v36, v36, v70
    v_mul_f32 v35, v35, v73
    v_mul_f32 v37, v37, v71
    v_cvt_pk_bf16_f32 v67, v36, v37
    v_mfma_f32_32x32x16_bf16 v[80:95], a[196:199], v[144:147], v[80:95]
    buffer_load_dwordx4 v[44:47], v1, s[20:23], s66 offen offset:1024 sc1
    buffer_store_dwordx4 v[64:67], v1, s[20:23], s92 offen offset:2048
    v_exp_f32 v34, v34
    v_exp_f32 v35, v35
    v_mul_f32 v74, v54, v74
    v_mfma_f32_32x32x16_bf16 v[80:95], a[204:207], v[148:151], v[80:95]
    s_waitcnt lgkmcnt(0)
    v_add_f32 v34, 1.0, v34
    v_mul_f32 v75, v54, v75
    v_add_f32 v35, 1.0, v35
    v_fma_f32 v36, v74, v74, s91
    v_rcp_f32 v34, v34
    v_fma_f32 v37, v75, v75, s91
    v_mfma_f32_32x32x16_bf16 v[80:95], a[212:215], v[152:155], v[80:95]
    buffer_load_dwordx4 v[48:51], v1, s[20:23], s67 offen offset:0 sc1
    v_rcp_f32 v35, v35
    v_mul_f32 v36, v36, v74
    v_mul_f32 v34, v34, v72
    v_mul_f32 v37, v37, v75
    v_mfma_f32_32x32x16_bf16 v[80:95], a[220:223], v[156:159], v[80:95]
    v_mul_f32 v35, v35, v73
    v_exp_f32 v36, v36
    v_cvt_pk_bf16_f32 v68, v34, v35
    v_exp_f32 v37, v37
    v_mul_f32 v76, v54, v76
    v_mfma_f32_32x32x16_bf16 v[80:95], v[58:61], v[60:63], v[80:95]
    v_add_f32 v36, 1.0, v36
    v_mul_f32 v77, v54, v77
    v_add_f32 v37, 1.0, v37
    v_fma_f32 v34, v76, v76, s91
    v_rcp_f32 v36, v36
    v_mfma_f32_32x32x16_bf16 v[128:143], a[224:227], v[96:99], 0
    buffer_load_dwordx4 v[56:59], v1, s[20:23], s67 offen offset:1024 sc1
    v_fma_f32 v35, v77, v77, s91
    v_rcp_f32 v37, v37
    v_mul_f32 v34, v34, v76
    v_mul_f32 v36, v36, v74
    v_mul_f32 v35, v35, v77
    v_mul_f32 v37, v37, v75
    v_mfma_f32_32x32x16_bf16 v[144:159], a[228:231], v[96:99], 0
    v_exp_f32 v34, v34
    v_cvt_pk_bf16_f32 v69, v36, v37
    v_exp_f32 v35, v35
    v_mul_f32 v78, v54, v78
    v_add_f32 v34, 1.0, v34
    v_mfma_f32_32x32x16_bf16 v[128:143], a[232:235], v[100:103], v[128:143]
    buffer_load_dwordx4 v[60:63], v1, s[20:23], s68 offen offset:0 sc1
    v_mul_f32 v79, v54, v79
    v_add_f32 v35, 1.0, v35
    v_fma_f32 v36, v78, v78, s91
    v_rcp_f32 v34, v34
    v_fma_f32 v37, v79, v79, s91
    v_mul_f32 v36, v36, v78
    v_mfma_f32_32x32x16_bf16 v[144:159], a[236:239], v[100:103], v[144:159]
    v_rcp_f32 v35, v35
    v_mul_f32 v34, v34, v76
    v_mul_f32 v37, v37, v79
    v_mul_f32 v35, v35, v77
    v_exp_f32 v36, v36
    v_mfma_f32_32x32x16_bf16 v[128:143], a[240:243], v[112:115], v[128:143]
    buffer_load_dwordx4 v[104:107], v1, s[20:23], s68 offen offset:1024 sc1
    buffer_load_dword v0, v3, s[20:23], s88 offen offset:288 sc1
    v_cvt_pk_bf16_f32 v70, v34, v35
    v_exp_f32 v37, v37
    v_mul_f32 v80, v54, v80
    v_add_f32 v36, 1.0, v36
    v_mfma_f32_32x32x16_bf16 v[144:159], a[244:247], v[112:115], v[144:159]
    v_mul_f32 v81, v54, v81
    v_add_f32 v37, 1.0, v37
    v_fma_f32 v34, v80, v80, s91
    v_rcp_f32 v36, v36
    v_fma_f32 v35, v81, v81, s91
    v_rcp_f32 v37, v37
    v_mfma_f32_32x32x16_bf16 v[128:143], a[248:251], v[116:119], v[128:143]
    buffer_load_dwordx4 v[108:111], v1, s[20:23], s69 offen offset:0 sc1
    v_mul_f32 v34, v34, v80
    v_mul_f32 v36, v36, v78
    v_mul_f32 v35, v35, v81
    v_mul_f32 v37, v37, v79
    v_exp_f32 v34, v34
    v_mfma_f32_32x32x16_bf16 v[144:159], a[252:255], v[116:119], v[144:159]
    s_waitcnt vmcnt(8)
    v_cvt_pk_bf16_f32 v71, v36, v37
    v_exp_f32 v35, v35
    v_mul_f32 v82, v54, v82
    v_add_f32 v34, 1.0, v34
    v_mul_f32 v83, v54, v83
    v_add_f32 v35, 1.0, v35
    v_fma_f32 v36, v82, v82, s91
    v_mfma_f32_32x32x16_bf16 v[128:143], v[160:163], v[40:43], v[128:143]
    buffer_load_dwordx4 v[120:123], v1, s[20:23], s69 offen offset:1024 sc1
    buffer_store_dwordx4 v[68:71], v1, s[20:23], s92 offen offset:3072
    v_rcp_f32 v34, v34
    v_fma_f32 v37, v83, v83, s91
    v_rcp_f32 v35, v35
    v_mfma_f32_32x32x16_bf16 v[144:159], v[164:167], v[40:43], v[144:159]
    s_waitcnt vmcnt(9)
    v_mul_f32 v36, v36, v82
    v_mul_f32 v34, v34, v80
    v_mul_f32 v37, v37, v83
    v_mul_f32 v35, v35, v81
    v_exp_f32 v36, v36
    v_cvt_pk_bf16_f32 v80, v34, v35
    v_mfma_f32_32x32x16_bf16 v[128:143], v[168:171], v[44:47], v[128:143]
    buffer_load_dwordx4 v[40:43], v1, s[20:23], s70 offen offset:0 sc1
    v_exp_f32 v37, v37
    v_mul_f32 v84, v54, v84
    v_add_f32 v36, 1.0, v36
    v_mul_f32 v85, v54, v85
    v_add_f32 v37, 1.0, v37
    v_fma_f32 v34, v84, v84, s91
    v_mfma_f32_32x32x16_bf16 v[144:159], v[172:175], v[44:47], v[144:159]
    s_waitcnt vmcnt(8)
    v_rcp_f32 v36, v36
    v_fma_f32 v35, v85, v85, s91
    v_rcp_f32 v37, v37
    v_mul_f32 v34, v34, v84
    v_mul_f32 v36, v36, v82
    v_mfma_f32_32x32x16_bf16 v[128:143], v[176:179], v[48:51], v[128:143]
    buffer_load_dwordx4 v[44:47], v1, s[20:23], s70 offen offset:1024 sc1
    v_mul_f32 v35, v35, v85
    v_mul_f32 v37, v37, v83
    v_exp_f32 v34, v34
    v_cvt_pk_bf16_f32 v81, v36, v37
    v_exp_f32 v35, v35
    v_mfma_f32_32x32x16_bf16 v[144:159], v[180:183], v[48:51], v[144:159]
    s_waitcnt vmcnt(8)
    v_mul_f32 v86, v54, v86
    v_add_f32 v34, 1.0, v34
    v_mul_f32 v87, v54, v87
    v_add_f32 v35, 1.0, v35
    v_fma_f32 v36, v86, v86, s91
    v_rcp_f32 v34, v34
    v_mfma_f32_32x32x16_bf16 v[128:143], v[184:187], v[56:59], v[128:143]
    buffer_load_dwordx4 v[48:51], v1, s[20:23], s71 offen offset:0 sc1
    v_fma_f32 v37, v87, v87, s91
    v_rcp_f32 v35, v35
    v_mul_f32 v36, v36, v86
    v_mul_f32 v34, v34, v84
    v_mul_f32 v37, v37, v87
    v_mfma_f32_32x32x16_bf16 v[144:159], v[188:191], v[56:59], v[144:159]
    s_waitcnt vmcnt(8)
    v_mul_f32 v35, v35, v85
    v_exp_f32 v36, v36
    v_cvt_pk_bf16_f32 v82, v34, v35
    v_exp_f32 v37, v37
    v_mul_f32 v88, v54, v88
    v_add_f32 v36, 1.0, v36
    v_mfma_f32_32x32x16_bf16 v[128:143], v[192:195], v[60:63], v[128:143]
    buffer_load_dwordx4 v[56:59], v1, s[20:23], s71 offen offset:1024 sc1
    v_mul_f32 v89, v54, v89
    v_add_f32 v37, 1.0, v37
    v_fma_f32 v34, v88, v88, s91
    v_rcp_f32 v36, v36
    v_fma_f32 v35, v89, v89, s91
    v_mfma_f32_32x32x16_bf16 v[144:159], v[196:199], v[60:63], v[144:159]
    s_waitcnt vmcnt(7)
    v_cmp_ne_u32 vcc, s59, v0
    v_rcp_f32 v37, v37
    v_mul_f32 v34, v34, v88
    v_mul_f32 v36, v36, v86
    v_mul_f32 v35, v35, v89
    v_mul_f32 v37, v37, v87
    v_cvt_pk_bf16_f32 v83, v36, v37
    v_mfma_f32_32x32x16_bf16 v[128:143], v[200:203], v[104:107], v[128:143]
    s_waitcnt vmcnt(4)
    buffer_store_dword v2, off, s[20:23], s89 offset:320
    buffer_store_dwordx4 v[80:83], v1, s[20:23], s92 offen offset:0
    s_cbranch_vccnz Lrt_169
Lck_168:
    v_exp_f32 v34, v34
    v_exp_f32 v35, v35
    v_mfma_f32_32x32x16_bf16 v[144:159], v[204:207], v[104:107], v[144:159]
    buffer_load_dwordx4 v[60:63], v1, s[20:23], s66 offen offset:2048 sc1
    v_mul_f32 v90, v54, v90
    v_add_f32 v34, 1.0, v34
    v_mul_f32 v91, v54, v91
    v_add_f32 v35, 1.0, v35
    v_fma_f32 v36, v90, v90, s91
    v_fma_f32 v37, v91, v91, s91
    v_mfma_f32_32x32x16_bf16 v[128:143], v[208:211], v[108:111], v[128:143]
    v_rcp_f32 v34, v34
    v_rcp_f32 v35, v35
    v_mul_f32 v36, v36, v90
    v_mul_f32 v34, v34, v88
    v_mul_f32 v37, v37, v91
    v_mul_f32 v35, v35, v89
    v_mfma_f32_32x32x16_bf16 v[144:159], v[212:215], v[108:111], v[144:159]
    buffer_load_dwordx4 v[104:107], v1, s[20:23], s66 offen offset:3072 sc1
    v_exp_f32 v36, v36
    v_cvt_pk_bf16_f32 v84, v34, v35
    v_exp_f32 v37, v37
    v_mul_f32 v92, v54, v92
    v_mfma_f32_32x32x16_bf16 v[128:143], v[216:219], v[120:123], v[128:143]
    v_add_f32 v36, 1.0, v36
    v_mul_f32 v93, v54, v93
    v_add_f32 v37, 1.0, v37
    v_fma_f32 v34, v92, v92, s91
    v_rcp_f32 v36, v36
    v_fma_f32 v35, v93, v93, s91
    v_mul_f32 v34, v34, v92
    v_mfma_f32_32x32x16_bf16 v[144:159], v[220:223], v[120:123], v[144:159]
    s_waitcnt vmcnt(7)
    buffer_load_dwordx4 v[108:111], v1, s[20:23], s67 offen offset:2048 sc1
    v_rcp_f32 v37, v37
    v_mul_f32 v36, v36, v90
    v_mul_f32 v35, v35, v93
    v_mul_f32 v37, v37, v91
    v_cvt_pk_bf16_f32 v85, v36, v37
    v_mfma_f32_32x32x16_bf16 v[128:143], v[224:227], v[40:43], v[128:143]
    v_exp_f32 v34, v34
    v_exp_f32 v35, v35
    v_mul_f32 v94, v54, v94
    v_add_f32 v34, 1.0, v34
    v_mul_f32 v95, v54, v95
    v_mfma_f32_32x32x16_bf16 v[144:159], v[228:231], v[40:43], v[144:159]
    s_waitcnt vmcnt(7)
    buffer_load_dwordx4 v[40:43], v1, s[20:23], s67 offen offset:3072 sc1
    v_add_f32 v35, 1.0, v35
    v_fma_f32 v36, v94, v94, s91
    v_rcp_f32 v34, v34
    v_fma_f32 v37, v95, v95, s91
    v_rcp_f32 v35, v35
    v_mfma_f32_32x32x16_bf16 v[128:143], v[232:235], v[44:47], v[128:143]
    v_mul_f32 v36, v36, v94
    v_mul_f32 v34, v34, v92
    v_mul_f32 v37, v37, v95
    v_mul_f32 v35, v35, v93
    v_exp_f32 v36, v36
    v_cvt_pk_bf16_f32 v86, v34, v35
    v_mfma_f32_32x32x16_bf16 v[144:159], v[236:239], v[44:47], v[144:159]
    s_waitcnt vmcnt(7)
    buffer_load_dwordx4 v[44:47], v1, s[20:23], s68 offen offset:2048 sc1
    v_exp_f32 v37, v37
    v_add_f32 v36, 1.0, v36
    v_add_f32 v37, 1.0, v37
    v_rcp_f32 v36, v36
    v_mfma_f32_32x32x16_bf16 v[128:143], v[240:243], v[48:51], v[128:143]
    ds_read_b64_tr_b16 a[0:1], v8 offset:16384
    ds_read_b64_tr_b16 a[2:3], v8 offset:17408
    v_rcp_f32 v37, v37
    v_mul_f32 v36, v36, v94
    v_mul_f32 v37, v37, v95
    v_cvt_pk_bf16_f32 v87, v36, v37
    v_mfma_f32_32x32x16_bf16 v[144:159], v[244:247], v[48:51], v[144:159]
    s_waitcnt vmcnt(7)
    buffer_load_dwordx4 v[48:51], v1, s[20:23], s68 offen offset:3072 sc1
    ds_read_b64_tr_b16 a[8:9], v9 offset:16384
    ds_read_b64_tr_b16 a[10:11], v9 offset:17408
    buffer_store_dwordx4 v[84:87], v1, s[20:23], s92 offen offset:1024
    v_mfma_f32_32x32x16_bf16 v[128:143], v[248:251], v[56:59], v[128:143]
    ds_read_b64_tr_b16 a[16:17], v8 offset:18432
    ds_read_b64_tr_b16 a[18:19], v8 offset:19456
    buffer_load_dword v0, v3, s[20:23], s88 offen offset:320 sc1
    v_mfma_f32_32x32x16_bf16 v[144:159], v[252:255], v[56:59], v[144:159]
    s_waitcnt vmcnt(7) lgkmcnt(4)
    buffer_load_dwordx4 v[56:59], v1, s[20:23], s69 offen offset:2048 sc1
    ds_read_b64_tr_b16 a[24:25], v9 offset:18432
    ds_read_b64_tr_b16 a[26:27], v9 offset:19456
    v_mfma_f32_32x32x16_bf16 v[128:143], a[0:3], v[60:63], v[128:143]
    s_waitcnt lgkmcnt(4)
    ds_read_b64_tr_b16 a[32:33], v8 offset:20480
    ds_read_b64_tr_b16 a[34:35], v8 offset:21504
    v_mfma_f32_32x32x16_bf16 v[144:159], a[8:11], v[60:63], v[144:159]
    s_waitcnt vmcnt(7) lgkmcnt(4)
    buffer_load_dwordx4 v[52:55], v1, s[20:23], s69 offen offset:3072 sc1
    ds_read_b64_tr_b16 a[40:41], v9 offset:20480
    ds_read_b64_tr_b16 a[42:43], v9 offset:21504
    v_mfma_f32_32x32x16_bf16 v[128:143], a[16:19], v[104:107], v[128:143]
    s_waitcnt lgkmcnt(4)
    ds_read_b64_tr_b16 a[48:49], v8 offset:22528
    ds_read_b64_tr_b16 a[50:51], v8 offset:23552
    v_mfma_f32_32x32x16_bf16 v[144:159], a[24:27], v[104:107], v[144:159]
    s_waitcnt vmcnt(7) lgkmcnt(4)
    buffer_load_dwordx4 v[60:63], v1, s[20:23], s70 offen offset:2048 sc1
    ds_read_b64_tr_b16 a[56:57], v9 offset:22528
    ds_read_b64_tr_b16 a[58:59], v9 offset:23552
    v_mfma_f32_32x32x16_bf16 v[128:143], a[32:35], v[108:111], v[128:143]
    s_waitcnt lgkmcnt(4)
    ds_read_b64_tr_b16 a[64:65], v8 offset:0
    ds_read_b64_tr_b16 a[66:67], v8 offset:1024
    v_mfma_f32_32x32x16_bf16 v[144:159], a[40:43], v[108:111], v[144:159]
    s_waitcnt vmcnt(7) lgkmcnt(4)
    buffer_load_dwordx4 v[104:107], v1, s[20:23], s70 offen offset:3072 sc1
    ds_read_b64_tr_b16 a[72:73], v9 offset:0
    ds_read_b64_tr_b16 a[74:75], v9 offset:1024
    v_mfma_f32_32x32x16_bf16 v[128:143], a[48:51], v[40:43], v[128:143]
    s_waitcnt lgkmcnt(4)
    ds_read_b64_tr_b16 a[80:81], v8 offset:2048
    ds_read_b64_tr_b16 a[82:83], v8 offset:3072
    v_mfma_f32_32x32x16_bf16 v[144:159], a[56:59], v[40:43], v[144:159]
    s_waitcnt vmcnt(5) lgkmcnt(4)
    buffer_load_dwordx4 a[4:7], v1, s[20:23], s71 offen offset:2048 sc1
    ds_read_b64_tr_b16 a[88:89], v9 offset:2048
    ds_read_b64_tr_b16 a[90:91], v9 offset:3072
    buffer_store_dword v2, off, s[20:23], s89 offset:352
    v_mfma_f32_32x32x16_bf16 v[128:143], a[64:67], v[44:47], v[128:143]
    s_waitcnt lgkmcnt(4)
    ds_read_b64_tr_b16 a[96:97], v8 offset:4096
    ds_read_b64_tr_b16 a[98:99], v8 offset:5120
    v_mfma_f32_32x32x16_bf16 v[144:159], a[72:75], v[44:47], v[144:159]
    s_waitcnt lgkmcnt(4)
    buffer_load_dwordx4 a[12:15], v1, s[20:23], s71 offen offset:3072 sc1
    ds_read_b64_tr_b16 a[104:105], v9 offset:4096
    ds_read_b64_tr_b16 a[106:107], v9 offset:5120
    v_mfma_f32_32x32x16_bf16 v[128:143], a[80:83], v[48:51], v[128:143]
    s_waitcnt vmcnt(7) lgkmcnt(4)
    s_sub_u32 s66, s66, 4290314240
    s_sub_u32 s67, s67, 4290314240
    ds_read_b64_tr_b16 a[112:113], v8 offset:6144
    ds_read_b64_tr_b16 a[114:115], v8 offset:7168
    v_cmp_ne_u32 vcc, s59, v0
    v_mfma_f32_32x32x16_bf16 v[144:159], a[88:91], v[48:51], v[144:159]
    s_waitcnt vmcnt(6) lgkmcnt(4)
    s_sub_u32 s68, s68, 4290314240
    s_sub_u32 s69, s69, 4290314240
    ds_read_b64_tr_b16 a[120:121], v9 offset:6144
    ds_read_b64_tr_b16 a[122:123], v9 offset:7168
    s_cbranch_vccnz Lrt_171
Lck_170:
    v_mfma_f32_32x32x16_bf16 v[128:143], a[96:99], v[56:59], v[128:143]
    s_waitcnt lgkmcnt(4)
    s_sub_u32 s70, s70, 4290314240
    s_sub_u32 s71, s71, 4290314240
    ds_read_b64_tr_b16 a[128:129], v8 offset:8192
    ds_read_b64_tr_b16 a[130:131], v8 offset:9216
    v_mfma_f32_32x32x16_bf16 v[144:159], a[104:107], v[56:59], v[144:159]
    s_waitcnt vmcnt(5) lgkmcnt(4)
    buffer_load_dwordx4 a[20:23], v1, s[20:23], s66 offen offset:2048 sc1
    ds_read_b64_tr_b16 a[144:145], v8 offset:10240
    ds_read_b64_tr_b16 a[146:147], v8 offset:11264
    v_mfma_f32_32x32x16_bf16 v[128:143], a[112:115], v[52:55], v[128:143]
    s_waitcnt lgkmcnt(4)
    buffer_load_dwordx4 a[28:31], v1, s[20:23], s66 offen offset:3072 sc1
    ds_read_b64_tr_b16 a[160:161], v8 offset:12288
    ds_read_b64_tr_b16 a[162:163], v8 offset:13312
    v_mfma_f32_32x32x16_bf16 v[144:159], a[120:123], v[52:55], v[144:159]
    s_waitcnt vmcnt(6) lgkmcnt(4)
    ds_read_b64_tr_b16 a[176:177], v8 offset:14336
    ds_read_b64_tr_b16 a[178:179], v8 offset:15360
    v_mfma_f32_32x32x16_bf16 v[128:143], a[128:131], v[60:63], v[128:143]
    s_waitcnt vmcnt(5) lgkmcnt(4)
    buffer_load_dwordx4 a[36:39], v1, s[20:23], s67 offen offset:2048 sc1
    ds_read_b64_tr_b16 a[136:137], v9 offset:8192
    ds_read_b64_tr_b16 a[138:139], v9 offset:9216
    v_mfma_f32_32x32x16_bf16 v[128:143], a[144:147], v[104:107], v[128:143]
    s_waitcnt vmcnt(5) lgkmcnt(4)
    ds_read_b64_tr_b16 a[152:153], v9 offset:10240
    ds_read_b64_tr_b16 a[154:155], v9 offset:11264
    v_mfma_f32_32x32x16_bf16 v[128:143], a[160:163], a[4:7], v[128:143]
    s_waitcnt vmcnt(3) lgkmcnt(4)
    buffer_load_dwordx4 a[44:47], v1, s[20:23], s67 offen offset:3072 sc1
    ds_read_b64_tr_b16 a[168:169], v9 offset:12288
    ds_read_b64_tr_b16 a[170:171], v9 offset:13312
    v_mfma_f32_32x32x16_bf16 v[128:143], a[176:179], a[12:15], v[128:143]
    s_waitcnt lgkmcnt(4)
    ds_read_b64_tr_b16 a[184:185], v9 offset:14336
    ds_read_b64_tr_b16 a[186:187], v9 offset:15360
    v_mfma_f32_32x32x16_bf16 v[144:159], a[136:139], v[60:63], v[144:159]
    s_waitcnt lgkmcnt(4)
    buffer_load_dwordx4 a[52:55], v1, s[20:23], s68 offen offset:2048 sc1
    v_mfma_f32_32x32x16_bf16 v[144:159], a[152:155], v[104:107], v[144:159]
    s_waitcnt lgkmcnt(2)
    buffer_load_dword v0, v3, s[20:23], s88 offen offset:352 sc1
    v_mfma_f32_32x32x16_bf16 v[144:159], a[168:171], a[4:7], v[144:159]
    s_waitcnt lgkmcnt(0)
    buffer_load_dwordx4 a[4:7], v1, s[20:23], s68 offen offset:3072 sc1
    v_mfma_f32_32x32x16_bf16 v[144:159], a[184:187], a[12:15], v[144:159]
    v_cvt_pk_f16_f32 v128, v128, v129
    v_cvt_pk_f16_f32 v129, v130, v131
    v_cvt_pk_f16_f32 v130, v132, v133
    v_cvt_pk_f16_f32 v131, v134, v135
    v_cvt_pk_f16_f32 v136, v136, v137
    v_cvt_pk_f16_f32 v137, v138, v139
    v_mfma_f32_32x32x16_bf16 v[96:111], a[224:227], v[64:67], 0
    buffer_load_dwordx4 a[12:15], v1, s[20:23], s69 offen offset:2048 sc1
    ds_write_b128 v6, v[128:131] offset:0
    v_cvt_pk_f16_f32 v138, v140, v141
    v_cvt_pk_f16_f32 v139, v142, v143
    v_bfe_u32 v39, v1, 5, 2
    v_bfe_u32 v34, v1, 4, 1
    v_lshl_add_u32 v39, v39, 3, v34
    v_mfma_f32_32x32x16_bf16 v[112:127], a[228:231], v[64:67], 0
    ds_write_b128 v6, v[136:139] offset:128
    v_lshrrev_b32 v34, 7, v1
    v_mul_u32_u24 v39, 1792, v39
    v_lshl_add_u32 v39, v34, 4, v39
    v_mfma_f32_32x32x16_bf16 v[96:111], a[232:235], v[68:71], v[96:111]
    buffer_load_dwordx4 a[60:63], v1, s[20:23], s69 offen offset:3072 sc1
    v_mfma_f32_32x32x16_bf16 v[112:127], a[236:239], v[68:71], v[112:127]
    v_cvt_pk_f16_f32 v144, v144, v145
    v_cvt_pk_f16_f32 v145, v146, v147
    v_cvt_pk_f16_f32 v146, v148, v149
    v_cvt_pk_f16_f32 v147, v150, v151
    v_cvt_pk_f16_f32 v152, v152, v153
    v_cvt_pk_f16_f32 v153, v154, v155
    v_mfma_f32_32x32x16_bf16 v[96:111], a[240:243], v[80:83], v[96:111]
    buffer_load_dwordx4 v[40:43], v1, s[20:23], s70 offen offset:2048 sc1
    ds_write_b128 v6, v[144:147] offset:512
    v_cvt_pk_f16_f32 v154, v156, v157
    v_cvt_pk_f16_f32 v155, v158, v159
    v_mfma_f32_32x32x16_bf16 v[112:127], a[244:247], v[80:83], v[112:127]
    ds_write_b128 v6, v[152:155] offset:640
    v_mfma_f32_32x32x16_bf16 v[96:111], a[248:251], v[84:87], v[96:111]
    s_waitcnt lgkmcnt(0)
    buffer_load_dwordx4 v[44:47], v1, s[20:23], s70 offen offset:3072 sc1
    s_barrier
    ds_read_b128 v[144:147], v38 offset:0
    ds_read_b128 v[148:151], v38 offset:1024
    ds_read_b128 v[152:155], v38 offset:2048
    ds_read_b128 v[156:159], v38 offset:3072
    v_mfma_f32_32x32x16_bf16 v[112:127], a[252:255], v[84:87], v[112:127]
    s_waitcnt vmcnt(10)
    v_mfma_f32_32x32x16_bf16 v[96:111], v[160:163], a[20:23], v[96:111]
    s_waitcnt lgkmcnt(2)
    buffer_load_dwordx4 v[48:51], v1, s[20:23], s71 offen offset:2048 sc1
    v_pk_add_f16 v144, v144, v148
    v_pk_add_f16 v145, v145, v149
    v_pk_add_f16 v146, v146, v150
    v_pk_add_f16 v147, v147, v151
    v_mfma_f32_32x32x16_bf16 v[112:127], v[164:167], a[20:23], v[112:127]
    s_waitcnt vmcnt(6) lgkmcnt(0)
    v_cmp_ne_u32 vcc, s59, v0
    v_pk_add_f16 v152, v152, v156
    v_pk_add_f16 v153, v153, v157
    v_pk_add_f16 v154, v154, v158
    v_pk_add_f16 v155, v155, v159
    v_pk_add_f16 v144, v144, v152
    v_pk_add_f16 v145, v145, v153
    v_pk_add_f16 v146, v146, v154
    v_mfma_f32_32x32x16_bf16 v[96:111], v[168:171], a[28:31], v[96:111]
    buffer_load_dwordx4 a[20:23], v1, s[20:23], s71 offen offset:3072 sc1
    s_cbranch_vccnz Lrt_173
Lck_172:
    v_pk_add_f16 v147, v147, v155
    v_fma_mix_f32 v10, v144, s80, v10 op_sel:[0,0,0] op_sel_hi:[1,0,0]
    v_fma_mix_f32 v11, v144, s80, v11 op_sel:[1,0,0] op_sel_hi:[1,0,0]
    v_fma_mix_f32 v12, v145, s80, v12 op_sel:[0,0,0] op_sel_hi:[1,0,0]
    v_fma_mix_f32 v13, v145, s80, v13 op_sel:[1,0,0] op_sel_hi:[1,0,0]
    v_mfma_f32_32x32x16_bf16 v[112:127], v[172:175], a[28:31], v[112:127]
    v_fma_mix_f32 v14, v146, s80, v14 op_sel:[0,0,0] op_sel_hi:[1,0,0]
    v_fma_mix_f32 v15, v146, s80, v15 op_sel:[1,0,0] op_sel_hi:[1,0,0]
    v_fma_mix_f32 v16, v147, s80, v16 op_sel:[0,0,0] op_sel_hi:[1,0,0]
    v_fma_mix_f32 v17, v147, s80, v17 op_sel:[1,0,0] op_sel_hi:[1,0,0]
    v_cvt_pk_bf16_f32 v144, v10, v11
    v_cvt_pk_bf16_f32 v145, v12, v13
    v_cvt_pk_bf16_f32 v146, v14, v15
    v_cvt_pk_bf16_f32 v147, v16, v17
    v_mfma_f32_32x32x16_bf16 v[96:111], v[176:179], a[36:39], v[96:111]
    buffer_load_dwordx4 a[28:31], v1, s[20:23], s66 offen offset:0 sc1
    v_mfma_f32_32x32x16_bf16 v[112:127], v[180:183], a[36:39], v[112:127]
    v_mfma_f32_32x32x16_bf16 v[96:111], v[184:187], a[44:47], v[96:111]
    buffer_load_dwordx4 a[36:39], v1, s[20:23], s66 offen offset:1024 sc1
    v_mfma_f32_32x32x16_bf16 v[112:127], v[188:191], a[44:47], v[112:127]
    v_mfma_f32_32x32x16_bf16 v[96:111], v[192:195], a[52:55], v[96:111]
    buffer_load_dwordx4 a[44:47], v1, s[20:23], s67 offen offset:0 sc1
    v_mfma_f32_32x32x16_bf16 v[112:127], v[196:199], a[52:55], v[112:127]
    s_waitcnt vmcnt(9)
    v_mfma_f32_32x32x16_bf16 v[96:111], v[200:203], a[4:7], v[96:111]
    buffer_load_dwordx4 a[52:55], v1, s[20:23], s67 offen offset:1024 sc1
    v_mfma_f32_32x32x16_bf16 v[112:127], v[204:207], a[4:7], v[112:127]
    s_waitcnt vmcnt(9)
    v_mfma_f32_32x32x16_bf16 v[96:111], v[208:211], a[12:15], v[96:111]
    buffer_load_dwordx4 a[4:7], v1, s[20:23], s68 offen offset:0 sc1
    v_mfma_f32_32x32x16_bf16 v[112:127], v[212:215], a[12:15], v[112:127]
    s_waitcnt vmcnt(9)
    v_mfma_f32_32x32x16_bf16 v[96:111], v[216:219], a[60:63], v[96:111]
    buffer_load_dwordx4 a[12:15], v1, s[20:23], s68 offen offset:1024 sc1
    v_mfma_f32_32x32x16_bf16 v[112:127], v[220:223], a[60:63], v[112:127]
    s_waitcnt vmcnt(9)
    v_mfma_f32_32x32x16_bf16 v[96:111], v[224:227], v[40:43], v[96:111]
    buffer_load_dwordx4 a[60:63], v1, s[20:23], s69 offen offset:0 sc1
    v_mfma_f32_32x32x16_bf16 v[112:127], v[228:231], v[40:43], v[112:127]
    s_waitcnt vmcnt(9)
    buffer_store_dword v2, off, s[20:23], s89 offset:192
    v_mfma_f32_32x32x16_bf16 v[96:111], v[232:235], v[44:47], v[96:111]
    buffer_load_dwordx4 v[40:43], v1, s[20:23], s69 offen offset:1024 sc1
    v_mfma_f32_32x32x16_bf16 v[112:127], v[236:239], v[44:47], v[112:127]
    s_waitcnt vmcnt(10)
    v_mfma_f32_32x32x16_bf16 v[96:111], v[240:243], v[48:51], v[96:111]
    buffer_load_dwordx4 v[44:47], v1, s[20:23], s70 offen offset:0 sc1
    v_mfma_f32_32x32x16_bf16 v[112:127], v[244:247], v[48:51], v[112:127]
    s_waitcnt vmcnt(10)
    buffer_load_dwordx4 v[48:51], v1, s[20:23], s70 offen offset:1024 sc1
L_i5038:
    s_cbranch_execz L_backM
    v_mfma_f32_32x32x16_bf16 v[96:111], v[248:251], a[20:23], v[96:111]
    buffer_load_dwordx4 v[52:55], v1, s[20:23], s71 offen offset:0 sc1
    v_mfma_f32_32x32x16_bf16 v[112:127], v[252:255], a[20:23], v[112:127]
    s_waitcnt vmcnt(11)
    buffer_load_dwordx4 a[20:23], v1, s[20:23], s71 offen offset:1024 sc1
    v_mfma_f32_32x32x16_bf16 v[96:111], a[0:3], a[28:31], v[96:111]
    v_mfma_f32_32x32x16_bf16 v[112:127], a[8:11], a[28:31], v[112:127]
    s_waitcnt vmcnt(11)
    v_mfma_f32_32x32x16_bf16 v[96:111], a[16:19], a[36:39], v[96:111]
    v_mfma_f32_32x32x16_bf16 v[112:127], a[24:27], a[36:39], v[112:127]
    s_waitcnt vmcnt(10)
    v_mfma_f32_32x32x16_bf16 v[96:111], a[32:35], a[44:47], v[96:111]
    v_mfma_f32_32x32x16_bf16 v[112:127], a[40:43], a[44:47], v[112:127]
    s_waitcnt vmcnt(9)
    v_mfma_f32_32x32x16_bf16 v[96:111], a[48:51], a[52:55], v[96:111]
    v_mfma_f32_32x32x16_bf16 v[112:127], a[56:59], a[52:55], v[112:127]
    s_waitcnt vmcnt(8)
    v_mfma_f32_32x32x16_bf16 v[96:111], a[64:67], a[4:7], v[96:111]
    v_mfma_f32_32x32x16_bf16 v[112:127], a[72:75], a[4:7], v[112:127]
    s_waitcnt vmcnt(7)
    v_mfma_f32_32x32x16_bf16 v[96:111], a[80:83], a[12:15], v[96:111]
    v_mfma_f32_32x32x16_bf16 v[112:127], a[88:91], a[12:15], v[112:127]
    s_waitcnt vmcnt(6)
    v_mfma_f32_32x32x16_bf16 v[96:111], a[96:99], a[60:63], v[96:111]
    v_mfma_f32_32x32x16_bf16 v[112:127], a[104:107], a[60:63], v[112:127]
    s_waitcnt vmcnt(4)
    v_mfma_f32_32x32x16_bf16 v[96:111], a[112:115], v[40:43], v[96:111]
    v_mfma_f32_32x32x16_bf16 v[112:127], a[120:123], v[40:43], v[112:127]
    s_waitcnt vmcnt(3)
    v_mfma_f32_32x32x16_bf16 v[96:111], a[128:131], v[44:47], v[96:111]
    s_waitcnt vmcnt(2)
    buffer_store_dwordx4 v[144:147], v39, s[48:51], s94 offen offset:0 sc0 sc1 nt
    v_mfma_f32_32x32x16_bf16 v[96:111], a[144:147], v[48:51], v[96:111]
    s_waitcnt vmcnt(2)
    v_mfma_f32_32x32x16_bf16 v[96:111], a[160:163], v[52:55], v[96:111]
    s_waitcnt vmcnt(1)
    v_mfma_f32_32x32x16_bf16 v[96:111], a[176:179], a[20:23], v[96:111]
    s_lshl2_add_u32 s57, s2, s53
    s_cmp_lg_u32 s57, 28
    s_cbranch_scc1 Lep_174
    buffer_store_dword v2, off, s[20:23], 0 sc0 sc1
Lep_174:
    v_mfma_f32_32x32x16_bf16 v[112:127], a[136:139], v[44:47], v[112:127]
    v_mfma_f32_32x32x16_bf16 v[112:127], a[152:155], v[48:51], v[112:127]
    v_mfma_f32_32x32x16_bf16 v[112:127], a[168:171], v[52:55], v[112:127]
    v_mfma_f32_32x32x16_bf16 v[112:127], a[184:187], a[20:23], v[112:127]
    s_nop 4
    v_cvt_pk_f16_f32 v96, v96, v97
    v_cvt_pk_f16_f32 v97, v98, v99
    v_cvt_pk_f16_f32 v98, v100, v101
    v_cvt_pk_f16_f32 v99, v102, v103
    v_cvt_pk_f16_f32 v104, v104, v105
    v_cvt_pk_f16_f32 v105, v106, v107
    ds_write_b128 v6, v[96:99] offset:8192
    v_cvt_pk_f16_f32 v106, v108, v109
    v_cvt_pk_f16_f32 v107, v110, v111
    ds_write_b128 v6, v[104:107] offset:8320
    v_cvt_pk_f16_f32 v112, v112, v113
    v_cvt_pk_f16_f32 v113, v114, v115
    v_cvt_pk_f16_f32 v114, v116, v117
    v_cvt_pk_f16_f32 v115, v118, v119
    v_cvt_pk_f16_f32 v120, v120, v121
    v_cvt_pk_f16_f32 v121, v122, v123
    ds_write_b128 v6, v[112:115] offset:8704
    v_cvt_pk_f16_f32 v122, v124, v125
    v_cvt_pk_f16_f32 v123, v126, v127
    ds_write_b128 v6, v[120:123] offset:8832
    s_waitcnt lgkmcnt(0)
    s_barrier
    ds_read_b128 v[112:115], v38 offset:8192
    ds_read_b128 v[116:119], v38 offset:9216
    ds_read_b128 v[120:123], v38 offset:10240
    ds_read_b128 v[124:127], v38 offset:11264
    s_waitcnt lgkmcnt(2)
    v_pk_add_f16 v112, v112, v116
    v_pk_add_f16 v113, v113, v117
    v_pk_add_f16 v114, v114, v118
    v_pk_add_f16 v115, v115, v119
    s_waitcnt lgkmcnt(0)
    v_pk_add_f16 v120, v120, v124
    v_pk_add_f16 v121, v121, v125
    v_pk_add_f16 v122, v122, v126
    v_pk_add_f16 v123, v123, v127
    v_pk_add_f16 v112, v112, v120
    v_pk_add_f16 v113, v113, v121
    v_pk_add_f16 v114, v114, v122
    v_pk_add_f16 v115, v115, v123
    v_fma_mix_f32 v18, v112, s80, v18 op_sel:[0,0,0] op_sel_hi:[1,0,0]
    v_fma_mix_f32 v19, v112, s80, v19 op_sel:[1,0,0] op_sel_hi:[1,0,0]
    v_fma_mix_f32 v20, v113, s80, v20 op_sel:[0,0,0] op_sel_hi:[1,0,0]
    v_fma_mix_f32 v21, v113, s80, v21 op_sel:[1,0,0] op_sel_hi:[1,0,0]
    v_fma_mix_f32 v22, v114, s80, v22 op_sel:[0,0,0] op_sel_hi:[1,0,0]
    v_fma_mix_f32 v23, v114, s80, v23 op_sel:[1,0,0] op_sel_hi:[1,0,0]
    v_fma_mix_f32 v24, v115, s80, v24 op_sel:[0,0,0] op_sel_hi:[1,0,0]
    v_fma_mix_f32 v25, v115, s80, v25 op_sel:[1,0,0] op_sel_hi:[1,0,0]
    v_cvt_pk_bf16_f32 v112, v18, v19
    v_cvt_pk_bf16_f32 v113, v20, v21
    v_cvt_pk_bf16_f32 v114, v22, v23
    v_cvt_pk_bf16_f32 v115, v24, v25
    buffer_store_dwordx4 v[112:115], v39, s[48:51], s94 offen offset:896 sc0 sc1 nt
    s_endpgm
Lrt_30:
    s_sub_u32 s58, s58, 1
    s_cbranch_scc1 L_exit
    s_mov_b64 exec, vcc
    buffer_load_dwordx4 v[144:147], v1, s[20:23], s98 offen offset:0 sc1
    buffer_load_dwordx4 v[148:151], v1, s[20:23], s98 offen offset:1024 sc1
    s_mov_b64 exec, -1
    s_waitcnt vmcnt(0)
    v_bitop3_b32 v152, v146, v150, s59 bitop3:0x7e
    v_bitop3_b32 v152, v147, v152, s59 bitop3:0xde
    v_bitop3_b32 v152, v151, v152, s59 bitop3:0xde
    v_cmp_ne_u32 vcc, 0, v152
    s_cbranch_vccnz Lrt_30
    s_branch Lck_29
Lrt_32:
    s_sub_u32 s58, s58, 1
    s_cbranch_scc1 L_exit
    s_mov_b64 exec, vcc
    buffer_load_dwordx4 v[80:83], v128, s[20:23], s65 offen offset:0 sc1
    buffer_load_dwordx4 v[84:87], v128, s[20:23], s65 offen offset:1024 sc1
    buffer_load_dwordx4 v[88:91], v128, s[20:23], s65 offen offset:2048 sc1
    buffer_load_dwordx4 v[92:95], v128, s[20:23], s65 offen offset:3072 sc1
    s_mov_b64 exec, -1
    s_waitcnt vmcnt(0)
    v_bitop3_b32 v129, v81, v83, s59 bitop3:0x7e
    v_bitop3_b32 v130, v85, v87, s59 bitop3:0x7e
    v_bitop3_b32 v129, v89, v129, s59 bitop3:0xde
    v_bitop3_b32 v130, v91, v130, s59 bitop3:0xde
    v_bitop3_b32 v129, v93, v129, s59 bitop3:0xde
    v_bitop3_b32 v130, v95, v130, s59 bitop3:0xde
    v_or_b32 v129, v129, v130
    v_cmp_ne_u32 vcc, 0, v129
    s_cbranch_vccnz Lrt_32
    s_branch Lck_31
Lrt_34:
    s_sub_u32 s58, s58, 1
    s_cbranch_scc1 L_exit
    s_mov_b64 exec, vcc
    buffer_load_dwordx4 v[96:99], v1, s[20:23], s98 offen offset:2048 sc1
    buffer_load_dwordx4 v[100:103], v1, s[20:23], s98 offen offset:3072 sc1
    s_mov_b64 exec, -1
    s_waitcnt vmcnt(0)
    v_bitop3_b32 v104, v98, v102, s59 bitop3:0x7e
    v_bitop3_b32 v104, v99, v104, s59 bitop3:0xde
    v_bitop3_b32 v104, v103, v104, s59 bitop3:0xde
    v_cmp_ne_u32 vcc, 0, v104
    s_cbranch_vccnz Lrt_34
    s_branch Lck_33
Lzr_68:
    s_sub_u32 s58, s58, 1
    s_cbranch_scc1 L_exit
    s_add_u32 m0, s87, 1024
    s_add_u32 s57, s66, 4290316288
    buffer_load_dwordx4 v1, s[20:23], s57 offen sc1 lds
    s_add_u32 m0, s87, 2048
    s_add_u32 s57, s67, 4290316288
    buffer_load_dwordx4 v1, s[20:23], s57 offen sc1 lds
    s_waitcnt vmcnt(0)
    ds_read2st64_b32 v[46:47], v50 offset0:4 offset1:8
    s_waitcnt lgkmcnt(0)
    v_max_u32 v46, v46, v47
    v_cmp_eq_u32 vcc, -1, v46
    s_cbranch_vccnz Lzr_68
    s_branch Lzc_67
Lzr_70:
    s_sub_u32 s58, s58, 1
    s_cbranch_scc1 L_exit
    s_add_u32 m0, s87, 3072
    s_add_u32 s57, s68, 4290316288
    buffer_load_dwordx4 v1, s[20:23], s57 offen sc1 lds
    s_add_u32 m0, s87, 4096
    s_add_u32 s57, s69, 4290316288
    buffer_load_dwordx4 v1, s[20:23], s57 offen sc1 lds
    s_add_u32 m0, s87, 5120
    s_add_u32 s57, s70, 4290316288
    buffer_load_dwordx4 v1, s[20:23], s57 offen sc1 lds
    s_add_u32 m0, s87, 6144
    s_add_u32 s57, s71, 4290316288
    buffer_load_dwordx4 v1, s[20:23], s57 offen sc1 lds
    s_waitcnt vmcnt(0)
    ds_read2st64_b32 v[46:47], v50 offset0:12 offset1:16
    ds_read2st64_b32 v[48:49], v50 offset0:20 offset1:24
    s_waitcnt lgkmcnt(0)
    v_max3_u32 v47, v47, v48, v49
    v_max_u32 v46, v46, v47
    v_cmp_eq_u32 vcc, -1, v46
    s_cbranch_vccnz Lzr_70
    s_branch Lzc_69
Lzr_72:
    s_sub_u32 s58, s58, 1
    s_cbranch_scc1 L_exit
    s_add_u32 m0, s87, 9216
    s_add_u32 s57, s66, 4290317312
    buffer_load_dwordx4 v1, s[20:23], s57 offen sc1 lds
    s_add_u32 m0, s87, 10240
    s_add_u32 s57, s67, 4290317312
    buffer_load_dwordx4 v1, s[20:23], s57 offen sc1 lds
    s_add_u32 m0, s87, 11264
    s_add_u32 s57, s68, 4290317312
    buffer_load_dwordx4 v1, s[20:23], s57 offen sc1 lds
    s_add_u32 m0, s87, 12288
    s_add_u32 s57, s69, 4290317312
    buffer_load_dwordx4 v1, s[20:23], s57 offen sc1 lds
    s_add_u32 m0, s87, 13312
    s_add_u32 s57, s70, 4290317312
    buffer_load_dwordx4 v1, s[20:23], s57 offen sc1 lds
    s_add_u32 m0, s87, 14336
    s_add_u32 s57, s71, 4290317312
    buffer_load_dwordx4 v1, s[20:23], s57 offen sc1 lds
    s_waitcnt vmcnt(0)
    ds_read2st64_b32 v[40:41], v50 offset0:36 offset1:40
    ds_read2st64_b32 v[42:43], v50 offset0:44 offset1:48
    ds_read2st64_b32 v[44:45], v50 offset0:52 offset1:56
    s_waitcnt lgkmcnt(0)
    v_max3_u32 v41, v41, v42, v43
    v_max3_u32 v40, v40, v44, v45
    v_max_u32 v40, v40, v41
    v_cmp_eq_u32 vcc, -1, v40
    s_cbranch_vccnz Lzr_72
    s_branch Lzc_71
Lrt_74:
    s_sub_u32 s58, s58, 1
    s_cbranch_scc1 L_exit
    buffer_load_dword v0, v3, s[20:23], s88 offen offset:64 sc1
    s_waitcnt vmcnt(0)
    v_cmp_ne_u32 vcc, s59, v0
    s_cbranch_vccnz Lrt_74
    s_branch Lck_73
Lrt_76:
    s_sub_u32 s58, s58, 1
    s_cbranch_scc1 L_exit
    buffer_load_dword v0, v3, s[20:23], s88 offen offset:96 sc1
    s_waitcnt vmcnt(0)
    v_cmp_ne_u32 vcc, s59, v0
    s_cbranch_vccnz Lrt_76
    s_branch Lck_75
Lrt_78:
    s_sub_u32 s58, s58, 1
    s_cbranch_scc1 L_exit
    buffer_load_dword v0, v3, s[20:23], s88 offen offset:128 sc1
    s_waitcnt vmcnt(0)
    v_cmp_ne_u32 vcc, s59, v0
    s_cbranch_vccnz Lrt_78
    s_branch Lck_77
Lrt_80:
    s_sub_u32 s58, s58, 1
    s_cbranch_scc1 L_exit
    buffer_load_dword v0, v3, s[20:23], s88 offen offset:160 sc1
    s_waitcnt vmcnt(0)
    v_cmp_ne_u32 vcc, s59, v0
    s_cbranch_vccnz Lrt_80
    s_branch Lck_79
Lrt_82:
    s_sub_u32 s58, s58, 1
    s_cbranch_scc1 L_exit
    buffer_load_dwordx2 v[144:145], v1, s[20:23], s98 offen offset:0 sc1
    buffer_load_dwordx2 v[146:147], v1, s[20:23], s98 offen offset:1024 sc1
    s_waitcnt vmcnt(0)
    v_bitop3_b32 v148, v145, v147, s83 bitop3:0x7e
    v_cmp_ne_u32 vcc, 0, v148
    s_cbranch_vccnz Lrt_82
    s_branch Lck_81
Lzr_153:
    s_sub_u32 s58, s58, 1
    s_cbranch_scc1 L_exit
    s_add_u32 m0, s87, 1024
    s_add_u32 s57, s66, 4653056
    buffer_load_dwordx4 v1, s[20:23], s57 offen sc1 lds
    s_add_u32 m0, s87, 2048
    s_add_u32 s57, s67, 4653056
    buffer_load_dwordx4 v1, s[20:23], s57 offen sc1 lds
    s_waitcnt vmcnt(0)
    ds_read2st64_b32 v[46:47], v38 offset0:4 offset1:8
    s_waitcnt lgkmcnt(0)
    v_max_u32 v46, v46, v47
    v_cmp_eq_u32 vcc, -1, v46
    s_cbranch_vccnz Lzr_153
    s_branch Lzc_152
Lrt_155:
    s_sub_u32 s58, s58, 1
    s_cbranch_scc1 L_exit
    buffer_load_dwordx2 v[80:81], v1, s[20:23], s98 offen offset:8 sc1
    buffer_load_dwordx2 v[82:83], v1, s[20:23], s98 offen offset:1032 sc1
    s_waitcnt vmcnt(0)
    v_bitop3_b32 v84, v81, v83, s83 bitop3:0x7e
    v_cmp_ne_u32 vcc, 0, v84
    s_cbranch_vccnz Lrt_155
    s_branch Lck_154
Lrt_157:
    s_sub_u32 s58, s58, 1
    s_cbranch_scc1 L_exit
    buffer_load_dwordx2 v[112:113], v1, s[20:23], s98 offen offset:2048 sc1
    buffer_load_dwordx2 v[114:115], v1, s[20:23], s98 offen offset:3072 sc1
    s_waitcnt vmcnt(0)
    v_bitop3_b32 v116, v113, v115, s83 bitop3:0x7e
    v_cmp_ne_u32 vcc, 0, v116
    s_cbranch_vccnz Lrt_157
    s_branch Lck_156
Lrt_159:
    s_sub_u32 s58, s58, 1
    s_cbranch_scc1 L_exit
    buffer_load_dwordx2 v[80:81], v1, s[20:23], s98 offen offset:2056 sc1
    buffer_load_dwordx2 v[82:83], v1, s[20:23], s98 offen offset:3080 sc1
    s_waitcnt vmcnt(0)
    v_bitop3_b32 v84, v81, v83, s83 bitop3:0x7e
    v_cmp_ne_u32 vcc, 0, v84
    s_cbranch_vccnz Lrt_159
    s_branch Lck_158
Lzr_161:
    s_sub_u32 s58, s58, 1
    s_cbranch_scc1 L_exit
    s_add_u32 m0, s87, 3072
    s_add_u32 s57, s68, 4653056
    buffer_load_dwordx4 v1, s[20:23], s57 offen sc1 lds
    s_add_u32 m0, s87, 4096
    s_add_u32 s57, s69, 4653056
    buffer_load_dwordx4 v1, s[20:23], s57 offen sc1 lds
    s_add_u32 m0, s87, 5120
    s_add_u32 s57, s70, 4653056
    buffer_load_dwordx4 v1, s[20:23], s57 offen sc1 lds
    s_add_u32 m0, s87, 6144
    s_add_u32 s57, s71, 4653056
    buffer_load_dwordx4 v1, s[20:23], s57 offen sc1 lds
    s_waitcnt vmcnt(0)
    ds_read2st64_b32 v[46:47], v38 offset0:12 offset1:16
    ds_read2st64_b32 v[48:49], v38 offset0:20 offset1:24
    s_waitcnt lgkmcnt(0)
    v_max3_u32 v47, v47, v48, v49
    v_max_u32 v46, v46, v47
    v_cmp_eq_u32 vcc, -1, v46
    s_cbranch_vccnz Lzr_161
    s_branch Lzc_160
Lzr_163:
    s_sub_u32 s58, s58, 1
    s_cbranch_scc1 L_exit
    s_add_u32 m0, s87, 9216
    s_add_u32 s57, s66, 4654080
    buffer_load_dwordx4 v1, s[20:23], s57 offen sc1 lds
    s_add_u32 m0, s87, 10240
    s_add_u32 s57, s67, 4654080
    buffer_load_dwordx4 v1, s[20:23], s57 offen sc1 lds
    s_waitcnt vmcnt(0)
    ds_read2st64_b32 v[46:47], v38 offset0:36 offset1:40
    s_waitcnt lgkmcnt(0)
    v_max_u32 v46, v46, v47
    v_cmp_eq_u32 vcc, -1, v46
    s_cbranch_vccnz Lzr_163
    s_branch Lzc_162
Lzr_165:
    s_sub_u32 s58, s58, 1
    s_cbranch_scc1 L_exit
    s_add_u32 m0, s87, 11264
    s_add_u32 s57, s68, 4654080
    buffer_load_dwordx4 v1, s[20:23], s57 offen sc1 lds
    s_add_u32 m0, s87, 12288
    s_add_u32 s57, s69, 4654080
    buffer_load_dwordx4 v1, s[20:23], s57 offen sc1 lds
    s_add_u32 m0, s87, 13312
    s_add_u32 s57, s70, 4654080
    buffer_load_dwordx4 v1, s[20:23], s57 offen sc1 lds
    s_add_u32 m0, s87, 14336
    s_add_u32 s57, s71, 4654080
    buffer_load_dwordx4 v1, s[20:23], s57 offen sc1 lds
    s_waitcnt vmcnt(0)
    ds_read2st64_b32 v[46:47], v38 offset0:44 offset1:48
    ds_read2st64_b32 v[48:49], v38 offset0:52 offset1:56
    s_waitcnt lgkmcnt(0)
    v_max3_u32 v47, v47, v48, v49
    v_max_u32 v46, v46, v47
    v_cmp_eq_u32 vcc, -1, v46
    s_cbranch_vccnz Lzr_165
    s_branch Lzc_164
Lrt_167:
    s_sub_u32 s58, s58, 1
    s_cbranch_scc1 L_exit
    buffer_load_dword v0, v3, s[20:23], s88 offen offset:256 sc1
    s_waitcnt vmcnt(0)
    v_cmp_ne_u32 vcc, s59, v0
    s_cbranch_vccnz Lrt_167
    s_branch Lck_166
Lrt_169:
    s_sub_u32 s58, s58, 1
    s_cbranch_scc1 L_exit
    buffer_load_dword v0, v3, s[20:23], s88 offen offset:288 sc1
    s_waitcnt vmcnt(0)
    v_cmp_ne_u32 vcc, s59, v0
    s_cbranch_vccnz Lrt_169
    s_branch Lck_168
Lrt_171:
    s_sub_u32 s58, s58, 1
    s_cbranch_scc1 L_exit
    buffer_load_dword v0, v3, s[20:23], s88 offen offset:320 sc1
    s_waitcnt vmcnt(0)
    v_cmp_ne_u32 vcc, s59, v0
    s_cbranch_vccnz Lrt_171
    s_branch Lck_170
Lrt_173:
    s_sub_u32 s58, s58, 1
    s_cbranch_scc1 L_exit
    buffer_load_dword v0, v3, s[20:23], s88 offen offset:352 sc1
    s_waitcnt vmcnt(0)
    v_cmp_ne_u32 vcc, s59, v0
    s_cbranch_vccnz Lrt_173
    s_branch Lck_172
Lrt_3:
    s_sub_u32 s58, s58, 1
    s_cbranch_scc1 L_exit
    s_and_b32 s57, s58, 15
    s_cbranch_scc1 Lua_5
    v_lshrrev_b32 v37, 2, v1
    v_and_b32 v37, 124, v37
    buffer_load_dword v37, v37, s[20:23], s90 offen sc1
    s_waitcnt vmcnt(0)
    v_cmp_ne_u32 vcc, s92, v37
    s_cbranch_vccz Lua_5
    v_xor_b32 v37, s59, v37
    v_and_b32 v37, 0x0fffffff, v37
    v_cmp_ne_u32 vcc, 0, v37
    s_cbranch_vccnz Lua_5
    buffer_store_dwordx4 v[10:13], v75, s[20:23], s79 offen offset:0 sc1
    buffer_store_dwordx4 v[14:17], v75, s[20:23], s79 offen offset:128 sc1
    buffer_store_dwordx4 v[18:21], v75, s[20:23], s79 offen offset:256 sc1
    buffer_store_dwordx4 v[22:25], v75, s[20:23], s79 offen offset:384 sc1
Lua_5:
    buffer_load_dwordx4 v[76:79], v235, s[20:23], s97 offen offset:0 sc1
    buffer_load_dwordx4 v[80:83], v235, s[20:23], s97 offen offset:128 sc1
    buffer_load_dwordx4 v[84:87], v235, s[20:23], s97 offen offset:256 sc1
    buffer_load_dwordx4 v[88:91], v235, s[20:23], s97 offen offset:384 sc1
    s_waitcnt vmcnt(0)
    v_bitop3_b32 v47, v77, v79, s59 bitop3:0x7e
    v_bitop3_b32 v48, v81, v83, s59 bitop3:0x7e
    v_bitop3_b32 v47, v85, v47, s59 bitop3:0xde
    v_bitop3_b32 v48, v87, v48, s59 bitop3:0xde
    v_bitop3_b32 v47, v89, v47, s59 bitop3:0xde
    v_bitop3_b32 v48, v91, v48, s59 bitop3:0xde
    v_or_b32 v47, v47, v48
    v_cmp_ne_u32 vcc, 0, v47
    s_cbranch_vccnz Lrt_3
    s_branch Lck_2
Lxq_10:
    s_sub_u32 s58, s58, 1
    s_cbranch_scc1 L_exit
    v_lshrrev_b32 v37, 2, v1
    v_and_b32 v37, 124, v37
    buffer_load_dword v37, v37, s[20:23], s90 offen sc1
    s_waitcnt vmcnt(0)
    s_branch Lxc_8
Lrt_14:
    s_sub_u32 s58, s58, 1
    s_cbranch_scc1 L_exit
    s_and_b32 s57, s58, 15
    s_cbranch_scc1 Lua_16
    v_lshrrev_b32 v37, 2, v1
    v_and_b32 v37, 124, v37
    buffer_load_dword v37, v37, s[20:23], s90 offen sc1
    s_waitcnt vmcnt(0)
    v_cmp_ne_u32 vcc, s92, v37
    s_cbranch_vccz Lua_16
    v_xor_b32 v37, s59, v37
    v_and_b32 v37, 0x0fffffff, v37
    v_cmp_ne_u32 vcc, 0, v37
    s_cbranch_vccnz Lua_16
    buffer_store_dwordx4 v[10:13], v75, s[20:23], s79 offen offset:0 sc1
    buffer_store_dwordx4 v[14:17], v75, s[20:23], s79 offen offset:128 sc1
    buffer_store_dwordx4 v[18:21], v75, s[20:23], s79 offen offset:256 sc1
    buffer_store_dwordx4 v[22:25], v75, s[20:23], s79 offen offset:384 sc1
Lua_16:
    buffer_load_dwordx4 v[76:79], v235, s[20:23], s97 offen offset:0 sc1
    buffer_load_dwordx4 v[80:83], v235, s[20:23], s97 offen offset:128 sc1
    buffer_load_dwordx4 v[84:87], v235, s[20:23], s97 offen offset:256 sc1
    buffer_load_dwordx4 v[88:91], v235, s[20:23], s97 offen offset:384 sc1
    s_waitcnt vmcnt(0)
    v_bitop3_b32 v47, v77, v79, s59 bitop3:0x7e
    v_bitop3_b32 v48, v81, v83, s59 bitop3:0x7e
    v_bitop3_b32 v47, v85, v47, s59 bitop3:0xde
    v_bitop3_b32 v48, v87, v48, s59 bitop3:0xde
    v_bitop3_b32 v47, v89, v47, s59 bitop3:0xde
    v_bitop3_b32 v48, v91, v48, s59 bitop3:0xde
    v_or_b32 v47, v47, v48
    v_cmp_ne_u32 vcc, 0, v47
    s_cbranch_vccnz Lrt_14
    s_branch Lck_13
Lxq_21:
    s_sub_u32 s58, s58, 1
    s_cbranch_scc1 L_exit
    v_lshrrev_b32 v37, 2, v1
    v_and_b32 v37, 124, v37
    buffer_load_dword v37, v37, s[20:23], s90 offen sc1
    s_waitcnt vmcnt(0)
    s_branch Lxc_19
Lxq_28:
    s_sub_u32 s58, s58, 1
    s_cbranch_scc1 L_exit
    v_lshrrev_b32 v37, 2, v1
    v_and_b32 v37, 124, v37
    buffer_load_dword v37, v37, s[20:23], s90 offen sc1
    s_waitcnt vmcnt(0)
    s_branch Lxc_26
L_help:
    buffer_load_dwordx4 v[76:79], v235, s[20:23], s97 offen offset:0 sc1
    buffer_load_dwordx4 v[80:83], v235, s[20:23], s97 offen offset:128 sc1
    buffer_load_dwordx4 v[84:87], v235, s[20:23], s97 offen offset:256 sc1
    buffer_load_dwordx4 v[88:91], v235, s[20:23], s97 offen offset:384 sc1
    v_mov_b32 v92, 0
    v_mov_b32 v93, 0
    v_mov_b32 v94, 0
    v_mov_b32 v95, 0
    v_and_b32 v49, 7, v44
    v_mul_u32_u24 v49, 4160, v49
    v_add_u32 v49, 98304, v49
    v_and_b32 v65, 31, v44
    v_min_u32 v65, 29, v65
    v_lshlrev_b32 v65, 4, v65
    v_lshrrev_b32 v64, 5, v44
    v_mul_u32_u24 v64, 4608, v64
    v_add3_u32 v64, v64, v65, s83
    ds_write_b128 v49, v[92:95]
    ds_write_b128 v64, v[92:95]
    v_and_b32 v65, 3, v44
    v_lshlrev_b32 v65, 4, v65
    v_sub_u32 v65, 48, v65
    s_waitcnt vmcnt(17)
    v_lshlrev_b64 v[94:95], v65, v[50:51]
    v_lshlrev_b64 v[94:95], 16, v[94:95]
    ds_write_b128 v49, v[92:95] offset:16
    s_and_b32 s85, s53, 1
    s_lshr_b32 s56, s53, 1
    v_not_b32 v64, v44
    v_bfe_u32 v49, v64, 3, 1
    v_lshrrev_b32 v65, 4, v44
    v_lshl_add_u32 v65, s85, 2, v65
    v_cmp_eq_u32 vcc, v49, v65
    v_bfe_u32 v49, v64, 1, 2
    v_and_b32 v64, 1, v64
    v_lshlrev_b32 v64, 4, v64
    v_cndmask_b32 v49, 7, v49, vcc
    s_waitcnt vmcnt(16)
    v_lshlrev_b32 v45, v64, v45
    v_cmp_eq_u32 vcc, 0, v49
    s_nop 1
    v_cndmask_b32 v68, 0, v45, vcc
    v_cmp_eq_u32 vcc, 1, v49
    s_nop 1
    v_cndmask_b32 v69, 0, v45, vcc
    v_cmp_eq_u32 vcc, 2, v49
    s_nop 1
    v_cndmask_b32 v70, 0, v45, vcc
    v_cmp_eq_u32 vcc, 3, v49
    s_nop 1
    v_cndmask_b32 v71, 0, v45, vcc
    v_and_b32 v49, 15, v44
    v_add_u32 v64, 1, v49
    v_and_b32 v65, 3, v64
    v_mul_u32_u24 v67, 4160, v65
    v_lshrrev_b32 v64, 2, v64
    v_lshl_add_u32 v67, v64, 3, v67
    v_lshrrev_b32 v65, 4, v44
    v_lshl_add_u32 v67, v65, 4, v67
    s_mul_i32 s57, s56, 16640
    s_lshl_b32 s82, s85, 8
    s_add_u32 s57, s57, s82
    s_add_u32 s57, s57, 98304
    v_add_u32 v67, s57, v67
    v_lshlrev_b32 v49, 5, v49
    v_lshlrev_b32 v65, 4, v65
    v_sub_u32 v72, v65, v49
    s_mul_i32 s57, s56, 4608
    s_add_u32 s57, s57, s82
    s_add_u32 s57, s57, 148448
    v_add_u32 v72, s57, v72
    s_mov_b64 exec, 0
    s_cmp_eq_u32 s53, 1
    s_cbranch_scc1 L_i6004
    s_cmp_eq_u32 s53, 2
    s_cbranch_scc1 L_i6318
    s_cmp_eq_u32 s53, 3
    s_cbranch_scc1 L_i6362
    s_branch L_i5734
L_backH:
    s_mov_b64 exec, -1
    s_waitcnt vmcnt(0)
    v_bitop3_b32 v47, v77, v79, s59 bitop3:0x7e
    v_bitop3_b32 v48, v81, v83, s59 bitop3:0x7e
    v_bitop3_b32 v47, v85, v47, s59 bitop3:0xde
    v_bitop3_b32 v48, v87, v48, s59 bitop3:0xde
    v_bitop3_b32 v47, v89, v47, s59 bitop3:0xde
    v_bitop3_b32 v48, v91, v48, s59 bitop3:0xde
    v_or_b32 v47, v47, v48
    v_cmp_ne_u32 vcc, 0, v47
    s_cbranch_vccnz Lrt_3
Lck_2:
    v_mov_b32 v77, v78
    v_mov_b32 v78, v80
    v_mov_b32 v79, v82
    ds_write_b128 v230, v[76:79] offset:0
    v_mov_b32 v85, v86
    v_mov_b32 v86, v88
    v_mov_b32 v87, v90
    ds_write_b128 v230, v[84:87] offset:4608
    v_lshrrev_b32 v37, 2, v1
    v_and_b32 v37, 124, v37
    buffer_load_dword v37, v37, s[20:23], s90 offen sc1
    s_waitcnt lgkmcnt(0)
    s_barrier
    ds_read_b128 a[32:35], v72 offset:3584
    ds_read_b128 a[36:39], v72 offset:3072
    ds_read_b128 a[40:43], v72 offset:2560
    ds_read_b128 a[44:47], v72 offset:2048
    ds_read_b64 a[0:1], v67 offset:0
    ds_read_b64 a[2:3], v67 offset:8
    ds_read_b64 a[4:5], v67 offset:512
    ds_read_b64 a[6:7], v67 offset:520
    ds_read_b64 a[8:9], v67 offset:1024
    ds_read_b64 a[10:11], v67 offset:1032
    ds_read_b64 a[12:13], v67 offset:1536
    ds_read_b64 a[14:15], v67 offset:1544
    s_cmp_eq_u32 s85, 1
    s_cbranch_scc1 Lh_6
    s_waitcnt lgkmcnt(10)
    v_mfma_f32_16x16x32_bf16 v[128:131], v[68:71], a[36:39], 0
    ds_read_b128 a[96:99], v72 offset:3648
    s_waitcnt lgkmcnt(10)
    v_mfma_f32_16x16x32_bf16 v[132:135], v[68:71], a[40:43], 0
    ds_read_b64 a[64:65], v67 offset:64
    s_waitcnt lgkmcnt(8)
    v_mfma_f32_16x16x32_bf16 v[128:131], a[0:3], a[36:39], v[128:131]
    ds_read_b64 a[66:67], v67 offset:72
    v_mfma_f32_16x16x32_bf16 v[132:135], a[0:3], a[40:43], v[132:135]
    ds_read_b128 a[100:103], v72 offset:3136
    s_waitcnt lgkmcnt(8)
    v_mfma_f32_16x16x32_bf16 v[128:131], a[4:7], a[32:35], v[128:131]
    ds_read_b64 a[68:69], v67 offset:576
    v_mfma_f32_16x16x32_bf16 v[132:135], a[4:7], a[36:39], v[132:135]
    ds_read_b64 a[70:71], v67 offset:584
    s_waitcnt lgkmcnt(8)
    v_mfma_f32_16x16x32_bf16 v[132:135], a[8:11], a[32:35], v[132:135]
    ds_read_b128 a[104:107], v72 offset:2624
    v_mfma_f32_16x16x32_bf16 v[124:127], v[68:71], a[32:35], 0
    ds_read_b64 a[72:73], v67 offset:1088
    s_waitcnt lgkmcnt(4)
    v_mfma_f32_16x16x32_bf16 v[128:131], a[64:67], a[100:103], v[128:131]
    ds_read_b64 a[74:75], v67 offset:1096
    v_mfma_f32_16x16x32_bf16 v[136:139], v[68:71], a[44:47], 0
    ds_read_b128 a[108:111], v72 offset:2112
    s_waitcnt lgkmcnt(4)
    v_mfma_f32_16x16x32_bf16 v[128:131], a[68:71], a[96:99], v[128:131]
    ds_read_b64 a[76:77], v67 offset:1600
    v_mfma_f32_16x16x32_bf16 v[132:135], a[68:71], a[100:103], v[132:135]
    ds_read_b64 a[78:79], v67 offset:1608
    s_waitcnt lgkmcnt(5)
    v_mfma_f32_16x16x32_bf16 v[132:135], a[64:67], a[104:107], v[132:135]
    s_lshl_b32 s57, s53, 10
    s_add_u32 s57, s57, 131584
    ds_read_b128 a[160:163], v72 offset:3712
    s_waitcnt lgkmcnt(4)
    v_mfma_f32_16x16x32_bf16 v[132:135], a[72:75], a[96:99], v[132:135]
    ds_read_b64 a[128:129], v67 offset:128
    v_add_u32 v45, s57, v1
    v_mfma_f32_16x16x32_bf16 v[124:127], a[0:3], a[32:35], v[124:127]
    ds_read_b64 a[130:131], v67 offset:136
    v_bfe_u32 v47, v44, 2, 2
    v_mfma_f32_16x16x32_bf16 v[136:139], a[0:3], a[44:47], v[136:139]
    ds_read_b128 a[164:167], v72 offset:3200
    v_lshrrev_b32 v48, 4, v44
    v_mfma_f32_16x16x32_bf16 v[136:139], a[4:7], a[40:43], v[136:139]
    ds_read_b64 a[132:133], v67 offset:640
    v_mul_u32_u24 v46, 114688, v47
    v_mfma_f32_16x16x32_bf16 v[136:139], a[8:11], a[36:39], v[136:139]
    ds_read_b64 a[134:135], v67 offset:648
    v_lshl_add_u32 v46, v48, 12, v46
    v_mfma_f32_16x16x32_bf16 v[136:139], a[12:15], a[32:35], v[136:139]
    ds_read_b128 a[168:171], v72 offset:2688
    v_and_b32 v48, 3, v44
    v_mfma_f32_16x16x32_bf16 v[124:127], a[64:67], a[96:99], v[124:127]
    s_xor_b32 s57, s57, 1024
    ds_read_b64 a[136:137], v67 offset:1152
    v_lshl_add_u32 v46, v48, 4, v46
    s_waitcnt lgkmcnt(4)
    v_mfma_f32_16x16x32_bf16 v[128:131], a[128:131], a[164:167], v[128:131]
    ds_read_b64 a[138:139], v67 offset:1160
    v_add_u32 v47, s57, v1
    v_mfma_f32_16x16x32_bf16 v[136:139], a[68:71], a[104:107], v[136:139]
    s_and_b32 s56, s52, 3
    s_lshr_b32 s57, s53, 1
    ds_read_b128 a[172:175], v72 offset:2176
    s_waitcnt lgkmcnt(4)
    v_mfma_f32_16x16x32_bf16 v[128:131], a[132:135], a[160:163], v[128:131]
    s_lshl1_add_u32 s56, s56, s57
    s_lshr_b32 s57, s52, 2
    ds_read_b64 a[140:141], v67 offset:1664
    v_mfma_f32_16x16x32_bf16 v[132:135], a[132:135], a[164:167], v[132:135]
    s_lshl3_add_u32 s56, s56, s57
    s_lshl_b32 s56, s56, 6
    ds_read_b64 a[142:143], v67 offset:1672
    s_waitcnt lgkmcnt(5)
    v_mfma_f32_16x16x32_bf16 v[132:135], a[128:131], a[168:171], v[132:135]
    s_lshl_b32 s57, s3, 14
    s_add_u32 s56, s56, s57
    ds_read_b128 a[224:227], v72 offset:3776
    s_waitcnt lgkmcnt(4)
    v_mfma_f32_16x16x32_bf16 v[132:135], a[136:139], a[160:163], v[132:135]
    s_add_u32 s82, s56, 4718592
    ds_read_b64 a[192:193], v67 offset:192
L_i5734:
    s_cbranch_execz L_backH
    v_mov_b32 v77, v2
    v_mfma_f32_16x16x32_bf16 v[136:139], a[72:75], a[100:103], v[136:139]
    ds_read_b64 a[194:195], v67 offset:200
    v_mov_b32 v79, v2
    v_mfma_f32_16x16x32_bf16 v[136:139], a[64:67], a[108:111], v[136:139]
    ds_read_b128 a[228:231], v72 offset:3264
    v_mov_b32 v81, v2
    v_mfma_f32_16x16x32_bf16 v[136:139], a[76:79], a[96:99], v[136:139]
    ds_read_b64 a[196:197], v67 offset:704
    v_mov_b32 v83, v2
    v_mfma_f32_16x16x32_bf16 v[124:127], a[128:131], a[160:163], v[124:127]
    ds_read_b64 a[198:199], v67 offset:712
    v_mov_b32 v85, v2
    v_mfma_f32_16x16x32_bf16 v[136:139], a[132:135], a[168:171], v[136:139]
    ds_read_b128 a[232:235], v72 offset:2752
    v_mov_b32 v87, v2
    v_mfma_f32_16x16x32_bf16 v[136:139], a[136:139], a[164:167], v[136:139]
    ds_read_b64 a[200:201], v67 offset:1216
    v_mov_b32 v89, v2
    s_waitcnt lgkmcnt(4)
    v_mfma_f32_16x16x32_bf16 v[128:131], a[192:195], a[228:231], v[128:131]
    ds_read_b64 a[202:203], v67 offset:1224
    v_mov_b32 v91, v2
    v_mfma_f32_16x16x32_bf16 v[136:139], a[128:131], a[172:175], v[136:139]
    ds_read_b128 a[236:239], v72 offset:2240
    s_waitcnt lgkmcnt(4)
    v_mfma_f32_16x16x32_bf16 v[128:131], a[196:199], a[224:227], v[128:131]
    ds_read_b64 a[204:205], v67 offset:1728
    v_mfma_f32_16x16x32_bf16 v[132:135], a[196:199], a[228:231], v[132:135]
    ds_read_b64 a[206:207], v67 offset:1736
    s_waitcnt lgkmcnt(5)
    v_mfma_f32_16x16x32_bf16 v[132:135], a[192:195], a[232:235], v[132:135]
    s_nop 2
    ds_write_b128 v45, v[128:131] offset:0
    s_waitcnt lgkmcnt(4)
    v_mfma_f32_16x16x32_bf16 v[132:135], a[200:203], a[224:227], v[132:135]
    v_mfma_f32_16x16x32_bf16 v[136:139], a[140:143], a[160:163], v[136:139]
    ds_read_b128 a[48:51], v72 offset:1536
    v_mfma_f32_16x16x32_bf16 v[124:127], a[192:195], a[224:227], v[124:127]
    ds_read_b64 a[16:17], v67 offset:2048
    s_nop 3
    ds_write_b128 v45, v[132:135] offset:4096
    v_mfma_f32_16x16x32_bf16 v[136:139], a[196:199], a[232:235], v[136:139]
    ds_read_b64 a[18:19], v67 offset:2056
    v_mfma_f32_16x16x32_bf16 v[136:139], a[200:203], a[228:231], v[136:139]
    ds_read_b128 a[52:55], v72 offset:1024
    s_waitcnt lgkmcnt(8)
    v_mfma_f32_16x16x32_bf16 v[136:139], a[192:195], a[236:239], v[136:139]
    s_waitcnt lgkmcnt(6)
    v_mfma_f32_16x16x32_bf16 v[136:139], a[204:207], a[224:227], v[136:139]
    ds_read_b64 a[20:21], v67 offset:2560
    v_mfma_f32_16x16x32_bf16 v[144:147], a[8:11], a[44:47], 0
    ds_read_b64 a[22:23], v67 offset:2568
    v_mfma_f32_16x16x32_bf16 v[144:147], a[12:15], a[40:43], v[144:147]
    ds_read_b128 a[112:115], v72 offset:1600
    v_mfma_f32_16x16x32_bf16 v[144:147], a[72:75], a[108:111], v[144:147]
    s_waitcnt lgkmcnt(5)
    s_barrier
    ds_read_b128 v[92:95], v47 offset:0
    ds_read_b128 v[96:99], v47 offset:4096
    v_mfma_f32_16x16x32_bf16 v[144:147], a[76:79], a[104:107], v[144:147]
    s_add_u32 s57, s82, 0
    ds_read_b64 a[80:81], v67 offset:2112
    v_mfma_f32_16x16x32_bf16 v[144:147], a[136:139], a[172:175], v[144:147]
    ds_read_b64 a[82:83], v67 offset:2120
    v_mfma_f32_16x16x32_bf16 v[144:147], a[140:143], a[168:171], v[144:147]
    ds_read_b128 a[116:119], v72 offset:1088
    v_mfma_f32_16x16x32_bf16 v[144:147], a[200:203], a[236:239], v[144:147]
    ds_read_b64 a[84:85], v67 offset:2624
    v_mfma_f32_16x16x32_bf16 v[144:147], a[204:207], a[232:235], v[144:147]
    ds_read_b64 a[86:87], v67 offset:2632
    v_mfma_f32_16x16x32_bf16 v[144:147], a[4:7], a[48:51], v[144:147]
    s_waitcnt lgkmcnt(6)
    v_add_f32 v124, v124, v92
    v_add_f32 v125, v125, v93
    v_mfma_f32_16x16x32_bf16 v[144:147], a[16:19], a[36:39], v[144:147]
    ds_read_b128 a[176:179], v72 offset:1664
    v_add_f32 v126, v126, v94
    v_mfma_f32_16x16x32_bf16 v[144:147], v[68:71], a[52:55], v[144:147]
    ds_read_b64 a[144:145], v67 offset:2176
    v_add_f32 v127, v127, v95
    v_mfma_f32_16x16x32_bf16 v[144:147], a[0:3], a[52:55], v[144:147]
    ds_read_b64 a[146:147], v67 offset:2184
    v_cvt_pk_bf16_f32 v76, v124, v125
    v_mfma_f32_16x16x32_bf16 v[144:147], a[20:23], a[32:35], v[144:147]
    ds_read_b128 a[180:183], v72 offset:1152
    v_cvt_pk_bf16_f32 v78, v126, v127
    v_mfma_f32_16x16x32_bf16 v[144:147], a[68:71], a[112:115], v[144:147]
    buffer_store_dwordx4 v[76:79], v46, s[20:23], s57 offen sc1
    s_add_u32 s57, s82, 1572864
    s_waitcnt lgkmcnt(7)
    v_mfma_f32_16x16x32_bf16 v[144:147], a[80:83], a[100:103], v[144:147]
    ds_read_b64 a[148:149], v67 offset:2688
    v_add_f32 v136, v136, v96
    s_waitcnt lgkmcnt(7)
    v_mfma_f32_16x16x32_bf16 v[144:147], a[64:67], a[116:119], v[144:147]
    ds_read_b64 a[150:151], v67 offset:2696
    v_add_f32 v137, v137, v97
    s_waitcnt lgkmcnt(6)
    v_mfma_f32_16x16x32_bf16 v[144:147], a[84:87], a[96:99], v[144:147]
    ds_read_b128 a[240:243], v72 offset:1728
    v_add_f32 v138, v138, v98
    s_waitcnt lgkmcnt(6)
    v_mfma_f32_16x16x32_bf16 v[144:147], a[132:135], a[176:179], v[144:147]
    ds_read_b64 a[208:209], v67 offset:2240
    v_add_f32 v139, v139, v99
    s_waitcnt lgkmcnt(5)
    v_mfma_f32_16x16x32_bf16 v[144:147], a[144:147], a[164:167], v[144:147]
    v_cvt_pk_bf16_f32 v80, v136, v137
    v_cvt_pk_bf16_f32 v82, v138, v139
    s_waitcnt lgkmcnt(4)
    v_mfma_f32_16x16x32_bf16 v[144:147], a[128:131], a[180:183], v[144:147]
    ds_read_b64 a[210:211], v67 offset:2248
    buffer_store_dwordx4 v[80:83], v46, s[20:23], s57 offen sc1
    s_waitcnt lgkmcnt(3)
    v_mfma_f32_16x16x32_bf16 v[144:147], a[148:151], a[160:163], v[144:147]
    ds_read_b128 a[244:247], v72 offset:1216
    s_waitcnt lgkmcnt(3)
    v_mfma_f32_16x16x32_bf16 v[144:147], a[196:199], a[240:243], v[144:147]
    ds_read_b64 a[212:213], v67 offset:2752
    v_mfma_f32_16x16x32_bf16 v[140:143], a[4:7], a[44:47], 0
    ds_read_b64 a[214:215], v67 offset:2760
    v_mfma_f32_16x16x32_bf16 v[140:143], a[8:11], a[40:43], v[140:143]
    s_waitcnt lgkmcnt(3)
    v_mfma_f32_16x16x32_bf16 v[144:147], a[208:211], a[228:231], v[144:147]
    s_waitcnt lgkmcnt(2)
    v_mfma_f32_16x16x32_bf16 v[144:147], a[192:195], a[244:247], v[144:147]
    v_mfma_f32_16x16x32_bf16 v[140:143], a[12:15], a[36:39], v[140:143]
    s_waitcnt lgkmcnt(0)
    v_mfma_f32_16x16x32_bf16 v[144:147], a[212:215], a[224:227], v[144:147]
    v_mfma_f32_16x16x32_bf16 v[140:143], a[72:75], a[104:107], v[140:143]
    ds_read_b128 a[56:59], v72 offset:512
    v_mfma_f32_16x16x32_bf16 v[140:143], a[68:71], a[108:111], v[140:143]
    ds_read_b64 a[24:25], v67 offset:3072
    s_nop 3
    ds_write_b128 v45, v[144:147] offset:12288
    v_mfma_f32_16x16x32_bf16 v[140:143], a[76:79], a[100:103], v[140:143]
    ds_read_b64 a[26:27], v67 offset:3080
    v_mfma_f32_16x16x32_bf16 v[140:143], a[136:139], a[168:171], v[140:143]
    v_mfma_f32_16x16x32_bf16 v[140:143], a[132:135], a[172:175], v[140:143]
    s_waitcnt lgkmcnt(1)
    s_barrier
    ds_read_b128 v[92:95], v47 offset:12288
    v_mfma_f32_16x16x32_bf16 v[140:143], a[140:143], a[164:167], v[140:143]
    s_add_u32 s57, s82, 2097152
    ds_read_b128 a[60:63], v72 offset:0
    ds_read_b64 a[28:29], v67 offset:3584
    v_mfma_f32_16x16x32_bf16 v[140:143], a[200:203], a[232:235], v[140:143]
    v_mfma_f32_16x16x32_bf16 v[140:143], a[196:199], a[236:239], v[140:143]
    ds_read_b64 a[30:31], v67 offset:3592
    v_mfma_f32_16x16x32_bf16 v[140:143], a[204:207], a[228:231], v[140:143]
    ds_read_b128 a[120:123], v72 offset:576
    v_mfma_f32_16x16x32_bf16 v[140:143], v[68:71], a[48:51], v[140:143]
    ds_read_b64 a[88:89], v67 offset:3136
    v_mfma_f32_16x16x32_bf16 v[140:143], a[0:3], a[48:51], v[140:143]
    v_mfma_f32_16x16x32_bf16 v[140:143], a[16:19], a[32:35], v[140:143]
    ds_read_b64 a[90:91], v67 offset:3144
    v_mfma_f32_16x16x32_bf16 v[140:143], a[64:67], a[112:115], v[140:143]
    ds_read_b128 a[124:127], v72 offset:64
    v_mfma_f32_16x16x32_bf16 v[140:143], a[80:83], a[96:99], v[140:143]
    v_mfma_f32_16x16x32_bf16 v[140:143], a[128:131], a[176:179], v[140:143]
    ds_read_b64 a[92:93], v67 offset:3648
    v_mfma_f32_16x16x32_bf16 v[140:143], a[144:147], a[160:163], v[140:143]
    ds_read_b64 a[94:95], v67 offset:3656
    v_mfma_f32_16x16x32_bf16 v[140:143], a[192:195], a[240:243], v[140:143]
    ds_read_b128 a[184:187], v72 offset:640
    v_mfma_f32_16x16x32_bf16 v[140:143], a[208:211], a[224:227], v[140:143]
    v_mfma_f32_16x16x32_bf16 v[148:151], a[12:15], a[44:47], 0
    ds_read_b64 a[152:153], v67 offset:3200
    v_mfma_f32_16x16x32_bf16 v[148:151], a[76:79], a[108:111], v[148:151]
    s_waitcnt lgkmcnt(11)
    ds_read_b64 a[154:155], v67 offset:3208
    s_nop 2
    v_add_f32 v140, v140, v92
    v_mfma_f32_16x16x32_bf16 v[148:151], a[140:143], a[172:175], v[148:151]
    v_add_f32 v141, v141, v93
    v_add_f32 v142, v142, v94
    v_mfma_f32_16x16x32_bf16 v[148:151], a[204:207], a[236:239], v[148:151]
    ds_read_b128 a[188:191], v72 offset:128
    v_add_f32 v143, v143, v95
    v_mfma_f32_16x16x32_bf16 v[148:151], a[8:11], a[48:51], v[148:151]
    ds_read_b64 a[156:157], v67 offset:3712
    v_cvt_pk_bf16_f32 v84, v140, v141
    v_mfma_f32_16x16x32_bf16 v[148:151], a[16:19], a[40:43], v[148:151]
    ds_read_b64 a[158:159], v67 offset:3720
    v_cvt_pk_bf16_f32 v86, v142, v143
    v_mfma_f32_16x16x32_bf16 v[148:151], a[4:7], a[52:55], v[148:151]
    buffer_store_dwordx4 v[84:87], v46, s[20:23], s57 offen sc1
    v_mfma_f32_16x16x32_bf16 v[148:151], a[20:23], a[36:39], v[148:151]
    ds_read_b128 a[248:251], v72 offset:704
    v_mfma_f32_16x16x32_bf16 v[148:151], a[72:75], a[112:115], v[148:151]
    ds_read_b64 a[216:217], v67 offset:3264
    v_mfma_f32_16x16x32_bf16 v[148:151], a[80:83], a[104:107], v[148:151]
    v_mfma_f32_16x16x32_bf16 v[148:151], a[68:71], a[116:119], v[148:151]
    ds_read_b64 a[218:219], v67 offset:3272
    v_mfma_f32_16x16x32_bf16 v[148:151], a[84:87], a[100:103], v[148:151]
    ds_read_b128 a[252:255], v72 offset:192
    v_mfma_f32_16x16x32_bf16 v[148:151], a[136:139], a[176:179], v[148:151]
    ds_read_b64 a[220:221], v67 offset:3776
    v_mfma_f32_16x16x32_bf16 v[148:151], a[144:147], a[168:171], v[148:151]
    v_mfma_f32_16x16x32_bf16 v[148:151], a[132:135], a[180:183], v[148:151]
    ds_read_b64 a[222:223], v67 offset:3784
    v_mfma_f32_16x16x32_bf16 v[148:151], a[148:151], a[164:167], v[148:151]
    v_mfma_f32_16x16x32_bf16 v[148:151], a[200:203], a[240:243], v[148:151]
    v_mfma_f32_16x16x32_bf16 v[148:151], a[208:211], a[232:235], v[148:151]
    v_mfma_f32_16x16x32_bf16 v[148:151], a[196:199], a[244:247], v[148:151]
    v_mfma_f32_16x16x32_bf16 v[148:151], a[212:215], a[228:231], v[148:151]
    v_mfma_f32_16x16x32_bf16 v[148:151], v[68:71], a[56:59], v[148:151]
    v_mfma_f32_16x16x32_bf16 v[148:151], a[0:3], a[56:59], v[148:151]
    v_mfma_f32_16x16x32_bf16 v[148:151], a[24:27], a[32:35], v[148:151]
    s_waitcnt lgkmcnt(15)
    v_mfma_f32_16x16x32_bf16 v[148:151], a[64:67], a[120:123], v[148:151]
    v_mfma_f32_16x16x32_bf16 v[148:151], a[88:91], a[96:99], v[148:151]
    s_waitcnt lgkmcnt(11)
    v_mfma_f32_16x16x32_bf16 v[148:151], a[128:131], a[184:187], v[148:151]
    s_waitcnt lgkmcnt(9)
    v_mfma_f32_16x16x32_bf16 v[148:151], a[152:155], a[160:163], v[148:151]
    s_waitcnt lgkmcnt(5)
    v_mfma_f32_16x16x32_bf16 v[148:151], a[192:195], a[248:251], v[148:151]
    s_waitcnt lgkmcnt(3)
    v_mfma_f32_16x16x32_bf16 v[148:151], a[216:219], a[224:227], v[148:151]
    v_mfma_f32_16x16x32_bf16 v[152:155], a[12:15], a[48:51], 0
    v_mfma_f32_16x16x32_bf16 v[152:155], a[16:19], a[44:47], v[152:155]
    s_nop 5
    ds_write_b128 v45, v[148:151] offset:8192
    v_mfma_f32_16x16x32_bf16 v[152:155], a[8:11], a[52:55], v[152:155]
    v_mfma_f32_16x16x32_bf16 v[152:155], a[20:23], a[40:43], v[152:155]
    v_mfma_f32_16x16x32_bf16 v[152:155], a[76:79], a[112:115], v[152:155]
    v_mfma_f32_16x16x32_bf16 v[152:155], a[80:83], a[108:111], v[152:155]
    v_mfma_f32_16x16x32_bf16 v[152:155], a[72:75], a[116:119], v[152:155]
    v_mfma_f32_16x16x32_bf16 v[152:155], a[84:87], a[104:107], v[152:155]
    v_mfma_f32_16x16x32_bf16 v[152:155], a[140:143], a[176:179], v[152:155]
    s_waitcnt lgkmcnt(0)
    s_barrier
    ds_read_b128 v[92:95], v47 offset:8192
    v_mfma_f32_16x16x32_bf16 v[152:155], a[144:147], a[172:175], v[152:155]
    s_add_u32 s57, s82, 3670016
    v_mfma_f32_16x16x32_bf16 v[152:155], a[136:139], a[180:183], v[152:155]
    v_mfma_f32_16x16x32_bf16 v[152:155], a[148:151], a[168:171], v[152:155]
    v_mfma_f32_16x16x32_bf16 v[152:155], a[204:207], a[240:243], v[152:155]
    v_mfma_f32_16x16x32_bf16 v[152:155], a[208:211], a[236:239], v[152:155]
    v_mfma_f32_16x16x32_bf16 v[152:155], a[200:203], a[244:247], v[152:155]
    v_mfma_f32_16x16x32_bf16 v[152:155], a[212:215], a[232:235], v[152:155]
    v_mfma_f32_16x16x32_bf16 v[152:155], a[4:7], a[56:59], v[152:155]
    v_mfma_f32_16x16x32_bf16 v[152:155], a[24:27], a[36:39], v[152:155]
    v_mfma_f32_16x16x32_bf16 v[152:155], v[68:71], a[60:63], v[152:155]
    v_mfma_f32_16x16x32_bf16 v[152:155], a[0:3], a[60:63], v[152:155]
    v_mfma_f32_16x16x32_bf16 v[152:155], a[28:31], a[32:35], v[152:155]
    v_mfma_f32_16x16x32_bf16 v[152:155], a[68:71], a[120:123], v[152:155]
    v_mfma_f32_16x16x32_bf16 v[152:155], a[88:91], a[100:103], v[152:155]
    v_mfma_f32_16x16x32_bf16 v[152:155], a[64:67], a[124:127], v[152:155]
    v_mfma_f32_16x16x32_bf16 v[152:155], a[92:95], a[96:99], v[152:155]
    v_mfma_f32_16x16x32_bf16 v[152:155], a[132:135], a[184:187], v[152:155]
    v_mfma_f32_16x16x32_bf16 v[152:155], a[152:155], a[164:167], v[152:155]
    v_mfma_f32_16x16x32_bf16 v[152:155], a[128:131], a[188:191], v[152:155]
    v_mfma_f32_16x16x32_bf16 v[152:155], a[156:159], a[160:163], v[152:155]
    v_mfma_f32_16x16x32_bf16 v[152:155], a[196:199], a[248:251], v[152:155]
    v_mfma_f32_16x16x32_bf16 v[152:155], a[216:219], a[228:231], v[152:155]
    v_mfma_f32_16x16x32_bf16 v[152:155], a[192:195], a[252:255], v[152:155]
    v_mfma_f32_16x16x32_bf16 v[152:155], a[220:223], a[224:227], v[152:155]
    s_waitcnt lgkmcnt(0)
    s_nop 6
    v_pk_add_f32 v[152:153], v[152:153], v[92:93]
    v_pk_add_f32 v[154:155], v[154:155], v[94:95]
    v_cvt_pk_bf16_f32 v88, v152, v153
    v_cvt_pk_bf16_f32 v90, v154, v155
    buffer_store_dwordx4 v[88:91], v46, s[20:23], s57 offen sc1
    s_branch Lh_7
Lh_6:
L_i6004:
    s_cbranch_execz L_backH
    s_waitcnt lgkmcnt(11)
    v_mfma_f32_16x16x32_bf16 v[124:127], v[68:71], a[32:35], 0
    ds_read_b128 a[96:99], v72 offset:3648
    s_waitcnt lgkmcnt(9)
    v_mfma_f32_16x16x32_bf16 v[136:139], v[68:71], a[44:47], 0
    ds_read_b64 a[64:65], v67 offset:64
    s_waitcnt lgkmcnt(8)
    v_mfma_f32_16x16x32_bf16 v[124:127], a[0:3], a[32:35], v[124:127]
    ds_read_b64 a[66:67], v67 offset:72
    v_mfma_f32_16x16x32_bf16 v[136:139], a[0:3], a[44:47], v[136:139]
    ds_read_b128 a[100:103], v72 offset:3136
    s_waitcnt lgkmcnt(8)
    v_mfma_f32_16x16x32_bf16 v[136:139], a[4:7], a[40:43], v[136:139]
    ds_read_b64 a[68:69], v67 offset:576
    s_waitcnt lgkmcnt(7)
    v_mfma_f32_16x16x32_bf16 v[136:139], a[8:11], a[36:39], v[136:139]
    ds_read_b64 a[70:71], v67 offset:584
    s_waitcnt lgkmcnt(6)
    v_mfma_f32_16x16x32_bf16 v[136:139], a[12:15], a[32:35], v[136:139]
    ds_read_b128 a[104:107], v72 offset:2624
    s_waitcnt lgkmcnt(4)
    v_mfma_f32_16x16x32_bf16 v[124:127], a[64:67], a[96:99], v[124:127]
    ds_read_b64 a[72:73], v67 offset:1088
    v_mfma_f32_16x16x32_bf16 v[128:131], v[68:71], a[36:39], 0
    ds_read_b64 a[74:75], v67 offset:1096
    v_mfma_f32_16x16x32_bf16 v[132:135], v[68:71], a[40:43], 0
    ds_read_b128 a[108:111], v72 offset:2112
    v_mfma_f32_16x16x32_bf16 v[128:131], a[0:3], a[36:39], v[128:131]
    ds_read_b64 a[76:77], v67 offset:1600
    s_waitcnt lgkmcnt(4)
    v_mfma_f32_16x16x32_bf16 v[136:139], a[68:71], a[104:107], v[136:139]
    ds_read_b64 a[78:79], v67 offset:1608
    v_mfma_f32_16x16x32_bf16 v[132:135], a[0:3], a[40:43], v[132:135]
    s_lshl_b32 s57, s53, 10
    s_add_u32 s57, s57, 131584
    ds_read_b128 a[160:163], v72 offset:3712
    s_waitcnt lgkmcnt(4)
    v_mfma_f32_16x16x32_bf16 v[136:139], a[72:75], a[100:103], v[136:139]
    ds_read_b64 a[128:129], v67 offset:128
    v_add_u32 v45, s57, v1
    s_waitcnt lgkmcnt(4)
    v_mfma_f32_16x16x32_bf16 v[136:139], a[64:67], a[108:111], v[136:139]
    ds_read_b64 a[130:131], v67 offset:136
    v_bfe_u32 v47, v44, 2, 2
    v_mfma_f32_16x16x32_bf16 v[128:131], a[4:7], a[32:35], v[128:131]
    ds_read_b128 a[164:167], v72 offset:3200
    v_lshrrev_b32 v48, 4, v44
    s_waitcnt lgkmcnt(4)
    v_mfma_f32_16x16x32_bf16 v[136:139], a[76:79], a[96:99], v[136:139]
    ds_read_b64 a[132:133], v67 offset:640
    v_mul_u32_u24 v46, 114688, v47
    v_mfma_f32_16x16x32_bf16 v[132:135], a[4:7], a[36:39], v[132:135]
    ds_read_b64 a[134:135], v67 offset:648
    v_lshl_add_u32 v46, v48, 12, v46
    v_mfma_f32_16x16x32_bf16 v[132:135], a[8:11], a[32:35], v[132:135]
    ds_read_b128 a[168:171], v72 offset:2688
    v_and_b32 v48, 3, v44
    s_waitcnt lgkmcnt(4)
    v_mfma_f32_16x16x32_bf16 v[124:127], a[128:131], a[160:163], v[124:127]
    s_xor_b32 s57, s57, 1024
    ds_read_b64 a[136:137], v67 offset:1152
    v_lshl_add_u32 v46, v48, 4, v46
    v_mfma_f32_16x16x32_bf16 v[128:131], a[64:67], a[100:103], v[128:131]
    ds_read_b64 a[138:139], v67 offset:1160
    v_add_u32 v47, s57, v1
    v_mfma_f32_16x16x32_bf16 v[128:131], a[68:71], a[96:99], v[128:131]
    s_and_b32 s56, s52, 3
    s_lshr_b32 s57, s53, 1
    ds_read_b128 a[172:175], v72 offset:2176
    v_mfma_f32_16x16x32_bf16 v[132:135], a[68:71], a[100:103], v[132:135]
    s_lshl1_add_u32 s56, s56, s57
    s_lshr_b32 s57, s52, 2
    ds_read_b64 a[140:141], v67 offset:1664
    s_waitcnt lgkmcnt(4)
    v_mfma_f32_16x16x32_bf16 v[136:139], a[132:135], a[168:171], v[136:139]
    s_lshl3_add_u32 s56, s56, s57
    s_lshl_b32 s56, s56, 6
    ds_read_b64 a[142:143], v67 offset:1672
    v_mfma_f32_16x16x32_bf16 v[132:135], a[64:67], a[104:107], v[132:135]
    s_lshl_b32 s57, s3, 14
    s_add_u32 s56, s56, s57
    ds_read_b128 a[224:227], v72 offset:3776
    s_waitcnt lgkmcnt(4)
    v_mfma_f32_16x16x32_bf16 v[136:139], a[136:139], a[164:167], v[136:139]
    s_add_u32 s82, s56, 4718592
    ds_read_b64 a[192:193], v67 offset:192
    v_mov_b32 v77, v2
    s_waitcnt lgkmcnt(4)
    v_mfma_f32_16x16x32_bf16 v[136:139], a[128:131], a[172:175], v[136:139]
    ds_read_b64 a[194:195], v67 offset:200
    v_mov_b32 v79, v2
    v_mfma_f32_16x16x32_bf16 v[132:135], a[72:75], a[96:99], v[132:135]
    ds_read_b128 a[228:231], v72 offset:3264
    v_mov_b32 v81, v2
    s_waitcnt lgkmcnt(4)
    v_mfma_f32_16x16x32_bf16 v[136:139], a[140:143], a[160:163], v[136:139]
    ds_read_b64 a[196:197], v67 offset:704
    v_mov_b32 v83, v2
    v_mfma_f32_16x16x32_bf16 v[128:131], a[128:131], a[164:167], v[128:131]
    ds_read_b64 a[198:199], v67 offset:712
    v_mov_b32 v85, v2
    v_mfma_f32_16x16x32_bf16 v[128:131], a[132:135], a[160:163], v[128:131]
    ds_read_b128 a[232:235], v72 offset:2752
    v_mov_b32 v87, v2
    s_waitcnt lgkmcnt(4)
    v_mfma_f32_16x16x32_bf16 v[124:127], a[192:195], a[224:227], v[124:127]
    ds_read_b64 a[200:201], v67 offset:1216
    v_mov_b32 v89, v2
    v_mfma_f32_16x16x32_bf16 v[132:135], a[132:135], a[164:167], v[132:135]
    ds_read_b64 a[202:203], v67 offset:1224
    v_mov_b32 v91, v2
    v_mfma_f32_16x16x32_bf16 v[132:135], a[128:131], a[168:171], v[132:135]
    ds_read_b128 a[236:239], v72 offset:2240
    s_nop 0
    ds_write_b128 v45, v[124:127] offset:0
    v_mfma_f32_16x16x32_bf16 v[132:135], a[136:139], a[160:163], v[132:135]
    ds_read_b64 a[204:205], v67 offset:1728
    s_waitcnt lgkmcnt(5)
    v_mfma_f32_16x16x32_bf16 v[136:139], a[196:199], a[232:235], v[136:139]
    ds_read_b64 a[206:207], v67 offset:1736
    v_mfma_f32_16x16x32_bf16 v[128:131], a[192:195], a[228:231], v[128:131]
    s_waitcnt lgkmcnt(4)
    v_mfma_f32_16x16x32_bf16 v[136:139], a[200:203], a[228:231], v[136:139]
    s_waitcnt lgkmcnt(3)
    v_mfma_f32_16x16x32_bf16 v[136:139], a[192:195], a[236:239], v[136:139]
    ds_read_b128 a[48:51], v72 offset:1536
    v_mfma_f32_16x16x32_bf16 v[128:131], a[196:199], a[224:227], v[128:131]
    ds_read_b64 a[16:17], v67 offset:2048
    s_waitcnt lgkmcnt(2)
    v_mfma_f32_16x16x32_bf16 v[136:139], a[204:207], a[224:227], v[136:139]
    ds_read_b64 a[18:19], v67 offset:2056
    v_mfma_f32_16x16x32_bf16 v[132:135], a[196:199], a[228:231], v[132:135]
    ds_read_b128 a[52:55], v72 offset:1024
    v_mfma_f32_16x16x32_bf16 v[132:135], a[192:195], a[232:235], v[132:135]
    s_nop 3
    ds_write_b128 v45, v[136:139] offset:4096
    v_mfma_f32_16x16x32_bf16 v[132:135], a[200:203], a[224:227], v[132:135]
    ds_read_b64 a[20:21], v67 offset:2560
    v_mfma_f32_16x16x32_bf16 v[140:143], a[4:7], a[44:47], 0
    ds_read_b64 a[22:23], v67 offset:2568
    v_mfma_f32_16x16x32_bf16 v[140:143], a[8:11], a[40:43], v[140:143]
    ds_read_b128 a[112:115], v72 offset:1600
    v_mfma_f32_16x16x32_bf16 v[140:143], a[12:15], a[36:39], v[140:143]
    s_waitcnt lgkmcnt(3)
    s_barrier
    ds_read_b128 v[92:95], v47 offset:0
    ds_read_b128 v[96:99], v47 offset:4096
    v_mfma_f32_16x16x32_bf16 v[140:143], a[72:75], a[104:107], v[140:143]
    s_add_u32 s57, s82, 524288
    ds_read_b64 a[80:81], v67 offset:2112
    v_mfma_f32_16x16x32_bf16 v[140:143], a[68:71], a[108:111], v[140:143]
    ds_read_b64 a[82:83], v67 offset:2120
    v_mfma_f32_16x16x32_bf16 v[140:143], a[76:79], a[100:103], v[140:143]
    ds_read_b128 a[116:119], v72 offset:1088
    v_mfma_f32_16x16x32_bf16 v[140:143], a[136:139], a[168:171], v[140:143]
    ds_read_b64 a[84:85], v67 offset:2624
    v_mfma_f32_16x16x32_bf16 v[140:143], a[132:135], a[172:175], v[140:143]
    ds_read_b64 a[86:87], v67 offset:2632
    v_mfma_f32_16x16x32_bf16 v[140:143], a[140:143], a[164:167], v[140:143]
    s_waitcnt lgkmcnt(6)
    v_add_f32 v128, v128, v92
    v_add_f32 v129, v129, v93
    v_mfma_f32_16x16x32_bf16 v[140:143], a[200:203], a[232:235], v[140:143]
    ds_read_b128 a[176:179], v72 offset:1664
    v_add_f32 v130, v130, v94
    v_mfma_f32_16x16x32_bf16 v[140:143], a[196:199], a[236:239], v[140:143]
    ds_read_b64 a[144:145], v67 offset:2176
    v_add_f32 v131, v131, v95
    v_mfma_f32_16x16x32_bf16 v[140:143], a[204:207], a[228:231], v[140:143]
    ds_read_b64 a[146:147], v67 offset:2184
    v_cvt_pk_bf16_f32 v76, v128, v129
    v_mfma_f32_16x16x32_bf16 v[140:143], v[68:71], a[48:51], v[140:143]
    ds_read_b128 a[180:183], v72 offset:1152
    v_cvt_pk_bf16_f32 v78, v130, v131
    v_mfma_f32_16x16x32_bf16 v[140:143], a[0:3], a[48:51], v[140:143]
    buffer_store_dwordx4 v[76:79], v46, s[20:23], s57 offen sc1
    s_add_u32 s57, s82, 1048576
    v_mfma_f32_16x16x32_bf16 v[140:143], a[16:19], a[32:35], v[140:143]
    s_waitcnt lgkmcnt(9)
    ds_read_b64 a[148:149], v67 offset:2688
    v_add_f32 v132, v132, v96
    v_mfma_f32_16x16x32_bf16 v[140:143], a[64:67], a[112:115], v[140:143]
    ds_read_b64 a[150:151], v67 offset:2696
    v_add_f32 v133, v133, v97
    s_waitcnt lgkmcnt(9)
    v_mfma_f32_16x16x32_bf16 v[140:143], a[80:83], a[96:99], v[140:143]
    ds_read_b128 a[240:243], v72 offset:1728
    v_add_f32 v134, v134, v98
    s_waitcnt lgkmcnt(6)
    v_mfma_f32_16x16x32_bf16 v[140:143], a[128:131], a[176:179], v[140:143]
    ds_read_b64 a[208:209], v67 offset:2240
    v_add_f32 v135, v135, v99
    s_waitcnt lgkmcnt(5)
    v_mfma_f32_16x16x32_bf16 v[140:143], a[144:147], a[160:163], v[140:143]
    v_cvt_pk_bf16_f32 v80, v132, v133
    v_cvt_pk_bf16_f32 v82, v134, v135
    v_mfma_f32_16x16x32_bf16 v[144:147], a[8:11], a[44:47], 0
    ds_read_b64 a[210:211], v67 offset:2248
    buffer_store_dwordx4 v[80:83], v46, s[20:23], s57 offen sc1
    v_mfma_f32_16x16x32_bf16 v[144:147], a[12:15], a[40:43], v[144:147]
    ds_read_b128 a[244:247], v72 offset:1216
    s_waitcnt lgkmcnt(3)
    v_mfma_f32_16x16x32_bf16 v[140:143], a[192:195], a[240:243], v[140:143]
    ds_read_b64 a[212:213], v67 offset:2752
    v_mfma_f32_16x16x32_bf16 v[144:147], a[72:75], a[108:111], v[144:147]
    ds_read_b64 a[214:215], v67 offset:2760
    v_mfma_f32_16x16x32_bf16 v[144:147], a[76:79], a[104:107], v[144:147]
    s_waitcnt lgkmcnt(3)
    v_mfma_f32_16x16x32_bf16 v[140:143], a[208:211], a[224:227], v[140:143]
    v_mfma_f32_16x16x32_bf16 v[144:147], a[136:139], a[172:175], v[144:147]
    v_mfma_f32_16x16x32_bf16 v[144:147], a[140:143], a[168:171], v[144:147]
    s_nop 5
    ds_write_b128 v45, v[140:143] offset:12288
    v_mfma_f32_16x16x32_bf16 v[144:147], a[200:203], a[236:239], v[144:147]
    v_mfma_f32_16x16x32_bf16 v[144:147], a[204:207], a[232:235], v[144:147]
    ds_read_b128 a[56:59], v72 offset:512
    v_mfma_f32_16x16x32_bf16 v[144:147], a[4:7], a[48:51], v[144:147]
    ds_read_b64 a[24:25], v67 offset:3072
    v_mfma_f32_16x16x32_bf16 v[144:147], a[16:19], a[36:39], v[144:147]
    ds_read_b64 a[26:27], v67 offset:3080
    v_mfma_f32_16x16x32_bf16 v[144:147], v[68:71], a[52:55], v[144:147]
    v_mfma_f32_16x16x32_bf16 v[144:147], a[0:3], a[52:55], v[144:147]
    s_waitcnt lgkmcnt(3)
    s_barrier
    ds_read_b128 v[92:95], v47 offset:12288
    v_mfma_f32_16x16x32_bf16 v[144:147], a[20:23], a[32:35], v[144:147]
    s_add_u32 s57, s82, 2621440
    ds_read_b128 a[60:63], v72 offset:0
    ds_read_b64 a[28:29], v67 offset:3584
    v_mfma_f32_16x16x32_bf16 v[144:147], a[68:71], a[112:115], v[144:147]
    v_mfma_f32_16x16x32_bf16 v[144:147], a[80:83], a[100:103], v[144:147]
    ds_read_b64 a[30:31], v67 offset:3592
    v_mfma_f32_16x16x32_bf16 v[144:147], a[64:67], a[116:119], v[144:147]
    ds_read_b128 a[120:123], v72 offset:576
    v_mfma_f32_16x16x32_bf16 v[144:147], a[84:87], a[96:99], v[144:147]
    ds_read_b64 a[88:89], v67 offset:3136
    v_mfma_f32_16x16x32_bf16 v[144:147], a[132:135], a[176:179], v[144:147]
    v_mfma_f32_16x16x32_bf16 v[144:147], a[144:147], a[164:167], v[144:147]
    ds_read_b64 a[90:91], v67 offset:3144
    v_mfma_f32_16x16x32_bf16 v[144:147], a[128:131], a[180:183], v[144:147]
    ds_read_b128 a[124:127], v72 offset:64
    v_mfma_f32_16x16x32_bf16 v[144:147], a[148:151], a[160:163], v[144:147]
    v_mfma_f32_16x16x32_bf16 v[144:147], a[196:199], a[240:243], v[144:147]
    ds_read_b64 a[92:93], v67 offset:3648
    v_mfma_f32_16x16x32_bf16 v[144:147], a[208:211], a[228:231], v[144:147]
    ds_read_b64 a[94:95], v67 offset:3656
    v_mfma_f32_16x16x32_bf16 v[144:147], a[192:195], a[244:247], v[144:147]
    ds_read_b128 a[184:187], v72 offset:640
    v_mfma_f32_16x16x32_bf16 v[144:147], a[212:215], a[224:227], v[144:147]
    v_mfma_f32_16x16x32_bf16 v[152:155], a[12:15], a[48:51], 0
    ds_read_b64 a[152:153], v67 offset:3200
    v_mfma_f32_16x16x32_bf16 v[152:155], a[16:19], a[44:47], v[152:155]
    s_waitcnt lgkmcnt(11)
    ds_read_b64 a[154:155], v67 offset:3208
    s_nop 2
    v_add_f32 v144, v144, v92
    v_mfma_f32_16x16x32_bf16 v[152:155], a[8:11], a[52:55], v[152:155]
    v_add_f32 v145, v145, v93
    v_add_f32 v146, v146, v94
    v_mfma_f32_16x16x32_bf16 v[152:155], a[20:23], a[40:43], v[152:155]
    ds_read_b128 a[188:191], v72 offset:128
    v_add_f32 v147, v147, v95
    v_mfma_f32_16x16x32_bf16 v[152:155], a[76:79], a[112:115], v[152:155]
    ds_read_b64 a[156:157], v67 offset:3712
    v_cvt_pk_bf16_f32 v84, v144, v145
    v_mfma_f32_16x16x32_bf16 v[152:155], a[80:83], a[108:111], v[152:155]
    ds_read_b64 a[158:159], v67 offset:3720
    v_cvt_pk_bf16_f32 v86, v146, v147
    v_mfma_f32_16x16x32_bf16 v[152:155], a[72:75], a[116:119], v[152:155]
    buffer_store_dwordx4 v[84:87], v46, s[20:23], s57 offen sc1
    v_mfma_f32_16x16x32_bf16 v[152:155], a[84:87], a[104:107], v[152:155]
    ds_read_b128 a[248:251], v72 offset:704
    v_mfma_f32_16x16x32_bf16 v[152:155], a[140:143], a[176:179], v[152:155]
    ds_read_b64 a[216:217], v67 offset:3264
    v_mfma_f32_16x16x32_bf16 v[152:155], a[144:147], a[172:175], v[152:155]
    v_mfma_f32_16x16x32_bf16 v[152:155], a[136:139], a[180:183], v[152:155]
    ds_read_b64 a[218:219], v67 offset:3272
    v_mfma_f32_16x16x32_bf16 v[152:155], a[148:151], a[168:171], v[152:155]
    ds_read_b128 a[252:255], v72 offset:192
    v_mfma_f32_16x16x32_bf16 v[152:155], a[204:207], a[240:243], v[152:155]
    ds_read_b64 a[220:221], v67 offset:3776
    v_mfma_f32_16x16x32_bf16 v[152:155], a[208:211], a[236:239], v[152:155]
    v_mfma_f32_16x16x32_bf16 v[152:155], a[200:203], a[244:247], v[152:155]
    ds_read_b64 a[222:223], v67 offset:3784
    v_mfma_f32_16x16x32_bf16 v[152:155], a[212:215], a[232:235], v[152:155]
    v_mfma_f32_16x16x32_bf16 v[152:155], a[4:7], a[56:59], v[152:155]
    v_mfma_f32_16x16x32_bf16 v[152:155], a[24:27], a[36:39], v[152:155]
    s_waitcnt lgkmcnt(15)
    v_mfma_f32_16x16x32_bf16 v[152:155], v[68:71], a[60:63], v[152:155]
    v_mfma_f32_16x16x32_bf16 v[152:155], a[0:3], a[60:63], v[152:155]
    v_mfma_f32_16x16x32_bf16 v[152:155], a[28:31], a[32:35], v[152:155]
    v_mfma_f32_16x16x32_bf16 v[152:155], a[68:71], a[120:123], v[152:155]
    v_mfma_f32_16x16x32_bf16 v[152:155], a[88:91], a[100:103], v[152:155]
    s_waitcnt lgkmcnt(14)
    v_mfma_f32_16x16x32_bf16 v[152:155], a[64:67], a[124:127], v[152:155]
    s_waitcnt lgkmcnt(12)
    v_mfma_f32_16x16x32_bf16 v[152:155], a[92:95], a[96:99], v[152:155]
    s_waitcnt lgkmcnt(11)
    v_mfma_f32_16x16x32_bf16 v[152:155], a[132:135], a[184:187], v[152:155]
    s_waitcnt lgkmcnt(9)
    v_mfma_f32_16x16x32_bf16 v[152:155], a[152:155], a[164:167], v[152:155]
    s_waitcnt lgkmcnt(8)
    v_mfma_f32_16x16x32_bf16 v[152:155], a[128:131], a[188:191], v[152:155]
    s_waitcnt lgkmcnt(6)
    v_mfma_f32_16x16x32_bf16 v[152:155], a[156:159], a[160:163], v[152:155]
    s_waitcnt lgkmcnt(5)
    v_mfma_f32_16x16x32_bf16 v[152:155], a[196:199], a[248:251], v[152:155]
    s_waitcnt lgkmcnt(3)
    v_mfma_f32_16x16x32_bf16 v[152:155], a[216:219], a[228:231], v[152:155]
    s_waitcnt lgkmcnt(2)
    v_mfma_f32_16x16x32_bf16 v[152:155], a[192:195], a[252:255], v[152:155]
    s_waitcnt lgkmcnt(0)
    v_mfma_f32_16x16x32_bf16 v[152:155], a[220:223], a[224:227], v[152:155]
L_i6318:
    s_cbranch_execz L_backH
    v_mfma_f32_16x16x32_bf16 v[148:151], a[12:15], a[44:47], 0
    v_mfma_f32_16x16x32_bf16 v[148:151], a[76:79], a[108:111], v[148:151]
    s_nop 5
    ds_write_b128 v45, v[152:155] offset:8192
    v_mfma_f32_16x16x32_bf16 v[148:151], a[140:143], a[172:175], v[148:151]
    v_mfma_f32_16x16x32_bf16 v[148:151], a[204:207], a[236:239], v[148:151]
    v_mfma_f32_16x16x32_bf16 v[148:151], a[8:11], a[48:51], v[148:151]
    s_waitcnt lgkmcnt(0)
    s_barrier
    ds_read_b128 v[92:95], v47 offset:8192
    v_mfma_f32_16x16x32_bf16 v[148:151], a[16:19], a[40:43], v[148:151]
    s_add_u32 s57, s82, 3145728
    v_mfma_f32_16x16x32_bf16 v[148:151], a[4:7], a[52:55], v[148:151]
    v_mfma_f32_16x16x32_bf16 v[148:151], a[20:23], a[36:39], v[148:151]
    v_mfma_f32_16x16x32_bf16 v[148:151], a[72:75], a[112:115], v[148:151]
    v_mfma_f32_16x16x32_bf16 v[148:151], a[80:83], a[104:107], v[148:151]
    v_mfma_f32_16x16x32_bf16 v[148:151], a[68:71], a[116:119], v[148:151]
    v_mfma_f32_16x16x32_bf16 v[148:151], a[84:87], a[100:103], v[148:151]
    v_mfma_f32_16x16x32_bf16 v[148:151], a[136:139], a[176:179], v[148:151]
    v_mfma_f32_16x16x32_bf16 v[148:151], a[144:147], a[168:171], v[148:151]
    v_mfma_f32_16x16x32_bf16 v[148:151], a[132:135], a[180:183], v[148:151]
    v_mfma_f32_16x16x32_bf16 v[148:151], a[148:151], a[164:167], v[148:151]
    v_mfma_f32_16x16x32_bf16 v[148:151], a[200:203], a[240:243], v[148:151]
    v_mfma_f32_16x16x32_bf16 v[148:151], a[208:211], a[232:235], v[148:151]
    v_mfma_f32_16x16x32_bf16 v[148:151], a[196:199], a[244:247], v[148:151]
    v_mfma_f32_16x16x32_bf16 v[148:151], a[212:215], a[228:231], v[148:151]
    v_mfma_f32_16x16x32_bf16 v[148:151], v[68:71], a[56:59], v[148:151]
    v_mfma_f32_16x16x32_bf16 v[148:151], a[0:3], a[56:59], v[148:151]
    v_mfma_f32_16x16x32_bf16 v[148:151], a[24:27], a[32:35], v[148:151]
    v_mfma_f32_16x16x32_bf16 v[148:151], a[64:67], a[120:123], v[148:151]
    v_mfma_f32_16x16x32_bf16 v[148:151], a[88:91], a[96:99], v[148:151]
    v_mfma_f32_16x16x32_bf16 v[148:151], a[128:131], a[184:187], v[148:151]
    v_mfma_f32_16x16x32_bf16 v[148:151], a[152:155], a[160:163], v[148:151]
    v_mfma_f32_16x16x32_bf16 v[148:151], a[192:195], a[248:251], v[148:151]
    v_mfma_f32_16x16x32_bf16 v[148:151], a[216:219], a[224:227], v[148:151]
    s_waitcnt lgkmcnt(0)
    s_nop 6
    v_pk_add_f32 v[148:149], v[148:149], v[92:93]
    v_pk_add_f32 v[150:151], v[150:151], v[94:95]
    v_cvt_pk_bf16_f32 v88, v148, v149
    v_cvt_pk_bf16_f32 v90, v150, v151
    buffer_store_dwordx4 v[88:91], v46, s[20:23], s57 offen sc1
Lh_7:
L_i6362:
    s_cbranch_execz L_backH
    s_mov_b32 s97, 0
    s_waitcnt vmcnt(4)
Lxc_8:
    v_cmp_ne_u32 vcc, s92, v37
    s_cbranch_vccz Lxs_9
    v_xor_b32 v37, s59, v37
    v_and_b32 v37, 0x0fffffff, v37
    v_cmp_ne_u32 vcc, 0, v37
    s_cbranch_vccnz Lxq_10
    s_mov_b32 s97, 1
    buffer_store_dwordx4 v[10:13], v75, s[20:23], s79 offen offset:0 sc1
    buffer_store_dwordx4 v[14:17], v75, s[20:23], s79 offen offset:128 sc1
    buffer_store_dwordx4 v[18:21], v75, s[20:23], s79 offen offset:256 sc1
    buffer_store_dwordx4 v[22:25], v75, s[20:23], s79 offen offset:384 sc1
Lxs_9:
    s_sub_u32 s56, s86, 112
    s_lshl4_add_u32 s56, s3, s56
    s_mul_i32 s56, s56, 4608
    s_add_u32 s88, s56, 8916992
    v_lshrrev_b32 v34, 2, v1
    v_min_u32 v34, 24, v34
Lhw_11:
    s_sub_u32 s58, s58, 1
    s_cbranch_scc1 L_exit
    buffer_load_dword v0, v34, s[20:23], s88 offen sc1
    s_waitcnt vmcnt(0)
    v_cmp_ne_u32 vcc, s59, v0
    s_cbranch_vccnz Lhw_11
    s_sub_u32 s56, s86, 112
    s_lshr_b32 s57, s56, 2
    s_and_b32 s56, s56, 3
    s_lshl3_add_u32 s56, s57, s56
    s_add_u32 s56, s56, 0
    s_mul_i32 s56, s56, 7168
    v_lshlrev_b32 v35, 3, v1
    v_min_u32 v35, 7040, v35
    buffer_load_dword v36, v35, s[32:35], s56 offen
    s_add_u32 s56, s56, 229376
    buffer_load_dword v36, v35, s[32:35], s56 offen
    s_add_u32 s56, s56, 229376
    buffer_load_dword v36, v35, s[32:35], s56 offen
    s_add_u32 s56, s56, 229376
    buffer_load_dword v36, v35, s[32:35], s56 offen
    s_add_u32 s56, s56, 229376
    buffer_load_dword v36, v35, s[32:35], s56 offen
    s_add_u32 s56, s56, 229376
    buffer_load_dword v36, v35, s[32:35], s56 offen
    s_add_u32 s56, s56, 229376
    buffer_load_dword v36, v35, s[32:35], s56 offen
    s_add_u32 s56, s56, 229376
    s_sub_u32 s56, s86, 112
    s_lshr_b32 s57, s56, 2
    s_and_b32 s56, s56, 3
    s_lshl3_add_u32 s56, s57, s56
    s_add_u32 s56, s56, 4
    s_mul_i32 s56, s56, 7168
    v_lshlrev_b32 v35, 3, v1
    v_min_u32 v35, 7040, v35
    buffer_load_dword v36, v35, s[32:35], s56 offen
    s_add_u32 s56, s56, 229376
    buffer_load_dword v36, v35, s[32:35], s56 offen
    s_add_u32 s56, s56, 229376
    buffer_load_dword v36, v35, s[32:35], s56 offen
    s_add_u32 s56, s56, 229376
    buffer_load_dword v36, v35, s[32:35], s56 offen
    s_add_u32 s56, s56, 229376
    buffer_load_dword v36, v35, s[32:35], s56 offen
    s_add_u32 s56, s56, 229376
    buffer_load_dword v36, v35, s[32:35], s56 offen
    s_add_u32 s56, s56, 229376
    buffer_load_dword v36, v35, s[32:35], s56 offen
    s_add_u32 s56, s56, 229376
    s_cmp_lg_u32 s86, 112
    s_cbranch_scc1 L_exit
    s_mul_i32 s88, s3, 73728
    s_add_u32 s88, s88, 8916992
    s_add_u32 s57, s88, 36864
    v_lshrrev_b32 v34, 7, v1
    v_bfe_u32 v35, v1, 4, 3
    v_mul_u32_u24 v34, 4608, v34
    v_min_u32 v35, 6, v35
    v_lshl_add_u32 v34, v35, 2, v34
Lwb_12:
    s_sub_u32 s58, s58, 1
    s_cbranch_scc1 L_exit
    buffer_load_dword v35, v34, s[20:23], s88 offen offset:192 sc1
    buffer_load_dword v36, v34, s[20:23], s57 offen offset:192 sc1
    s_waitcnt vmcnt(0)
    v_bitop3_b32 v35, v35, v36, s59 bitop3:0x7e
    v_cmp_ne_u32 vcc, 0, v35
    s_cbranch_vccnz Lwb_12
    buffer_wbl2 sc1
    s_waitcnt vmcnt(0)
    s_branch L_exit
L_x7:
    s_waitcnt lgkmcnt(0)
    buffer_load_dword v2, off, s[20:23], 0 sc0 sc1
    s_mul_i32 s56, s52, 37
    s_lshr_b32 s56, s56, 8
    s_mul_i32 s57, s56, 7
    s_sub_u32 s54, s52, s57
    s_lshl2_add_u32 s55, s3, s56
    s_lshl2_add_u32 s86, s52, s53
    s_lshl3_add_u32 s96, s52, s53
    s_mov_b32 s60, 0xffff0000
    v_lshrrev_b32 v45, 3, v44
    v_lshrrev_b32 v46, 2, v44
    v_and_b32 v46, 4, v46
    v_and_b32 v47, 7, v44
    v_xor_b32 v46, v46, v47
    v_lshlrev_b32 v46, 4, v46
    v_mul_u32_u24 v47, 896, v45
    v_add_u32 v38, v47, v46
    v_lshl_add_u32 v40, v47, 2, v46
    v_add_u32 v39, 6144, v38
    v_add_u32 v41, 27648, v40
    s_lshl2_add_u32 s56, s54, s53
    s_lshl_b32 s61, s56, 7
    s_mul_i32 s62, s53, 24576
    v_bfe_u32 v45, v44, 2, 2
    v_lshlrev_b32 v45, 7, v45
    v_bfe_u32 v46, v44, 3, 1
    v_lshl_add_u32 v45, v46, 6, v45
    v_add_u32 v45, s62, v45
    v_lshrrev_b32 v46, 5, v44
    v_bfe_u32 v47, v44, 4, 1
    v_lshl_add_u32 v42, v46, 10, v45
    v_lshl_add_u32 v8, v46, 9, v45
    v_lshl_add_u32 v42, v47, 5, v42
    v_lshl_add_u32 v8, v47, 4, v8
    v_bfe_u32 v46, v44, 1, 1
    v_and_b32 v47, 1, v44
    v_lshl_add_u32 v42, v46, 4, v42
    v_lshl_add_u32 v8, v46, 3, v8
    v_lshl_add_u32 v42, v47, 3, v42
    v_lshl_add_u32 v8, v47, 5, v8
    v_xor_b32 v43, 64, v42
    v_xor_b32 v9, 64, v8
    s_and_b32 s56, s55, 3
    s_mul_i32 s56, s56, 6
    s_add_u32 s56, s56, 2
    s_lshr_b32 s56, s56, 2
    s_lshl_b32 s57, s3, 5
    s_add_u32 s57, s57, s52
    s_sub_u32 s57, s57, s54
    s_lshl2_add_u32 s57, s57, s53
    s_lshl_b32 s57, s57, 12
    s_add_u32 s57, s57, 4718592
    s_lshl_b32 s64, s54, 14
    s_add_u32 s65, s57, s64
    s_add_u32 s56, s56, s3
    s_cmp_ge_u32 s56, 6
    s_cselect_b32 s63, 6, 0
    s_sub_u32 s56, s56, s63
    s_cmp_ge_u32 s56, 6
    s_cselect_b32 s63, 6, 0
    s_sub_u32 s56, s56, s63
    s_add_u32 s63, s56, 1
    s_cmp_gt_u32 s63, 6
    s_cselect_b32 s72, 6, 0
    s_sub_u32 s63, s63, s72
    s_add_u32 s63, s63, s54
    s_cmp_gt_u32 s63, 6
    s_cselect_b32 s72, 7, 0
    s_sub_u32 s63, s63, s72
    s_lshl_b32 s63, s63, 14
    s_add_u32 s66, s57, s63
    s_add_u32 s63, s56, 2
    s_cmp_gt_u32 s63, 6
    s_cselect_b32 s72, 6, 0
    s_sub_u32 s63, s63, s72
    s_add_u32 s63, s63, s54
    s_cmp_gt_u32 s63, 6
    s_cselect_b32 s72, 7, 0
    s_sub_u32 s63, s63, s72
    s_lshl_b32 s63, s63, 14
    s_add_u32 s67, s57, s63
    s_add_u32 s63, s56, 3
    s_cmp_gt_u32 s63, 6
    s_cselect_b32 s72, 6, 0
    s_sub_u32 s63, s63, s72
    s_add_u32 s63, s63, s54
    s_cmp_gt_u32 s63, 6
    s_cselect_b32 s72, 7, 0
    s_sub_u32 s63, s63, s72
    s_lshl_b32 s63, s63, 14
    s_add_u32 s68, s57, s63
    s_add_u32 s63, s56, 4
    s_cmp_gt_u32 s63, 6
    s_cselect_b32 s72, 6, 0
    s_sub_u32 s63, s63, s72
    s_add_u32 s63, s63, s54
    s_cmp_gt_u32 s63, 6
    s_cselect_b32 s72, 7, 0
    s_sub_u32 s63, s63, s72
    s_lshl_b32 s63, s63, 14
    s_add_u32 s69, s57, s63
    s_add_u32 s63, s56, 5
    s_cmp_gt_u32 s63, 6
    s_cselect_b32 s72, 6, 0
    s_sub_u32 s63, s63, s72
    s_add_u32 s63, s63, s54
    s_cmp_gt_u32 s63, 6
    s_cselect_b32 s72, 7, 0
    s_sub_u32 s63, s63, s72
    s_lshl_b32 s63, s63, 14
    s_add_u32 s70, s57, s63
    s_add_u32 s63, s56, 6
    s_cmp_gt_u32 s63, 6
    s_cselect_b32 s72, 6, 0
    s_sub_u32 s63, s63, s72
    s_add_u32 s63, s63, s54
    s_cmp_gt_u32 s63, 6
    s_cselect_b32 s72, 7, 0
    s_sub_u32 s63, s63, s72
    s_lshl_b32 s63, s63, 14
    s_add_u32 s71, s57, s63
    s_mul_i32 s57, s57, 14
    s_sub_u32 s57, s61, s57
    s_mul_i32 s72, s65, 14
    s_add_u32 s72, s72, s57
    s_mul_i32 s73, s66, 14
    s_add_u32 s73, s73, s57
    s_mul_i32 s74, s67, 14
    s_add_u32 s74, s74, s57
    s_mul_i32 s75, s68, 14
    s_add_u32 s75, s75, s57
    s_mul_i32 s76, s69, 14
    s_add_u32 s76, s76, s57
    s_mul_i32 s77, s70, 14
    s_add_u32 s77, s77, s57
    s_mul_i32 s78, s71, 14
    s_add_u32 s78, s78, s57
    s_mul_i32 s56, s53, 57344
    s_sub_u32 s61, s56, s61
    s_lshl_b32 s57, s54, 7
    s_add_u32 s61, s61, s57
    s_waitcnt vmcnt(0)
    v_add_u32 v2, 1, v2
    s_nop 0
    v_readfirstlane_b32 s59, v2
    s_barrier
    s_lshl_b32 s90, s3, 7
    s_add_u32 s90, s90, 4096
    s_getreg_b32 s92, hwreg(HW_REG_XCC_ID, 0, 4)
    s_lshl_b32 s92, s92, 28
    s_xor_b32 s92, s92, s59
    s_cmp_lg_u32 s53, 0
    s_cbranch_scc1 Lxp_22
    v_mov_b32 v45, s92
    s_lshl2_add_u32 s57, s52, s90
    buffer_store_dword v45, off, s[20:23], s57 sc1
Lxp_22:
    s_cmp_lt_u32 s52, 28
    s_cbranch_scc1 Lnh_23
    s_mov_b32 s56, 3735552
    s_sub_u32 s57, s86, 112
    s_lshl_b32 s57, s57, 6
    v_add_u32 v45, s57, v44
    v_lshlrev_b32 v46, 7, v45
    v_add_u32 v45, 1024, v45
    buffer_load_dword v36, v46, s[20:23], s56 offen
    v_lshlrev_b32 v46, 7, v45
    v_add_u32 v45, 1024, v45
    buffer_load_dword v36, v46, s[20:23], s56 offen
    v_lshlrev_b32 v46, 7, v45
    v_add_u32 v45, 1024, v45
    buffer_load_dword v36, v46, s[20:23], s56 offen
    v_min_u32 v45, 3583, v45
    v_lshlrev_b32 v46, 7, v45
    v_add_u32 v45, 1024, v45
    buffer_load_dword v36, v46, s[20:23], s56 offen
    s_sub_u32 s56, s86, 112
    s_lshl4_add_u32 s56, s3, s56
    s_mul_i32 s56, s56, 4608
    s_add_u32 s88, s56, 8916992
    v_lshrrev_b32 v34, 2, v1
    v_min_u32 v34, 24, v34
Lhw_24:
    s_sub_u32 s58, s58, 1
    s_cbranch_scc1 L_exit
    buffer_load_dword v0, v34, s[20:23], s88 offen sc1
    s_waitcnt vmcnt(0)
    v_cmp_ne_u32 vcc, s59, v0
    s_cbranch_vccnz Lhw_24
    s_sub_u32 s56, s86, 112
    s_lshr_b32 s57, s56, 2
    s_and_b32 s56, s56, 3
    s_lshl3_add_u32 s56, s57, s56
    s_add_u32 s56, s56, 0
    s_mul_i32 s56, s56, 7168
    v_lshlrev_b32 v35, 3, v1
    v_min_u32 v35, 7040, v35
    buffer_load_dword v36, v35, s[32:35], s56 offen
    s_add_u32 s56, s56, 229376
    buffer_load_dword v36, v35, s[32:35], s56 offen
    s_add_u32 s56, s56, 229376
    buffer_load_dword v36, v35, s[32:35], s56 offen
    s_add_u32 s56, s56, 229376
    buffer_load_dword v36, v35, s[32:35], s56 offen
    s_add_u32 s56, s56, 229376
    buffer_load_dword v36, v35, s[32:35], s56 offen
    s_add_u32 s56, s56, 229376
    buffer_load_dword v36, v35, s[32:35], s56 offen
    s_add_u32 s56, s56, 229376
    buffer_load_dword v36, v35, s[32:35], s56 offen
    s_add_u32 s56, s56, 229376
    s_sub_u32 s56, s86, 112
    s_lshr_b32 s57, s56, 2
    s_and_b32 s56, s56, 3
    s_lshl3_add_u32 s56, s57, s56
    s_add_u32 s56, s56, 4
    s_mul_i32 s56, s56, 7168
    v_lshlrev_b32 v35, 3, v1
    v_min_u32 v35, 7040, v35
    buffer_load_dword v36, v35, s[32:35], s56 offen
    s_add_u32 s56, s56, 229376
    buffer_load_dword v36, v35, s[32:35], s56 offen
    s_add_u32 s56, s56, 229376
    buffer_load_dword v36, v35, s[32:35], s56 offen
    s_add_u32 s56, s56, 229376
    buffer_load_dword v36, v35, s[32:35], s56 offen
    s_add_u32 s56, s56, 229376
    buffer_load_dword v36, v35, s[32:35], s56 offen
    s_add_u32 s56, s56, 229376
    buffer_load_dword v36, v35, s[32:35], s56 offen
    s_add_u32 s56, s56, 229376
    buffer_load_dword v36, v35, s[32:35], s56 offen
    s_add_u32 s56, s56, 229376
    s_cmp_lg_u32 s86, 112
    s_cbranch_scc1 L_exit
    s_mul_i32 s88, s3, 73728
    s_add_u32 s88, s88, 8916992
    s_add_u32 s57, s88, 36864
    v_lshrrev_b32 v34, 7, v1
    v_bfe_u32 v35, v1, 4, 3
    v_mul_u32_u24 v34, 4608, v34
    v_min_u32 v35, 6, v35
    v_lshl_add_u32 v34, v35, 2, v34
Lwb_25:
    s_sub_u32 s58, s58, 1
    s_cbranch_scc1 L_exit
    buffer_load_dword v35, v34, s[20:23], s88 offen offset:192 sc1
    buffer_load_dword v36, v34, s[20:23], s57 offen offset:192 sc1
    s_waitcnt vmcnt(0)
    v_bitop3_b32 v35, v35, v36, s59 bitop3:0x7e
    v_cmp_ne_u32 vcc, 0, v35
    s_cbranch_vccnz Lwb_25
    buffer_wbl2 sc1
    s_waitcnt vmcnt(0)
    s_branch L_exit
Lnh_23:
    s_waitcnt vmcnt(1)
    s_add_u32 s57, s65, 4290316288
    v_mov_b32 v35, -1
    buffer_store_dword v35, v1, s[20:23], s57 offen offset:0
    buffer_store_dword v35, v1, s[20:23], s57 offen offset:1024
    v_bfe_u32 v46, v44, 3, 1
    v_lshrrev_b32 v45, 4, v44
    v_lshl_add_u32 v45, v45, 3, v46
    v_and_b32 v46, 7, v44
    v_mul_u32_u24 v45, 1792, v45
    v_lshl_add_u32 v45, v46, 4, v45
    s_lshl4_add_u32 s56, s55, s53
    s_mul_i32 s94, s56, 3584
    s_lshl_b32 s57, s54, 7
    s_add_u32 s94, s94, s57
    s_lshl2_add_u32 s56, s54, s53
    v_lshlrev_b32 v46, 1, v44
    s_lshl_b32 s56, s56, 7
    buffer_load_dwordx4 v[26:29], v45, s[24:27], s94 offen offset:0
    buffer_load_dwordx4 v[30:33], v45, s[24:27], s94 offen offset:896
    buffer_load_ushort v34, v46, s[36:39], s56 offen
    buffer_load_ushort v35, v46, s[40:43], s57 offen
    s_mul_i32 s57, s54, 5
    s_lshl2_add_u32 s56, s55, s53
    v_min_u32 v45, 4, v44
    s_mul_i32 s56, s56, 4608
    v_add_u32 v45, s57, v45
    s_add_u32 s56, s56, 8912896
    v_min_u32 v45, 35, v45
    v_lshlrev_b32 v45, 7, v45
    buffer_load_dword v36, v45, s[20:23], s56 offen
    s_mul_i32 s87, s53, 15360
    s_add_u32 s87, s87, 98304
    v_bfe_u32 v45, v44, 3, 2
    v_and_b32 v46, 7, v44
    v_lshlrev_b32 v46, 4, v46
    v_mul_u32_u24 v45, 15360, v45
    v_add_u32 v46, v45, v46
    v_lshrrev_b32 v45, 5, v44
    v_lshl_add_u32 v6, v45, 8, v46
    v_bfe_u32 v4, v44, 4, 1
    v_xor_b32 v45, v45, v4
    v_lshl_add_u32 v4, v45, 7, v46
    v_add_u32 v4, 98304, v4
    s_lshl_b32 s56, s53, 10
    s_add_u32 s56, s56, 98304
    v_add_u32 v6, s56, v6
    v_add_u32 v52, s87, v1
    v_min_u32 v45, 6, v44
    v_lshlrev_b32 v3, 2, v45
    v_lshlrev_b32 v46, 2, v44
    v_add_u32 v55, 160768, v46
    v_and_b32 v45, 7, v44
    v_lshrrev_b32 v46, 3, v44
    v_lshlrev_b32 v45, 7, v45
    v_lshl_add_u32 v45, v46, 4, v45
    v_add_u32 v60, s87, v45
    s_lshl2_add_u32 s56, s55, s53
    s_mul_i32 s57, s56, 4608
    s_add_u32 s98, s57, 8912896
    s_lshr_b32 s56, s54, 2
    s_lshl_b32 s56, s56, 9
    s_lshl_b32 s99, s54, 7
    s_add_u32 s56, s56, s98
    s_add_u32 s99, s99, s56
    s_cmp_eq_u32 s54, 6
    s_cselect_b32 s86, 0x80, 0
    s_add_u32 s86, s86, 0x270
    s_add_u32 s88, s57, 8916992
    s_lshl2_add_u32 s89, s54, s88
    s_xor_b32 s83, s59, 2147483648
    s_mov_b32 s91, 0x409d30fc
    s_mov_b32 s80, 0xc0088e99
    s_mov_b32 s93, 160768
    s_lshl_b32 s56, s53, 7
    s_add_u32 s95, s56, 161792
    v_lshrrev_b32 v45, 2, v44
    v_lshrrev_b32 v46, 4, v44
    v_xor_b32 v45, v45, v46
    v_and_b32 v45, 1, v45
    v_and_or_b32 v45, v44, 3, v45
    v_cmp_eq_u32 vcc, 0, v45
    v_mov_b32 v46, 0x3f803f80
    s_nop 0
    v_cndmask_b32 v120, 0, v46, vcc
    v_mov_b32 v62, 0
    v_mov_b32 v63, 0
    v_mov_b32 v121, v120
    v_mov_b32 v122, v120
    v_mov_b32 v123, v120
    s_add_u32 m0, s62, 0
    s_add_u32 s63, s73, 0
    buffer_load_dwordx4 v40, s[28:31], s63 offen offset:0 lds
    buffer_load_dwordx4 v41, s[28:31], s63 offen offset:1024 lds
    s_add_u32 m0, s62, 2048
    s_add_u32 s63, s73, 57344
    buffer_load_dwordx4 v40, s[28:31], s63 offen offset:0 lds
    buffer_load_dwordx4 v41, s[28:31], s63 offen offset:1024 lds
    s_add_u32 m0, s62, 4096
    s_add_u32 s63, s73, 114688
    buffer_load_dwordx4 v40, s[28:31], s63 offen offset:0 lds
    buffer_load_dwordx4 v41, s[28:31], s63 offen offset:1024 lds
    s_add_u32 m0, s62, 6144
    s_add_u32 s63, s73, 172032
    buffer_load_dwordx4 v40, s[28:31], s63 offen offset:0 lds
    buffer_load_dwordx4 v41, s[28:31], s63 offen offset:1024 lds
    s_add_u32 m0, s62, 8192
    s_add_u32 s63, s74, 0
    buffer_load_dwordx4 v40, s[28:31], s63 offen offset:0 lds
    buffer_load_dwordx4 v41, s[28:31], s63 offen offset:1024 lds
    s_add_u32 m0, s62, 10240
    s_add_u32 s63, s74, 57344
    buffer_load_dwordx4 v40, s[28:31], s63 offen offset:0 lds
    buffer_load_dwordx4 v41, s[28:31], s63 offen offset:1024 lds
    s_add_u32 m0, s62, 12288
    s_add_u32 s63, s74, 114688
    buffer_load_dwordx4 v40, s[28:31], s63 offen offset:0 lds
    buffer_load_dwordx4 v41, s[28:31], s63 offen offset:1024 lds
    s_add_u32 m0, s62, 14336
    s_add_u32 s63, s74, 172032
    buffer_load_dwordx4 v40, s[28:31], s63 offen offset:0 lds
    buffer_load_dwordx4 v41, s[28:31], s63 offen offset:1024 lds
    v_mov_b32 v224, 0
    v_mov_b32 v225, 0
    v_mov_b32 v226, 0
    v_mov_b32 v227, 0
    v_mov_b32 v228, 0
    v_mov_b32 v229, 0
    v_mov_b32 v235, 0
    v_mov_b32 v75, 0
    s_mov_b64 exec, 0
    s_cmp_eq_u32 s53, 1
    s_cbranch_scc1 L_i1007
    s_cmp_eq_u32 s53, 2
    s_cbranch_scc1 L_i1165
    s_cmp_eq_u32 s53, 3
    s_cbranch_scc1 L_i1505
    s_branch L_i556
L_backX:
    s_mov_b64 exec, -1
    v_lshrrev_b32 v37, 2, v1
    v_and_b32 v37, 124, v37
    buffer_load_dword v37, v37, s[20:23], s90 offen sc1
    s_mov_b32 s97, 0
    s_waitcnt vmcnt(0)
Lxc_26:
    v_cmp_ne_u32 vcc, s92, v37
    s_cbranch_vccz Lxs_27
    v_xor_b32 v37, s59, v37
    v_and_b32 v37, 0x0fffffff, v37
    v_cmp_ne_u32 vcc, 0, v37
    s_cbranch_vccnz Lxq_28
    s_mov_b32 s97, 1
Lxs_27:
    s_branch L_join
L_pf_end:
L_mlpS:
    s_add_u32 s56, s65, 5769216
    v_mov_b32 v129, -1
    buffer_store_dword v129, v1, s[20:23], s56 offen offset:0 sc1
    buffer_store_dword v129, v1, s[20:23], s56 offen offset:1024 sc1
    s_add_u32 m0, s62, 16384
    s_add_u32 s63, s72, 0
    buffer_load_dwordx4 v40, s[28:31], s63 offen offset:0 lds
    ds_write_b128 v52, v[26:29] offset:0
    ds_write_b128 v52, v[30:33] offset:1024
    ds_read_b128 v[80:83], v60 offset:0
    ds_read_b128 v[84:87], v60 offset:1024
    s_waitcnt vmcnt(22)
    ds_read_b64_tr_b16 a[32:33], v42 offset:0
    ds_read_b64_tr_b16 a[34:35], v42 offset:512
    ds_read_b64_tr_b16 a[36:37], v43 offset:0
    ds_read_b64_tr_b16 a[38:39], v43 offset:512
    s_waitcnt vmcnt(20)
    ds_read_b64_tr_b16 a[40:41], v42 offset:2048
    ds_read_b64_tr_b16 a[42:43], v42 offset:2560
    s_waitcnt lgkmcnt(4)
    v_mfma_f32_16x16x32_bf16 v[112:115], v[120:123], a[32:35], 0
    buffer_load_dwordx4 v41, s[28:31], s63 offen offset:1024 lds
    ds_read_b64_tr_b16 a[44:45], v43 offset:2048
    ds_read_b64_tr_b16 a[46:47], v43 offset:2560
    s_waitcnt lgkmcnt(4)
    v_mfma_f32_16x16x32_bf16 v[116:119], v[120:123], a[36:39], 0
    v_lshlrev_b32 v34, 16, v34
    v_lshlrev_b32 v35, 16, v35
    v_mul_f32 v34, 0x3f80002a, v34
    s_lshr_b32 s56, s53, 1
    s_lshl_b32 s90, s56, 7
    ds_write_b32 v55, v35
    v_lshlrev_b32 v10, 16, v80
    v_and_b32 v11, s60, v80
    v_lshlrev_b32 v12, 16, v81
    v_and_b32 v13, s60, v81
    v_lshlrev_b32 v14, 16, v82
    v_and_b32 v15, s60, v82
    v_lshlrev_b32 v16, 16, v83
    v_and_b32 v17, s60, v83
    v_lshlrev_b32 v18, 16, v84
    v_and_b32 v19, s60, v84
    v_lshlrev_b32 v20, 16, v85
    v_and_b32 v21, s60, v85
    v_lshlrev_b32 v22, 16, v86
    v_and_b32 v23, s60, v86
    v_lshlrev_b32 v24, 16, v87
    v_and_b32 v25, s60, v87
    v_pk_add_f32 v[64:65], v[10:11], v[12:13]
    v_pk_mul_f32 v[68:69], v[10:11], v[10:11]
    v_pk_add_f32 v[66:67], v[18:19], v[20:21]
    v_pk_mul_f32 v[70:71], v[18:19], v[18:19]
    v_pk_fma_f32 v[68:69], v[12:13], v[12:13], v[68:69]
    v_pk_fma_f32 v[70:71], v[20:21], v[20:21], v[70:71]
    v_pk_add_f32 v[64:65], v[64:65], v[14:15]
    v_pk_fma_f32 v[68:69], v[14:15], v[14:15], v[68:69]
    v_pk_add_f32 v[66:67], v[66:67], v[22:23]
    v_pk_fma_f32 v[70:71], v[22:23], v[22:23], v[70:71]
    v_pk_add_f32 v[64:65], v[64:65], v[16:17]
    v_pk_fma_f32 v[68:69], v[16:17], v[16:17], v[68:69]
    v_pk_add_f32 v[66:67], v[66:67], v[24:25]
    v_pk_fma_f32 v[70:71], v[24:25], v[24:25], v[70:71]
    v_add_f32 v72, v64, v65
    v_add_f32 v73, v66, v67
    v_add_f32 v76, v68, v69
    v_add_f32 v77, v70, v71
    v_and_b32 v78, s86, v1
    v_mov_b32 v74, v2
    v_mov_b32 v75, v2
    v_permlane32_swap_b32 v72, v76
    v_permlane32_swap_b32 v73, v77
    v_pk_add_f32 v[72:73], v[72:73], v[76:77]
    v_mov_b32 v76, v72
    v_mov_b32 v77, v73
    s_nop 0
    v_permlane16_swap_b32 v72, v76
    v_permlane16_swap_b32 v73, v77
    v_pk_add_f32 v[72:73], v[72:73], v[76:77]
    s_nop 1
    v_add_f32_dpp v72, v72, v72 row_ror:8 row_mask:0xf bank_mask:0xf
    v_add_f32_dpp v73, v73, v73 row_ror:8 row_mask:0xf bank_mask:0xf
    s_waitcnt vmcnt(2)
    buffer_store_dwordx4 v[72:75], v78, s[20:23], s99 offen offset:0 sc1
    ds_read_b64_tr_b16 a[48:49], v42 offset:4096
    ds_read_b64_tr_b16 a[50:51], v42 offset:4608
    s_waitcnt lgkmcnt(5)
    v_mfma_f32_16x16x32_bf16 v[112:115], v[120:123], a[40:43], v[112:115]
    s_add_u32 m0, s62, 18432
    s_add_u32 s63, s72, 57344
    buffer_load_dwordx4 v40, s[28:31], s63 offen offset:0 lds
    ds_read_b64_tr_b16 a[52:53], v43 offset:4096
    ds_read_b64_tr_b16 a[54:55], v43 offset:4608
    s_waitcnt lgkmcnt(5)
    v_mfma_f32_16x16x32_bf16 v[116:119], v[120:123], a[44:47], v[116:119]
    ds_read_b64_tr_b16 a[56:57], v42 offset:6144
    ds_read_b64_tr_b16 a[58:59], v42 offset:6656
    s_waitcnt lgkmcnt(4)
    v_mfma_f32_16x16x32_bf16 v[112:115], v[120:123], a[48:51], v[112:115]
    ds_read_b64_tr_b16 a[60:61], v43 offset:6144
    ds_read_b64_tr_b16 a[62:63], v43 offset:6656
    s_waitcnt lgkmcnt(4)
    v_mfma_f32_16x16x32_bf16 v[116:119], v[120:123], a[52:55], v[116:119]
    ds_read_b64_tr_b16 a[64:65], v42 offset:8192
    ds_read_b64_tr_b16 a[66:67], v42 offset:8704
    buffer_load_dwordx4 v41, s[28:31], s63 offen offset:1024 lds
    s_waitcnt lgkmcnt(4)
    v_mfma_f32_16x16x32_bf16 v[112:115], v[120:123], a[56:59], v[112:115]
    ds_read_b64_tr_b16 a[68:69], v43 offset:8192
    ds_read_b64_tr_b16 a[70:71], v43 offset:8704
    s_waitcnt lgkmcnt(4)
    v_mfma_f32_16x16x32_bf16 v[116:119], v[120:123], a[60:63], v[116:119]
    ds_read_b64_tr_b16 a[72:73], v42 offset:10240
    ds_read_b64_tr_b16 a[74:75], v42 offset:10752
    s_waitcnt lgkmcnt(4)
    v_mfma_f32_16x16x32_bf16 v[112:115], v[120:123], a[64:67], v[112:115]
    ds_read_b64_tr_b16 a[76:77], v43 offset:10240
    ds_read_b64_tr_b16 a[78:79], v43 offset:10752
    s_waitcnt lgkmcnt(4)
    v_mfma_f32_16x16x32_bf16 v[116:119], v[120:123], a[68:71], v[116:119]
    ds_read_b64_tr_b16 a[80:81], v42 offset:12288
    s_add_u32 m0, s62, 20480
    s_add_u32 s63, s72, 114688
    buffer_load_dwordx4 v40, s[28:31], s63 offen offset:0 lds
    ds_read_b64_tr_b16 a[82:83], v42 offset:12800
    s_waitcnt lgkmcnt(4)
    v_mfma_f32_16x16x32_bf16 v[112:115], v[120:123], a[72:75], v[112:115]
    ds_read_b64_tr_b16 a[84:85], v43 offset:12288
    ds_read_b64_tr_b16 a[86:87], v43 offset:12800
    s_waitcnt lgkmcnt(4)
    v_mfma_f32_16x16x32_bf16 v[116:119], v[120:123], a[76:79], v[116:119]
    ds_read_b64_tr_b16 a[88:89], v42 offset:14336
    ds_read_b64_tr_b16 a[90:91], v42 offset:14848
    s_waitcnt lgkmcnt(4)
    v_mfma_f32_16x16x32_bf16 v[112:115], v[120:123], a[80:83], v[112:115]
    ds_read_b64_tr_b16 a[92:93], v43 offset:14336
    ds_read_b64_tr_b16 a[94:95], v43 offset:14848
    s_waitcnt lgkmcnt(4)
    v_mfma_f32_16x16x32_bf16 v[116:119], v[120:123], a[84:87], v[116:119]
    buffer_load_dwordx4 v41, s[28:31], s63 offen offset:1024 lds
    v_lshrrev_b32 v128, 1, v1
    v_bfe_u32 v129, v1, 4, 1
    v_and_b32 v128, 0x1f0, v128
    v_lshl_add_u32 v128, v129, 9, v128
    s_add_u32 m0, s62, 22528
    s_add_u32 s63, s72, 172032
    buffer_load_dwordx4 v40, s[28:31], s63 offen offset:0 lds
    buffer_load_dwordx4 v41, s[28:31], s63 offen offset:1024 lds
    s_add_u32 m0, s62, 0
    s_add_u32 s63, s75, 0
    buffer_load_dwordx4 v40, s[28:31], s63 offen offset:0 lds
    buffer_load_dwordx4 v41, s[28:31], s63 offen offset:1024 lds
    s_add_u32 m0, s62, 2048
    s_add_u32 s63, s75, 57344
    buffer_load_dwordx4 v40, s[28:31], s63 offen offset:0 lds
    buffer_load_dwordx4 v41, s[28:31], s63 offen offset:1024 lds
    s_add_u32 m0, s62, 4096
    s_add_u32 s63, s75, 114688
    buffer_load_dwordx4 v40, s[28:31], s63 offen offset:0 lds
    buffer_load_dwordx4 v41, s[28:31], s63 offen offset:1024 lds
    s_add_u32 m0, s62, 6144
    s_add_u32 s63, s75, 172032
    buffer_load_dwordx4 v40, s[28:31], s63 offen offset:0 lds
    buffer_load_dwordx4 v41, s[28:31], s63 offen offset:1024 lds
    buffer_load_dwordx4 v[144:147], v1, s[20:23], s98 offen offset:0 sc1
    buffer_load_dwordx4 v[148:151], v1, s[20:23], s98 offen offset:1024 sc1
    buffer_load_dwordx4 v[80:83], v128, s[20:23], s65 offen offset:0 sc1
    buffer_load_dwordx4 v[84:87], v128, s[20:23], s65 offen offset:1024 sc1
    buffer_load_dwordx4 v[88:91], v128, s[20:23], s65 offen offset:2048 sc1
    buffer_load_dwordx4 v[92:95], v128, s[20:23], s65 offen offset:3072 sc1
    buffer_store_dword v2, off, s[20:23], s89 offset:0 sc1
    s_barrier
    s_add_u32 m0, s62, 8192
    s_add_u32 s63, s76, 0
    buffer_load_dwordx4 v40, s[28:31], s63 offen offset:0 lds
    v_xor_b32 v131, s90, v1
    v_xor_b32 v133, s90, v52
    buffer_load_dwordx4 v41, s[28:31], s63 offen offset:1024 lds
    v_mov_b32 v50, v52
    v_lshrrev_b32 v132, 7, v1
    s_add_u32 m0, s62, 10240
    s_add_u32 s63, s76, 57344
    buffer_load_dwordx4 v40, s[28:31], s63 offen offset:0 lds
    v_lshl_add_u32 v132, v132, 5, s93
    buffer_load_dwordx4 v41, s[28:31], s63 offen offset:1024 lds
    ds_read_b128 v[136:139], v132 offset:0
    ds_read_b128 v[140:143], v132 offset:16
    s_waitcnt vmcnt(9)
    v_bitop3_b32 v152, v146, v150, s59 bitop3:0x7e
    v_bitop3_b32 v152, v147, v152, s59 bitop3:0xde
    v_bitop3_b32 v152, v151, v152, s59 bitop3:0xde
    v_cmp_ne_u32 vcc, 0, v152
    s_cbranch_vccnz Lrt_176
Lck_175:
    v_add_f32_dpp v144, v148, v144 quad_perm:[0,1,2,3] row_mask:0xf bank_mask:0x3
    v_add_f32_dpp v145, v149, v145 quad_perm:[0,1,2,3] row_mask:0xf bank_mask:0x3
    s_nop 0
    v_add_f32_dpp v144, v148, v144 quad_perm:[0,1,2,3] row_mask:0x5 bank_mask:0xc
    v_add_f32_dpp v145, v149, v145 quad_perm:[0,1,2,3] row_mask:0x5 bank_mask:0xc
    s_nop 0
    v_add_f32_dpp v144, v144, v144 row_ror:8 row_mask:0xf bank_mask:0xf
    v_add_f32_dpp v145, v145, v145 row_ror:8 row_mask:0xf bank_mask:0xf
    v_mov_b32 v146, v144
    v_mov_b32 v147, v145
    s_nop 0
    v_permlane16_swap_b32 v144, v146
    v_permlane16_swap_b32 v145, v147
    v_add_f32 v144, v144, v146
    v_add_f32 v145, v145, v147
    v_mov_b32 v146, v144
    v_mov_b32 v147, v145
    s_nop 0
    v_permlane32_swap_b32 v144, v146
    v_permlane32_swap_b32 v145, v147
    v_mul_f32 v152, 0xbb124925, v144
    v_mul_f32 v156, 0xbb124925, v145
    v_fmaak_f32 v153, v152, v152, 0xb727c5ac
    v_fmaak_f32 v157, v156, v156, 0xb727c5ac
    v_fmac_f32 v153, 0xbb124925, v146
    v_fmac_f32 v157, 0xbb124925, v147
    v_rsq_f32_e64 v153, |v153|
    v_rsq_f32_e64 v157, |v157|
    v_mul_f32 v152, v152, v153
    v_mul_f32 v156, v156, v157
    v_pk_fma_f32 v[96:97], v[10:11], v[152:153], v[152:153] op_sel:[0,1,0] op_sel_hi:[1,1,0]
    v_pk_fma_f32 v[98:99], v[12:13], v[152:153], v[152:153] op_sel:[0,1,0] op_sel_hi:[1,1,0]
    v_pk_fma_f32 v[100:101], v[14:15], v[152:153], v[152:153] op_sel:[0,1,0] op_sel_hi:[1,1,0]
    v_pk_fma_f32 v[102:103], v[16:17], v[152:153], v[152:153] op_sel:[0,1,0] op_sel_hi:[1,1,0]
    v_pk_fma_f32 v[104:105], v[18:19], v[156:157], v[156:157] op_sel:[0,1,0] op_sel_hi:[1,1,0]
    v_pk_fma_f32 v[106:107], v[20:21], v[156:157], v[156:157] op_sel:[0,1,0] op_sel_hi:[1,1,0]
    v_pk_fma_f32 v[108:109], v[22:23], v[156:157], v[156:157] op_sel:[0,1,0] op_sel_hi:[1,1,0]
    v_pk_fma_f32 v[110:111], v[24:25], v[156:157], v[156:157] op_sel:[0,1,0] op_sel_hi:[1,1,0]
    s_add_u32 s56, s65, 5769216
    s_waitcnt vmcnt(5)
    v_bitop3_b32 v129, v81, v83, s59 bitop3:0x7e
    v_bitop3_b32 v130, v85, v87, s59 bitop3:0x7e
    v_bitop3_b32 v129, v89, v129, s59 bitop3:0xde
    v_bitop3_b32 v130, v91, v130, s59 bitop3:0xde
    v_bitop3_b32 v129, v93, v129, s59 bitop3:0xde
    v_bitop3_b32 v130, v95, v130, s59 bitop3:0xde
    v_or_b32 v129, v129, v130
    v_cmp_ne_u32 vcc, 0, v129
    s_cbranch_vccnz Lrt_178
Lck_177:
    s_mov_b32 vcc_lo, 0x55555555
    s_mov_b32 vcc_hi, 0x55555555
    v_cndmask_b32_dpp v26, v82, v80, vcc quad_perm:[1,0,3,2] row_mask:0xf bank_mask:0xf
    v_cndmask_b32_dpp v28, v86, v84, vcc quad_perm:[1,0,3,2] row_mask:0xf bank_mask:0xf
    v_cndmask_b32_dpp v30, v90, v88, vcc quad_perm:[1,0,3,2] row_mask:0xf bank_mask:0xf
    v_cndmask_b32_dpp v32, v94, v92, vcc quad_perm:[1,0,3,2] row_mask:0xf bank_mask:0xf
    s_not_b64 vcc, vcc
    v_cndmask_b32_dpp v27, v80, v82, vcc quad_perm:[1,0,3,2] row_mask:0xf bank_mask:0xf
    v_cndmask_b32_dpp v29, v84, v86, vcc quad_perm:[1,0,3,2] row_mask:0xf bank_mask:0xf
    v_cndmask_b32_dpp v31, v88, v90, vcc quad_perm:[1,0,3,2] row_mask:0xf bank_mask:0xf
    v_cndmask_b32_dpp v33, v92, v94, vcc quad_perm:[1,0,3,2] row_mask:0xf bank_mask:0xf
    v_lshlrev_b32 v64, 16, v26
    v_lshlrev_b32 v65, 16, v27
    v_lshlrev_b32 v66, 16, v28
    v_lshlrev_b32 v67, 16, v29
    v_lshlrev_b32 v68, 16, v30
    v_lshlrev_b32 v69, 16, v31
    v_lshlrev_b32 v70, 16, v32
    v_lshlrev_b32 v71, 16, v33
    v_pk_fma_f32 v[10:11], v[96:97], v[64:65], v[10:11]
    v_pk_fma_f32 v[12:13], v[98:99], v[66:67], v[12:13]
    v_pk_fma_f32 v[14:15], v[100:101], v[68:69], v[14:15]
    v_pk_fma_f32 v[16:17], v[102:103], v[70:71], v[16:17]
    v_cvt_pk_bf16_f32 v144, v10, v11
    v_cvt_pk_bf16_f32 v145, v12, v13
    v_cvt_pk_bf16_f32 v146, v14, v15
    v_cvt_pk_bf16_f32 v147, v16, v17
    buffer_store_dwordx4 v[144:147], v131, s[20:23], s56 offen offset:0 sc1
    ds_write_b128 v133, v[144:147] offset:0
    v_and_b32 v72, s60, v26
    v_and_b32 v73, s60, v27
    v_and_b32 v74, s60, v28
    v_and_b32 v75, s60, v29
    v_and_b32 v76, s60, v30
    v_and_b32 v77, s60, v31
    v_and_b32 v78, s60, v32
    v_and_b32 v79, s60, v33
    v_pk_fma_f32 v[18:19], v[104:105], v[72:73], v[18:19]
    v_pk_fma_f32 v[20:21], v[106:107], v[74:75], v[20:21]
    v_pk_fma_f32 v[22:23], v[108:109], v[76:77], v[22:23]
    v_pk_fma_f32 v[24:25], v[110:111], v[78:79], v[24:25]
    v_cvt_pk_bf16_f32 v148, v18, v19
    v_cvt_pk_bf16_f32 v149, v20, v21
    v_cvt_pk_bf16_f32 v150, v22, v23
    v_cvt_pk_bf16_f32 v151, v24, v25
    buffer_store_dwordx4 v[148:151], v131, s[20:23], s56 offen offset:1024 sc1
    ds_write_b128 v133, v[148:151] offset:8192
    v_pk_add_f32 v[64:65], v[10:11], v[12:13]
    v_pk_mul_f32 v[68:69], v[10:11], v[10:11]
    v_pk_add_f32 v[66:67], v[18:19], v[20:21]
    v_pk_mul_f32 v[70:71], v[18:19], v[18:19]
    v_pk_fma_f32 v[68:69], v[12:13], v[12:13], v[68:69]
    v_pk_fma_f32 v[70:71], v[20:21], v[20:21], v[70:71]
    v_pk_add_f32 v[64:65], v[64:65], v[14:15]
    v_pk_fma_f32 v[68:69], v[14:15], v[14:15], v[68:69]
    v_pk_add_f32 v[66:67], v[66:67], v[22:23]
    v_pk_fma_f32 v[70:71], v[22:23], v[22:23], v[70:71]
    v_pk_add_f32 v[64:65], v[64:65], v[16:17]
    v_pk_fma_f32 v[68:69], v[16:17], v[16:17], v[68:69]
    v_pk_add_f32 v[66:67], v[66:67], v[24:25]
    v_pk_fma_f32 v[70:71], v[24:25], v[24:25], v[70:71]
    v_add_f32 v72, v64, v65
    v_add_f32 v73, v66, v67
    v_add_f32 v76, v68, v69
    v_add_f32 v77, v70, v71
    v_and_b32 v78, s86, v1
    v_mov_b32 v74, v2
    v_mov_b32 v75, v2
    v_permlane32_swap_b32 v72, v76
    v_permlane32_swap_b32 v73, v77
    v_pk_add_f32 v[72:73], v[72:73], v[76:77]
    v_mov_b32 v76, v72
    v_mov_b32 v77, v73
    s_nop 0
    v_permlane16_swap_b32 v72, v76
    v_permlane16_swap_b32 v73, v77
    v_pk_add_f32 v[72:73], v[72:73], v[76:77]
    s_nop 1
    v_add_f32_dpp v72, v72, v72 row_ror:8 row_mask:0xf bank_mask:0xf
    v_add_f32_dpp v73, v73, v73 row_ror:8 row_mask:0xf bank_mask:0xf
    buffer_store_dwordx4 v[72:75], v78, s[20:23], s99 offen offset:2048 sc1
    buffer_load_dwordx4 v[96:99], v1, s[20:23], s98 offen offset:2048 sc1
    buffer_load_dwordx4 v[100:103], v1, s[20:23], s98 offen offset:3072 sc1
    s_waitcnt lgkmcnt(3)
    v_pk_add_f32 v[10:11], v[10:11], v[136:137]
    v_pk_add_f32 v[12:13], v[12:13], v[138:139]
    s_waitcnt lgkmcnt(2)
    v_pk_add_f32 v[14:15], v[14:15], v[140:141]
    v_pk_add_f32 v[16:17], v[16:17], v[142:143]
    v_pk_add_f32 v[18:19], v[18:19], v[136:137]
    v_pk_add_f32 v[20:21], v[20:21], v[138:139]
    v_pk_add_f32 v[22:23], v[22:23], v[140:141]
    v_pk_add_f32 v[24:25], v[24:25], v[142:143]
    ds_read_b64_tr_b16 a[0:1], v42 offset:16384
    ds_read_b64_tr_b16 a[2:3], v42 offset:16896
    v_mfma_f32_16x16x32_bf16 v[112:115], v[120:123], a[88:91], v[112:115]
    ds_read_b64_tr_b16 a[4:5], v43 offset:16384
    ds_read_b64_tr_b16 a[6:7], v43 offset:16896
    v_mfma_f32_16x16x32_bf16 v[116:119], v[120:123], a[92:95], v[116:119]
    ds_read_b64_tr_b16 a[8:9], v42 offset:18432
    ds_read_b64_tr_b16 a[10:11], v42 offset:18944
    s_add_u32 m0, s62, 12288
    s_add_u32 s63, s76, 114688
    buffer_load_dwordx4 v40, s[28:31], s63 offen offset:0 lds
    s_waitcnt lgkmcnt(4)
    v_mfma_f32_16x16x32_bf16 v[112:115], v[120:123], a[0:3], v[112:115]
    ds_read_b64_tr_b16 a[12:13], v43 offset:18432
    ds_read_b64_tr_b16 a[14:15], v43 offset:18944
    s_waitcnt lgkmcnt(4)
    v_mfma_f32_16x16x32_bf16 v[116:119], v[120:123], a[4:7], v[116:119]
    ds_read_b64_tr_b16 a[16:17], v42 offset:20480
    ds_read_b64_tr_b16 a[18:19], v42 offset:20992
    s_waitcnt lgkmcnt(4)
    v_mfma_f32_16x16x32_bf16 v[112:115], v[120:123], a[8:11], v[112:115]
    ds_read_b64_tr_b16 a[20:21], v43 offset:20480
    buffer_load_dwordx4 v41, s[28:31], s63 offen offset:1024 lds
    ds_read_b64_tr_b16 a[22:23], v43 offset:20992
    s_waitcnt lgkmcnt(4)
    v_mfma_f32_16x16x32_bf16 v[116:119], v[120:123], a[12:15], v[116:119]
    ds_read_b64_tr_b16 a[24:25], v42 offset:22528
    ds_read_b64_tr_b16 a[26:27], v42 offset:23040
    s_waitcnt lgkmcnt(4)
    v_mfma_f32_16x16x32_bf16 v[112:115], v[120:123], a[16:19], v[112:115]
    ds_read_b64_tr_b16 a[28:29], v43 offset:22528
    ds_read_b64_tr_b16 a[30:31], v43 offset:23040
    s_waitcnt lgkmcnt(4)
    v_mfma_f32_16x16x32_bf16 v[116:119], v[120:123], a[20:23], v[116:119]
    s_add_u32 m0, s62, 14336
    s_add_u32 s63, s76, 172032
    buffer_load_dwordx4 v40, s[28:31], s63 offen offset:0 lds
    ds_read_b64_tr_b16 a[96:97], v42 offset:0
    ds_read_b64_tr_b16 a[98:99], v42 offset:512
    s_waitcnt lgkmcnt(4)
    v_mfma_f32_16x16x32_bf16 v[112:115], v[120:123], a[24:27], v[112:115]
    ds_read_b64_tr_b16 a[100:101], v43 offset:0
    ds_read_b64_tr_b16 a[102:103], v43 offset:512
    s_waitcnt lgkmcnt(4)
    v_mfma_f32_16x16x32_bf16 v[116:119], v[120:123], a[28:31], v[116:119]
    ds_read_b64_tr_b16 a[104:105], v42 offset:2048
    ds_read_b64_tr_b16 a[106:107], v42 offset:2560
    buffer_load_dwordx4 v41, s[28:31], s63 offen offset:1024 lds
    s_waitcnt lgkmcnt(4)
    v_mfma_f32_16x16x32_bf16 v[112:115], v[120:123], a[96:99], v[112:115]
    ds_read_b64_tr_b16 a[108:109], v43 offset:2048
    ds_read_b64_tr_b16 a[110:111], v43 offset:2560
    s_waitcnt lgkmcnt(4)
    v_mfma_f32_16x16x32_bf16 v[116:119], v[120:123], a[100:103], v[116:119]
    ds_read_b64_tr_b16 a[112:113], v42 offset:4096
    ds_read_b64_tr_b16 a[114:115], v42 offset:4608
    s_waitcnt lgkmcnt(4)
    v_mfma_f32_16x16x32_bf16 v[112:115], v[120:123], a[104:107], v[112:115]
    ds_read_b64_tr_b16 a[116:117], v43 offset:4096
    s_add_u32 m0, s62, 16384
    s_add_u32 s63, s77, 0
    buffer_load_dwordx4 v40, s[28:31], s63 offen offset:0 lds
    ds_read_b64_tr_b16 a[118:119], v43 offset:4608
    s_waitcnt lgkmcnt(4)
    v_mfma_f32_16x16x32_bf16 v[116:119], v[120:123], a[108:111], v[116:119]
    ds_read_b64_tr_b16 a[120:121], v42 offset:6144
    ds_read_b64_tr_b16 a[122:123], v42 offset:6656
    s_waitcnt lgkmcnt(4)
    v_mfma_f32_16x16x32_bf16 v[112:115], v[120:123], a[112:115], v[112:115]
    ds_read_b64_tr_b16 a[124:125], v43 offset:6144
    ds_read_b64_tr_b16 a[126:127], v43 offset:6656
    s_waitcnt lgkmcnt(4)
    v_mfma_f32_16x16x32_bf16 v[116:119], v[120:123], a[116:119], v[116:119]
    buffer_load_dwordx4 v41, s[28:31], s63 offen offset:1024 lds
    s_add_u32 m0, s62, 18432
    s_add_u32 s63, s77, 57344
    buffer_load_dwordx4 v40, s[28:31], s63 offen offset:0 lds
    buffer_load_dwordx4 v41, s[28:31], s63 offen offset:1024 lds
    s_waitcnt vmcnt(8)
    v_bitop3_b32 v104, v98, v102, s59 bitop3:0x7e
    v_bitop3_b32 v104, v99, v104, s59 bitop3:0xde
    v_bitop3_b32 v104, v103, v104, s59 bitop3:0xde
    v_cmp_ne_u32 vcc, 0, v104
    s_cbranch_vccnz Lrt_180
Lck_179:
    s_add_u32 m0, s87, 1024
    s_add_u32 s57, s66, 5769216
    buffer_load_dwordx4 v1, s[20:23], s57 offen sc1 lds
    ds_read_b64_tr_b16 a[128:129], v42 offset:8192
    ds_read_b64_tr_b16 a[130:131], v42 offset:8704
    s_waitcnt lgkmcnt(4)
    v_mfma_f32_16x16x32_bf16 v[112:115], v[120:123], a[120:123], v[112:115]
    s_add_u32 m0, s87, 2048
    s_add_u32 s57, s67, 5769216
    buffer_load_dwordx4 v1, s[20:23], s57 offen sc1 lds
    ds_read_b64_tr_b16 a[132:133], v43 offset:8192
    ds_read_b64_tr_b16 a[134:135], v43 offset:8704
    s_waitcnt lgkmcnt(4)
    v_mfma_f32_16x16x32_bf16 v[116:119], v[120:123], a[124:127], v[116:119]
    s_add_u32 m0, s87, 3072
    s_add_u32 s57, s68, 5769216
    buffer_load_dwordx4 v1, s[20:23], s57 offen sc1 lds
    ds_read_b64_tr_b16 a[136:137], v42 offset:10240
    ds_read_b64_tr_b16 a[138:139], v42 offset:10752
    s_waitcnt lgkmcnt(4)
    v_mfma_f32_16x16x32_bf16 v[112:115], v[120:123], a[128:131], v[112:115]
    s_add_u32 m0, s87, 4096
    s_add_u32 s57, s69, 5769216
    buffer_load_dwordx4 v1, s[20:23], s57 offen sc1 lds
    ds_read_b64_tr_b16 a[140:141], v43 offset:10240
    ds_read_b64_tr_b16 a[142:143], v43 offset:10752
    s_waitcnt lgkmcnt(4)
    v_mfma_f32_16x16x32_bf16 v[116:119], v[120:123], a[132:135], v[116:119]
    s_add_u32 m0, s87, 5120
    s_add_u32 s57, s70, 5769216
    buffer_load_dwordx4 v1, s[20:23], s57 offen sc1 lds
    s_add_u32 m0, s87, 6144
    s_add_u32 s57, s71, 5769216
    buffer_load_dwordx4 v1, s[20:23], s57 offen sc1 lds
    s_add_u32 m0, s62, 20480
    s_add_u32 s63, s77, 114688
    buffer_load_dwordx4 v40, s[28:31], s63 offen offset:0 lds
    buffer_load_dwordx4 v41, s[28:31], s63 offen offset:1024 lds
    s_add_u32 m0, s62, 22528
    s_add_u32 s63, s77, 172032
    buffer_load_dwordx4 v40, s[28:31], s63 offen offset:0 lds
    buffer_load_dwordx4 v41, s[28:31], s63 offen offset:1024 lds
    s_waitcnt vmcnt(8)
    ds_read2st64_b32 v[46:47], v50 offset0:4 offset1:8
    s_waitcnt lgkmcnt(0)
    v_max_u32 v46, v46, v47
    v_cmp_eq_u32 vcc, -1, v46
    s_cbranch_vccnz Lzr_214
Lzc_213:
    s_barrier
    ds_read_b128 v[128:131], v4 offset:0
    ds_read_b128 v[132:135], v4 offset:256
    ds_read_b128 v[136:139], v4 offset:512
    ds_read_b128 v[140:143], v4 offset:768
    ds_read_b128 v[144:147], v4 offset:1024
    ds_read_b128 v[148:151], v4 offset:1280
    ds_read_b128 v[152:155], v4 offset:1536
    s_waitcnt lgkmcnt(6)
    v_mfma_f32_32x32x16_bf16 v[64:79], a[0:3], v[128:131], 0
    s_waitcnt lgkmcnt(5)
    ds_read_b128 v[156:159], v4 offset:1792
    ds_read_b64_tr_b16 a[144:145], v42 offset:12288
    ds_read_b64_tr_b16 a[146:147], v42 offset:12800
    ds_read_b64_tr_b16 a[148:149], v43 offset:12288
    ds_read_b64_tr_b16 a[150:151], v43 offset:12800
    v_mfma_f32_16x16x32_bf16 v[112:115], v[120:123], a[136:139], v[112:115]
    s_add_u32 m0, s62, 0
    s_add_u32 s63, s78, 0
    buffer_load_dwordx4 v40, s[28:31], s63 offen offset:0 lds
    buffer_load_dwordx4 v41, s[28:31], s63 offen offset:1024 lds
    v_mfma_f32_16x16x32_bf16 v[116:119], v[120:123], a[140:143], v[116:119]
    v_mfma_f32_32x32x16_bf16 v[64:79], a[8:11], v[132:135], v[64:79]
    s_waitcnt vmcnt(6) lgkmcnt(8)
    ds_read_b128 v[128:131], v4 offset:2048
    ds_read2st64_b32 v[46:47], v50 offset0:12 offset1:16
    ds_read2st64_b32 v[48:49], v50 offset0:20 offset1:24
    v_mfma_f32_32x32x16_bf16 v[64:79], a[16:19], v[136:139], v[64:79]
    s_add_u32 m0, s62, 2048
    s_add_u32 s63, s78, 57344
    ds_read_b128 v[132:135], v4 offset:2304
    buffer_load_dwordx4 v40, s[28:31], s63 offen offset:0 lds
    buffer_load_dwordx4 v41, s[28:31], s63 offen offset:1024 lds
    ds_read_b64_tr_b16 a[152:153], v42 offset:14336
    v_mfma_f32_32x32x16_bf16 v[64:79], a[24:27], v[140:143], v[64:79]
    s_waitcnt lgkmcnt(2)
    ds_read_b128 v[136:139], v4 offset:2560
    ds_read_b64_tr_b16 a[154:155], v42 offset:14848
    ds_read_b64_tr_b16 a[156:157], v43 offset:14336
    v_max3_u32 v47, v47, v48, v49
    v_max_u32 v46, v46, v47
    v_cmp_eq_u32 vcc, -1, v46
    v_mfma_f32_16x16x32_bf16 v[112:115], v[120:123], a[144:147], v[112:115]
    ds_read_b64_tr_b16 a[158:159], v43 offset:14848
    v_mfma_f32_16x16x32_bf16 v[116:119], v[120:123], a[148:151], v[116:119]
    s_add_u32 m0, s62, 4096
    s_add_u32 s63, s78, 114688
    buffer_load_dwordx4 v40, s[28:31], s63 offen offset:0 lds
    buffer_load_dwordx4 v41, s[28:31], s63 offen offset:1024 lds
    v_mfma_f32_32x32x16_bf16 v[64:79], a[32:35], v[144:147], v[64:79]
    ds_read_b128 v[140:143], v4 offset:2816
    s_cbranch_vccnz Lzr_216
Lzc_215:
    s_barrier
    v_mfma_f32_32x32x16_bf16 v[64:79], a[40:43], v[148:151], v[64:79]
    s_waitcnt lgkmcnt(1)
    s_add_u32 m0, s62, 6144
    s_add_u32 s63, s78, 172032
    ds_read_b128 v[144:147], v4 offset:3072
    buffer_load_dwordx4 v40, s[28:31], s63 offen offset:0 lds
    buffer_load_dwordx4 v41, s[28:31], s63 offen offset:1024 lds
    ds_read_b64_tr_b16 a[160:161], v42 offset:16384
    v_mfma_f32_16x16x32_bf16 v[112:115], v[120:123], a[152:155], v[112:115]
    ds_read_b64_tr_b16 a[162:163], v42 offset:16896
    ds_read_b64_tr_b16 a[164:165], v43 offset:16384
    v_mfma_f32_16x16x32_bf16 v[116:119], v[120:123], a[156:159], v[116:119]
    ds_read_b64_tr_b16 a[166:167], v43 offset:16896
    v_mfma_f32_32x32x16_bf16 v[64:79], a[48:51], v[152:155], v[64:79]
    s_add_u32 m0, s87, 9216
    s_add_u32 s57, s66, 5770240
    ds_read_b128 v[148:151], v4 offset:3328
    buffer_load_dwordx4 v1, s[20:23], s57 offen sc1 lds
    ds_read_b64_tr_b16 a[168:169], v42 offset:18432
    ds_read_b64_tr_b16 a[170:171], v42 offset:18944
    v_mfma_f32_32x32x16_bf16 v[64:79], a[56:59], v[156:159], v[64:79]
    s_waitcnt lgkmcnt(3)
    ds_read_b128 v[152:155], v4 offset:3584
    ds_read_b64_tr_b16 a[172:173], v43 offset:18432
    ds_read_b64_tr_b16 a[174:175], v43 offset:18944
    v_mfma_f32_16x16x32_bf16 v[112:115], v[120:123], a[160:163], v[112:115]
    v_mfma_f32_16x16x32_bf16 v[116:119], v[120:123], a[164:167], v[116:119]
    v_mfma_f32_32x32x16_bf16 v[64:79], a[64:67], v[128:131], v[64:79]
    s_waitcnt vmcnt(11)
    ds_read_b128 v[156:159], v4 offset:3840
    ds_read_b64_tr_b16 a[176:177], v42 offset:20480
    ds_read_b64_tr_b16 a[178:179], v42 offset:20992
    ds_read_b64_tr_b16 a[180:181], v43 offset:20480
    ds_read_b64_tr_b16 a[182:183], v43 offset:20992
    v_add_f32_dpp v96, v100, v96 quad_perm:[0,1,2,3] row_mask:0xf bank_mask:0x3
    v_mfma_f32_32x32x16_bf16 v[64:79], a[72:75], v[132:135], v[64:79]
    s_waitcnt lgkmcnt(5)
    s_add_u32 m0, s87, 10240
    s_add_u32 s57, s67, 5770240
    ds_read_b128 v[128:131], v4 offset:4096
    buffer_load_dwordx4 v1, s[20:23], s57 offen sc1 lds
    v_add_f32_dpp v97, v101, v97 quad_perm:[0,1,2,3] row_mask:0xf bank_mask:0x3
    v_add_f32_dpp v96, v100, v96 quad_perm:[0,1,2,3] row_mask:0x5 bank_mask:0xc
    v_mfma_f32_16x16x32_bf16 v[112:115], v[120:123], a[168:171], v[112:115]
    v_add_f32_dpp v97, v101, v97 quad_perm:[0,1,2,3] row_mask:0x5 bank_mask:0xc
    v_add_f32_dpp v96, v96, v96 row_ror:8 row_mask:0xf bank_mask:0xf
    v_mfma_f32_16x16x32_bf16 v[116:119], v[120:123], a[172:175], v[116:119]
    v_add_f32_dpp v97, v97, v97 row_ror:8 row_mask:0xf bank_mask:0xf
    v_mov_b32 v98, v96
    v_mfma_f32_32x32x16_bf16 v[64:79], a[80:83], v[136:139], v[64:79]
    s_waitcnt vmcnt(10)
    ds_read_b128 v[132:135], v4 offset:4352
    ds_read_b64_tr_b16 a[184:185], v42 offset:22528
    ds_read_b64_tr_b16 a[186:187], v42 offset:23040
    ds_read_b64_tr_b16 a[188:189], v43 offset:22528
    ds_read_b64_tr_b16 a[190:191], v43 offset:23040
    v_mov_b32 v99, v97
    v_mfma_f32_32x32x16_bf16 v[64:79], a[88:91], v[140:143], v[64:79]
    s_waitcnt lgkmcnt(6)
    ds_read_b128 v[136:139], v4 offset:4608
    v_permlane16_swap_b32 v96, v98
    v_permlane16_swap_b32 v97, v99
    v_add_f32 v96, v96, v98
    v_mfma_f32_16x16x32_bf16 v[112:115], v[120:123], a[176:179], v[112:115]
    v_add_f32 v97, v97, v99
    v_mov_b32 v98, v96
    v_mfma_f32_16x16x32_bf16 v[116:119], v[120:123], a[180:183], v[116:119]
    v_mov_b32 v99, v97
    v_mfma_f32_32x32x16_bf16 v[64:79], a[96:99], v[144:147], v[64:79]
    s_add_u32 m0, s87, 11264
    s_add_u32 s57, s68, 5770240
    ds_read_b128 v[140:143], v4 offset:4864
    buffer_load_dwordx4 v1, s[20:23], s57 offen sc1 lds
    v_permlane32_swap_b32 v96, v98
    v_mfma_f32_32x32x16_bf16 v[64:79], a[104:107], v[148:151], v[64:79]
    s_waitcnt lgkmcnt(2)
    ds_read_b128 v[144:147], v4 offset:5120
    v_permlane32_swap_b32 v97, v99
    v_and_b32 v110, 0x270, v1
    v_add_u32 v110, s95, v110
    v_mul_f32 v104, 0xbb124925, v96
    v_mfma_f32_16x16x32_bf16 v[112:115], v[120:123], a[184:187], v[112:115]
    v_mul_f32 v105, 0xbb124925, v97
    v_fmaak_f32 v106, v104, v104, 0xaedbe66f
    v_mfma_f32_16x16x32_bf16 v[116:119], v[120:123], a[188:191], v[116:119]
    v_fmaak_f32 v107, v105, v105, 0xaedbe66f
    v_fmac_f32 v106, 0xbb124925, v98
    v_mfma_f32_32x32x16_bf16 v[64:79], a[112:115], v[152:155], v[64:79]
    s_waitcnt vmcnt(9)
    ds_read_b128 v[148:151], v4 offset:5376
    ds_read_b64_tr_b16 a[192:193], v42 offset:0
    ds_read_b64_tr_b16 a[194:195], v42 offset:512
    ds_read_b64_tr_b16 a[196:197], v43 offset:0
    ds_read_b64_tr_b16 a[198:199], v43 offset:512
    v_fmac_f32 v107, 0xbb124925, v99
    v_mfma_f32_32x32x16_bf16 v[64:79], a[120:123], v[156:159], v[64:79]
    s_add_u32 m0, s87, 12288
    s_add_u32 s57, s69, 5770240
    ds_read_b128 v[152:155], v4 offset:5632
    buffer_load_dwordx4 v1, s[20:23], s57 offen sc1 lds
    v_rsq_f32_e64 v108, |v106|
    v_mfma_f32_32x32x16_bf16 v[64:79], a[128:131], v[128:131], v[64:79]
    s_waitcnt vmcnt(8)
    ds_read_b128 v[156:159], v4 offset:5888
    ds_read_b64_tr_b16 a[200:201], v42 offset:2048
    ds_read_b64_tr_b16 a[202:203], v42 offset:2560
    ds_read_b64_tr_b16 a[204:205], v43 offset:2048
    ds_read_b64_tr_b16 a[206:207], v43 offset:2560
    v_mfma_f32_32x32x16_bf16 v[64:79], a[136:139], v[132:135], v[64:79]
    s_waitcnt lgkmcnt(6)
    ds_read_b128 v[128:131], v4 offset:6144
    v_rsq_f32_e64 v109, |v107|
    v_mul_f32_e64 v106, |v106|, v108
    v_mul_f32_e64 v107, |v107|, v109
    v_mul_f32 v100, 0xbeeff509, v108
    v_mfma_f32_16x16x32_bf16 v[112:115], v[120:123], a[192:195], v[112:115]
    v_mul_f32 v102, 0xbeeff509, v109
    v_mov_b32_dpp v106, v104 quad_perm:[0,1,2,3] row_mask:0x3 bank_mask:0xf
    v_mfma_f32_16x16x32_bf16 v[116:119], v[120:123], a[196:199], v[116:119]
    v_mov_b32_dpp v107, v105 quad_perm:[0,1,2,3] row_mask:0x3 bank_mask:0xf
    v_cvt_pk_bf16_f32 v108, v106, v106
    v_mfma_f32_32x32x16_bf16 v[64:79], a[144:147], v[136:139], v[64:79]
    s_waitcnt vmcnt(6)
    s_add_u32 m0, s87, 13312
    s_add_u32 s57, s70, 5770240
    ds_read_b128 v[132:135], v4 offset:6400
    buffer_load_dwordx4 v1, s[20:23], s57 offen sc1 lds
    ds_read_b64_tr_b16 a[208:209], v42 offset:4096
    ds_read_b64_tr_b16 a[210:211], v42 offset:4608
    v_mfma_f32_32x32x16_bf16 v[64:79], a[152:155], v[140:143], v[64:79]
    s_waitcnt lgkmcnt(4)
    ds_read_b128 v[136:139], v4 offset:6656
    ds_read_b64_tr_b16 a[212:213], v43 offset:4096
    ds_read_b64_tr_b16 a[214:215], v43 offset:4608
    v_cvt_pk_bf16_f32 v109, v107, v107
    v_lshlrev_b32 v108, 16, v108
    v_lshlrev_b32 v109, 16, v109
    v_mfma_f32_16x16x32_bf16 v[112:115], v[120:123], a[200:203], v[112:115]
    v_sub_f32 v108, v106, v108
    v_sub_f32 v109, v107, v109
    v_mfma_f32_16x16x32_bf16 v[116:119], v[120:123], a[204:207], v[116:119]
    v_cvt_pk_bf16_f32 v101, v106, v108
    v_cvt_pk_bf16_f32 v103, v107, v109
    v_mfma_f32_32x32x16_bf16 v[64:79], a[160:163], v[144:147], v[64:79]
    s_waitcnt vmcnt(5)
    ds_read_b128 v[140:143], v4 offset:6912
    ds_write_b128 v110, v[100:103]
    ds_read_b64_tr_b16 a[216:217], v42 offset:6144
    ds_read_b64_tr_b16 a[218:219], v42 offset:6656
    ds_read_b64_tr_b16 a[220:221], v43 offset:6144
    ds_read_b64_tr_b16 a[222:223], v43 offset:6656
    v_mfma_f32_32x32x16_bf16 v[64:79], a[168:171], v[148:151], v[64:79]
    s_waitcnt lgkmcnt(6)
    s_add_u32 m0, s87, 14336
    s_add_u32 s57, s71, 5770240
    s_add_u32 s72, s72, s61
    s_add_u32 s73, s73, s61
    ds_read_b128 v[144:147], v4 offset:0
    buffer_load_dwordx4 v1, s[20:23], s57 offen sc1 lds
    v_mfma_f32_16x16x32_bf16 v[112:115], v[120:123], a[208:211], v[112:115]
    s_add_u32 s74, s74, s61
    s_add_u32 s75, s75, s61
    s_add_u32 s76, s76, s61
    v_mfma_f32_16x16x32_bf16 v[116:119], v[120:123], a[212:215], v[116:119]
    s_add_u32 s77, s77, s61
    s_add_u32 s78, s78, s61
    v_mfma_f32_32x32x16_bf16 v[64:79], a[176:179], v[152:155], v[64:79]
    s_add_u32 m0, s62, 8192
    s_add_u32 s63, s72, 0
    ds_read_b128 v[148:151], v4 offset:256
    buffer_load_dwordx4 v38, s[32:35], s63 offen offset:0 lds
    buffer_load_dwordx4 v39, s[32:35], s63 offen offset:1024 lds
    v_mfma_f32_32x32x16_bf16 v[64:79], a[184:187], v[156:159], v[64:79]
    s_waitcnt lgkmcnt(2)
    s_add_u32 m0, s62, 10240
    s_add_u32 s63, s72, 14336
    ds_read_b128 v[152:155], v4 offset:512
    buffer_load_dwordx4 v38, s[32:35], s63 offen offset:0 lds
    buffer_load_dwordx4 v39, s[32:35], s63 offen offset:1024 lds
    v_add_u32 v96, 161792, v1
    v_mfma_f32_16x16x32_bf16 v[112:115], v[120:123], a[216:219], v[112:115]
    v_mfma_f32_16x16x32_bf16 v[116:119], v[120:123], a[220:223], v[116:119]
    v_mfma_f32_32x32x16_bf16 v[64:79], a[192:195], v[128:131], v[64:79]
    ds_read_b128 v[156:159], v4 offset:768
    s_barrier
    ds_read_b128 v[52:55], v96
    s_nop 2
    v_permlane32_swap_b32 v112, v34
    s_nop 1
    v_mov_b32_dpp v34, v116 quad_perm:[0,1,2,3] row_mask:0x3 bank_mask:0xf
    v_cvt_pk_bf16_f32 v56, v112, v112
    v_cvt_pk_bf16_f32 v58, v34, v34
    v_mfma_f32_32x32x16_bf16 v[64:79], a[200:203], v[132:135], v[64:79]
    ds_read_b128 v[128:131], v4 offset:1024
    v_lshlrev_b32 v113, 16, v56
    v_lshlrev_b32 v117, 16, v58
    v_sub_f32 v113, v112, v113
    v_sub_f32 v117, v34, v117
    v_mfma_f32_32x32x16_bf16 v[64:79], a[208:211], v[136:139], v[64:79]
    s_waitcnt lgkmcnt(1)
    ds_read_b128 v[132:135], v4 offset:1280
    v_cvt_pk_bf16_f32 v57, v113, 0
    v_cvt_pk_bf16_f32 v59, v117, 0
    v_cvt_pk_bf16_f32 v5, v112, v113
    v_cvt_pk_bf16_f32 v7, v34, v117
    v_mfma_f32_32x32x16_bf16 v[64:79], a[216:219], v[140:143], v[64:79]
    ds_read_b128 v[136:139], v4 offset:1536
    v_mov_b32 v60, v53
    v_mov_b32 v61, v53
    s_nop 1
    v_mfma_f32_32x32x16_bf16 v[64:79], v[56:59], v[60:63], v[64:79]
    s_add_u32 m0, s62, 12288
    s_add_u32 s63, s73, 0
    buffer_load_dwordx4 v38, s[32:35], s63 offen offset:0 lds
    buffer_load_dwordx4 v39, s[32:35], s63 offen offset:1024 lds
    v_mfma_f32_32x32x16_bf16 v[80:95], a[4:7], v[144:147], 0
    ds_read_b128 v[140:143], v4 offset:1792
    v_mfma_f32_32x32x16_bf16 v[80:95], a[12:15], v[148:151], v[80:95]
    s_add_u32 m0, s62, 14336
    s_add_u32 s63, s73, 14336
    ds_read_b128 v[144:147], v4 offset:2048
    buffer_load_dwordx4 v38, s[32:35], s63 offen offset:0 lds
    buffer_load_dwordx4 v39, s[32:35], s63 offen offset:1024 lds
    v_mfma_f32_32x32x16_bf16 v[80:95], a[20:23], v[152:155], v[80:95]
    s_add_u32 s92, s65, 0
    ds_read_b128 v[148:151], v4 offset:2304
    v_mul_f32 v64, v52, v64
    v_mul_f32 v65, v52, v65
    v_fma_f32 v34, v64, v64, s91
    v_fma_f32 v35, v65, v65, s91
    v_mul_f32 v34, v34, v64
    v_mul_f32 v35, v35, v65
    v_mfma_f32_32x32x16_bf16 v[80:95], a[28:31], v[156:159], v[80:95]
    s_waitcnt lgkmcnt(4)
    ds_read_b128 v[152:155], v4 offset:2560
    v_mul_f32 v66, v52, v66
    v_exp_f32 v34, v34
    v_mul_f32 v67, v52, v67
    v_exp_f32 v35, v35
    v_fma_f32 v36, v66, v66, s91
    v_mfma_f32_32x32x16_bf16 v[80:95], a[36:39], v[128:131], v[80:95]
    s_add_u32 m0, s62, 16384
    s_add_u32 s63, s74, 0
    ds_read_b128 v[156:159], v4 offset:2816
    buffer_load_dwordx4 v38, s[32:35], s63 offen offset:0 lds
    buffer_load_dwordx4 v39, s[32:35], s63 offen offset:1024 lds
    v_add_f32 v34, 1.0, v34
    v_fma_f32 v37, v67, v67, s91
    v_add_f32 v35, 1.0, v35
    v_mfma_f32_32x32x16_bf16 v[80:95], a[44:47], v[132:135], v[80:95]
    s_waitcnt lgkmcnt(4)
    ds_read_b128 v[128:131], v4 offset:3072
    v_mul_f32 v36, v36, v66
    v_rcp_f32 v34, v34
    v_mul_f32 v37, v37, v67
    v_rcp_f32 v35, v35
    v_mul_f32 v34, v34, v64
    v_mfma_f32_32x32x16_bf16 v[80:95], a[52:55], v[136:139], v[80:95]
    ds_read_b128 v[132:135], v4 offset:3328
    v_exp_f32 v36, v36
    v_exp_f32 v37, v37
    v_mul_f32 v35, v35, v65
    v_add_f32 v36, 1.0, v36
    v_cvt_pk_bf16_f32 v64, v34, v35
    v_mfma_f32_32x32x16_bf16 v[80:95], a[60:63], v[140:143], v[80:95]
    s_waitcnt lgkmcnt(4)
    s_add_u32 m0, s62, 18432
    s_add_u32 s63, s74, 14336
    ds_read_b128 v[136:139], v4 offset:3584
    buffer_load_dwordx4 v38, s[32:35], s63 offen offset:0 lds
    buffer_load_dwordx4 v39, s[32:35], s63 offen offset:1024 lds
    v_add_f32 v37, 1.0, v37
    v_mul_f32 v68, v52, v68
    v_mfma_f32_32x32x16_bf16 v[80:95], a[68:71], v[144:147], v[80:95]
    ds_read_b128 v[140:143], v4 offset:3840
    v_rcp_f32 v36, v36
    v_mul_f32 v69, v52, v69
    v_rcp_f32 v37, v37
    v_fma_f32 v34, v68, v68, s91
    v_mul_f32 v36, v36, v66
    v_mfma_f32_32x32x16_bf16 v[80:95], a[76:79], v[148:151], v[80:95]
    s_waitcnt lgkmcnt(4)
    ds_read_b128 v[144:147], v4 offset:4096
    v_fma_f32 v35, v69, v69, s91
    v_mul_f32 v37, v37, v67
    v_mul_f32 v34, v34, v68
    v_cvt_pk_bf16_f32 v65, v36, v37
    v_mul_f32 v35, v35, v69
    v_mul_f32 v70, v52, v70
    v_mul_f32 v71, v52, v71
    v_mfma_f32_32x32x16_bf16 v[80:95], a[84:87], v[152:155], v[80:95]
    s_add_u32 m0, s62, 20480
    s_add_u32 s63, s75, 0
    ds_read_b128 v[148:151], v4 offset:4352
    buffer_load_dwordx4 v38, s[32:35], s63 offen offset:0 lds
    buffer_load_dwordx4 v39, s[32:35], s63 offen offset:1024 lds
    v_exp_f32 v34, v34
    v_fma_f32 v36, v70, v70, s91
    v_mfma_f32_32x32x16_bf16 v[80:95], a[92:95], v[156:159], v[80:95]
    s_waitcnt lgkmcnt(4)
    ds_read_b128 v[152:155], v4 offset:4608
    v_exp_f32 v35, v35
    v_add_f32 v34, 1.0, v34
    v_fma_f32 v37, v71, v71, s91
    v_add_f32 v35, 1.0, v35
    v_mul_f32 v36, v36, v70
    v_mul_f32 v37, v37, v71
    v_mfma_f32_32x32x16_bf16 v[80:95], a[100:103], v[128:131], v[80:95]
    ds_read_b128 v[156:159], v4 offset:4864
    v_rcp_f32 v34, v34
    v_rcp_f32 v35, v35
    v_exp_f32 v36, v36
    v_mfma_f32_32x32x16_bf16 v[80:95], a[108:111], v[132:135], v[80:95]
    s_waitcnt lgkmcnt(4)
    s_add_u32 m0, s62, 22528
    s_add_u32 s63, s75, 14336
    ds_read_b128 v[128:131], v4 offset:5120
    buffer_load_dwordx4 v38, s[32:35], s63 offen offset:0 lds
    buffer_load_dwordx4 v39, s[32:35], s63 offen offset:1024 lds
    v_mul_f32 v34, v34, v68
    v_exp_f32 v37, v37
    v_mfma_f32_32x32x16_bf16 v[80:95], a[116:119], v[136:139], v[80:95]
    ds_read_b128 v[132:135], v4 offset:5376
    v_mul_f32 v35, v35, v69
    v_add_f32 v36, 1.0, v36
    v_cvt_pk_bf16_f32 v66, v34, v35
    v_add_f32 v37, 1.0, v37
    v_mul_f32 v72, v52, v72
    v_rcp_f32 v36, v36
    v_mfma_f32_32x32x16_bf16 v[80:95], a[124:127], v[140:143], v[80:95]
    s_waitcnt lgkmcnt(4)
    ds_read_b128 v[136:139], v4 offset:5632
    v_mul_f32 v73, v52, v73
    v_rcp_f32 v37, v37
    v_fma_f32 v34, v72, v72, s91
    v_mul_f32 v36, v36, v70
    v_fma_f32 v35, v73, v73, s91
    v_mul_f32 v37, v37, v71
    v_mfma_f32_32x32x16_bf16 v[80:95], a[132:135], v[144:147], v[80:95]
    s_add_u32 m0, s62, 0
    s_add_u32 s63, s76, 0
    ds_read_b128 v[140:143], v4 offset:5888
    buffer_load_dwordx4 v38, s[32:35], s63 offen offset:0 lds
    buffer_load_dwordx4 v39, s[32:35], s63 offen offset:1024 lds
    v_mul_f32 v34, v34, v72
    v_cvt_pk_bf16_f32 v67, v36, v37
    v_mul_f32 v35, v35, v73
    v_mfma_f32_32x32x16_bf16 v[80:95], a[140:143], v[148:151], v[80:95]
    s_waitcnt lgkmcnt(4)
    ds_read_b128 v[144:147], v4 offset:6144
    buffer_store_dwordx4 v[64:67], v1, s[20:23], s92 offen offset:0 sc1
    v_mul_f32 v74, v52, v74
    v_exp_f32 v34, v34
    v_mul_f32 v75, v52, v75
    v_fma_f32 v36, v74, v74, s91
    v_mfma_f32_32x32x16_bf16 v[80:95], a[148:151], v[152:155], v[80:95]
    ds_read_b128 v[148:151], v4 offset:6400
    v_exp_f32 v35, v35
    v_add_f32 v34, 1.0, v34
    v_fma_f32 v37, v75, v75, s91
    v_add_f32 v35, 1.0, v35
    v_mul_f32 v36, v36, v74
    v_mul_f32 v37, v37, v75
    v_mfma_f32_32x32x16_bf16 v[80:95], a[156:159], v[156:159], v[80:95]
    s_waitcnt lgkmcnt(4)
    ds_read_b128 v[152:155], v4 offset:6656
    v_rcp_f32 v34, v34
    v_rcp_f32 v35, v35
    v_exp_f32 v36, v36
    v_mul_f32 v34, v34, v72
    v_mfma_f32_32x32x16_bf16 v[80:95], a[164:167], v[128:131], v[80:95]
    s_waitcnt vmcnt(17)
    ds_read_b128 v[156:159], v4 offset:6912
    ds_read_b64_tr_b16 a[224:225], v8 offset:8192
    ds_read_b64_tr_b16 a[226:227], v8 offset:9216
    ds_read_b64_tr_b16 a[228:229], v9 offset:8192
    ds_read_b64_tr_b16 a[230:231], v9 offset:9216
    v_exp_f32 v37, v37
    v_mul_f32 v35, v35, v73
    v_mfma_f32_32x32x16_bf16 v[80:95], a[172:175], v[132:135], v[80:95]
    s_waitcnt vmcnt(15) lgkmcnt(8)
    s_add_u32 m0, s62, 2048
    s_add_u32 s63, s76, 14336
    buffer_load_dwordx4 v38, s[32:35], s63 offen offset:0 lds
    buffer_load_dwordx4 v39, s[32:35], s63 offen offset:1024 lds
    ds_read_b64_tr_b16 a[232:233], v8 offset:10240
    ds_read_b64_tr_b16 a[234:235], v8 offset:11264
    ds_read_b64_tr_b16 a[236:237], v9 offset:10240
    ds_read_b64_tr_b16 a[238:239], v9 offset:11264
    v_mfma_f32_32x32x16_bf16 v[80:95], a[180:183], v[136:139], v[80:95]
    s_add_u32 m0, s62, 4096
    s_add_u32 s63, s77, 0
    ds_read2st64_b32 v[40:41], v50 offset0:36 offset1:40
    ds_read2st64_b32 v[42:43], v50 offset0:44 offset1:48
    ds_read2st64_b32 v[44:45], v50 offset0:52 offset1:56
    buffer_load_dwordx4 v38, s[32:35], s63 offen offset:0 lds
    buffer_load_dwordx4 v39, s[32:35], s63 offen offset:1024 lds
    v_mfma_f32_32x32x16_bf16 v[80:95], a[188:191], v[140:143], v[80:95]
    s_waitcnt lgkmcnt(13)
    v_add_f32 v36, 1.0, v36
    v_cvt_pk_bf16_f32 v68, v34, v35
    v_add_f32 v37, 1.0, v37
    v_mul_f32 v76, v52, v76
    v_rcp_f32 v36, v36
    v_mul_f32 v77, v52, v77
    v_fma_f32 v34, v76, v76, s91
    v_mfma_f32_32x32x16_bf16 v[80:95], a[196:199], v[144:147], v[80:95]
    s_waitcnt lgkmcnt(0)
    v_max3_u32 v41, v41, v42, v43
    v_max3_u32 v40, v40, v44, v45
    v_max_u32 v40, v40, v41
    v_cmp_eq_u32 vcc, -1, v40
    v_rcp_f32 v37, v37
    v_mul_f32 v36, v36, v74
    v_fma_f32 v35, v77, v77, s91
    v_mfma_f32_32x32x16_bf16 v[80:95], a[204:207], v[148:151], v[80:95]
    s_waitcnt vmcnt(17)
    ds_read_b64_tr_b16 v[160:161], v8 offset:12288
    ds_read_b64_tr_b16 v[162:163], v8 offset:13312
    ds_read_b64_tr_b16 v[164:165], v9 offset:12288
    ds_read_b64_tr_b16 v[166:167], v9 offset:13312
    s_cbranch_vccnz Lzr_218
Lzc_217:
    s_barrier
    v_mul_f32 v37, v37, v75
    v_mfma_f32_32x32x16_bf16 v[80:95], a[212:215], v[152:155], v[80:95]
    s_add_u32 m0, s62, 6144
    s_add_u32 s63, s77, 14336
    ds_read_b128 v[128:131], v4 offset:8192
    ds_read_b128 v[132:135], v4 offset:8448
    ds_read_b128 v[136:139], v4 offset:8704
    ds_read_b128 v[140:143], v4 offset:8960
    buffer_load_dwordx4 v38, s[32:35], s63 offen offset:0 lds
    buffer_load_dwordx4 v39, s[32:35], s63 offen offset:1024 lds
    v_mfma_f32_32x32x16_bf16 v[80:95], a[220:223], v[156:159], v[80:95]
    s_waitcnt vmcnt(17) lgkmcnt(2)
    ds_read_b128 v[144:147], v4 offset:9216
    ds_read_b128 v[148:151], v4 offset:9472
    ds_read_b128 v[152:155], v4 offset:9728
    ds_read_b64_tr_b16 v[168:169], v8 offset:14336
    ds_read_b64_tr_b16 v[170:171], v8 offset:15360
    ds_read_b64_tr_b16 v[172:173], v9 offset:14336
    ds_read_b64_tr_b16 v[174:175], v9 offset:15360
    v_mfma_f32_32x32x16_bf16 v[80:95], v[58:61], v[60:63], v[80:95]
    v_mul_f32 v34, v34, v76
    v_cvt_pk_bf16_f32 v69, v36, v37
    v_mul_f32 v35, v35, v77
    v_mul_f32 v78, v52, v78
    v_exp_f32 v34, v34
    v_mfma_f32_32x32x16_bf16 v[96:111], a[0:3], v[128:131], 0
    s_add_u32 m0, s62, 8192
    s_add_u32 s63, s78, 0
    ds_read_b128 v[156:159], v4 offset:9984
    buffer_load_dwordx4 v38, s[32:35], s63 offen offset:0 lds
    buffer_load_dwordx4 v39, s[32:35], s63 offen offset:1024 lds
    v_mul_f32 v79, v52, v79
    v_exp_f32 v35, v35
    v_mfma_f32_32x32x16_bf16 v[96:111], a[8:11], v[132:135], v[96:111]
    s_waitcnt lgkmcnt(8)
    ds_read_b128 v[128:131], v4 offset:10240
    v_mov_b32 v60, v55
    v_mov_b32 v61, v55
    v_fma_f32 v36, v78, v78, s91
    v_add_f32 v34, 1.0, v34
    v_fma_f32 v37, v79, v79, s91
    v_add_f32 v35, 1.0, v35
    v_mul_f32 v36, v36, v78
    v_mfma_f32_32x32x16_bf16 v[96:111], a[16:19], v[136:139], v[96:111]
    s_waitcnt vmcnt(17)
    ds_read_b128 v[132:135], v4 offset:10496
    ds_read_b64_tr_b16 v[176:177], v8 offset:16384
    ds_read_b64_tr_b16 v[178:179], v8 offset:17408
    ds_read_b64_tr_b16 v[180:181], v9 offset:16384
    ds_read_b64_tr_b16 v[182:183], v9 offset:17408
    v_rcp_f32 v34, v34
    v_mul_f32 v37, v37, v79
    v_mfma_f32_32x32x16_bf16 v[96:111], a[24:27], v[140:143], v[96:111]
    s_waitcnt lgkmcnt(12)
    s_add_u32 m0, s62, 10240
    s_add_u32 s63, s78, 14336
    ds_read_b128 v[136:139], v4 offset:10752
    buffer_load_dwordx4 v38, s[32:35], s63 offen offset:0 lds
    buffer_load_dwordx4 v39, s[32:35], s63 offen offset:1024 lds
    v_rcp_f32 v35, v35
    v_mul_f32 v34, v34, v76
    v_mfma_f32_32x32x16_bf16 v[96:111], a[32:35], v[144:147], v[96:111]
    ds_read_b128 v[140:143], v4 offset:11008
    v_exp_f32 v36, v36
    v_exp_f32 v37, v37
    v_mul_f32 v35, v35, v77
    v_add_f32 v36, 1.0, v36
    v_mfma_f32_32x32x16_bf16 v[96:111], a[40:43], v[148:151], v[96:111]
    s_waitcnt vmcnt(17) lgkmcnt(8)
    ds_read_b128 v[144:147], v4 offset:11264
    ds_read_b64_tr_b16 v[184:185], v8 offset:18432
    ds_read_b64_tr_b16 v[186:187], v8 offset:19456
    ds_read_b64_tr_b16 v[188:189], v9 offset:18432
    ds_read_b64_tr_b16 v[190:191], v9 offset:19456
    v_cvt_pk_bf16_f32 v70, v34, v35
    v_add_f32 v37, 1.0, v37
    v_mul_f32 v80, v52, v80
    v_mfma_f32_32x32x16_bf16 v[96:111], a[48:51], v[152:155], v[96:111]
    s_add_u32 m0, s62, 12288
    s_add_u32 s63, s72, 28672
    ds_read_b128 v[148:151], v4 offset:11520
    buffer_load_dwordx4 v38, s[32:35], s63 offen offset:0 lds
    buffer_load_dwordx4 v39, s[32:35], s63 offen offset:1024 lds
    v_rcp_f32 v36, v36
    v_mul_f32 v81, v52, v81
    v_mfma_f32_32x32x16_bf16 v[96:111], a[56:59], v[156:159], v[96:111]
    s_waitcnt lgkmcnt(12)
    ds_read_b128 v[152:155], v4 offset:11776
    v_rcp_f32 v37, v37
    v_fma_f32 v34, v80, v80, s91
    v_mul_f32 v36, v36, v78
    v_fma_f32 v35, v81, v81, s91
    v_mul_f32 v37, v37, v79
    v_mul_f32 v34, v34, v80
    v_mfma_f32_32x32x16_bf16 v[96:111], a[64:67], v[128:131], v[96:111]
    s_waitcnt vmcnt(17)
    ds_read_b128 v[156:159], v4 offset:12032
    ds_read_b64_tr_b16 v[192:193], v8 offset:20480
    ds_read_b64_tr_b16 v[194:195], v8 offset:21504
    ds_read_b64_tr_b16 v[196:197], v9 offset:20480
    ds_read_b64_tr_b16 v[198:199], v9 offset:21504
    v_cvt_pk_bf16_f32 v71, v36, v37
    v_mul_f32 v35, v35, v81
    v_mul_f32 v82, v52, v82
    v_mfma_f32_32x32x16_bf16 v[96:111], a[72:75], v[132:135], v[96:111]
    s_waitcnt lgkmcnt(12)
    s_add_u32 m0, s62, 14336
    s_add_u32 s63, s72, 43008
    ds_read_b128 v[128:131], v4 offset:12288
    buffer_store_dwordx4 v[68:71], v1, s[20:23], s92 offen offset:1024 sc1
    buffer_load_dwordx4 v38, s[32:35], s63 offen offset:0 lds
    buffer_load_dwordx4 v39, s[32:35], s63 offen offset:1024 lds
    v_mul_f32 v83, v52, v83
    v_mfma_f32_32x32x16_bf16 v[96:111], a[80:83], v[136:139], v[96:111]
    ds_read_b128 v[132:135], v4 offset:12544
    v_exp_f32 v34, v34
    v_exp_f32 v35, v35
    v_fma_f32 v36, v82, v82, s91
    v_add_f32 v34, 1.0, v34
    v_fma_f32 v37, v83, v83, s91
    v_mfma_f32_32x32x16_bf16 v[96:111], a[88:91], v[140:143], v[96:111]
    s_waitcnt vmcnt(18) lgkmcnt(8)
    ds_read_b128 v[136:139], v4 offset:12800
    ds_read_b64_tr_b16 v[200:201], v8 offset:22528
    ds_read_b64_tr_b16 v[202:203], v8 offset:23552
    ds_read_b64_tr_b16 v[204:205], v9 offset:22528
    ds_read_b64_tr_b16 v[206:207], v9 offset:23552
    v_add_f32 v35, 1.0, v35
    v_mul_f32 v36, v36, v82
    v_mul_f32 v37, v37, v83
    v_mfma_f32_32x32x16_bf16 v[96:111], a[96:99], v[144:147], v[96:111]
    s_add_u32 m0, s62, 16384
    s_add_u32 s63, s73, 28672
    ds_read_b128 v[140:143], v4 offset:13056
    buffer_load_dwordx4 v38, s[32:35], s63 offen offset:0 lds
    buffer_load_dwordx4 v39, s[32:35], s63 offen offset:1024 lds
    v_rcp_f32 v34, v34
    v_mfma_f32_32x32x16_bf16 v[96:111], a[104:107], v[148:151], v[96:111]
    s_waitcnt lgkmcnt(12)
    ds_read_b128 v[144:147], v4 offset:13312
    v_rcp_f32 v35, v35
    v_exp_f32 v36, v36
    v_mul_f32 v34, v34, v80
    v_exp_f32 v37, v37
    v_mfma_f32_32x32x16_bf16 v[96:111], a[112:115], v[152:155], v[96:111]
    s_waitcnt vmcnt(18)
    ds_read_b128 v[148:151], v4 offset:13568
    ds_read_b64_tr_b16 v[208:209], v8 offset:0
    ds_read_b64_tr_b16 v[210:211], v8 offset:1024
    ds_read_b64_tr_b16 v[212:213], v9 offset:0
    ds_read_b64_tr_b16 v[214:215], v9 offset:1024
    v_mul_f32 v35, v35, v81
    v_add_f32 v36, 1.0, v36
    v_cvt_pk_bf16_f32 v80, v34, v35
    v_mfma_f32_32x32x16_bf16 v[96:111], a[120:123], v[156:159], v[96:111]
    s_waitcnt lgkmcnt(12)
    s_add_u32 m0, s62, 18432
    s_add_u32 s63, s73, 43008
    ds_read_b128 v[152:155], v4 offset:13824
    buffer_load_dwordx4 v38, s[32:35], s63 offen offset:0 lds
    buffer_load_dwordx4 v39, s[32:35], s63 offen offset:1024 lds
    v_add_f32 v37, 1.0, v37
    v_mul_f32 v84, v52, v84
    v_mul_f32 v85, v52, v85
    v_mfma_f32_32x32x16_bf16 v[96:111], a[128:131], v[128:131], v[96:111]
    ds_read_b128 v[156:159], v4 offset:14080
    v_rcp_f32 v36, v36
    v_rcp_f32 v37, v37
    v_fma_f32 v34, v84, v84, s91
    v_mul_f32 v36, v36, v82
    v_fma_f32 v35, v85, v85, s91
    v_mfma_f32_32x32x16_bf16 v[96:111], a[136:139], v[132:135], v[96:111]
    s_waitcnt lgkmcnt(8)
    ds_read_b128 v[128:131], v4 offset:14336
    v_mul_f32 v37, v37, v83
    v_mul_f32 v34, v34, v84
    v_cvt_pk_bf16_f32 v81, v36, v37
    v_mul_f32 v35, v35, v85
    v_mul_f32 v86, v52, v86
    v_exp_f32 v34, v34
    v_mfma_f32_32x32x16_bf16 v[96:111], a[144:147], v[136:139], v[96:111]
    ds_read_b128 v[132:135], v4 offset:14592
    v_mul_f32 v87, v52, v87
    v_exp_f32 v35, v35
    v_fma_f32 v36, v86, v86, s91
    v_add_f32 v34, 1.0, v34
    v_fma_f32 v37, v87, v87, s91
    v_add_f32 v35, 1.0, v35
    v_mfma_f32_32x32x16_bf16 v[96:111], a[152:155], v[140:143], v[96:111]
    s_waitcnt vmcnt(6) lgkmcnt(8)
    ds_read_b128 v[136:139], v4 offset:14848
    buffer_store_dword v2, off, s[20:23], s89 offset:64 sc1
    ds_read_b64_tr_b16 v[216:217], v8 offset:2048
    ds_read_b64_tr_b16 v[218:219], v8 offset:3072
    ds_read_b64_tr_b16 v[220:221], v9 offset:2048
    ds_read_b64_tr_b16 v[222:223], v9 offset:3072
    v_mul_f32 v36, v36, v86
    v_mul_f32 v37, v37, v87
    v_mfma_f32_32x32x16_bf16 v[96:111], a[160:163], v[144:147], v[96:111]
    s_add_u32 m0, s62, 20480
    s_add_u32 s63, s74, 28672
    ds_read_b128 v[140:143], v4 offset:15104
    buffer_load_dwordx4 v38, s[32:35], s63 offen offset:0 lds
    buffer_load_dwordx4 v39, s[32:35], s63 offen offset:1024 lds
    ds_read_b64_tr_b16 v[224:225], v8 offset:4096
    ds_read_b64_tr_b16 v[226:227], v8 offset:5120
    ds_read_b64_tr_b16 v[228:229], v9 offset:4096
    v_mfma_f32_32x32x16_bf16 v[96:111], a[168:171], v[148:151], v[96:111]
    s_waitcnt lgkmcnt(11)
    s_add_u32 m0, s62, 22528
    s_add_u32 s63, s74, 43008
    ds_read_b128 v[144:147], v4 offset:8192
    ds_read_b64_tr_b16 v[230:231], v9 offset:5120
    buffer_load_dwordx4 v38, s[32:35], s63 offen offset:0 lds
    buffer_load_dwordx4 v39, s[32:35], s63 offen offset:1024 lds
    v_rcp_f32 v34, v34
    v_mfma_f32_32x32x16_bf16 v[96:111], a[176:179], v[152:155], v[96:111]
    ds_read_b128 v[148:151], v4 offset:8448
    v_rcp_f32 v35, v35
    v_exp_f32 v36, v36
    v_mul_f32 v34, v34, v84
    v_exp_f32 v37, v37
    v_mfma_f32_32x32x16_bf16 v[96:111], a[184:187], v[156:159], v[96:111]
    s_waitcnt lgkmcnt(12)
    ds_read_b128 v[152:155], v4 offset:8704
    v_mul_f32 v35, v35, v85
    v_add_f32 v36, 1.0, v36
    v_cvt_pk_bf16_f32 v82, v34, v35
    v_add_f32 v37, 1.0, v37
    v_mul_f32 v88, v52, v88
    v_rcp_f32 v36, v36
    v_mul_f32 v89, v52, v89
    v_mfma_f32_32x32x16_bf16 v[96:111], a[192:195], v[128:131], v[96:111]
    ds_read_b128 v[156:159], v4 offset:8960
    ds_read_b64_tr_b16 v[232:233], v8 offset:6144
    ds_read_b64_tr_b16 v[234:235], v8 offset:7168
    ds_read_b64_tr_b16 v[236:237], v9 offset:6144
    ds_read_b64_tr_b16 v[238:239], v9 offset:7168
    v_rcp_f32 v37, v37
    v_fma_f32 v34, v88, v88, s91
    v_mfma_f32_32x32x16_bf16 v[96:111], a[200:203], v[132:135], v[96:111]
    s_waitcnt lgkmcnt(12)
    s_add_u32 m0, s62, 0
    s_add_u32 s63, s75, 28672
    ds_read_b128 v[128:131], v4 offset:9216
    buffer_load_dwordx4 v38, s[32:35], s63 offen offset:0 lds
    buffer_load_dwordx4 v39, s[32:35], s63 offen offset:1024 lds
    v_mul_f32 v36, v36, v86
    v_fma_f32 v35, v89, v89, s91
    v_mul_f32 v37, v37, v87
    v_mfma_f32_32x32x16_bf16 v[96:111], a[208:211], v[136:139], v[96:111]
    ds_read_b128 v[132:135], v4 offset:9472
    ds_read_b64_tr_b16 v[240:241], v8 offset:8192
    ds_read_b64_tr_b16 v[242:243], v8 offset:9216
    ds_read_b64_tr_b16 v[244:245], v9 offset:8192
    ds_read_b64_tr_b16 v[246:247], v9 offset:9216
    v_mul_f32 v34, v34, v88
    v_cvt_pk_bf16_f32 v83, v36, v37
    v_mul_f32 v35, v35, v89
    v_mfma_f32_32x32x16_bf16 v[96:111], a[216:219], v[140:143], v[96:111]
    s_waitcnt lgkmcnt(12)
    s_add_u32 m0, s62, 2048
    s_add_u32 s63, s75, 43008
    ds_read_b128 v[136:139], v4 offset:9728
    buffer_store_dwordx4 v[80:83], v1, s[20:23], s92 offen offset:2048 sc1
    buffer_load_dwordx4 v38, s[32:35], s63 offen offset:0 lds
    buffer_load_dwordx4 v39, s[32:35], s63 offen offset:1024 lds
    v_mul_f32 v90, v52, v90
    v_mul_f32 v91, v52, v91
    v_mfma_f32_32x32x16_bf16 v[96:111], v[56:59], v[60:63], v[96:111]
    v_exp_f32 v34, v34
    v_exp_f32 v35, v35
    v_fma_f32 v36, v90, v90, s91
    v_add_f32 v34, 1.0, v34
    v_mfma_f32_32x32x16_bf16 v[112:127], a[4:7], v[144:147], 0
    ds_read_b128 v[140:143], v4 offset:9984
    v_fma_f32 v37, v91, v91, s91
    v_add_f32 v35, 1.0, v35
    v_mul_f32 v36, v36, v90
    v_rcp_f32 v34, v34
    v_mul_f32 v37, v37, v91
    v_mfma_f32_32x32x16_bf16 v[112:127], a[12:15], v[148:151], v[112:127]
    s_waitcnt lgkmcnt(12)
    ds_read_b128 v[144:147], v4 offset:10240
    ds_read_b64_tr_b16 v[248:249], v8 offset:10240
    ds_read_b64_tr_b16 v[250:251], v8 offset:11264
    ds_read_b64_tr_b16 v[252:253], v9 offset:10240
    ds_read_b64_tr_b16 v[254:255], v9 offset:11264
    v_rcp_f32 v35, v35
    v_mfma_f32_32x32x16_bf16 v[112:127], a[20:23], v[152:155], v[112:127]
    s_add_u32 m0, s62, 4096
    s_add_u32 s63, s76, 28672
    ds_read_b128 v[148:151], v4 offset:10496
    buffer_load_dwordx4 v38, s[32:35], s63 offen offset:0 lds
    buffer_load_dwordx4 v39, s[32:35], s63 offen offset:1024 lds
    v_exp_f32 v36, v36
    v_mul_f32 v34, v34, v88
    v_mfma_f32_32x32x16_bf16 v[112:127], a[28:31], v[156:159], v[112:127]
    s_waitcnt lgkmcnt(12)
    ds_read_b128 v[152:155], v4 offset:10752
    buffer_load_dword v0, v3, s[20:23], s88 offen offset:64 sc1
    v_exp_f32 v37, v37
    v_mul_f32 v35, v35, v89
    v_add_f32 v36, 1.0, v36
    v_cvt_pk_bf16_f32 v84, v34, v35
    v_add_f32 v37, 1.0, v37
    v_mfma_f32_32x32x16_bf16 v[112:127], a[36:39], v[128:131], v[112:127]
    ds_read_b128 v[156:159], v4 offset:11008
    ds_read_b64_tr_b16 a[240:241], v8 offset:12288
    ds_read_b64_tr_b16 a[242:243], v8 offset:13312
    ds_read_b64_tr_b16 a[244:245], v9 offset:12288
    ds_read_b64_tr_b16 a[246:247], v9 offset:13312
    v_mul_f32 v92, v52, v92
    v_rcp_f32 v36, v36
    v_mfma_f32_32x32x16_bf16 v[112:127], a[44:47], v[132:135], v[112:127]
    s_waitcnt lgkmcnt(12)
    s_add_u32 m0, s62, 6144
    s_add_u32 s63, s76, 43008
    ds_read_b128 v[128:131], v4 offset:11264
    buffer_load_dwordx4 v38, s[32:35], s63 offen offset:0 lds
    buffer_load_dwordx4 v39, s[32:35], s63 offen offset:1024 lds
    v_mul_f32 v93, v52, v93
    v_rcp_f32 v37, v37
    v_mfma_f32_32x32x16_bf16 v[112:127], a[52:55], v[136:139], v[112:127]
    ds_read_b128 v[132:135], v4 offset:11520
    v_fma_f32 v34, v92, v92, s91
    v_mul_f32 v36, v36, v90
    v_fma_f32 v35, v93, v93, s91
    v_mul_f32 v37, v37, v91
    v_mul_f32 v34, v34, v92
    v_cvt_pk_bf16_f32 v85, v36, v37
    v_mfma_f32_32x32x16_bf16 v[112:127], a[60:63], v[140:143], v[112:127]
    s_waitcnt vmcnt(19) lgkmcnt(8)
    ds_read_b128 v[136:139], v4 offset:11776
    ds_read_b64_tr_b16 a[248:249], v8 offset:14336
    ds_read_b64_tr_b16 a[250:251], v8 offset:15360
    ds_read_b64_tr_b16 a[252:253], v9 offset:14336
    ds_read_b64_tr_b16 a[254:255], v9 offset:15360
    v_mul_f32 v35, v35, v93
    v_mul_f32 v94, v52, v94
    v_mul_f32 v95, v52, v95
    v_mfma_f32_32x32x16_bf16 v[112:127], a[68:71], v[144:147], v[112:127]
    s_add_u32 m0, s62, 8192
    s_add_u32 s63, s77, 28672
    ds_read_b128 v[140:143], v4 offset:12032
    buffer_load_dwordx4 v38, s[32:35], s63 offen offset:0 lds
    buffer_load_dwordx4 v39, s[32:35], s63 offen offset:1024 lds
    v_exp_f32 v34, v34
    v_fma_f32 v36, v94, v94, s91
    v_mfma_f32_32x32x16_bf16 v[112:127], a[76:79], v[148:151], v[112:127]
    s_waitcnt lgkmcnt(12)
    ds_read_b128 v[144:147], v4 offset:12288
    v_exp_f32 v35, v35
    v_add_f32 v34, 1.0, v34
    v_fma_f32 v37, v95, v95, s91
    v_add_f32 v35, 1.0, v35
    v_mul_f32 v36, v36, v94
    v_mul_f32 v37, v37, v95
    v_mfma_f32_32x32x16_bf16 v[112:127], a[84:87], v[152:155], v[112:127]
    ds_read_b128 v[148:151], v4 offset:12544
    v_rcp_f32 v34, v34
    v_rcp_f32 v35, v35
    v_exp_f32 v36, v36
    v_mul_f32 v34, v34, v92
    v_mfma_f32_32x32x16_bf16 v[112:127], a[92:95], v[156:159], v[112:127]
    s_waitcnt lgkmcnt(8)
    s_add_u32 m0, s62, 10240
    s_add_u32 s63, s77, 43008
    ds_read_b128 v[152:155], v4 offset:12800
    buffer_load_dwordx4 v38, s[32:35], s63 offen offset:0 lds
    buffer_load_dwordx4 v39, s[32:35], s63 offen offset:1024 lds
    v_exp_f32 v37, v37
    v_mfma_f32_32x32x16_bf16 v[112:127], a[100:103], v[128:131], v[112:127]
    ds_read_b128 v[156:159], v4 offset:13056
    v_mul_f32 v35, v35, v93
    v_add_f32 v36, 1.0, v36
    v_cvt_pk_bf16_f32 v86, v34, v35
    v_add_f32 v37, 1.0, v37
    v_mul_f32 v96, v54, v96
    v_rcp_f32 v36, v36
    v_mfma_f32_32x32x16_bf16 v[112:127], a[108:111], v[132:135], v[112:127]
    s_waitcnt lgkmcnt(4)
    ds_read_b128 v[128:131], v4 offset:13312
    v_mul_f32 v97, v54, v97
    v_rcp_f32 v37, v37
    v_fma_f32 v34, v96, v96, s91
    v_mul_f32 v36, v36, v94
    v_fma_f32 v35, v97, v97, s91
    v_mul_f32 v37, v37, v95
    v_mfma_f32_32x32x16_bf16 v[112:127], a[116:119], v[136:139], v[112:127]
    s_add_u32 m0, s62, 12288
    s_add_u32 s63, s78, 28672
    ds_read_b128 v[132:135], v4 offset:13568
    buffer_load_dwordx4 v38, s[32:35], s63 offen offset:0 lds
    buffer_load_dwordx4 v39, s[32:35], s63 offen offset:1024 lds
    v_mul_f32 v34, v34, v96
    v_cvt_pk_bf16_f32 v87, v36, v37
    v_mul_f32 v35, v35, v97
    v_mfma_f32_32x32x16_bf16 v[112:127], a[124:127], v[140:143], v[112:127]
    s_waitcnt vmcnt(8) lgkmcnt(4)
    ds_read_b128 v[136:139], v4 offset:13824
    buffer_store_dwordx4 v[84:87], v1, s[20:23], s92 offen offset:3072 sc1
    v_cmp_ne_u32 vcc, s59, v0
    s_add_u32 s92, s65, 5767168
    v_mul_f32 v98, v54, v98
    v_exp_f32 v34, v34
    v_mul_f32 v99, v54, v99
    v_mfma_f32_32x32x16_bf16 v[112:127], a[132:135], v[144:147], v[112:127]
    ds_read_b128 v[140:143], v4 offset:14080
    s_cbranch_vccnz Lrt_220
Lck_219:
    v_exp_f32 v35, v35
    v_fma_f32 v36, v98, v98, s91
    v_add_f32 v34, 1.0, v34
    v_fma_f32 v37, v99, v99, s91
    v_mfma_f32_32x32x16_bf16 v[112:127], a[140:143], v[148:151], v[112:127]
    s_waitcnt lgkmcnt(4)
    s_add_u32 m0, s62, 14336
    s_add_u32 s63, s78, 43008
    ds_read_b128 v[144:147], v4 offset:14336
    buffer_load_dwordx4 v[40:43], v1, s[20:23], s66 offen offset:0 sc1
    buffer_load_dwordx4 v38, s[32:35], s63 offen offset:0 lds
    buffer_load_dwordx4 v39, s[32:35], s63 offen offset:1024 lds
    v_add_f32 v35, 1.0, v35
    v_mul_f32 v36, v36, v98
    v_mfma_f32_32x32x16_bf16 v[112:127], a[148:151], v[152:155], v[112:127]
    ds_read_b128 v[148:151], v4 offset:14592
    v_rcp_f32 v34, v34
    v_mul_f32 v37, v37, v99
    v_rcp_f32 v35, v35
    v_exp_f32 v36, v36
    v_mfma_f32_32x32x16_bf16 v[112:127], a[156:159], v[156:159], v[112:127]
    s_waitcnt lgkmcnt(4)
    ds_read_b128 v[152:155], v4 offset:14848
    buffer_load_dwordx4 v[44:47], v1, s[20:23], s66 offen offset:1024 sc1
    v_mul_f32 v34, v34, v96
    v_exp_f32 v37, v37
    v_mul_f32 v35, v35, v97
    v_add_f32 v36, 1.0, v36
    v_cvt_pk_bf16_f32 v96, v34, v35
    v_mfma_f32_32x32x16_bf16 v[112:127], a[164:167], v[128:131], v[112:127]
    ds_read_b128 v[156:159], v4 offset:15104
    v_add_f32 v37, 1.0, v37
    v_mul_f32 v100, v54, v100
    v_rcp_f32 v36, v36
    v_mul_f32 v101, v54, v101
    v_rcp_f32 v37, v37
    v_mfma_f32_32x32x16_bf16 v[112:127], a[172:175], v[132:135], v[112:127]
    s_waitcnt lgkmcnt(4)
    buffer_load_dwordx4 v[48:51], v1, s[20:23], s67 offen offset:0 sc1
    v_fma_f32 v34, v100, v100, s91
    v_mul_f32 v36, v36, v98
    v_fma_f32 v35, v101, v101, s91
    v_mul_f32 v37, v37, v99
    v_mul_f32 v34, v34, v100
    v_cvt_pk_bf16_f32 v97, v36, v37
    v_mfma_f32_32x32x16_bf16 v[112:127], a[180:183], v[136:139], v[112:127]
    v_mul_f32 v35, v35, v101
    v_mul_f32 v102, v54, v102
    v_exp_f32 v34, v34
    v_mul_f32 v103, v54, v103
    v_exp_f32 v35, v35
    v_fma_f32 v36, v102, v102, s91
    v_mfma_f32_32x32x16_bf16 v[112:127], a[188:191], v[140:143], v[112:127]
    s_waitcnt lgkmcnt(2)
    buffer_load_dwordx4 v[72:75], v1, s[20:23], s67 offen offset:1024 sc1
    v_add_f32 v34, 1.0, v34
    v_fma_f32 v37, v103, v103, s91
    v_add_f32 v35, 1.0, v35
    v_mul_f32 v36, v36, v102
    v_rcp_f32 v34, v34
    v_mul_f32 v37, v37, v103
    v_mfma_f32_32x32x16_bf16 v[112:127], a[196:199], v[144:147], v[112:127]
    v_rcp_f32 v35, v35
    v_exp_f32 v36, v36
    v_mul_f32 v34, v34, v100
    v_exp_f32 v37, v37
    v_mul_f32 v35, v35, v101
    v_mfma_f32_32x32x16_bf16 v[112:127], a[204:207], v[148:151], v[112:127]
    s_waitcnt lgkmcnt(0)
    buffer_load_dwordx4 v[76:79], v1, s[20:23], s68 offen offset:0 sc1
    v_add_f32 v36, 1.0, v36
    v_cvt_pk_bf16_f32 v98, v34, v35
    v_add_f32 v37, 1.0, v37
    v_mul_f32 v104, v54, v104
    v_rcp_f32 v36, v36
    v_mul_f32 v105, v54, v105
    v_mfma_f32_32x32x16_bf16 v[112:127], a[212:215], v[152:155], v[112:127]
    s_waitcnt vmcnt(7)
    buffer_store_dword v2, off, s[20:23], s89 offset:96 sc1
    v_rcp_f32 v37, v37
    v_fma_f32 v34, v104, v104, s91
    v_mul_f32 v36, v36, v102
    v_fma_f32 v35, v105, v105, s91
    v_mul_f32 v37, v37, v103
    v_mfma_f32_32x32x16_bf16 v[112:127], a[220:223], v[156:159], v[112:127]
    buffer_load_dwordx4 v[88:91], v1, s[20:23], s68 offen offset:1024 sc1
    v_mul_f32 v34, v34, v104
    v_cvt_pk_bf16_f32 v99, v36, v37
    v_mul_f32 v35, v35, v105
    v_mul_f32 v106, v54, v106
    v_exp_f32 v34, v34
    v_mul_f32 v107, v54, v107
    v_mfma_f32_32x32x16_bf16 v[112:127], v[58:61], v[60:63], v[112:127]
    v_exp_f32 v35, v35
    v_fma_f32 v36, v106, v106, s91
    v_add_f32 v34, 1.0, v34
    v_fma_f32 v37, v107, v107, s91
    v_add_f32 v35, 1.0, v35
    v_mfma_f32_32x32x16_bf16 v[128:143], a[224:227], v[64:67], 0
    buffer_store_dwordx4 v[96:99], v1, s[20:23], s92 offen offset:0 sc1
    v_mul_f32 v36, v36, v106
    v_rcp_f32 v34, v34
    v_mul_f32 v37, v37, v107
    v_rcp_f32 v35, v35
    v_mfma_f32_32x32x16_bf16 v[144:159], a[228:231], v[64:67], 0
    buffer_load_dwordx4 v[56:59], v1, s[20:23], s69 offen offset:0 sc1
    v_exp_f32 v36, v36
    v_mul_f32 v34, v34, v104
    v_exp_f32 v37, v37
    v_mul_f32 v35, v35, v105
    v_mfma_f32_32x32x16_bf16 v[128:143], a[232:235], v[68:71], v[128:143]
    v_add_f32 v36, 1.0, v36
    v_cvt_pk_bf16_f32 v100, v34, v35
    v_add_f32 v37, 1.0, v37
    v_mul_f32 v108, v54, v108
    v_rcp_f32 v36, v36
    v_mul_f32 v109, v54, v109
    v_mfma_f32_32x32x16_bf16 v[144:159], a[236:239], v[68:71], v[144:159]
    buffer_load_dwordx4 v[60:63], v1, s[20:23], s69 offen offset:1024 sc1
    v_rcp_f32 v37, v37
    v_fma_f32 v34, v108, v108, s91
    v_mul_f32 v36, v36, v106
    v_fma_f32 v35, v109, v109, s91
    v_mul_f32 v37, v37, v107
    v_mfma_f32_32x32x16_bf16 v[128:143], a[240:243], v[80:83], v[128:143]
    v_mul_f32 v34, v34, v108
    v_cvt_pk_bf16_f32 v101, v36, v37
    v_mul_f32 v35, v35, v109
    v_mul_f32 v110, v54, v110
    v_exp_f32 v34, v34
    v_mul_f32 v111, v54, v111
    v_mfma_f32_32x32x16_bf16 v[144:159], a[244:247], v[80:83], v[144:159]
    buffer_load_dwordx4 v[92:95], v1, s[20:23], s70 offen offset:0 sc1
    v_exp_f32 v35, v35
    v_fma_f32 v36, v110, v110, s91
    v_add_f32 v34, 1.0, v34
    v_fma_f32 v37, v111, v111, s91
    v_add_f32 v35, 1.0, v35
    v_mfma_f32_32x32x16_bf16 v[128:143], a[248:251], v[84:87], v[128:143]
    v_mul_f32 v36, v36, v110
    v_rcp_f32 v34, v34
    v_mul_f32 v37, v37, v111
    v_rcp_f32 v35, v35
    v_mul_f32 v34, v34, v108
    v_mfma_f32_32x32x16_bf16 v[144:159], a[252:255], v[84:87], v[144:159]
    s_waitcnt vmcnt(12)
    v_exp_f32 v36, v36
    v_exp_f32 v37, v37
    v_mul_f32 v35, v35, v109
    v_add_f32 v36, 1.0, v36
    v_cvt_pk_bf16_f32 v102, v34, v35
    v_mfma_f32_32x32x16_bf16 v[128:143], v[160:163], v[40:43], v[128:143]
    buffer_load_dword v0, v3, s[20:23], s88 offen offset:96 sc1
    v_add_f32 v37, 1.0, v37
    v_mul_f32 v112, v54, v112
    v_rcp_f32 v36, v36
    v_mul_f32 v113, v54, v113
    v_fma_f32 v34, v112, v112, s91
    v_mfma_f32_32x32x16_bf16 v[144:159], v[164:167], v[40:43], v[144:159]
    s_waitcnt vmcnt(10)
    buffer_load_dwordx4 v[40:43], v1, s[20:23], s70 offen offset:1024 sc1
    v_rcp_f32 v37, v37
    v_mul_f32 v36, v36, v110
    v_fma_f32 v35, v113, v113, s91
    v_mul_f32 v37, v37, v111
    v_mul_f32 v34, v34, v112
    v_mfma_f32_32x32x16_bf16 v[128:143], v[168:171], v[44:47], v[128:143]
    v_cvt_pk_bf16_f32 v103, v36, v37
    v_mul_f32 v35, v35, v113
    v_mul_f32 v114, v54, v114
    v_exp_f32 v34, v34
    v_mul_f32 v115, v54, v115
    v_fma_f32 v36, v114, v114, s91
    v_mfma_f32_32x32x16_bf16 v[144:159], v[172:175], v[44:47], v[144:159]
    s_waitcnt vmcnt(10)
    buffer_load_dwordx4 v[44:47], v1, s[20:23], s71 offen offset:0 sc1
    buffer_store_dwordx4 v[100:103], v1, s[20:23], s92 offen offset:1024 sc1
    v_exp_f32 v35, v35
    v_add_f32 v34, 1.0, v34
    v_fma_f32 v37, v115, v115, s91
    v_add_f32 v35, 1.0, v35
    v_mfma_f32_32x32x16_bf16 v[128:143], v[176:179], v[48:51], v[128:143]
    v_mul_f32 v36, v36, v114
    v_rcp_f32 v34, v34
    v_mul_f32 v37, v37, v115
    v_rcp_f32 v35, v35
    v_mul_f32 v34, v34, v112
    v_mfma_f32_32x32x16_bf16 v[144:159], v[180:183], v[48:51], v[144:159]
    s_waitcnt vmcnt(11)
    buffer_load_dwordx4 v[48:51], v1, s[20:23], s71 offen offset:1024 sc1
    v_exp_f32 v36, v36
    v_exp_f32 v37, v37
    v_mul_f32 v35, v35, v113
    v_add_f32 v36, 1.0, v36
    v_mfma_f32_32x32x16_bf16 v[128:143], v[184:187], v[72:75], v[128:143]
    v_cvt_pk_bf16_f32 v112, v34, v35
    v_add_f32 v37, 1.0, v37
    v_mul_f32 v116, v54, v116
    v_rcp_f32 v36, v36
    v_mul_f32 v117, v54, v117
    v_fma_f32 v34, v116, v116, s91
    v_mfma_f32_32x32x16_bf16 v[144:159], v[188:191], v[72:75], v[144:159]
    s_waitcnt vmcnt(11)
    v_rcp_f32 v37, v37
    v_mul_f32 v36, v36, v114
    v_fma_f32 v35, v117, v117, s91
    v_mul_f32 v37, v37, v115
    v_mul_f32 v34, v34, v116
    v_cvt_pk_bf16_f32 v113, v36, v37
    v_mfma_f32_32x32x16_bf16 v[128:143], v[192:195], v[76:79], v[128:143]
    v_mul_f32 v35, v35, v117
    v_mul_f32 v118, v54, v118
    v_exp_f32 v34, v34
    v_mul_f32 v119, v54, v119
    v_exp_f32 v35, v35
    v_mfma_f32_32x32x16_bf16 v[144:159], v[196:199], v[76:79], v[144:159]
    s_waitcnt vmcnt(9)
    v_fma_f32 v36, v118, v118, s91
    v_add_f32 v34, 1.0, v34
    v_fma_f32 v37, v119, v119, s91
    v_add_f32 v35, 1.0, v35
    v_mul_f32 v36, v36, v118
    v_rcp_f32 v34, v34
    v_mfma_f32_32x32x16_bf16 v[128:143], v[200:203], v[88:91], v[128:143]
    v_mul_f32 v37, v37, v119
    v_rcp_f32 v35, v35
    v_exp_f32 v36, v36
    v_mul_f32 v34, v34, v116
    v_mul_f32 v35, v35, v117
    v_mfma_f32_32x32x16_bf16 v[144:159], v[204:207], v[88:91], v[144:159]
    s_waitcnt vmcnt(4)
    v_cmp_ne_u32 vcc, s59, v0
    v_exp_f32 v37, v37
    v_add_f32 v36, 1.0, v36
    v_cvt_pk_bf16_f32 v114, v34, v35
    v_add_f32 v37, 1.0, v37
    v_mul_f32 v120, v54, v120
    v_mfma_f32_32x32x16_bf16 v[128:143], v[208:211], v[56:59], v[128:143]
    s_cbranch_vccnz Lrt_222
Lck_221:
    v_rcp_f32 v36, v36
    v_mul_f32 v121, v54, v121
    v_rcp_f32 v37, v37
    v_fma_f32 v34, v120, v120, s91
    v_mfma_f32_32x32x16_bf16 v[144:159], v[212:215], v[56:59], v[144:159]
    s_waitcnt vmcnt(0)
    buffer_load_dwordx4 v[56:59], v1, s[20:23], s66 offen offset:2048 sc1
    buffer_store_dword v2, off, s[20:23], s89 offset:128 sc1
    v_mul_f32 v36, v36, v118
    v_fma_f32 v35, v121, v121, s91
    v_mul_f32 v37, v37, v119
    v_mul_f32 v34, v34, v120
    v_cvt_pk_bf16_f32 v115, v36, v37
    v_mfma_f32_32x32x16_bf16 v[128:143], v[216:219], v[60:63], v[128:143]
    buffer_load_dwordx4 v[72:75], v1, s[20:23], s66 offen offset:3072 sc1
    buffer_store_dwordx4 v[112:115], v1, s[20:23], s92 offen offset:2048 sc1
    v_mul_f32 v35, v35, v121
    v_mul_f32 v122, v54, v122
    v_exp_f32 v34, v34
    v_mul_f32 v123, v54, v123
    v_mfma_f32_32x32x16_bf16 v[144:159], v[220:223], v[60:63], v[144:159]
    v_exp_f32 v35, v35
    v_fma_f32 v36, v122, v122, s91
    v_add_f32 v34, 1.0, v34
    v_fma_f32 v37, v123, v123, s91
    v_add_f32 v35, 1.0, v35
    v_mul_f32 v36, v36, v122
    v_mfma_f32_32x32x16_bf16 v[128:143], v[224:227], v[92:95], v[128:143]
    buffer_load_dwordx4 v[60:63], v1, s[20:23], s67 offen offset:2048 sc1
    v_rcp_f32 v34, v34
    v_mul_f32 v37, v37, v123
    v_rcp_f32 v35, v35
    v_mul_f32 v34, v34, v120
    v_mfma_f32_32x32x16_bf16 v[144:159], v[228:231], v[92:95], v[144:159]
    v_exp_f32 v36, v36
    v_exp_f32 v37, v37
    v_mul_f32 v35, v35, v121
    v_add_f32 v36, 1.0, v36
    v_cvt_pk_bf16_f32 v116, v34, v35
    v_mfma_f32_32x32x16_bf16 v[128:143], v[232:235], v[40:43], v[128:143]
    buffer_load_dwordx4 v[76:79], v1, s[20:23], s67 offen offset:3072 sc1
    v_add_f32 v37, 1.0, v37
    v_mul_f32 v124, v54, v124
    v_rcp_f32 v36, v36
    v_mul_f32 v125, v54, v125
    v_fma_f32 v34, v124, v124, s91
    v_mfma_f32_32x32x16_bf16 v[144:159], v[236:239], v[40:43], v[144:159]
    v_rcp_f32 v37, v37
    v_mul_f32 v36, v36, v122
    v_fma_f32 v35, v125, v125, s91
    v_mul_f32 v37, v37, v123
    v_mul_f32 v34, v34, v124
    v_cvt_pk_bf16_f32 v117, v36, v37
    v_mfma_f32_32x32x16_bf16 v[128:143], v[240:243], v[44:47], v[128:143]
    buffer_load_dwordx4 v[40:43], v1, s[20:23], s68 offen offset:2048 sc1
    ds_read_b64_tr_b16 v[64:65], v8 offset:16384
    ds_read_b64_tr_b16 v[66:67], v8 offset:17408
    v_mul_f32 v35, v35, v125
    v_mul_f32 v126, v54, v126
    v_exp_f32 v34, v34
    v_mfma_f32_32x32x16_bf16 v[144:159], v[244:247], v[44:47], v[144:159]
    ds_read_b64_tr_b16 v[68:69], v9 offset:16384
    ds_read_b64_tr_b16 v[70:71], v9 offset:17408
    v_mul_f32 v127, v54, v127
    v_exp_f32 v35, v35
    v_fma_f32 v36, v126, v126, s91
    v_add_f32 v34, 1.0, v34
    v_mfma_f32_32x32x16_bf16 v[128:143], v[248:251], v[48:51], v[128:143]
    buffer_load_dwordx4 v[44:47], v1, s[20:23], s68 offen offset:3072 sc1
    ds_read_b64_tr_b16 v[80:81], v8 offset:18432
    ds_read_b64_tr_b16 v[82:83], v8 offset:19456
    v_fma_f32 v37, v127, v127, s91
    v_add_f32 v35, 1.0, v35
    v_mul_f32 v36, v36, v126
    v_mul_f32 v37, v37, v127
    v_mfma_f32_32x32x16_bf16 v[144:159], v[252:255], v[48:51], v[144:159]
    s_waitcnt vmcnt(7) lgkmcnt(4)
    ds_read_b64_tr_b16 v[84:85], v9 offset:18432
    ds_read_b64_tr_b16 v[86:87], v9 offset:19456
    v_rcp_f32 v34, v34
    v_rcp_f32 v35, v35
    v_mul_f32 v34, v34, v124
    v_mfma_f32_32x32x16_bf16 v[128:143], v[64:67], v[56:59], v[128:143]
    s_waitcnt lgkmcnt(4)
    buffer_load_dwordx4 v[48:51], v1, s[20:23], s69 offen offset:2048 sc1
    ds_read_b64_tr_b16 v[64:65], v8 offset:20480
    ds_read_b64_tr_b16 v[66:67], v8 offset:21504
    v_exp_f32 v36, v36
    v_mul_f32 v35, v35, v125
    v_mfma_f32_32x32x16_bf16 v[144:159], v[68:71], v[56:59], v[144:159]
    s_waitcnt vmcnt(6) lgkmcnt(4)
    ds_read_b64_tr_b16 v[68:69], v9 offset:20480
    ds_read_b64_tr_b16 v[70:71], v9 offset:21504
    v_exp_f32 v37, v37
    v_add_f32 v36, 1.0, v36
    v_cvt_pk_bf16_f32 v118, v34, v35
    v_mfma_f32_32x32x16_bf16 v[128:143], v[80:83], v[72:75], v[128:143]
    s_waitcnt lgkmcnt(4)
    buffer_load_dwordx4 v[56:59], v1, s[20:23], s69 offen offset:3072 sc1
    ds_read_b64_tr_b16 v[80:81], v8 offset:22528
    ds_read_b64_tr_b16 v[82:83], v8 offset:23552
    buffer_load_dword v0, v3, s[20:23], s88 offen offset:128 sc1
    v_add_f32 v37, 1.0, v37
    v_mfma_f32_32x32x16_bf16 v[144:159], v[84:87], v[72:75], v[144:159]
    s_waitcnt vmcnt(6) lgkmcnt(4)
    ds_read_b64_tr_b16 v[84:85], v9 offset:22528
    ds_read_b64_tr_b16 v[86:87], v9 offset:23552
    v_rcp_f32 v36, v36
    v_rcp_f32 v37, v37
    v_mfma_f32_32x32x16_bf16 v[128:143], v[64:67], v[60:63], v[128:143]
    s_waitcnt lgkmcnt(4)
    buffer_load_dwordx4 v[72:75], v1, s[20:23], s70 offen offset:2048 sc1
    ds_read_b64_tr_b16 v[64:65], v8 offset:0
    ds_read_b64_tr_b16 v[66:67], v8 offset:1024
    v_mul_f32 v36, v36, v126
    v_mul_f32 v37, v37, v127
    v_cvt_pk_bf16_f32 v119, v36, v37
    v_mfma_f32_32x32x16_bf16 v[144:159], v[68:71], v[60:63], v[144:159]
    s_waitcnt vmcnt(6) lgkmcnt(4)
    ds_read_b64_tr_b16 v[68:69], v9 offset:0
    ds_read_b64_tr_b16 v[70:71], v9 offset:1024
    buffer_store_dwordx4 v[116:119], v1, s[20:23], s92 offen offset:3072 sc1
    v_mfma_f32_32x32x16_bf16 v[128:143], v[80:83], v[76:79], v[128:143]
    s_waitcnt lgkmcnt(4)
    buffer_load_dwordx4 v[60:63], v1, s[20:23], s70 offen offset:3072 sc1
    ds_read_b64_tr_b16 v[80:81], v8 offset:2048
    ds_read_b64_tr_b16 v[82:83], v8 offset:3072
    v_mfma_f32_32x32x16_bf16 v[144:159], v[84:87], v[76:79], v[144:159]
    s_waitcnt vmcnt(7) lgkmcnt(4)
    buffer_load_dwordx4 v[76:79], v1, s[20:23], s71 offen offset:2048 sc1
    ds_read_b64_tr_b16 v[84:85], v9 offset:2048
    ds_read_b64_tr_b16 v[86:87], v9 offset:3072
    v_mfma_f32_32x32x16_bf16 v[128:143], v[64:67], v[40:43], v[128:143]
    s_waitcnt lgkmcnt(4)
    buffer_load_dwordx4 v[88:91], v1, s[20:23], s71 offen offset:3072 sc1
    ds_read_b64_tr_b16 v[64:65], v8 offset:4096
    ds_read_b64_tr_b16 v[66:67], v8 offset:5120
    v_mfma_f32_32x32x16_bf16 v[144:159], v[68:71], v[40:43], v[144:159]
    s_waitcnt vmcnt(8) lgkmcnt(4)
    s_add_u32 s66, s66, 5767168
    s_add_u32 s67, s67, 5767168
    ds_read_b64_tr_b16 v[68:69], v9 offset:4096
    ds_read_b64_tr_b16 v[70:71], v9 offset:5120
    v_mfma_f32_32x32x16_bf16 v[128:143], v[80:83], v[44:47], v[128:143]
    s_waitcnt lgkmcnt(4)
    s_add_u32 s68, s68, 5767168
    s_add_u32 s69, s69, 5767168
    ds_read_b64_tr_b16 v[80:81], v8 offset:6144
    ds_read_b64_tr_b16 v[82:83], v8 offset:7168
    v_mfma_f32_32x32x16_bf16 v[144:159], v[84:87], v[44:47], v[144:159]
    s_waitcnt vmcnt(7) lgkmcnt(4)
    s_add_u32 s70, s70, 5767168
    s_add_u32 s71, s71, 5767168
    ds_read_b64_tr_b16 v[84:85], v9 offset:6144
    ds_read_b64_tr_b16 v[86:87], v9 offset:7168
    v_mfma_f32_32x32x16_bf16 v[128:143], v[64:67], v[48:51], v[128:143]
    s_waitcnt lgkmcnt(4)
    ds_read_b64_tr_b16 v[64:65], v8 offset:8192
    ds_read_b64_tr_b16 v[66:67], v8 offset:9216
    v_mfma_f32_32x32x16_bf16 v[144:159], v[68:71], v[48:51], v[144:159]
    s_waitcnt vmcnt(5) lgkmcnt(4)
    ds_read_b64_tr_b16 v[68:69], v9 offset:8192
    ds_read_b64_tr_b16 v[70:71], v9 offset:9216
    v_cmp_ne_u32 vcc, s59, v0
    v_mfma_f32_32x32x16_bf16 v[128:143], v[80:83], v[56:59], v[128:143]
    s_waitcnt lgkmcnt(4)
    ds_read_b64_tr_b16 v[80:81], v8 offset:10240
    ds_read_b64_tr_b16 v[82:83], v8 offset:11264
    s_cbranch_vccnz Lrt_224
Lck_223:
    v_mfma_f32_32x32x16_bf16 v[144:159], v[84:87], v[56:59], v[144:159]
    s_waitcnt vmcnt(4) lgkmcnt(4)
    buffer_load_dwordx4 v[40:43], v1, s[20:23], s66 offen offset:0 sc1
    ds_read_b64_tr_b16 v[84:85], v8 offset:12288
    ds_read_b64_tr_b16 v[86:87], v8 offset:13312
    v_mov_b32 v0, -1
    v_mfma_f32_32x32x16_bf16 v[128:143], v[64:67], v[72:75], v[128:143]
    s_waitcnt lgkmcnt(4)
    buffer_store_dword v0, v1, s[20:23], s65 offen offset:0 sc1
    ds_read_b64_tr_b16 v[64:65], v8 offset:14336
    ds_read_b64_tr_b16 v[66:67], v8 offset:15360
    v_mfma_f32_32x32x16_bf16 v[144:159], v[68:71], v[72:75], v[144:159]
    s_waitcnt vmcnt(4) lgkmcnt(4)
    buffer_load_dwordx4 v[44:47], v1, s[20:23], s66 offen offset:1024 sc1
    buffer_store_dword v0, v1, s[20:23], s65 offen offset:1024 sc1
    ds_read_b64_tr_b16 v[68:69], v9 offset:10240
    ds_read_b64_tr_b16 v[70:71], v9 offset:11264
    buffer_store_dword v2, off, s[20:23], s89 offset:160 sc1
    v_mfma_f32_32x32x16_bf16 v[128:143], v[80:83], v[60:63], v[128:143]
    s_waitcnt vmcnt(6) lgkmcnt(4)
    ds_read_b64_tr_b16 v[80:81], v9 offset:12288
    ds_read_b64_tr_b16 v[82:83], v9 offset:13312
    v_mfma_f32_32x32x16_bf16 v[128:143], v[84:87], v[76:79], v[128:143]
    s_waitcnt vmcnt(5) lgkmcnt(4)
    buffer_load_dwordx4 v[48:51], v1, s[20:23], s67 offen offset:0 sc1
    ds_read_b64_tr_b16 v[84:85], v9 offset:14336
    ds_read_b64_tr_b16 v[86:87], v9 offset:15360
    v_mfma_f32_32x32x16_bf16 v[128:143], v[64:67], v[88:91], v[128:143]
    s_waitcnt lgkmcnt(4)
    v_mfma_f32_32x32x16_bf16 v[144:159], v[68:71], v[60:63], v[144:159]
    s_waitcnt lgkmcnt(2)
    buffer_load_dwordx4 v[52:55], v1, s[20:23], s67 offen offset:1024 sc1
    v_mfma_f32_32x32x16_bf16 v[144:159], v[80:83], v[76:79], v[144:159]
    s_waitcnt lgkmcnt(0)
    v_add_u32 v38, s87, v1
    v_mfma_f32_32x32x16_bf16 v[144:159], v[84:87], v[88:91], v[144:159]
    buffer_load_dwordx4 v[56:59], v1, s[20:23], s68 offen offset:0 sc1
    s_nop 2
    v_cvt_pk_f16_f32 v128, v128, v129
    v_cvt_pk_f16_f32 v129, v130, v131
    v_cvt_pk_f16_f32 v130, v132, v133
    v_cvt_pk_f16_f32 v131, v134, v135
    v_cvt_pk_f16_f32 v136, v136, v137
    v_mfma_f32_32x32x16_bf16 v[64:79], a[224:227], v[96:99], 0
    v_cvt_pk_f16_f32 v137, v138, v139
    v_mfma_f32_32x32x16_bf16 v[80:95], a[228:231], v[96:99], 0
    buffer_load_dwordx4 v[60:63], v1, s[20:23], s68 offen offset:1024 sc1
    ds_write_b128 v6, v[128:131] offset:0
    v_cvt_pk_f16_f32 v138, v140, v141
    v_cvt_pk_f16_f32 v139, v142, v143
    v_mfma_f32_32x32x16_bf16 v[64:79], a[232:235], v[100:103], v[64:79]
    ds_write_b128 v6, v[136:139] offset:128
    v_cvt_pk_f16_f32 v144, v144, v145
    v_cvt_pk_f16_f32 v145, v146, v147
    v_cvt_pk_f16_f32 v146, v148, v149
    v_cvt_pk_f16_f32 v147, v150, v151
    v_cvt_pk_f16_f32 v152, v152, v153
    v_mfma_f32_32x32x16_bf16 v[80:95], a[236:239], v[100:103], v[80:95]
    buffer_load_dwordx4 v[104:107], v1, s[20:23], s69 offen offset:0 sc1
    v_cvt_pk_f16_f32 v153, v154, v155
    v_mfma_f32_32x32x16_bf16 v[64:79], a[240:243], v[112:115], v[64:79]
    ds_write_b128 v6, v[144:147] offset:512
    v_cvt_pk_f16_f32 v154, v156, v157
    v_cvt_pk_f16_f32 v155, v158, v159
    v_mfma_f32_32x32x16_bf16 v[80:95], a[244:247], v[112:115], v[80:95]
    buffer_load_dwordx4 v[108:111], v1, s[20:23], s69 offen offset:1024 sc1
    ds_write_b128 v6, v[152:155] offset:640
    v_mfma_f32_32x32x16_bf16 v[64:79], a[248:251], v[116:119], v[64:79]
    v_mfma_f32_32x32x16_bf16 v[80:95], a[252:255], v[116:119], v[80:95]
    s_waitcnt vmcnt(10) lgkmcnt(0)
    buffer_load_dwordx4 v[120:123], v1, s[20:23], s70 offen offset:0 sc1
    s_barrier
    ds_read_b128 v[144:147], v38 offset:0
    ds_read_b128 v[148:151], v38 offset:1024
    ds_read_b128 v[152:155], v38 offset:2048
    ds_read_b128 v[156:159], v38 offset:3072
    v_mfma_f32_32x32x16_bf16 v[64:79], v[160:163], v[40:43], v[64:79]
    buffer_load_dword v0, v3, s[20:23], s88 offen offset:160 sc1
    v_mfma_f32_32x32x16_bf16 v[80:95], v[164:167], v[40:43], v[80:95]
    s_waitcnt vmcnt(10)
    buffer_load_dwordx4 v[40:43], v1, s[20:23], s70 offen offset:1024 sc1
    v_mfma_f32_32x32x16_bf16 v[64:79], v[168:171], v[44:47], v[64:79]
    s_waitcnt lgkmcnt(2)
    v_pk_add_f16 v144, v144, v148
    v_pk_add_f16 v145, v145, v149
    v_pk_add_f16 v146, v146, v150
    v_pk_add_f16 v147, v147, v151
    v_mfma_f32_32x32x16_bf16 v[80:95], v[172:175], v[44:47], v[80:95]
    s_waitcnt vmcnt(8) lgkmcnt(0)
    buffer_load_dwordx4 v[44:47], v1, s[20:23], s71 offen offset:0 sc1
    v_pk_add_f16 v152, v152, v156
    v_pk_add_f16 v153, v153, v157
    v_pk_add_f16 v154, v154, v158
    v_pk_add_f16 v155, v155, v159
    v_pk_add_f16 v144, v144, v152
    v_pk_add_f16 v145, v145, v153
    v_mfma_f32_32x32x16_bf16 v[64:79], v[176:179], v[48:51], v[64:79]
    v_pk_add_f16 v146, v146, v154
    v_pk_add_f16 v147, v147, v155
    v_fma_mix_f32 v10, v144, s80, v10 op_sel:[0,0,0] op_sel_hi:[1,0,0]
    v_fma_mix_f32 v11, v144, s80, v11 op_sel:[1,0,0] op_sel_hi:[1,0,0]
    v_fma_mix_f32 v12, v145, s80, v12 op_sel:[0,0,0] op_sel_hi:[1,0,0]
    v_fma_mix_f32 v13, v145, s80, v13 op_sel:[1,0,0] op_sel_hi:[1,0,0]
    v_mfma_f32_32x32x16_bf16 v[80:95], v[180:183], v[48:51], v[80:95]
    s_waitcnt vmcnt(8)
    buffer_load_dwordx4 v[48:51], v1, s[20:23], s71 offen offset:1024 sc1
    v_fma_mix_f32 v14, v146, s80, v14 op_sel:[0,0,0] op_sel_hi:[1,0,0]
    v_fma_mix_f32 v15, v146, s80, v15 op_sel:[1,0,0] op_sel_hi:[1,0,0]
    v_fma_mix_f32 v16, v147, s80, v16 op_sel:[0,0,0] op_sel_hi:[1,0,0]
    v_fma_mix_f32 v17, v147, s80, v17 op_sel:[1,0,0] op_sel_hi:[1,0,0]
    v_mul_f32 v138, v10, v10
    v_mfma_f32_32x32x16_bf16 v[64:79], v[184:187], v[52:55], v[64:79]
    v_add_f32 v136, v10, v11
    v_fmac_f32 v138, v11, v11
    v_add_f32 v136, v136, v12
    v_fmac_f32 v138, v12, v12
    v_add_f32 v136, v136, v13
    v_fmac_f32 v138, v13, v13
    v_add_f32 v136, v136, v14
    v_mfma_f32_32x32x16_bf16 v[80:95], v[188:191], v[52:55], v[80:95]
    s_waitcnt vmcnt(8)
    v_fmac_f32 v138, v14, v14
    v_add_f32 v136, v136, v15
    v_fmac_f32 v138, v15, v15
    v_add_f32 v136, v136, v16
    v_fmac_f32 v138, v16, v16
    v_add_f32 v136, v136, v17
    v_fmac_f32 v138, v17, v17
    v_mfma_f32_32x32x16_bf16 v[64:79], v[192:195], v[56:59], v[64:79]
    v_and_b32 v140, s86, v1
    v_xor_b32 v137, 2147483648, v2
    v_permlane32_swap_b32 v136, v138
    v_add_f32 v136, v136, v138
    v_mov_b32 v139, v136
    v_lshlrev_b32 v128, 16, v26
    v_mfma_f32_32x32x16_bf16 v[80:95], v[196:199], v[56:59], v[80:95]
    s_waitcnt vmcnt(7)
    v_lshlrev_b32 v129, 16, v27
    v_permlane16_swap_b32 v136, v139
    v_add_f32 v136, v136, v139
    v_lshlrev_b32 v130, 16, v28
    v_lshlrev_b32 v131, 16, v29
    v_add_f32_dpp v136, v136, v136 row_ror:8 row_mask:0xf bank_mask:0xf
    v_mfma_f32_32x32x16_bf16 v[64:79], v[200:203], v[60:63], v[64:79]
    buffer_store_dwordx2 v[136:137], v140, s[20:23], s99 offen offset:0 sc1
    v_mfma_f32_32x32x16_bf16 v[80:95], v[204:207], v[60:63], v[80:95]
    s_waitcnt vmcnt(4)
    v_cmp_ne_u32 vcc, s59, v0
    v_mfma_f32_32x32x16_bf16 v[64:79], v[208:211], v[104:107], v[64:79]
    s_cbranch_vccnz Lrt_226
Lck_225:
    v_mfma_f32_32x32x16_bf16 v[80:95], v[212:215], v[104:107], v[80:95]
    buffer_load_dwordx4 v[52:55], v1, s[20:23], s66 offen offset:2048 sc1
    v_mfma_f32_32x32x16_bf16 v[64:79], v[216:219], v[108:111], v[64:79]
    buffer_load_dwordx4 v[56:59], v1, s[20:23], s66 offen offset:3072 sc1
    v_mfma_f32_32x32x16_bf16 v[80:95], v[220:223], v[108:111], v[80:95]
    v_mfma_f32_32x32x16_bf16 v[64:79], v[224:227], v[120:123], v[64:79]
    buffer_load_dwordx4 v[60:63], v1, s[20:23], s67 offen offset:2048 sc1
    v_mfma_f32_32x32x16_bf16 v[80:95], v[228:231], v[120:123], v[80:95]
    s_waitcnt vmcnt(6)
    v_mfma_f32_32x32x16_bf16 v[64:79], v[232:235], v[40:43], v[64:79]
    buffer_load_dwordx4 v[104:107], v1, s[20:23], s67 offen offset:3072 sc1
    v_mfma_f32_32x32x16_bf16 v[80:95], v[236:239], v[40:43], v[80:95]
    s_waitcnt vmcnt(6)
    buffer_load_dwordx2 v[144:145], v1, s[20:23], s98 offen offset:0 sc1
    buffer_load_dwordx2 v[146:147], v1, s[20:23], s98 offen offset:1024 sc1
    v_mfma_f32_32x32x16_bf16 v[64:79], v[240:243], v[44:47], v[64:79]
    buffer_load_dwordx4 v[40:43], v1, s[20:23], s68 offen offset:2048 sc1
    ds_read_b64_tr_b16 v[96:97], v8 offset:16384
    ds_read_b64_tr_b16 v[98:99], v8 offset:17408
    v_mfma_f32_32x32x16_bf16 v[80:95], v[244:247], v[44:47], v[80:95]
    s_waitcnt vmcnt(8)
    ds_read_b64_tr_b16 v[100:101], v9 offset:16384
    ds_read_b64_tr_b16 v[102:103], v9 offset:17408
    v_mfma_f32_32x32x16_bf16 v[64:79], v[248:251], v[48:51], v[64:79]
    buffer_load_dwordx4 v[44:47], v1, s[20:23], s68 offen offset:3072 sc1
    ds_read_b64_tr_b16 v[112:113], v8 offset:18432
    ds_read_b64_tr_b16 v[114:115], v8 offset:19456
    v_mfma_f32_32x32x16_bf16 v[80:95], v[252:255], v[48:51], v[80:95]
    s_waitcnt vmcnt(7) lgkmcnt(4)
    ds_read_b64_tr_b16 v[116:117], v9 offset:18432
    ds_read_b64_tr_b16 v[118:119], v9 offset:19456
    v_mfma_f32_32x32x16_bf16 v[64:79], v[96:99], v[52:55], v[64:79]
    s_waitcnt lgkmcnt(4)
    buffer_load_dwordx4 v[48:51], v1, s[20:23], s69 offen offset:2048 sc1
    ds_read_b64_tr_b16 v[96:97], v8 offset:20480
    ds_read_b64_tr_b16 v[98:99], v8 offset:21504
    v_mfma_f32_32x32x16_bf16 v[80:95], v[100:103], v[52:55], v[80:95]
    s_waitcnt vmcnt(7) lgkmcnt(4)
    ds_read_b64_tr_b16 v[100:101], v9 offset:20480
    ds_read_b64_tr_b16 v[102:103], v9 offset:21504
    v_mfma_f32_32x32x16_bf16 v[64:79], v[112:115], v[56:59], v[64:79]
    s_waitcnt lgkmcnt(4)
    buffer_load_dwordx4 v[52:55], v1, s[20:23], s69 offen offset:3072 sc1
    ds_read_b64_tr_b16 v[112:113], v8 offset:22528
    ds_read_b64_tr_b16 v[114:115], v8 offset:23552
    v_mfma_f32_32x32x16_bf16 v[80:95], v[116:119], v[56:59], v[80:95]
    s_waitcnt vmcnt(7) lgkmcnt(4)
    ds_read_b64_tr_b16 v[116:117], v9 offset:22528
    ds_read_b64_tr_b16 v[118:119], v9 offset:23552
    v_mfma_f32_32x32x16_bf16 v[64:79], v[96:99], v[60:63], v[64:79]
    s_waitcnt vmcnt(4) lgkmcnt(4)
    buffer_load_dwordx4 v[56:59], v1, s[20:23], s70 offen offset:2048 sc1
    ds_read_b64_tr_b16 v[96:97], v8 offset:0
    ds_read_b64_tr_b16 v[98:99], v8 offset:1024
    v_bitop3_b32 v148, v145, v147, s83 bitop3:0x7e
    v_cmp_ne_u32 vcc, 0, v148
    v_mfma_f32_32x32x16_bf16 v[80:95], v[100:103], v[60:63], v[80:95]
    s_waitcnt lgkmcnt(4)
    ds_read_b64_tr_b16 v[100:101], v9 offset:0
    ds_read_b64_tr_b16 v[102:103], v9 offset:1024
    s_cbranch_vccnz Lrt_228
Lck_227:
    v_add_f32_dpp v144, v146, v144 quad_perm:[0,1,2,3] row_mask:0xf bank_mask:0x3
    v_lshlrev_b32 v132, 16, v30
    v_lshlrev_b32 v133, 16, v31
    v_add_f32_dpp v144, v146, v144 quad_perm:[0,1,2,3] row_mask:0x5 bank_mask:0xc
    v_mfma_f32_32x32x16_bf16 v[64:79], v[112:115], v[104:107], v[64:79]
    s_waitcnt lgkmcnt(4)
    buffer_load_dwordx4 v[60:63], v1, s[20:23], s70 offen offset:3072 sc1
    ds_read_b64_tr_b16 v[112:113], v8 offset:2048
    ds_read_b64_tr_b16 v[114:115], v8 offset:3072
    v_lshlrev_b32 v134, 16, v32
    v_lshlrev_b32 v135, 16, v33
    v_add_f32_dpp v144, v144, v144 row_ror:8 row_mask:0xf bank_mask:0xf
    v_mov_b32 v148, v144
    v_mfma_f32_32x32x16_bf16 v[80:95], v[116:119], v[104:107], v[80:95]
    s_waitcnt vmcnt(5) lgkmcnt(4)
    buffer_load_dwordx4 v[104:107], v1, s[20:23], s71 offen offset:2048 sc1
    ds_read_b64_tr_b16 v[116:117], v9 offset:2048
    ds_read_b64_tr_b16 v[118:119], v9 offset:3072
    v_xor_b32 v141, s90, v1
    v_xor_b32 v143, s90, v38
    v_permlane16_swap_b32 v144, v148
    v_mfma_f32_32x32x16_bf16 v[64:79], v[96:99], v[40:43], v[64:79]
    s_waitcnt lgkmcnt(4)
    buffer_load_dwordx4 v[108:111], v1, s[20:23], s71 offen offset:3072 sc1
    ds_read_b64_tr_b16 v[96:97], v8 offset:4096
    ds_read_b64_tr_b16 v[98:99], v8 offset:5120
    v_add_f32 v144, v144, v148
    v_mov_b32 v148, v144
    v_lshrrev_b32 v142, 7, v1
    v_lshl_add_u32 v142, v142, 5, s93
    v_mfma_f32_32x32x16_bf16 v[80:95], v[100:103], v[40:43], v[80:95]
    s_waitcnt vmcnt(6) lgkmcnt(4)
    ds_read_b64_tr_b16 v[100:101], v9 offset:4096
    ds_read_b64_tr_b16 v[102:103], v9 offset:5120
    v_permlane32_swap_b32 v144, v148
    v_mul_f32 v149, 0xbb124925, v144
    v_fmaak_f32 v150, v149, v149, 0xb727c5ac
    v_fmac_f32 v150, 0xbb124925, v148
    v_mfma_f32_32x32x16_bf16 v[64:79], v[112:115], v[44:47], v[64:79]
    s_waitcnt lgkmcnt(4)
    ds_read_b64_tr_b16 v[112:113], v8 offset:6144
    ds_read_b64_tr_b16 v[114:115], v8 offset:7168
    v_rsq_f32_e64 v150, |v150|
    s_add_u32 s64, s65, 0
    v_mul_f32 v149, v149, v150
    v_fma_f32 v152, v10, v150, v149
    v_mfma_f32_32x32x16_bf16 v[80:95], v[116:119], v[44:47], v[80:95]
    s_waitcnt vmcnt(5) lgkmcnt(4)
    ds_read_b64_tr_b16 v[116:117], v9 offset:6144
    ds_read_b64_tr_b16 v[118:119], v9 offset:7168
    v_fma_f32 v153, v11, v150, v149
    v_fmac_f32 v10, v152, v128
    v_fmac_f32 v11, v153, v129
    v_fma_f32 v152, v12, v150, v149
    v_fma_f32 v153, v13, v150, v149
    v_mfma_f32_32x32x16_bf16 v[64:79], v[96:99], v[48:51], v[64:79]
    s_waitcnt lgkmcnt(4)
    ds_read_b64_tr_b16 v[96:97], v8 offset:8192
    ds_read_b64_tr_b16 v[98:99], v8 offset:9216
    v_cvt_pk_bf16_f32 v156, v10, v11
    v_fmac_f32 v12, v152, v130
    v_fmac_f32 v13, v153, v131
    v_fma_f32 v152, v14, v150, v149
    v_fma_f32 v153, v15, v150, v149
    v_mfma_f32_32x32x16_bf16 v[80:95], v[100:103], v[48:51], v[80:95]
    s_waitcnt vmcnt(4) lgkmcnt(4)
    ds_read_b64_tr_b16 v[100:101], v9 offset:8192
    ds_read_b64_tr_b16 v[102:103], v9 offset:9216
    v_cvt_pk_bf16_f32 v157, v12, v13
    v_fmac_f32 v14, v152, v132
    v_fmac_f32 v15, v153, v133
    v_fma_f32 v152, v16, v150, v149
    v_fma_f32 v153, v17, v150, v149
    v_mfma_f32_32x32x16_bf16 v[64:79], v[112:115], v[52:55], v[64:79]
    s_waitcnt lgkmcnt(4)
    ds_read_b64_tr_b16 v[112:113], v8 offset:10240
    ds_read_b64_tr_b16 v[114:115], v8 offset:11264
    v_cvt_pk_bf16_f32 v158, v14, v15
    v_fmac_f32 v16, v152, v134
    v_fmac_f32 v17, v153, v135
    v_cvt_pk_bf16_f32 v159, v16, v17
    v_mfma_f32_32x32x16_bf16 v[80:95], v[116:119], v[52:55], v[80:95]
    s_waitcnt vmcnt(3) lgkmcnt(4)
    ds_read_b64_tr_b16 v[116:117], v8 offset:12288
    ds_read_b64_tr_b16 v[118:119], v8 offset:13312
    buffer_store_dwordx4 v[156:159], v141, s[20:23], s64 offen sc1
    ds_write_b128 v143, v[156:159] offset:0
    ds_read_b128 v[144:147], v142 offset:0
    ds_read_b128 v[148:151], v142 offset:16
    v_mul_f32 v138, v10, v10
    v_mfma_f32_32x32x16_bf16 v[64:79], v[96:99], v[56:59], v[64:79]
    s_waitcnt lgkmcnt(7)
    ds_read_b64_tr_b16 v[96:97], v8 offset:14336
    ds_read_b64_tr_b16 v[98:99], v8 offset:15360
    v_add_f32 v136, v10, v11
    v_fmac_f32 v138, v11, v11
    v_add_f32 v136, v136, v12
    v_fmac_f32 v138, v12, v12
    v_add_f32 v136, v136, v13
    v_mfma_f32_32x32x16_bf16 v[80:95], v[100:103], v[56:59], v[80:95]
    s_waitcnt vmcnt(3) lgkmcnt(7)
    ds_read_b64_tr_b16 v[100:101], v9 offset:10240
    ds_read_b64_tr_b16 v[102:103], v9 offset:11264
    v_fmac_f32 v138, v13, v13
    v_add_f32 v136, v136, v14
    v_fmac_f32 v138, v14, v14
    v_add_f32 v136, v136, v15
    v_fmac_f32 v138, v15, v15
    v_mfma_f32_32x32x16_bf16 v[64:79], v[112:115], v[60:63], v[64:79]
    s_waitcnt vmcnt(2) lgkmcnt(7)
    ds_read_b64_tr_b16 v[112:113], v9 offset:12288
    ds_read_b64_tr_b16 v[114:115], v9 offset:13312
    v_add_f32 v136, v136, v16
    v_fmac_f32 v138, v16, v16
    v_add_f32 v136, v136, v17
    v_fmac_f32 v138, v17, v17
    v_mfma_f32_32x32x16_bf16 v[64:79], v[116:119], v[104:107], v[64:79]
    s_waitcnt vmcnt(1) lgkmcnt(4)
    ds_read_b64_tr_b16 v[116:117], v9 offset:14336
    ds_read_b64_tr_b16 v[118:119], v9 offset:15360
    v_permlane32_swap_b32 v136, v138
    v_add_f32 v136, v136, v138
    v_mov_b32 v139, v136
    v_mfma_f32_32x32x16_bf16 v[64:79], v[96:99], v[108:111], v[64:79]
    s_waitcnt lgkmcnt(4)
    v_permlane16_swap_b32 v136, v139
    v_add_f32 v136, v136, v139
    s_nop 1
    v_add_f32_dpp v136, v136, v136 row_ror:8 row_mask:0xf bank_mask:0xf
    v_mfma_f32_32x32x16_bf16 v[80:95], v[100:103], v[60:63], v[80:95]
    s_waitcnt lgkmcnt(2)
    buffer_store_dwordx2 v[136:137], v140, s[20:23], s99 offen offset:2048 sc1
    v_add_f32 v10, v10, v144
    v_add_f32 v11, v11, v145
    v_add_f32 v12, v12, v146
    v_add_f32 v13, v13, v147
    v_add_f32 v14, v14, v148
    v_add_f32 v15, v15, v149
    v_mfma_f32_32x32x16_bf16 v[80:95], v[112:115], v[104:107], v[80:95]
    s_waitcnt lgkmcnt(0)
    v_add_f32 v16, v16, v150
    v_add_f32 v17, v17, v151
    v_mfma_f32_32x32x16_bf16 v[80:95], v[116:119], v[108:111], v[80:95]
    v_cvt_pk_f16_f32 v64, v64, v65
    v_cvt_pk_f16_f32 v65, v66, v67
    v_cvt_pk_f16_f32 v66, v68, v69
    v_cvt_pk_f16_f32 v67, v70, v71
    v_cvt_pk_f16_f32 v72, v72, v73
    v_cvt_pk_f16_f32 v73, v74, v75
    ds_write_b128 v6, v[64:67] offset:8192
    v_cvt_pk_f16_f32 v74, v76, v77
    v_cvt_pk_f16_f32 v75, v78, v79
    ds_write_b128 v6, v[72:75] offset:8320
    s_nop 1
    v_cvt_pk_f16_f32 v80, v80, v81
    v_cvt_pk_f16_f32 v81, v82, v83
    v_cvt_pk_f16_f32 v82, v84, v85
    v_cvt_pk_f16_f32 v83, v86, v87
    v_cvt_pk_f16_f32 v88, v88, v89
    v_cvt_pk_f16_f32 v89, v90, v91
    ds_write_b128 v6, v[80:83] offset:8704
    v_cvt_pk_f16_f32 v90, v92, v93
    v_cvt_pk_f16_f32 v91, v94, v95
    ds_write_b128 v6, v[88:91] offset:8832
    s_waitcnt lgkmcnt(0)
    s_barrier
    ds_read_b128 v[80:83], v38 offset:8192
    ds_read_b128 v[84:87], v38 offset:9216
    ds_read_b128 v[88:91], v38 offset:10240
    ds_read_b128 v[92:95], v38 offset:11264
    s_waitcnt lgkmcnt(2)
    v_pk_add_f16 v80, v80, v84
    v_pk_add_f16 v81, v81, v85
    v_pk_add_f16 v82, v82, v86
    v_pk_add_f16 v83, v83, v87
    s_waitcnt lgkmcnt(0)
    v_pk_add_f16 v88, v88, v92
    v_pk_add_f16 v89, v89, v93
    v_pk_add_f16 v90, v90, v94
    v_pk_add_f16 v91, v91, v95
    v_pk_add_f16 v80, v80, v88
    v_pk_add_f16 v81, v81, v89
    v_pk_add_f16 v82, v82, v90
    v_pk_add_f16 v83, v83, v91
    v_fma_mix_f32 v18, v80, s80, v18 op_sel:[0,0,0] op_sel_hi:[1,0,0]
    v_fma_mix_f32 v19, v80, s80, v19 op_sel:[1,0,0] op_sel_hi:[1,0,0]
    v_fma_mix_f32 v20, v81, s80, v20 op_sel:[0,0,0] op_sel_hi:[1,0,0]
    v_fma_mix_f32 v21, v81, s80, v21 op_sel:[1,0,0] op_sel_hi:[1,0,0]
    v_fma_mix_f32 v22, v82, s80, v22 op_sel:[0,0,0] op_sel_hi:[1,0,0]
    v_fma_mix_f32 v23, v82, s80, v23 op_sel:[1,0,0] op_sel_hi:[1,0,0]
    v_fma_mix_f32 v24, v83, s80, v24 op_sel:[0,0,0] op_sel_hi:[1,0,0]
    v_fma_mix_f32 v25, v83, s80, v25 op_sel:[1,0,0] op_sel_hi:[1,0,0]
    v_pk_add_f32 v[88:89], v[18:19], v[20:21]
    v_pk_mul_f32 v[90:91], v[18:19], v[18:19]
    v_pk_fma_f32 v[90:91], v[20:21], v[20:21], v[90:91]
    v_pk_add_f32 v[88:89], v[88:89], v[22:23]
    v_pk_fma_f32 v[90:91], v[22:23], v[22:23], v[90:91]
    v_pk_add_f32 v[88:89], v[88:89], v[24:25]
    v_pk_fma_f32 v[90:91], v[24:25], v[24:25], v[90:91]
    v_add_f32 v72, v88, v89
    v_add_f32 v74, v90, v91
    v_and_b32 v76, s86, v1
    v_xor_b32 v73, 2147483648, v2
    v_permlane32_swap_b32 v72, v74
    v_add_f32 v72, v72, v74
    v_mov_b32 v75, v72
    v_and_b32 v64, s60, v26
    v_and_b32 v65, s60, v27
    v_permlane16_swap_b32 v72, v75
    v_add_f32 v72, v72, v75
    v_and_b32 v66, s60, v28
    v_and_b32 v67, s60, v29
    v_add_f32_dpp v72, v72, v72 row_ror:8 row_mask:0xf bank_mask:0xf
    buffer_store_dwordx2 v[72:73], v76, s[20:23], s99 offen offset:8 sc1
    s_add_u32 m0, s87, 1024
    s_add_u32 s57, s66, 4289200128
    buffer_load_dwordx4 v1, s[20:23], s57 offen sc1 lds
    s_add_u32 m0, s87, 2048
    s_add_u32 s57, s67, 4289200128
    buffer_load_dwordx4 v1, s[20:23], s57 offen sc1 lds
    s_add_u32 m0, s87, 3072
    s_add_u32 s57, s68, 4289200128
    buffer_load_dwordx4 v1, s[20:23], s57 offen sc1 lds
    s_add_u32 m0, s87, 4096
    s_add_u32 s57, s69, 4289200128
    buffer_load_dwordx4 v1, s[20:23], s57 offen sc1 lds
    s_add_u32 m0, s87, 5120
    s_add_u32 s57, s70, 4289200128
    buffer_load_dwordx4 v1, s[20:23], s57 offen sc1 lds
    s_add_u32 m0, s87, 6144
    s_add_u32 s57, s71, 4289200128
    buffer_load_dwordx4 v1, s[20:23], s57 offen sc1 lds
    buffer_load_dwordx2 v[80:81], v1, s[20:23], s98 offen offset:8 sc1
    buffer_load_dwordx2 v[82:83], v1, s[20:23], s98 offen offset:1032 sc1
    buffer_load_dwordx2 v[112:113], v1, s[20:23], s98 offen offset:2048 sc1
    buffer_load_dwordx2 v[114:115], v1, s[20:23], s98 offen offset:3072 sc1
    v_pk_add_u16 v56, v5, 0 op_sel_hi:[0,0]
    v_lshrrev_b32 v57, 16, v5
    v_mov_b32 v62, 0
    v_pk_add_u16 v58, v7, 0 op_sel_hi:[0,0]
    v_lshrrev_b32 v59, 16, v7
    v_mov_b32 v63, 0
    s_waitcnt vmcnt(8)
    ds_read2st64_b32 v[46:47], v38 offset0:4 offset1:8
    s_waitcnt lgkmcnt(0)
    v_max_u32 v46, v46, v47
    v_cmp_eq_u32 vcc, -1, v46
    s_cbranch_vccnz Lzr_299
Lzc_298:
    s_barrier
    ds_read_b128 v[128:131], v4 offset:0
    ds_read_b128 v[132:135], v4 offset:256
    ds_read_b128 v[136:139], v4 offset:512
    ds_read_b128 v[140:143], v4 offset:768
    ds_read_b128 v[144:147], v4 offset:1024
    ds_read_b128 v[148:151], v4 offset:1280
    ds_read_b128 v[152:155], v4 offset:1536
    s_waitcnt lgkmcnt(6)
    v_mfma_f32_32x32x16_bf16 v[96:111], a[0:3], v[128:131], 0
    s_waitcnt lgkmcnt(5)
    ds_read_b128 v[156:159], v4 offset:1792
    v_mfma_f32_32x32x16_bf16 v[96:111], a[8:11], v[132:135], v[96:111]
    s_waitcnt lgkmcnt(4)
    ds_read_b128 v[128:131], v4 offset:2048
    v_mfma_f32_32x32x16_bf16 v[96:111], a[16:19], v[136:139], v[96:111]
    s_waitcnt vmcnt(4)
    ds_read_b128 v[132:135], v4 offset:2304
    ds_read2st64_b32 v[46:47], v38 offset0:12 offset1:16
    ds_read2st64_b32 v[48:49], v38 offset0:20 offset1:24
    v_mfma_f32_32x32x16_bf16 v[96:111], a[24:27], v[140:143], v[96:111]
    s_waitcnt lgkmcnt(6)
    ds_read_b128 v[136:139], v4 offset:2560
    v_mfma_f32_32x32x16_bf16 v[96:111], a[32:35], v[144:147], v[96:111]
    ds_read_b128 v[140:143], v4 offset:2816
    v_mfma_f32_32x32x16_bf16 v[96:111], a[40:43], v[148:151], v[96:111]
    s_waitcnt vmcnt(2) lgkmcnt(6)
    v_bitop3_b32 v84, v81, v83, s83 bitop3:0x7e
    v_cmp_ne_u32 vcc, 0, v84
    v_mfma_f32_32x32x16_bf16 v[96:111], a[48:51], v[152:155], v[96:111]
    s_cbranch_vccnz Lrt_301
Lck_300:
    v_add_f32_dpp v80, v82, v80 quad_perm:[0,1,2,3] row_mask:0xf bank_mask:0x3
    v_and_b32 v68, s60, v30
    v_and_b32 v69, s60, v31
    v_add_f32_dpp v80, v82, v80 quad_perm:[0,1,2,3] row_mask:0x5 bank_mask:0xc
    v_and_b32 v70, s60, v32
    v_and_b32 v71, s60, v33
    v_mfma_f32_32x32x16_bf16 v[96:111], a[56:59], v[156:159], v[96:111]
    s_waitcnt lgkmcnt(2)
    v_max3_u32 v47, v47, v48, v49
    v_max_u32 v46, v46, v47
    v_cmp_eq_u32 vcc, -1, v46
    v_add_f32_dpp v80, v80, v80 row_ror:8 row_mask:0xf bank_mask:0xf
    v_mov_b32 v84, v80
    v_xor_b32 v77, s90, v1
    v_mfma_f32_32x32x16_bf16 v[96:111], a[64:67], v[128:131], v[96:111]
    s_cbranch_vccnz Lzr_307
Lzc_306:
    s_barrier
    v_xor_b32 v79, s90, v38
    v_permlane16_swap_b32 v80, v84
    v_mfma_f32_32x32x16_bf16 v[96:111], a[72:75], v[132:135], v[96:111]
    s_waitcnt lgkmcnt(0)
    ds_read_b128 v[144:147], v4 offset:3072
    ds_read_b128 v[148:151], v4 offset:3328
    ds_read_b128 v[152:155], v4 offset:3584
    v_add_f32 v80, v80, v84
    v_mov_b32 v84, v80
    v_lshrrev_b32 v78, 7, v1
    v_lshl_add_u32 v78, v78, 5, s93
    v_mfma_f32_32x32x16_bf16 v[96:111], a[80:83], v[136:139], v[96:111]
    ds_read_b128 v[156:159], v4 offset:3840
    ds_read_b128 v[128:131], v4 offset:4096
    v_permlane32_swap_b32 v80, v84
    v_mul_f32 v85, 0xbb124925, v80
    v_fmaak_f32 v86, v85, v85, 0xb727c5ac
    v_mfma_f32_32x32x16_bf16 v[96:111], a[88:91], v[140:143], v[96:111]
    s_waitcnt lgkmcnt(3)
    ds_read_b128 v[132:135], v4 offset:4352
    ds_read_b128 v[136:139], v4 offset:4608
    v_fmac_f32 v86, 0xbb124925, v84
    v_rsq_f32_e64 v86, |v86|
    s_add_u32 s64, s65, 1024
    v_mfma_f32_32x32x16_bf16 v[96:111], a[96:99], v[144:147], v[96:111]
    s_waitcnt vmcnt(0)
    ds_read_b128 v[140:143], v4 offset:4864
    v_bitop3_b32 v116, v113, v115, s83 bitop3:0x7e
    v_cmp_ne_u32 vcc, 0, v116
    v_mul_f32 v85, v85, v86
    v_fma_f32 v88, v18, v86, v85
    v_fma_f32 v89, v19, v86, v85
    v_mfma_f32_32x32x16_bf16 v[96:111], a[104:107], v[148:151], v[96:111]
    s_waitcnt lgkmcnt(4)
    ds_read_b128 v[144:147], v4 offset:5120
    s_cbranch_vccnz Lrt_303
Lck_302:
    v_fmac_f32 v18, v88, v64
    v_fmac_f32 v19, v89, v65
    v_fma_f32 v88, v20, v86, v85
    v_fma_f32 v89, v21, v86, v85
    v_cvt_pk_bf16_f32 v92, v18, v19
    v_mfma_f32_32x32x16_bf16 v[96:111], a[112:115], v[152:155], v[96:111]
    ds_read_b128 v[148:151], v4 offset:5376
    v_fmac_f32 v20, v88, v66
    v_fmac_f32 v21, v89, v67
    v_fma_f32 v88, v22, v86, v85
    v_fma_f32 v89, v23, v86, v85
    v_cvt_pk_bf16_f32 v93, v20, v21
    v_mfma_f32_32x32x16_bf16 v[96:111], a[120:123], v[156:159], v[96:111]
    s_waitcnt lgkmcnt(4)
    ds_read_b128 v[152:155], v4 offset:5632
    v_fmac_f32 v22, v88, v68
    v_fmac_f32 v23, v89, v69
    v_fma_f32 v88, v24, v86, v85
    v_fma_f32 v89, v25, v86, v85
    v_cvt_pk_bf16_f32 v94, v22, v23
    v_mfma_f32_32x32x16_bf16 v[96:111], a[128:131], v[128:131], v[96:111]
    ds_read_b128 v[156:159], v4 offset:5888
    v_fmac_f32 v24, v88, v70
    v_fmac_f32 v25, v89, v71
    v_cvt_pk_bf16_f32 v95, v24, v25
    v_add_f32_dpp v112, v114, v112 quad_perm:[0,1,2,3] row_mask:0xf bank_mask:0x3
    v_and_b32 v113, 0x270, v1
    v_add_u32 v113, s95, v113
    v_mfma_f32_32x32x16_bf16 v[96:111], a[136:139], v[132:135], v[96:111]
    s_waitcnt lgkmcnt(4)
    ds_read_b128 v[128:131], v4 offset:6144
    buffer_store_dwordx4 v[92:95], v77, s[20:23], s64 offen sc1
    ds_write_b128 v79, v[92:95] offset:8192
    ds_read_b128 v[80:83], v78 offset:0
    ds_read_b128 v[84:87], v78 offset:16
    v_add_f32_dpp v112, v114, v112 quad_perm:[0,1,2,3] row_mask:0x5 bank_mask:0xc
    v_mfma_f32_32x32x16_bf16 v[96:111], a[144:147], v[136:139], v[96:111]
    ds_read_b128 v[132:135], v4 offset:6400
    v_add_f32_dpp v112, v112, v112 row_ror:8 row_mask:0xf bank_mask:0xf
    v_mov_b32 v116, v112
    s_nop 1
    v_permlane16_swap_b32 v112, v116
    v_add_f32 v112, v112, v116
    v_mfma_f32_32x32x16_bf16 v[96:111], a[152:155], v[140:143], v[96:111]
    s_waitcnt lgkmcnt(7)
    ds_read_b128 v[136:139], v4 offset:6656
    v_mov_b32 v116, v112
    s_nop 1
    v_permlane32_swap_b32 v112, v116
    v_mul_f32 v117, 0xbb124925, v112
    v_fmaak_f32 v118, v117, v117, 0xaedbe66f
    v_fmac_f32 v118, 0xbb124925, v116
    v_mfma_f32_32x32x16_bf16 v[96:111], a[160:163], v[144:147], v[96:111]
    ds_read_b128 v[140:143], v4 offset:6912
    v_rsq_f32_e64 v119, |v118|
    v_mul_f32 v74, v18, v18
    v_mul_f32_e64 v118, |v118|, v119
    v_mul_f32 v114, 0xbeeff509, v119
    v_mfma_f32_32x32x16_bf16 v[96:111], a[168:171], v[148:151], v[96:111]
    s_waitcnt lgkmcnt(7)
    ds_read_b128 v[144:147], v4 offset:0
    v_mov_b32_dpp v118, v117 quad_perm:[0,1,2,3] row_mask:0x3 bank_mask:0xf
    v_cvt_pk_bf16_f32 v119, v118, v118
    v_lshlrev_b32 v119, 16, v119
    v_sub_f32 v119, v118, v119
    v_cvt_pk_bf16_f32 v115, v118, v119
    v_mfma_f32_32x32x16_bf16 v[96:111], a[176:179], v[152:155], v[96:111]
    ds_read_b128 v[148:151], v4 offset:256
    ds_write_b64 v113, v[114:115] offset:0
    v_add_f32 v72, v18, v19
    v_fmac_f32 v74, v19, v19
    v_add_f32 v72, v72, v20
    v_fmac_f32 v74, v20, v20
    v_mfma_f32_32x32x16_bf16 v[96:111], a[184:187], v[156:159], v[96:111]
    s_waitcnt lgkmcnt(5)
    ds_read_b128 v[152:155], v4 offset:512
    v_add_u32 v112, 161792, v1
    v_add_f32 v72, v72, v21
    v_fmac_f32 v74, v21, v21
    v_add_f32 v72, v72, v22
    v_fmac_f32 v74, v22, v22
    v_add_f32 v72, v72, v23
    v_mfma_f32_32x32x16_bf16 v[96:111], a[192:195], v[128:131], v[96:111]
    s_waitcnt lgkmcnt(1)
    ds_read_b128 v[156:159], v4 offset:768
    s_barrier
    ds_read_b64 v[52:53], v112 offset:0
    v_fmac_f32 v74, v23, v23
    v_add_f32 v72, v72, v24
    v_mfma_f32_32x32x16_bf16 v[96:111], a[200:203], v[132:135], v[96:111]
    ds_read_b128 v[128:131], v4 offset:1024
    v_fmac_f32 v74, v24, v24
    v_add_f32 v72, v72, v25
    v_fmac_f32 v74, v25, v25
    s_nop 1
    v_permlane32_swap_b32 v72, v74
    v_mfma_f32_32x32x16_bf16 v[96:111], a[208:211], v[136:139], v[96:111]
    s_waitcnt lgkmcnt(1)
    ds_read_b128 v[132:135], v4 offset:1280
    v_add_f32 v72, v72, v74
    v_mov_b32 v75, v72
    s_nop 1
    v_permlane16_swap_b32 v72, v75
    v_add_f32 v72, v72, v75
    s_nop 1
    v_add_f32_dpp v72, v72, v72 row_ror:8 row_mask:0xf bank_mask:0xf
    v_mfma_f32_32x32x16_bf16 v[96:111], a[216:219], v[140:143], v[96:111]
    ds_read_b128 v[136:139], v4 offset:1536
    buffer_store_dwordx2 v[72:73], v76, s[20:23], s99 offen offset:2056 sc1
    v_mov_b32 v60, v53
    v_mov_b32 v61, v53
    v_add_f32 v18, v18, v80
    v_add_f32 v19, v19, v81
    v_mfma_f32_32x32x16_bf16 v[96:111], v[56:59], v[60:63], v[96:111]
    v_add_f32 v20, v20, v82
    v_add_f32 v21, v21, v83
    v_add_f32 v22, v22, v84
    v_add_f32 v23, v23, v85
    v_add_f32 v24, v24, v86
    v_add_f32 v25, v25, v87
    v_mfma_f32_32x32x16_bf16 v[112:127], a[4:7], v[144:147], 0
    s_add_u32 m0, s87, 9216
    s_add_u32 s57, s66, 4289201152
    ds_read_b128 v[140:143], v4 offset:1792
    buffer_load_dwordx4 v1, s[20:23], s57 offen sc1 lds
    v_mfma_f32_32x32x16_bf16 v[112:127], a[12:15], v[148:151], v[112:127]
    s_add_u32 m0, s87, 10240
    s_add_u32 s57, s67, 4289201152
    ds_read_b128 v[144:147], v4 offset:2048
    buffer_load_dwordx4 v1, s[20:23], s57 offen sc1 lds
    v_mfma_f32_32x32x16_bf16 v[112:127], a[20:23], v[152:155], v[112:127]
    s_add_u32 s92, s65, 5767168
    s_add_u32 m0, s87, 11264
    s_add_u32 s57, s68, 4289201152
    ds_read_b128 v[148:151], v4 offset:2304
    buffer_load_dwordx4 v1, s[20:23], s57 offen sc1 lds
    v_mul_f32 v96, v52, v96
    v_mul_f32 v97, v52, v97
    v_mfma_f32_32x32x16_bf16 v[112:127], a[28:31], v[156:159], v[112:127]
    s_waitcnt lgkmcnt(4)
    s_add_u32 m0, s87, 12288
    s_add_u32 s57, s69, 4289201152
    ds_read_b128 v[152:155], v4 offset:2560
    buffer_load_dwordx4 v1, s[20:23], s57 offen sc1 lds
    v_fma_f32 v34, v96, v96, s91
    v_fma_f32 v35, v97, v97, s91
    v_mul_f32 v34, v34, v96
    v_mfma_f32_32x32x16_bf16 v[112:127], a[36:39], v[128:131], v[112:127]
    s_add_u32 m0, s87, 13312
    s_add_u32 s57, s70, 4289201152
    ds_read_b128 v[156:159], v4 offset:2816
    buffer_load_dwordx4 v1, s[20:23], s57 offen sc1 lds
    v_mul_f32 v35, v35, v97
    v_exp_f32 v34, v34
    v_mul_f32 v98, v52, v98
    v_mfma_f32_32x32x16_bf16 v[112:127], a[44:47], v[132:135], v[112:127]
    s_waitcnt lgkmcnt(4)
    s_add_u32 m0, s87, 14336
    s_add_u32 s57, s71, 4289201152
    ds_read_b128 v[128:131], v4 offset:3072
    buffer_load_dwordx4 v1, s[20:23], s57 offen sc1 lds
    v_exp_f32 v35, v35
    v_mfma_f32_32x32x16_bf16 v[112:127], a[52:55], v[136:139], v[112:127]
    ds_read_b128 v[132:135], v4 offset:3328
    v_add_f32 v34, 1.0, v34
    v_mul_f32 v99, v52, v99
    v_add_f32 v35, 1.0, v35
    v_fma_f32 v36, v98, v98, s91
    v_rcp_f32 v34, v34
    v_mfma_f32_32x32x16_bf16 v[112:127], a[60:63], v[140:143], v[112:127]
    s_waitcnt lgkmcnt(4)
    ds_read_b128 v[136:139], v4 offset:3584
    v_fma_f32 v37, v99, v99, s91
    v_rcp_f32 v35, v35
    v_mul_f32 v36, v36, v98
    v_mul_f32 v34, v34, v96
    v_mul_f32 v37, v37, v99
    v_mfma_f32_32x32x16_bf16 v[112:127], a[68:71], v[144:147], v[112:127]
    ds_read_b128 v[140:143], v4 offset:3840
    v_mul_f32 v35, v35, v97
    v_exp_f32 v36, v36
    v_cvt_pk_bf16_f32 v96, v34, v35
    v_mul_f32 v100, v52, v100
    v_mfma_f32_32x32x16_bf16 v[112:127], a[76:79], v[148:151], v[112:127]
    s_waitcnt lgkmcnt(4)
    ds_read_b128 v[144:147], v4 offset:4096
    v_exp_f32 v37, v37
    v_add_f32 v36, 1.0, v36
    v_mul_f32 v101, v52, v101
    v_add_f32 v37, 1.0, v37
    v_fma_f32 v34, v100, v100, s91
    v_mfma_f32_32x32x16_bf16 v[112:127], a[84:87], v[152:155], v[112:127]
    ds_read_b128 v[148:151], v4 offset:4352
    v_rcp_f32 v36, v36
    v_fma_f32 v35, v101, v101, s91
    v_rcp_f32 v37, v37
    v_mul_f32 v34, v34, v100
    v_mfma_f32_32x32x16_bf16 v[112:127], a[92:95], v[156:159], v[112:127]
    s_waitcnt lgkmcnt(4)
    ds_read_b128 v[152:155], v4 offset:4608
    v_mul_f32 v36, v36, v98
    v_mul_f32 v35, v35, v101
    v_mul_f32 v37, v37, v99
    v_exp_f32 v34, v34
    v_cvt_pk_bf16_f32 v97, v36, v37
    v_mfma_f32_32x32x16_bf16 v[112:127], a[100:103], v[128:131], v[112:127]
    ds_read_b128 v[156:159], v4 offset:4864
    v_exp_f32 v35, v35
    v_mul_f32 v102, v52, v102
    v_add_f32 v34, 1.0, v34
    v_mul_f32 v103, v52, v103
    v_mfma_f32_32x32x16_bf16 v[112:127], a[108:111], v[132:135], v[112:127]
    s_waitcnt lgkmcnt(4)
    ds_read_b128 v[128:131], v4 offset:5120
    v_add_f32 v35, 1.0, v35
    v_fma_f32 v36, v102, v102, s91
    v_rcp_f32 v34, v34
    v_fma_f32 v37, v103, v103, s91
    v_mul_f32 v36, v36, v102
    v_mfma_f32_32x32x16_bf16 v[112:127], a[116:119], v[136:139], v[112:127]
    ds_read_b128 v[132:135], v4 offset:5376
    v_rcp_f32 v35, v35
    v_mul_f32 v34, v34, v100
    v_mul_f32 v37, v37, v103
    v_mul_f32 v35, v35, v101
    v_cvt_pk_bf16_f32 v98, v34, v35
    v_mfma_f32_32x32x16_bf16 v[112:127], a[124:127], v[140:143], v[112:127]
    s_waitcnt lgkmcnt(4)
    ds_read_b128 v[136:139], v4 offset:5632
    v_exp_f32 v36, v36
    v_exp_f32 v37, v37
    v_mul_f32 v104, v52, v104
    v_mfma_f32_32x32x16_bf16 v[112:127], a[132:135], v[144:147], v[112:127]
    s_waitcnt vmcnt(4)
    buffer_load_dwordx2 v[80:81], v1, s[20:23], s98 offen offset:2056 sc1
    buffer_load_dwordx2 v[82:83], v1, s[20:23], s98 offen offset:3080 sc1
    ds_read_b128 v[140:143], v4 offset:5888
    ds_read2st64_b32 v[46:47], v38 offset0:36 offset1:40
    v_add_f32 v36, 1.0, v36
    v_mul_f32 v105, v52, v105
    v_add_f32 v37, 1.0, v37
    v_mfma_f32_32x32x16_bf16 v[112:127], a[140:143], v[148:151], v[112:127]
    s_waitcnt lgkmcnt(5)
    ds_read_b128 v[144:147], v4 offset:6144
    v_fma_f32 v34, v104, v104, s91
    v_rcp_f32 v36, v36
    v_fma_f32 v35, v105, v105, s91
    v_rcp_f32 v37, v37
    v_mfma_f32_32x32x16_bf16 v[112:127], a[148:151], v[152:155], v[112:127]
    ds_read_b128 v[148:151], v4 offset:6400
    v_mul_f32 v34, v34, v104
    v_mul_f32 v36, v36, v102
    v_mul_f32 v35, v35, v105
    v_mul_f32 v37, v37, v103
    v_cvt_pk_bf16_f32 v99, v36, v37
    v_mfma_f32_32x32x16_bf16 v[112:127], a[156:159], v[156:159], v[112:127]
    s_waitcnt lgkmcnt(5)
    ds_read_b128 v[152:155], v4 offset:6656
    buffer_store_dwordx4 v[96:99], v1, s[20:23], s92 offen offset:0 sc1
    v_exp_f32 v34, v34
    v_exp_f32 v35, v35
    v_mul_f32 v106, v52, v106
    v_mfma_f32_32x32x16_bf16 v[112:127], a[164:167], v[128:131], v[112:127]
    ds_read_b128 v[156:159], v4 offset:6912
    v_add_f32 v34, 1.0, v34
    v_mul_f32 v107, v52, v107
    v_add_f32 v35, 1.0, v35
    v_fma_f32 v36, v106, v106, s91
    v_rcp_f32 v34, v34
    v_mfma_f32_32x32x16_bf16 v[112:127], a[172:175], v[132:135], v[112:127]
    s_waitcnt lgkmcnt(4)
    v_max_u32 v46, v46, v47
    v_cmp_eq_u32 vcc, -1, v46
    v_fma_f32 v37, v107, v107, s91
    v_rcp_f32 v35, v35
    v_mul_f32 v36, v36, v106
    v_mul_f32 v34, v34, v104
    v_mfma_f32_32x32x16_bf16 v[112:127], a[180:183], v[136:139], v[112:127]
    s_cbranch_vccnz Lzr_309
Lzc_308:
    s_barrier
    v_mul_f32 v37, v37, v107
    v_mul_f32 v35, v35, v105
    v_cvt_pk_bf16_f32 v100, v34, v35
    v_mfma_f32_32x32x16_bf16 v[112:127], a[188:191], v[140:143], v[112:127]
    s_waitcnt lgkmcnt(2)
    ds_read_b128 v[128:131], v4 offset:8192
    ds_read_b128 v[132:135], v4 offset:8448
    v_exp_f32 v36, v36
    v_exp_f32 v37, v37
    v_mul_f32 v108, v52, v108
    v_mfma_f32_32x32x16_bf16 v[112:127], a[196:199], v[144:147], v[112:127]
    ds_read_b128 v[136:139], v4 offset:8704
    v_add_f32 v36, 1.0, v36
    v_mul_f32 v109, v52, v109
    v_add_f32 v37, 1.0, v37
    v_fma_f32 v34, v108, v108, s91
    v_rcp_f32 v36, v36
    v_mfma_f32_32x32x16_bf16 v[112:127], a[204:207], v[148:151], v[112:127]
    s_waitcnt lgkmcnt(3)
    ds_read_b128 v[140:143], v4 offset:8960
    ds_read_b128 v[144:147], v4 offset:9216
    v_fma_f32 v35, v109, v109, s91
    v_rcp_f32 v37, v37
    v_mul_f32 v34, v34, v108
    v_mfma_f32_32x32x16_bf16 v[112:127], a[212:215], v[152:155], v[112:127]
    ds_read_b128 v[148:151], v4 offset:9472
    v_mul_f32 v36, v36, v106
    v_mul_f32 v35, v35, v109
    v_mul_f32 v37, v37, v107
    v_exp_f32 v34, v34
    v_cvt_pk_bf16_f32 v101, v36, v37
    v_mfma_f32_32x32x16_bf16 v[112:127], a[220:223], v[156:159], v[112:127]
    s_waitcnt vmcnt(1) lgkmcnt(4)
    ds_read_b128 v[152:155], v4 offset:9728
    v_bitop3_b32 v84, v81, v83, s83 bitop3:0x7e
    v_cmp_ne_u32 vcc, 0, v84
    v_exp_f32 v35, v35
    v_mul_f32 v110, v52, v110
    v_add_f32 v34, 1.0, v34
    v_mfma_f32_32x32x16_bf16 v[112:127], v[58:61], v[60:63], v[112:127]
    v_mul_f32 v111, v52, v111
    v_add_f32 v35, 1.0, v35
    v_fma_f32 v36, v110, v110, s91
    v_rcp_f32 v34, v34
    v_fma_f32 v37, v111, v111, s91
    v_mfma_f32_32x32x16_bf16 v[64:79], a[0:3], v[128:131], 0
    ds_read_b128 v[156:159], v4 offset:9984
    s_cbranch_vccnz Lrt_305
Lck_304:
    v_add_f32_dpp v80, v82, v80 quad_perm:[0,1,2,3] row_mask:0xf bank_mask:0x3
    v_and_b32 v81, 0x270, v1
    v_add_u32 v81, s95, v81
    v_add_f32_dpp v80, v82, v80 quad_perm:[0,1,2,3] row_mask:0x5 bank_mask:0xc
    v_mfma_f32_32x32x16_bf16 v[64:79], a[8:11], v[132:135], v[64:79]
    s_waitcnt lgkmcnt(4)
    ds_read_b128 v[128:131], v4 offset:10240
    v_add_f32_dpp v80, v80, v80 row_ror:8 row_mask:0xf bank_mask:0xf
    v_mov_b32 v84, v80
    s_nop 1
    v_permlane16_swap_b32 v80, v84
    v_add_f32 v80, v80, v84
    v_mov_b32 v84, v80
    v_mfma_f32_32x32x16_bf16 v[64:79], a[16:19], v[136:139], v[64:79]
    ds_read_b128 v[132:135], v4 offset:10496
    ds_read2st64_b32 v[46:47], v38 offset0:44 offset1:48
    ds_read2st64_b32 v[48:49], v38 offset0:52 offset1:56
    v_permlane32_swap_b32 v80, v84
    v_mul_f32 v85, 0xbb124925, v80
    v_fmaak_f32 v86, v85, v85, 0xaedbe66f
    v_mfma_f32_32x32x16_bf16 v[64:79], a[24:27], v[140:143], v[64:79]
    s_waitcnt lgkmcnt(6)
    ds_read_b128 v[136:139], v4 offset:10752
    v_fmac_f32 v86, 0xbb124925, v84
    v_rsq_f32_e64 v87, |v86|
    v_rcp_f32 v35, v35
    v_mul_f32_e64 v86, |v86|, v87
    v_mfma_f32_32x32x16_bf16 v[64:79], a[32:35], v[144:147], v[64:79]
    ds_read_b128 v[140:143], v4 offset:11008
    v_mul_f32 v82, 0xbeeff509, v87
    v_mov_b32_dpp v86, v85 quad_perm:[0,1,2,3] row_mask:0x3 bank_mask:0xf
    v_cvt_pk_bf16_f32 v87, v86, v86
    v_lshlrev_b32 v87, 16, v87
    v_sub_f32 v87, v86, v87
    v_mfma_f32_32x32x16_bf16 v[64:79], a[40:43], v[148:151], v[64:79]
    s_waitcnt lgkmcnt(6)
    v_cvt_pk_bf16_f32 v83, v86, v87
    v_mul_f32 v36, v36, v110
    v_mul_f32 v34, v34, v108
    v_mul_f32 v37, v37, v111
    v_mul_f32 v35, v35, v109
    v_exp_f32 v36, v36
    v_mfma_f32_32x32x16_bf16 v[64:79], a[48:51], v[152:155], v[64:79]
    ds_write_b64 v81, v[82:83] offset:8
    v_cvt_pk_bf16_f32 v102, v34, v35
    v_exp_f32 v37, v37
    v_mul_f32 v112, v52, v112
    v_add_f32 v36, 1.0, v36
    v_mul_f32 v113, v52, v113
    v_mfma_f32_32x32x16_bf16 v[64:79], a[56:59], v[156:159], v[64:79]
    s_waitcnt lgkmcnt(3)
    v_max3_u32 v47, v47, v48, v49
    v_max_u32 v46, v46, v47
    v_cmp_eq_u32 vcc, -1, v46
    v_add_u32 v80, 161792, v1
    v_add_f32 v37, 1.0, v37
    v_fma_f32 v34, v112, v112, s91
    v_mfma_f32_32x32x16_bf16 v[64:79], a[64:67], v[128:131], v[64:79]
    s_cbranch_vccnz Lzr_311
Lzc_310:
    s_barrier
    s_waitcnt lgkmcnt(0)
    s_barrier
    ds_read_b64 v[54:55], v80 offset:8
    v_mfma_f32_32x32x16_bf16 v[64:79], a[72:75], v[132:135], v[64:79]
    ds_read_b128 v[144:147], v4 offset:11264
    ds_read_b128 v[148:151], v4 offset:11520
    ds_read_b128 v[152:155], v4 offset:11776
    v_rcp_f32 v36, v36
    v_fma_f32 v35, v113, v113, s91
    v_mul_f32 v34, v34, v112
    v_mfma_f32_32x32x16_bf16 v[64:79], a[80:83], v[136:139], v[64:79]
    ds_read_b128 v[156:159], v4 offset:12032
    ds_read_b128 v[128:131], v4 offset:12288
    v_rcp_f32 v37, v37
    v_mul_f32 v36, v36, v110
    v_mul_f32 v35, v35, v113
    v_mfma_f32_32x32x16_bf16 v[64:79], a[88:91], v[140:143], v[64:79]
    s_waitcnt lgkmcnt(3)
    ds_read_b128 v[132:135], v4 offset:12544
    ds_read_b128 v[136:139], v4 offset:12800
    v_mul_f32 v37, v37, v111
    v_exp_f32 v34, v34
    v_cvt_pk_bf16_f32 v103, v36, v37
    v_mul_f32 v114, v52, v114
    v_mfma_f32_32x32x16_bf16 v[64:79], a[96:99], v[144:147], v[64:79]
    ds_read_b128 v[140:143], v4 offset:13056
    buffer_store_dwordx4 v[100:103], v1, s[20:23], s92 offen offset:1024 sc1
    v_mov_b32 v60, v55
    v_mov_b32 v61, v55
    v_exp_f32 v35, v35
    v_add_f32 v34, 1.0, v34
    v_mfma_f32_32x32x16_bf16 v[64:79], a[104:107], v[148:151], v[64:79]
    s_waitcnt lgkmcnt(4)
    ds_read_b128 v[144:147], v4 offset:13312
    v_mul_f32 v115, v52, v115
    v_add_f32 v35, 1.0, v35
    v_fma_f32 v36, v114, v114, s91
    v_rcp_f32 v34, v34
    v_fma_f32 v37, v115, v115, s91
    v_mfma_f32_32x32x16_bf16 v[64:79], a[112:115], v[152:155], v[64:79]
    ds_read_b128 v[148:151], v4 offset:13568
    v_rcp_f32 v35, v35
    v_mul_f32 v36, v36, v114
    v_mul_f32 v34, v34, v112
    v_mul_f32 v37, v37, v115
    v_mfma_f32_32x32x16_bf16 v[64:79], a[120:123], v[156:159], v[64:79]
    s_waitcnt lgkmcnt(4)
    ds_read_b128 v[152:155], v4 offset:13824
    v_mul_f32 v35, v35, v113
    v_exp_f32 v36, v36
    v_cvt_pk_bf16_f32 v112, v34, v35
    v_exp_f32 v37, v37
    v_mfma_f32_32x32x16_bf16 v[64:79], a[128:131], v[128:131], v[64:79]
    ds_read_b128 v[156:159], v4 offset:14080
    v_mul_f32 v116, v52, v116
    v_add_f32 v36, 1.0, v36
    v_mul_f32 v117, v52, v117
    v_add_f32 v37, 1.0, v37
    v_fma_f32 v34, v116, v116, s91
    v_fma_f32 v35, v117, v117, s91
    v_mfma_f32_32x32x16_bf16 v[64:79], a[136:139], v[132:135], v[64:79]
    s_waitcnt lgkmcnt(4)
    ds_read_b128 v[128:131], v4 offset:14336
    v_rcp_f32 v36, v36
    v_rcp_f32 v37, v37
    v_mul_f32 v34, v34, v116
    v_mfma_f32_32x32x16_bf16 v[64:79], a[144:147], v[136:139], v[64:79]
    ds_read_b128 v[132:135], v4 offset:14592
    v_mul_f32 v36, v36, v114
    v_mul_f32 v35, v35, v117
    v_mul_f32 v37, v37, v115
    v_exp_f32 v34, v34
    v_cvt_pk_bf16_f32 v113, v36, v37
    v_mfma_f32_32x32x16_bf16 v[64:79], a[152:155], v[140:143], v[64:79]
    s_waitcnt lgkmcnt(4)
    ds_read_b128 v[136:139], v4 offset:14848
    v_exp_f32 v35, v35
    v_mul_f32 v118, v52, v118
    v_add_f32 v34, 1.0, v34
    v_mul_f32 v119, v52, v119
    v_add_f32 v35, 1.0, v35
    v_mfma_f32_32x32x16_bf16 v[64:79], a[160:163], v[144:147], v[64:79]
    ds_read_b128 v[140:143], v4 offset:15104
    v_fma_f32 v36, v118, v118, s91
    v_rcp_f32 v34, v34
    v_fma_f32 v37, v119, v119, s91
    v_mul_f32 v36, v36, v118
    v_mfma_f32_32x32x16_bf16 v[64:79], a[168:171], v[148:151], v[64:79]
    s_waitcnt vmcnt(0) lgkmcnt(4)
    ds_read_b128 v[144:147], v4 offset:8192
    buffer_store_dword v2, off, s[20:23], s89 offset:256 sc1
    v_rcp_f32 v35, v35
    v_mul_f32 v34, v34, v116
    v_mul_f32 v37, v37, v119
    v_mul_f32 v35, v35, v117
    v_mfma_f32_32x32x16_bf16 v[64:79], a[176:179], v[152:155], v[64:79]
    ds_read_b128 v[148:151], v4 offset:8448
    v_exp_f32 v36, v36
    v_cvt_pk_bf16_f32 v114, v34, v35
    v_exp_f32 v37, v37
    v_mul_f32 v120, v52, v120
    v_mfma_f32_32x32x16_bf16 v[64:79], a[184:187], v[156:159], v[64:79]
    s_waitcnt lgkmcnt(4)
    ds_read_b128 v[152:155], v4 offset:8704
    v_add_f32 v36, 1.0, v36
    v_mul_f32 v121, v52, v121
    v_add_f32 v37, 1.0, v37
    v_fma_f32 v34, v120, v120, s91
    v_rcp_f32 v36, v36
    v_mfma_f32_32x32x16_bf16 v[64:79], a[192:195], v[128:131], v[64:79]
    ds_read_b128 v[156:159], v4 offset:8960
    v_fma_f32 v35, v121, v121, s91
    v_rcp_f32 v37, v37
    v_mul_f32 v34, v34, v120
    v_mul_f32 v36, v36, v118
    v_mfma_f32_32x32x16_bf16 v[64:79], a[200:203], v[132:135], v[64:79]
    s_waitcnt lgkmcnt(4)
    ds_read_b128 v[128:131], v4 offset:9216
    v_mul_f32 v35, v35, v121
    v_mul_f32 v37, v37, v119
    v_exp_f32 v34, v34
    v_cvt_pk_bf16_f32 v115, v36, v37
    v_mul_f32 v122, v52, v122
    v_mfma_f32_32x32x16_bf16 v[64:79], a[208:211], v[136:139], v[64:79]
    ds_read_b128 v[132:135], v4 offset:9472
    buffer_store_dwordx4 v[112:115], v1, s[20:23], s92 offen offset:2048 sc1
    v_exp_f32 v35, v35
    v_add_f32 v34, 1.0, v34
    v_mul_f32 v123, v52, v123
    v_add_f32 v35, 1.0, v35
    v_mfma_f32_32x32x16_bf16 v[64:79], a[216:219], v[140:143], v[64:79]
    s_waitcnt lgkmcnt(4)
    ds_read_b128 v[136:139], v4 offset:9728
    v_fma_f32 v36, v122, v122, s91
    v_rcp_f32 v34, v34
    v_fma_f32 v37, v123, v123, s91
    v_mul_f32 v36, v36, v122
    v_mfma_f32_32x32x16_bf16 v[64:79], v[56:59], v[60:63], v[64:79]
    v_rcp_f32 v35, v35
    v_mul_f32 v34, v34, v120
    v_mul_f32 v37, v37, v123
    v_mul_f32 v35, v35, v121
    v_cvt_pk_bf16_f32 v116, v34, v35
    v_mfma_f32_32x32x16_bf16 v[80:95], a[4:7], v[144:147], 0
    ds_read_b128 v[140:143], v4 offset:9984
    v_exp_f32 v36, v36
    v_exp_f32 v37, v37
    v_mul_f32 v124, v52, v124
    v_add_f32 v36, 1.0, v36
    v_mfma_f32_32x32x16_bf16 v[80:95], a[12:15], v[148:151], v[80:95]
    s_waitcnt lgkmcnt(4)
    ds_read_b128 v[144:147], v4 offset:10240
    v_mul_f32 v125, v52, v125
    v_add_f32 v37, 1.0, v37
    v_fma_f32 v34, v124, v124, s91
    v_rcp_f32 v36, v36
    v_fma_f32 v35, v125, v125, s91
    v_mfma_f32_32x32x16_bf16 v[80:95], a[20:23], v[152:155], v[80:95]
    ds_read_b128 v[148:151], v4 offset:10496
    v_rcp_f32 v37, v37
    v_mul_f32 v34, v34, v124
    v_mul_f32 v36, v36, v122
    v_mul_f32 v35, v35, v125
    v_mfma_f32_32x32x16_bf16 v[80:95], a[28:31], v[156:159], v[80:95]
    s_waitcnt lgkmcnt(4)
    ds_read_b128 v[152:155], v4 offset:10752
    v_mul_f32 v37, v37, v123
    v_exp_f32 v34, v34
    v_cvt_pk_bf16_f32 v117, v36, v37
    v_exp_f32 v35, v35
    v_mfma_f32_32x32x16_bf16 v[80:95], a[36:39], v[128:131], v[80:95]
    ds_read_b128 v[156:159], v4 offset:11008
    v_mul_f32 v126, v52, v126
    v_add_f32 v34, 1.0, v34
    v_mul_f32 v127, v52, v127
    v_add_f32 v35, 1.0, v35
    v_fma_f32 v36, v126, v126, s91
    v_fma_f32 v37, v127, v127, s91
    v_mfma_f32_32x32x16_bf16 v[80:95], a[44:47], v[132:135], v[80:95]
    s_waitcnt lgkmcnt(4)
    ds_read_b128 v[128:131], v4 offset:11264
    v_rcp_f32 v34, v34
    v_rcp_f32 v35, v35
    v_mul_f32 v36, v36, v126
    v_mul_f32 v34, v34, v124
    v_mfma_f32_32x32x16_bf16 v[80:95], a[52:55], v[136:139], v[80:95]
    ds_read_b128 v[132:135], v4 offset:11520
    v_mul_f32 v37, v37, v127
    v_mul_f32 v35, v35, v125
    v_exp_f32 v36, v36
    v_cvt_pk_bf16_f32 v118, v34, v35
    v_mfma_f32_32x32x16_bf16 v[80:95], a[60:63], v[140:143], v[80:95]
    s_waitcnt lgkmcnt(4)
    ds_read_b128 v[136:139], v4 offset:11776
    v_exp_f32 v37, v37
    v_mul_f32 v64, v54, v64
    v_add_f32 v36, 1.0, v36
    v_mul_f32 v65, v54, v65
    v_add_f32 v37, 1.0, v37
    v_mfma_f32_32x32x16_bf16 v[80:95], a[68:71], v[144:147], v[80:95]
    ds_read_b128 v[140:143], v4 offset:12032
    v_fma_f32 v34, v64, v64, s91
    v_rcp_f32 v36, v36
    v_fma_f32 v35, v65, v65, s91
    v_rcp_f32 v37, v37
    v_mfma_f32_32x32x16_bf16 v[80:95], a[76:79], v[148:151], v[80:95]
    s_waitcnt lgkmcnt(4)
    ds_read_b128 v[144:147], v4 offset:12288
    v_mul_f32 v34, v34, v64
    v_mul_f32 v36, v36, v126
    v_mul_f32 v35, v35, v65
    v_mul_f32 v37, v37, v127
    v_cvt_pk_bf16_f32 v119, v36, v37
    v_mfma_f32_32x32x16_bf16 v[80:95], a[84:87], v[152:155], v[80:95]
    ds_read_b128 v[148:151], v4 offset:12544
    buffer_store_dwordx4 v[116:119], v1, s[20:23], s92 offen offset:3072 sc1
    buffer_load_dword v0, v3, s[20:23], s88 offen offset:256 sc1
    s_add_u32 s92, s65, 0
    v_exp_f32 v34, v34
    v_mul_f32 v66, v54, v66
    v_mfma_f32_32x32x16_bf16 v[80:95], a[92:95], v[156:159], v[80:95]
    s_waitcnt lgkmcnt(4)
    ds_read_b128 v[152:155], v4 offset:12800
    v_exp_f32 v35, v35
    v_add_f32 v34, 1.0, v34
    v_mul_f32 v67, v54, v67
    v_add_f32 v35, 1.0, v35
    v_fma_f32 v36, v66, v66, s91
    v_mfma_f32_32x32x16_bf16 v[80:95], a[100:103], v[128:131], v[80:95]
    ds_read_b128 v[156:159], v4 offset:13056
    v_rcp_f32 v34, v34
    v_fma_f32 v37, v67, v67, s91
    v_rcp_f32 v35, v35
    v_mfma_f32_32x32x16_bf16 v[80:95], a[108:111], v[132:135], v[80:95]
    s_waitcnt lgkmcnt(4)
    ds_read_b128 v[128:131], v4 offset:13312
    v_mul_f32 v36, v36, v66
    v_mul_f32 v34, v34, v64
    v_mul_f32 v37, v37, v67
    v_mul_f32 v35, v35, v65
    v_exp_f32 v36, v36
    v_mfma_f32_32x32x16_bf16 v[80:95], a[116:119], v[136:139], v[80:95]
    ds_read_b128 v[132:135], v4 offset:13568
    v_cvt_pk_bf16_f32 v64, v34, v35
    v_exp_f32 v37, v37
    v_mul_f32 v68, v54, v68
    v_add_f32 v36, 1.0, v36
    v_mul_f32 v69, v54, v69
    v_mfma_f32_32x32x16_bf16 v[80:95], a[124:127], v[140:143], v[80:95]
    s_waitcnt lgkmcnt(4)
    ds_read_b128 v[136:139], v4 offset:13824
    v_add_f32 v37, 1.0, v37
    v_fma_f32 v34, v68, v68, s91
    v_rcp_f32 v36, v36
    v_fma_f32 v35, v69, v69, s91
    v_mul_f32 v34, v34, v68
    v_mfma_f32_32x32x16_bf16 v[80:95], a[132:135], v[144:147], v[80:95]
    ds_read_b128 v[140:143], v4 offset:14080
    v_rcp_f32 v37, v37
    v_mul_f32 v36, v36, v66
    v_mul_f32 v35, v35, v69
    v_mul_f32 v37, v37, v67
    v_mfma_f32_32x32x16_bf16 v[80:95], a[140:143], v[148:151], v[80:95]
    s_waitcnt lgkmcnt(4)
    ds_read_b128 v[144:147], v4 offset:14336
    v_exp_f32 v34, v34
    v_cvt_pk_bf16_f32 v65, v36, v37
    v_exp_f32 v35, v35
    v_mul_f32 v70, v54, v70
    v_mfma_f32_32x32x16_bf16 v[80:95], a[148:151], v[152:155], v[80:95]
    ds_read_b128 v[148:151], v4 offset:14592
    v_add_f32 v34, 1.0, v34
    v_mul_f32 v71, v54, v71
    v_add_f32 v35, 1.0, v35
    v_fma_f32 v36, v70, v70, s91
    v_rcp_f32 v34, v34
    v_mfma_f32_32x32x16_bf16 v[80:95], a[156:159], v[156:159], v[80:95]
    s_waitcnt lgkmcnt(4)
    ds_read_b128 v[152:155], v4 offset:14848
    v_fma_f32 v37, v71, v71, s91
    v_rcp_f32 v35, v35
    v_mul_f32 v36, v36, v70
    v_mul_f32 v34, v34, v68
    v_mfma_f32_32x32x16_bf16 v[80:95], a[164:167], v[128:131], v[80:95]
    s_waitcnt vmcnt(0)
    ds_read_b128 v[156:159], v4 offset:15104
    v_cmp_ne_u32 vcc, s59, v0
    v_mul_f32 v37, v37, v71
    v_mul_f32 v35, v35, v69
    v_exp_f32 v36, v36
    v_cvt_pk_bf16_f32 v66, v34, v35
    v_mfma_f32_32x32x16_bf16 v[80:95], a[172:175], v[132:135], v[80:95]
    s_waitcnt lgkmcnt(4)
    buffer_store_dword v2, off, s[20:23], s89 offset:288 sc1
    s_cbranch_vccnz Lrt_313
Lck_312:
    v_exp_f32 v37, v37
    v_mul_f32 v72, v54, v72
    v_add_f32 v36, 1.0, v36
    v_mul_f32 v73, v54, v73
    v_mfma_f32_32x32x16_bf16 v[80:95], a[180:183], v[136:139], v[80:95]
    buffer_load_dwordx4 v[40:43], v1, s[20:23], s66 offen offset:0 sc1
    v_add_f32 v37, 1.0, v37
    v_fma_f32 v34, v72, v72, s91
    v_rcp_f32 v36, v36
    v_fma_f32 v35, v73, v73, s91
    v_mfma_f32_32x32x16_bf16 v[80:95], a[188:191], v[140:143], v[80:95]
    s_waitcnt lgkmcnt(2)
    v_rcp_f32 v37, v37
    v_mul_f32 v34, v34, v72
    v_mul_f32 v36, v36, v70
    v_mul_f32 v35, v35, v73
    v_mul_f32 v37, v37, v71
    v_cvt_pk_bf16_f32 v67, v36, v37
    v_mfma_f32_32x32x16_bf16 v[80:95], a[196:199], v[144:147], v[80:95]
    buffer_load_dwordx4 v[44:47], v1, s[20:23], s66 offen offset:1024 sc1
    buffer_store_dwordx4 v[64:67], v1, s[20:23], s92 offen offset:2048 sc1
    v_exp_f32 v34, v34
    v_exp_f32 v35, v35
    v_mul_f32 v74, v54, v74
    v_mfma_f32_32x32x16_bf16 v[80:95], a[204:207], v[148:151], v[80:95]
    s_waitcnt lgkmcnt(0)
    v_add_f32 v34, 1.0, v34
    v_mul_f32 v75, v54, v75
    v_add_f32 v35, 1.0, v35
    v_fma_f32 v36, v74, v74, s91
    v_rcp_f32 v34, v34
    v_fma_f32 v37, v75, v75, s91
    v_mfma_f32_32x32x16_bf16 v[80:95], a[212:215], v[152:155], v[80:95]
    buffer_load_dwordx4 v[48:51], v1, s[20:23], s67 offen offset:0 sc1
    v_rcp_f32 v35, v35
    v_mul_f32 v36, v36, v74
    v_mul_f32 v34, v34, v72
    v_mul_f32 v37, v37, v75
    v_mfma_f32_32x32x16_bf16 v[80:95], a[220:223], v[156:159], v[80:95]
    v_mul_f32 v35, v35, v73
    v_exp_f32 v36, v36
    v_cvt_pk_bf16_f32 v68, v34, v35
    v_exp_f32 v37, v37
    v_mul_f32 v76, v54, v76
    v_mfma_f32_32x32x16_bf16 v[80:95], v[58:61], v[60:63], v[80:95]
    v_add_f32 v36, 1.0, v36
    v_mul_f32 v77, v54, v77
    v_add_f32 v37, 1.0, v37
    v_fma_f32 v34, v76, v76, s91
    v_rcp_f32 v36, v36
    v_mfma_f32_32x32x16_bf16 v[128:143], a[224:227], v[96:99], 0
    buffer_load_dwordx4 v[56:59], v1, s[20:23], s67 offen offset:1024 sc1
    v_fma_f32 v35, v77, v77, s91
    v_rcp_f32 v37, v37
    v_mul_f32 v34, v34, v76
    v_mul_f32 v36, v36, v74
    v_mul_f32 v35, v35, v77
    v_mul_f32 v37, v37, v75
    v_mfma_f32_32x32x16_bf16 v[144:159], a[228:231], v[96:99], 0
    v_exp_f32 v34, v34
    v_cvt_pk_bf16_f32 v69, v36, v37
    v_exp_f32 v35, v35
    v_mul_f32 v78, v54, v78
    v_add_f32 v34, 1.0, v34
    v_mfma_f32_32x32x16_bf16 v[128:143], a[232:235], v[100:103], v[128:143]
    buffer_load_dwordx4 v[60:63], v1, s[20:23], s68 offen offset:0 sc1
    v_mul_f32 v79, v54, v79
    v_add_f32 v35, 1.0, v35
    v_fma_f32 v36, v78, v78, s91
    v_rcp_f32 v34, v34
    v_fma_f32 v37, v79, v79, s91
    v_mul_f32 v36, v36, v78
    v_mfma_f32_32x32x16_bf16 v[144:159], a[236:239], v[100:103], v[144:159]
    v_rcp_f32 v35, v35
    v_mul_f32 v34, v34, v76
    v_mul_f32 v37, v37, v79
    v_mul_f32 v35, v35, v77
    v_exp_f32 v36, v36
    v_mfma_f32_32x32x16_bf16 v[128:143], a[240:243], v[112:115], v[128:143]
    buffer_load_dwordx4 v[104:107], v1, s[20:23], s68 offen offset:1024 sc1
    buffer_load_dword v0, v3, s[20:23], s88 offen offset:288 sc1
    v_cvt_pk_bf16_f32 v70, v34, v35
    v_exp_f32 v37, v37
    v_mul_f32 v80, v54, v80
    v_add_f32 v36, 1.0, v36
    v_mfma_f32_32x32x16_bf16 v[144:159], a[244:247], v[112:115], v[144:159]
    v_mul_f32 v81, v54, v81
    v_add_f32 v37, 1.0, v37
    v_fma_f32 v34, v80, v80, s91
    v_rcp_f32 v36, v36
    v_fma_f32 v35, v81, v81, s91
    v_rcp_f32 v37, v37
    v_mfma_f32_32x32x16_bf16 v[128:143], a[248:251], v[116:119], v[128:143]
    buffer_load_dwordx4 v[108:111], v1, s[20:23], s69 offen offset:0 sc1
    v_mul_f32 v34, v34, v80
    v_mul_f32 v36, v36, v78
    v_mul_f32 v35, v35, v81
    v_mul_f32 v37, v37, v79
    v_exp_f32 v34, v34
    v_mfma_f32_32x32x16_bf16 v[144:159], a[252:255], v[116:119], v[144:159]
    s_waitcnt vmcnt(8)
    v_cvt_pk_bf16_f32 v71, v36, v37
    v_exp_f32 v35, v35
    v_mul_f32 v82, v54, v82
    v_add_f32 v34, 1.0, v34
    v_mul_f32 v83, v54, v83
    v_add_f32 v35, 1.0, v35
    v_fma_f32 v36, v82, v82, s91
    v_mfma_f32_32x32x16_bf16 v[128:143], v[160:163], v[40:43], v[128:143]
    buffer_load_dwordx4 v[120:123], v1, s[20:23], s69 offen offset:1024 sc1
    buffer_store_dwordx4 v[68:71], v1, s[20:23], s92 offen offset:3072 sc1
    v_rcp_f32 v34, v34
    v_fma_f32 v37, v83, v83, s91
    v_rcp_f32 v35, v35
    v_mfma_f32_32x32x16_bf16 v[144:159], v[164:167], v[40:43], v[144:159]
    s_waitcnt vmcnt(9)
    v_mul_f32 v36, v36, v82
    v_mul_f32 v34, v34, v80
    v_mul_f32 v37, v37, v83
    v_mul_f32 v35, v35, v81
    v_exp_f32 v36, v36
    v_cvt_pk_bf16_f32 v80, v34, v35
    v_mfma_f32_32x32x16_bf16 v[128:143], v[168:171], v[44:47], v[128:143]
    buffer_load_dwordx4 v[40:43], v1, s[20:23], s70 offen offset:0 sc1
    v_exp_f32 v37, v37
    v_mul_f32 v84, v54, v84
    v_add_f32 v36, 1.0, v36
    v_mul_f32 v85, v54, v85
    v_add_f32 v37, 1.0, v37
    v_fma_f32 v34, v84, v84, s91
    v_mfma_f32_32x32x16_bf16 v[144:159], v[172:175], v[44:47], v[144:159]
    s_waitcnt vmcnt(8)
    v_rcp_f32 v36, v36
    v_fma_f32 v35, v85, v85, s91
    v_rcp_f32 v37, v37
    v_mul_f32 v34, v34, v84
    v_mul_f32 v36, v36, v82
    v_mfma_f32_32x32x16_bf16 v[128:143], v[176:179], v[48:51], v[128:143]
    buffer_load_dwordx4 v[44:47], v1, s[20:23], s70 offen offset:1024 sc1
    v_mul_f32 v35, v35, v85
    v_mul_f32 v37, v37, v83
    v_exp_f32 v34, v34
    v_cvt_pk_bf16_f32 v81, v36, v37
    v_exp_f32 v35, v35
    v_mfma_f32_32x32x16_bf16 v[144:159], v[180:183], v[48:51], v[144:159]
    s_waitcnt vmcnt(8)
    v_mul_f32 v86, v54, v86
    v_add_f32 v34, 1.0, v34
    v_mul_f32 v87, v54, v87
    v_add_f32 v35, 1.0, v35
    v_fma_f32 v36, v86, v86, s91
    v_rcp_f32 v34, v34
    v_mfma_f32_32x32x16_bf16 v[128:143], v[184:187], v[56:59], v[128:143]
    buffer_load_dwordx4 v[48:51], v1, s[20:23], s71 offen offset:0 sc1
    v_fma_f32 v37, v87, v87, s91
    v_rcp_f32 v35, v35
    v_mul_f32 v36, v36, v86
    v_mul_f32 v34, v34, v84
    v_mul_f32 v37, v37, v87
    v_mfma_f32_32x32x16_bf16 v[144:159], v[188:191], v[56:59], v[144:159]
    s_waitcnt vmcnt(8)
    v_mul_f32 v35, v35, v85
    v_exp_f32 v36, v36
    v_cvt_pk_bf16_f32 v82, v34, v35
    v_exp_f32 v37, v37
    v_mul_f32 v88, v54, v88
    v_add_f32 v36, 1.0, v36
    v_mfma_f32_32x32x16_bf16 v[128:143], v[192:195], v[60:63], v[128:143]
    buffer_load_dwordx4 v[56:59], v1, s[20:23], s71 offen offset:1024 sc1
    v_mul_f32 v89, v54, v89
    v_add_f32 v37, 1.0, v37
    v_fma_f32 v34, v88, v88, s91
    v_rcp_f32 v36, v36
    v_fma_f32 v35, v89, v89, s91
    v_mfma_f32_32x32x16_bf16 v[144:159], v[196:199], v[60:63], v[144:159]
    s_waitcnt vmcnt(7)
    v_cmp_ne_u32 vcc, s59, v0
    v_rcp_f32 v37, v37
    v_mul_f32 v34, v34, v88
    v_mul_f32 v36, v36, v86
    v_mul_f32 v35, v35, v89
    v_mul_f32 v37, v37, v87
    v_cvt_pk_bf16_f32 v83, v36, v37
    v_mfma_f32_32x32x16_bf16 v[128:143], v[200:203], v[104:107], v[128:143]
    s_waitcnt vmcnt(4)
    buffer_store_dword v2, off, s[20:23], s89 offset:320 sc1
    buffer_store_dwordx4 v[80:83], v1, s[20:23], s92 offen offset:0 sc1
    s_cbranch_vccnz Lrt_315
Lck_314:
    v_exp_f32 v34, v34
    v_exp_f32 v35, v35
    v_mfma_f32_32x32x16_bf16 v[144:159], v[204:207], v[104:107], v[144:159]
    buffer_load_dwordx4 v[60:63], v1, s[20:23], s66 offen offset:2048 sc1
    v_mul_f32 v90, v54, v90
    v_add_f32 v34, 1.0, v34
    v_mul_f32 v91, v54, v91
    v_add_f32 v35, 1.0, v35
    v_fma_f32 v36, v90, v90, s91
    v_fma_f32 v37, v91, v91, s91
    v_mfma_f32_32x32x16_bf16 v[128:143], v[208:211], v[108:111], v[128:143]
    v_rcp_f32 v34, v34
    v_rcp_f32 v35, v35
    v_mul_f32 v36, v36, v90
    v_mul_f32 v34, v34, v88
    v_mul_f32 v37, v37, v91
    v_mul_f32 v35, v35, v89
    v_mfma_f32_32x32x16_bf16 v[144:159], v[212:215], v[108:111], v[144:159]
    buffer_load_dwordx4 v[104:107], v1, s[20:23], s66 offen offset:3072 sc1
    v_exp_f32 v36, v36
    v_cvt_pk_bf16_f32 v84, v34, v35
    v_exp_f32 v37, v37
    v_mul_f32 v92, v54, v92
    v_mfma_f32_32x32x16_bf16 v[128:143], v[216:219], v[120:123], v[128:143]
    v_add_f32 v36, 1.0, v36
    v_mul_f32 v93, v54, v93
    v_add_f32 v37, 1.0, v37
    v_fma_f32 v34, v92, v92, s91
    v_rcp_f32 v36, v36
    v_fma_f32 v35, v93, v93, s91
    v_mul_f32 v34, v34, v92
    v_mfma_f32_32x32x16_bf16 v[144:159], v[220:223], v[120:123], v[144:159]
    s_waitcnt vmcnt(7)
    buffer_load_dwordx4 v[108:111], v1, s[20:23], s67 offen offset:2048 sc1
    v_rcp_f32 v37, v37
    v_mul_f32 v36, v36, v90
    v_mul_f32 v35, v35, v93
    v_mul_f32 v37, v37, v91
    v_cvt_pk_bf16_f32 v85, v36, v37
    v_mfma_f32_32x32x16_bf16 v[128:143], v[224:227], v[40:43], v[128:143]
    v_exp_f32 v34, v34
    v_exp_f32 v35, v35
    v_mul_f32 v94, v54, v94
    v_add_f32 v34, 1.0, v34
    v_mul_f32 v95, v54, v95
    v_mfma_f32_32x32x16_bf16 v[144:159], v[228:231], v[40:43], v[144:159]
    s_waitcnt vmcnt(7)
    buffer_load_dwordx4 v[40:43], v1, s[20:23], s67 offen offset:3072 sc1
    v_add_f32 v35, 1.0, v35
    v_fma_f32 v36, v94, v94, s91
    v_rcp_f32 v34, v34
    v_fma_f32 v37, v95, v95, s91
    v_rcp_f32 v35, v35
    v_mfma_f32_32x32x16_bf16 v[128:143], v[232:235], v[44:47], v[128:143]
    v_mul_f32 v36, v36, v94
    v_mul_f32 v34, v34, v92
    v_mul_f32 v37, v37, v95
    v_mul_f32 v35, v35, v93
    v_exp_f32 v36, v36
    v_cvt_pk_bf16_f32 v86, v34, v35
    v_mfma_f32_32x32x16_bf16 v[144:159], v[236:239], v[44:47], v[144:159]
    s_waitcnt vmcnt(7)
    buffer_load_dwordx4 v[44:47], v1, s[20:23], s68 offen offset:2048 sc1
    v_exp_f32 v37, v37
    v_add_f32 v36, 1.0, v36
    v_add_f32 v37, 1.0, v37
    v_rcp_f32 v36, v36
    v_mfma_f32_32x32x16_bf16 v[128:143], v[240:243], v[48:51], v[128:143]
    ds_read_b64_tr_b16 a[0:1], v8 offset:16384
    ds_read_b64_tr_b16 a[2:3], v8 offset:17408
    v_rcp_f32 v37, v37
    v_mul_f32 v36, v36, v94
    v_mul_f32 v37, v37, v95
    v_cvt_pk_bf16_f32 v87, v36, v37
    v_mfma_f32_32x32x16_bf16 v[144:159], v[244:247], v[48:51], v[144:159]
    s_waitcnt vmcnt(7)
    buffer_load_dwordx4 v[48:51], v1, s[20:23], s68 offen offset:3072 sc1
    ds_read_b64_tr_b16 a[8:9], v9 offset:16384
    ds_read_b64_tr_b16 a[10:11], v9 offset:17408
    buffer_store_dwordx4 v[84:87], v1, s[20:23], s92 offen offset:1024 sc1
    v_mfma_f32_32x32x16_bf16 v[128:143], v[248:251], v[56:59], v[128:143]
    ds_read_b64_tr_b16 a[16:17], v8 offset:18432
    ds_read_b64_tr_b16 a[18:19], v8 offset:19456
    buffer_load_dword v0, v3, s[20:23], s88 offen offset:320 sc1
    v_mfma_f32_32x32x16_bf16 v[144:159], v[252:255], v[56:59], v[144:159]
    s_waitcnt vmcnt(7) lgkmcnt(4)
    buffer_load_dwordx4 v[56:59], v1, s[20:23], s69 offen offset:2048 sc1
    ds_read_b64_tr_b16 a[24:25], v9 offset:18432
    ds_read_b64_tr_b16 a[26:27], v9 offset:19456
    v_mfma_f32_32x32x16_bf16 v[128:143], a[0:3], v[60:63], v[128:143]
    s_waitcnt lgkmcnt(4)
    ds_read_b64_tr_b16 a[32:33], v8 offset:20480
    ds_read_b64_tr_b16 a[34:35], v8 offset:21504
    v_mfma_f32_32x32x16_bf16 v[144:159], a[8:11], v[60:63], v[144:159]
    s_waitcnt vmcnt(7) lgkmcnt(4)
    buffer_load_dwordx4 v[52:55], v1, s[20:23], s69 offen offset:3072 sc1
    ds_read_b64_tr_b16 a[40:41], v9 offset:20480
    ds_read_b64_tr_b16 a[42:43], v9 offset:21504
    v_mfma_f32_32x32x16_bf16 v[128:143], a[16:19], v[104:107], v[128:143]
    s_waitcnt lgkmcnt(4)
    ds_read_b64_tr_b16 a[48:49], v8 offset:22528
    ds_read_b64_tr_b16 a[50:51], v8 offset:23552
    v_mfma_f32_32x32x16_bf16 v[144:159], a[24:27], v[104:107], v[144:159]
    s_waitcnt vmcnt(7) lgkmcnt(4)
    buffer_load_dwordx4 v[60:63], v1, s[20:23], s70 offen offset:2048 sc1
    ds_read_b64_tr_b16 a[56:57], v9 offset:22528
    ds_read_b64_tr_b16 a[58:59], v9 offset:23552
    v_mfma_f32_32x32x16_bf16 v[128:143], a[32:35], v[108:111], v[128:143]
    s_waitcnt lgkmcnt(4)
    ds_read_b64_tr_b16 a[64:65], v8 offset:0
    ds_read_b64_tr_b16 a[66:67], v8 offset:1024
    v_mfma_f32_32x32x16_bf16 v[144:159], a[40:43], v[108:111], v[144:159]
    s_waitcnt vmcnt(7) lgkmcnt(4)
    buffer_load_dwordx4 v[104:107], v1, s[20:23], s70 offen offset:3072 sc1
    ds_read_b64_tr_b16 a[72:73], v9 offset:0
    ds_read_b64_tr_b16 a[74:75], v9 offset:1024
    v_mfma_f32_32x32x16_bf16 v[128:143], a[48:51], v[40:43], v[128:143]
    s_waitcnt lgkmcnt(4)
    ds_read_b64_tr_b16 a[80:81], v8 offset:2048
    ds_read_b64_tr_b16 a[82:83], v8 offset:3072
    v_mfma_f32_32x32x16_bf16 v[144:159], a[56:59], v[40:43], v[144:159]
    s_waitcnt vmcnt(5) lgkmcnt(4)
    buffer_load_dwordx4 a[4:7], v1, s[20:23], s71 offen offset:2048 sc1
    ds_read_b64_tr_b16 a[88:89], v9 offset:2048
    ds_read_b64_tr_b16 a[90:91], v9 offset:3072
    buffer_store_dword v2, off, s[20:23], s89 offset:352 sc1
    v_mfma_f32_32x32x16_bf16 v[128:143], a[64:67], v[44:47], v[128:143]
    s_waitcnt lgkmcnt(4)
    ds_read_b64_tr_b16 a[96:97], v8 offset:4096
    ds_read_b64_tr_b16 a[98:99], v8 offset:5120
    v_mfma_f32_32x32x16_bf16 v[144:159], a[72:75], v[44:47], v[144:159]
    s_waitcnt lgkmcnt(4)
    buffer_load_dwordx4 a[12:15], v1, s[20:23], s71 offen offset:3072 sc1
    ds_read_b64_tr_b16 a[104:105], v9 offset:4096
    ds_read_b64_tr_b16 a[106:107], v9 offset:5120
    v_mfma_f32_32x32x16_bf16 v[128:143], a[80:83], v[48:51], v[128:143]
    s_waitcnt vmcnt(7) lgkmcnt(4)
    s_sub_u32 s66, s66, 5767168
    s_sub_u32 s67, s67, 5767168
    ds_read_b64_tr_b16 a[112:113], v8 offset:6144
    ds_read_b64_tr_b16 a[114:115], v8 offset:7168
    v_cmp_ne_u32 vcc, s59, v0
    v_mfma_f32_32x32x16_bf16 v[144:159], a[88:91], v[48:51], v[144:159]
    s_waitcnt vmcnt(6) lgkmcnt(4)
    s_sub_u32 s68, s68, 5767168
    s_sub_u32 s69, s69, 5767168
    ds_read_b64_tr_b16 a[120:121], v9 offset:6144
    ds_read_b64_tr_b16 a[122:123], v9 offset:7168
    s_cbranch_vccnz Lrt_317
Lck_316:
    v_mfma_f32_32x32x16_bf16 v[128:143], a[96:99], v[56:59], v[128:143]
    s_waitcnt lgkmcnt(4)
    s_sub_u32 s70, s70, 5767168
    s_sub_u32 s71, s71, 5767168
    ds_read_b64_tr_b16 a[128:129], v8 offset:8192
    ds_read_b64_tr_b16 a[130:131], v8 offset:9216
    v_mfma_f32_32x32x16_bf16 v[144:159], a[104:107], v[56:59], v[144:159]
    s_waitcnt vmcnt(5) lgkmcnt(4)
    buffer_load_dwordx4 a[20:23], v1, s[20:23], s66 offen offset:2048 sc1
    ds_read_b64_tr_b16 a[144:145], v8 offset:10240
    ds_read_b64_tr_b16 a[146:147], v8 offset:11264
    v_mfma_f32_32x32x16_bf16 v[128:143], a[112:115], v[52:55], v[128:143]
    s_waitcnt lgkmcnt(4)
    buffer_load_dwordx4 a[28:31], v1, s[20:23], s66 offen offset:3072 sc1
    ds_read_b64_tr_b16 a[160:161], v8 offset:12288
    ds_read_b64_tr_b16 a[162:163], v8 offset:13312
    v_mfma_f32_32x32x16_bf16 v[144:159], a[120:123], v[52:55], v[144:159]
    s_waitcnt vmcnt(6) lgkmcnt(4)
    ds_read_b64_tr_b16 a[176:177], v8 offset:14336
    ds_read_b64_tr_b16 a[178:179], v8 offset:15360
    v_mfma_f32_32x32x16_bf16 v[128:143], a[128:131], v[60:63], v[128:143]
    s_waitcnt vmcnt(5) lgkmcnt(4)
    buffer_load_dwordx4 a[36:39], v1, s[20:23], s67 offen offset:2048 sc1
    ds_read_b64_tr_b16 a[136:137], v9 offset:8192
    ds_read_b64_tr_b16 a[138:139], v9 offset:9216
    v_mfma_f32_32x32x16_bf16 v[128:143], a[144:147], v[104:107], v[128:143]
    s_waitcnt vmcnt(5) lgkmcnt(4)
    ds_read_b64_tr_b16 a[152:153], v9 offset:10240
    ds_read_b64_tr_b16 a[154:155], v9 offset:11264
    v_mfma_f32_32x32x16_bf16 v[128:143], a[160:163], a[4:7], v[128:143]
    s_waitcnt vmcnt(3) lgkmcnt(4)
    buffer_load_dwordx4 a[44:47], v1, s[20:23], s67 offen offset:3072 sc1
    ds_read_b64_tr_b16 a[168:169], v9 offset:12288
    ds_read_b64_tr_b16 a[170:171], v9 offset:13312
    v_mfma_f32_32x32x16_bf16 v[128:143], a[176:179], a[12:15], v[128:143]
    s_waitcnt lgkmcnt(4)
    ds_read_b64_tr_b16 a[184:185], v9 offset:14336
    ds_read_b64_tr_b16 a[186:187], v9 offset:15360
    v_mfma_f32_32x32x16_bf16 v[144:159], a[136:139], v[60:63], v[144:159]
    s_waitcnt lgkmcnt(4)
    buffer_load_dwordx4 a[52:55], v1, s[20:23], s68 offen offset:2048 sc1
    v_mfma_f32_32x32x16_bf16 v[144:159], a[152:155], v[104:107], v[144:159]
    s_waitcnt lgkmcnt(2)
    buffer_load_dword v0, v3, s[20:23], s88 offen offset:352 sc1
    v_mfma_f32_32x32x16_bf16 v[144:159], a[168:171], a[4:7], v[144:159]
    s_waitcnt lgkmcnt(0)
    buffer_load_dwordx4 a[4:7], v1, s[20:23], s68 offen offset:3072 sc1
    v_mfma_f32_32x32x16_bf16 v[144:159], a[184:187], a[12:15], v[144:159]
    v_cvt_pk_f16_f32 v128, v128, v129
    v_cvt_pk_f16_f32 v129, v130, v131
    v_cvt_pk_f16_f32 v130, v132, v133
    v_cvt_pk_f16_f32 v131, v134, v135
    v_cvt_pk_f16_f32 v136, v136, v137
    v_cvt_pk_f16_f32 v137, v138, v139
    v_mfma_f32_32x32x16_bf16 v[96:111], a[224:227], v[64:67], 0
    buffer_load_dwordx4 a[12:15], v1, s[20:23], s69 offen offset:2048 sc1
    ds_write_b128 v6, v[128:131] offset:0
    v_cvt_pk_f16_f32 v138, v140, v141
    v_cvt_pk_f16_f32 v139, v142, v143
    v_bfe_u32 v39, v1, 5, 2
    v_bfe_u32 v34, v1, 4, 1
    v_lshl_add_u32 v39, v39, 3, v34
    v_mfma_f32_32x32x16_bf16 v[112:127], a[228:231], v[64:67], 0
    ds_write_b128 v6, v[136:139] offset:128
    v_lshrrev_b32 v34, 7, v1
    v_mul_u32_u24 v39, 1792, v39
    v_lshl_add_u32 v39, v34, 4, v39
    v_mfma_f32_32x32x16_bf16 v[96:111], a[232:235], v[68:71], v[96:111]
    buffer_load_dwordx4 a[60:63], v1, s[20:23], s69 offen offset:3072 sc1
    v_mfma_f32_32x32x16_bf16 v[112:127], a[236:239], v[68:71], v[112:127]
    v_cvt_pk_f16_f32 v144, v144, v145
    v_cvt_pk_f16_f32 v145, v146, v147
    v_cvt_pk_f16_f32 v146, v148, v149
    v_cvt_pk_f16_f32 v147, v150, v151
    v_cvt_pk_f16_f32 v152, v152, v153
    v_cvt_pk_f16_f32 v153, v154, v155
    v_mfma_f32_32x32x16_bf16 v[96:111], a[240:243], v[80:83], v[96:111]
    buffer_load_dwordx4 v[40:43], v1, s[20:23], s70 offen offset:2048 sc1
    ds_write_b128 v6, v[144:147] offset:512
    v_cvt_pk_f16_f32 v154, v156, v157
    v_cvt_pk_f16_f32 v155, v158, v159
    v_mfma_f32_32x32x16_bf16 v[112:127], a[244:247], v[80:83], v[112:127]
    ds_write_b128 v6, v[152:155] offset:640
    v_mfma_f32_32x32x16_bf16 v[96:111], a[248:251], v[84:87], v[96:111]
    s_waitcnt lgkmcnt(0)
    buffer_load_dwordx4 v[44:47], v1, s[20:23], s70 offen offset:3072 sc1
    s_barrier
    ds_read_b128 v[144:147], v38 offset:0
    ds_read_b128 v[148:151], v38 offset:1024
    ds_read_b128 v[152:155], v38 offset:2048
    ds_read_b128 v[156:159], v38 offset:3072
    v_mfma_f32_32x32x16_bf16 v[112:127], a[252:255], v[84:87], v[112:127]
    s_waitcnt vmcnt(10)
    v_mfma_f32_32x32x16_bf16 v[96:111], v[160:163], a[20:23], v[96:111]
    s_waitcnt lgkmcnt(2)
    buffer_load_dwordx4 v[48:51], v1, s[20:23], s71 offen offset:2048 sc1
    v_pk_add_f16 v144, v144, v148
    v_pk_add_f16 v145, v145, v149
    v_pk_add_f16 v146, v146, v150
    v_pk_add_f16 v147, v147, v151
    v_mfma_f32_32x32x16_bf16 v[112:127], v[164:167], a[20:23], v[112:127]
    s_waitcnt vmcnt(6) lgkmcnt(0)
    v_cmp_ne_u32 vcc, s59, v0
    v_pk_add_f16 v152, v152, v156
    v_pk_add_f16 v153, v153, v157
    v_pk_add_f16 v154, v154, v158
    v_pk_add_f16 v155, v155, v159
    v_pk_add_f16 v144, v144, v152
    v_pk_add_f16 v145, v145, v153
    v_pk_add_f16 v146, v146, v154
    v_mfma_f32_32x32x16_bf16 v[96:111], v[168:171], a[28:31], v[96:111]
    buffer_load_dwordx4 a[20:23], v1, s[20:23], s71 offen offset:3072 sc1
    s_cbranch_vccnz Lrt_319
Lck_318:
    v_pk_add_f16 v147, v147, v155
    v_fma_mix_f32 v10, v144, s80, v10 op_sel:[0,0,0] op_sel_hi:[1,0,0]
    v_fma_mix_f32 v11, v144, s80, v11 op_sel:[1,0,0] op_sel_hi:[1,0,0]
    v_fma_mix_f32 v12, v145, s80, v12 op_sel:[0,0,0] op_sel_hi:[1,0,0]
    v_fma_mix_f32 v13, v145, s80, v13 op_sel:[1,0,0] op_sel_hi:[1,0,0]
    v_mfma_f32_32x32x16_bf16 v[112:127], v[172:175], a[28:31], v[112:127]
    v_fma_mix_f32 v14, v146, s80, v14 op_sel:[0,0,0] op_sel_hi:[1,0,0]
    v_fma_mix_f32 v15, v146, s80, v15 op_sel:[1,0,0] op_sel_hi:[1,0,0]
    v_fma_mix_f32 v16, v147, s80, v16 op_sel:[0,0,0] op_sel_hi:[1,0,0]
    v_fma_mix_f32 v17, v147, s80, v17 op_sel:[1,0,0] op_sel_hi:[1,0,0]
    v_cvt_pk_bf16_f32 v144, v10, v11
    v_cvt_pk_bf16_f32 v145, v12, v13
    v_cvt_pk_bf16_f32 v146, v14, v15
    v_cvt_pk_bf16_f32 v147, v16, v17
    v_mfma_f32_32x32x16_bf16 v[96:111], v[176:179], a[36:39], v[96:111]
    buffer_load_dwordx4 a[28:31], v1, s[20:23], s66 offen offset:0 sc1
    v_mfma_f32_32x32x16_bf16 v[112:127], v[180:183], a[36:39], v[112:127]
    v_mfma_f32_32x32x16_bf16 v[96:111], v[184:187], a[44:47], v[96:111]
    buffer_load_dwordx4 a[36:39], v1, s[20:23], s66 offen offset:1024 sc1
    v_mfma_f32_32x32x16_bf16 v[112:127], v[188:191], a[44:47], v[112:127]
    v_mfma_f32_32x32x16_bf16 v[96:111], v[192:195], a[52:55], v[96:111]
    buffer_load_dwordx4 a[44:47], v1, s[20:23], s67 offen offset:0 sc1
    v_mfma_f32_32x32x16_bf16 v[112:127], v[196:199], a[52:55], v[112:127]
    s_waitcnt vmcnt(9)
    v_mfma_f32_32x32x16_bf16 v[96:111], v[200:203], a[4:7], v[96:111]
    buffer_load_dwordx4 a[52:55], v1, s[20:23], s67 offen offset:1024 sc1
    v_mfma_f32_32x32x16_bf16 v[112:127], v[204:207], a[4:7], v[112:127]
    s_waitcnt vmcnt(9)
    v_mfma_f32_32x32x16_bf16 v[96:111], v[208:211], a[12:15], v[96:111]
    buffer_load_dwordx4 a[4:7], v1, s[20:23], s68 offen offset:0 sc1
    v_mfma_f32_32x32x16_bf16 v[112:127], v[212:215], a[12:15], v[112:127]
    s_waitcnt vmcnt(9)
    v_mfma_f32_32x32x16_bf16 v[96:111], v[216:219], a[60:63], v[96:111]
    buffer_load_dwordx4 a[12:15], v1, s[20:23], s68 offen offset:1024 sc1
    v_mfma_f32_32x32x16_bf16 v[112:127], v[220:223], a[60:63], v[112:127]
    s_waitcnt vmcnt(9)
    v_mfma_f32_32x32x16_bf16 v[96:111], v[224:227], v[40:43], v[96:111]
    buffer_load_dwordx4 a[60:63], v1, s[20:23], s69 offen offset:0 sc1
    v_mfma_f32_32x32x16_bf16 v[112:127], v[228:231], v[40:43], v[112:127]
    s_waitcnt vmcnt(9)
    buffer_store_dword v2, off, s[20:23], s89 offset:192 sc1
    v_mfma_f32_32x32x16_bf16 v[96:111], v[232:235], v[44:47], v[96:111]
    buffer_load_dwordx4 v[40:43], v1, s[20:23], s69 offen offset:1024 sc1
    v_mfma_f32_32x32x16_bf16 v[112:127], v[236:239], v[44:47], v[112:127]
    s_waitcnt vmcnt(10)
    v_mfma_f32_32x32x16_bf16 v[96:111], v[240:243], v[48:51], v[96:111]
    buffer_load_dwordx4 v[44:47], v1, s[20:23], s70 offen offset:0 sc1
    v_mfma_f32_32x32x16_bf16 v[112:127], v[244:247], v[48:51], v[112:127]
    s_waitcnt vmcnt(10)
    buffer_load_dwordx4 v[48:51], v1, s[20:23], s70 offen offset:1024 sc1
    v_mfma_f32_32x32x16_bf16 v[96:111], v[248:251], a[20:23], v[96:111]
    buffer_load_dwordx4 v[52:55], v1, s[20:23], s71 offen offset:0 sc1
    v_mfma_f32_32x32x16_bf16 v[112:127], v[252:255], a[20:23], v[112:127]
    s_waitcnt vmcnt(11)
    buffer_load_dwordx4 a[20:23], v1, s[20:23], s71 offen offset:1024 sc1
    v_mfma_f32_32x32x16_bf16 v[96:111], a[0:3], a[28:31], v[96:111]
    v_mfma_f32_32x32x16_bf16 v[112:127], a[8:11], a[28:31], v[112:127]
    s_waitcnt vmcnt(11)
    v_mfma_f32_32x32x16_bf16 v[96:111], a[16:19], a[36:39], v[96:111]
    v_mfma_f32_32x32x16_bf16 v[112:127], a[24:27], a[36:39], v[112:127]
    s_waitcnt vmcnt(10)
    v_mfma_f32_32x32x16_bf16 v[96:111], a[32:35], a[44:47], v[96:111]
    v_mfma_f32_32x32x16_bf16 v[112:127], a[40:43], a[44:47], v[112:127]
    s_waitcnt vmcnt(9)
    v_mfma_f32_32x32x16_bf16 v[96:111], a[48:51], a[52:55], v[96:111]
    v_mfma_f32_32x32x16_bf16 v[112:127], a[56:59], a[52:55], v[112:127]
    s_waitcnt vmcnt(8)
    v_mfma_f32_32x32x16_bf16 v[96:111], a[64:67], a[4:7], v[96:111]
    v_mfma_f32_32x32x16_bf16 v[112:127], a[72:75], a[4:7], v[112:127]
    s_waitcnt vmcnt(7)
    v_mfma_f32_32x32x16_bf16 v[96:111], a[80:83], a[12:15], v[96:111]
    v_mfma_f32_32x32x16_bf16 v[112:127], a[88:91], a[12:15], v[112:127]
    s_waitcnt vmcnt(6)
    v_mfma_f32_32x32x16_bf16 v[96:111], a[96:99], a[60:63], v[96:111]
    v_mfma_f32_32x32x16_bf16 v[112:127], a[104:107], a[60:63], v[112:127]
    s_waitcnt vmcnt(4)
    v_mfma_f32_32x32x16_bf16 v[96:111], a[112:115], v[40:43], v[96:111]
    v_mfma_f32_32x32x16_bf16 v[112:127], a[120:123], v[40:43], v[112:127]
    s_waitcnt vmcnt(3)
    v_mfma_f32_32x32x16_bf16 v[96:111], a[128:131], v[44:47], v[96:111]
    s_waitcnt vmcnt(2)
    buffer_store_dwordx4 v[144:147], v39, s[48:51], s94 offen offset:0 sc0 sc1 nt
    v_mfma_f32_32x32x16_bf16 v[96:111], a[144:147], v[48:51], v[96:111]
    s_waitcnt vmcnt(2)
    v_mfma_f32_32x32x16_bf16 v[96:111], a[160:163], v[52:55], v[96:111]
    s_waitcnt vmcnt(1)
    v_mfma_f32_32x32x16_bf16 v[96:111], a[176:179], a[20:23], v[96:111]
    s_lshl2_add_u32 s57, s2, s53
    s_cmp_lg_u32 s57, 28
    s_cbranch_scc1 Lep_320
    buffer_store_dword v2, off, s[20:23], 0 sc0 sc1
Lep_320:
    v_mfma_f32_32x32x16_bf16 v[112:127], a[136:139], v[44:47], v[112:127]
    v_mfma_f32_32x32x16_bf16 v[112:127], a[152:155], v[48:51], v[112:127]
    v_mfma_f32_32x32x16_bf16 v[112:127], a[168:171], v[52:55], v[112:127]
    v_mfma_f32_32x32x16_bf16 v[112:127], a[184:187], a[20:23], v[112:127]
    s_nop 4
    v_cvt_pk_f16_f32 v96, v96, v97
    v_cvt_pk_f16_f32 v97, v98, v99
    v_cvt_pk_f16_f32 v98, v100, v101
    v_cvt_pk_f16_f32 v99, v102, v103
    v_cvt_pk_f16_f32 v104, v104, v105
    v_cvt_pk_f16_f32 v105, v106, v107
    ds_write_b128 v6, v[96:99] offset:8192
    v_cvt_pk_f16_f32 v106, v108, v109
    v_cvt_pk_f16_f32 v107, v110, v111
    ds_write_b128 v6, v[104:107] offset:8320
    v_cvt_pk_f16_f32 v112, v112, v113
    v_cvt_pk_f16_f32 v113, v114, v115
    v_cvt_pk_f16_f32 v114, v116, v117
    v_cvt_pk_f16_f32 v115, v118, v119
    v_cvt_pk_f16_f32 v120, v120, v121
    v_cvt_pk_f16_f32 v121, v122, v123
    ds_write_b128 v6, v[112:115] offset:8704
    v_cvt_pk_f16_f32 v122, v124, v125
    v_cvt_pk_f16_f32 v123, v126, v127
    ds_write_b128 v6, v[120:123] offset:8832
    s_waitcnt lgkmcnt(0)
    s_barrier
    ds_read_b128 v[112:115], v38 offset:8192
    ds_read_b128 v[116:119], v38 offset:9216
    ds_read_b128 v[120:123], v38 offset:10240
    ds_read_b128 v[124:127], v38 offset:11264
    s_waitcnt lgkmcnt(2)
    v_pk_add_f16 v112, v112, v116
    v_pk_add_f16 v113, v113, v117
    v_pk_add_f16 v114, v114, v118
    v_pk_add_f16 v115, v115, v119
    s_waitcnt lgkmcnt(0)
    v_pk_add_f16 v120, v120, v124
    v_pk_add_f16 v121, v121, v125
    v_pk_add_f16 v122, v122, v126
    v_pk_add_f16 v123, v123, v127
    v_pk_add_f16 v112, v112, v120
    v_pk_add_f16 v113, v113, v121
    v_pk_add_f16 v114, v114, v122
    v_pk_add_f16 v115, v115, v123
    v_fma_mix_f32 v18, v112, s80, v18 op_sel:[0,0,0] op_sel_hi:[1,0,0]
    v_fma_mix_f32 v19, v112, s80, v19 op_sel:[1,0,0] op_sel_hi:[1,0,0]
    v_fma_mix_f32 v20, v113, s80, v20 op_sel:[0,0,0] op_sel_hi:[1,0,0]
    v_fma_mix_f32 v21, v113, s80, v21 op_sel:[1,0,0] op_sel_hi:[1,0,0]
    v_fma_mix_f32 v22, v114, s80, v22 op_sel:[0,0,0] op_sel_hi:[1,0,0]
    v_fma_mix_f32 v23, v114, s80, v23 op_sel:[1,0,0] op_sel_hi:[1,0,0]
    v_fma_mix_f32 v24, v115, s80, v24 op_sel:[0,0,0] op_sel_hi:[1,0,0]
    v_fma_mix_f32 v25, v115, s80, v25 op_sel:[1,0,0] op_sel_hi:[1,0,0]
    v_cvt_pk_bf16_f32 v112, v18, v19
    v_cvt_pk_bf16_f32 v113, v20, v21
    v_cvt_pk_bf16_f32 v114, v22, v23
    v_cvt_pk_bf16_f32 v115, v24, v25
    buffer_store_dwordx4 v[112:115], v39, s[48:51], s94 offen offset:896 sc0 sc1 nt
    s_endpgm
Lrt_176:
    s_sub_u32 s58, s58, 1
    s_cbranch_scc1 L_exit
    s_mov_b64 exec, vcc
    buffer_load_dwordx4 v[144:147], v1, s[20:23], s98 offen offset:0 sc1
    buffer_load_dwordx4 v[148:151], v1, s[20:23], s98 offen offset:1024 sc1
    s_mov_b64 exec, -1
    s_waitcnt vmcnt(0)
    v_bitop3_b32 v152, v146, v150, s59 bitop3:0x7e
    v_bitop3_b32 v152, v147, v152, s59 bitop3:0xde
    v_bitop3_b32 v152, v151, v152, s59 bitop3:0xde
    v_cmp_ne_u32 vcc, 0, v152
    s_cbranch_vccnz Lrt_176
    s_branch Lck_175
Lrt_178:
    s_sub_u32 s58, s58, 1
    s_cbranch_scc1 L_exit
    s_mov_b64 exec, vcc
    buffer_load_dwordx4 v[80:83], v128, s[20:23], s65 offen offset:0 sc1
    buffer_load_dwordx4 v[84:87], v128, s[20:23], s65 offen offset:1024 sc1
    buffer_load_dwordx4 v[88:91], v128, s[20:23], s65 offen offset:2048 sc1
    buffer_load_dwordx4 v[92:95], v128, s[20:23], s65 offen offset:3072 sc1
    s_mov_b64 exec, -1
    s_waitcnt vmcnt(0)
    v_bitop3_b32 v129, v81, v83, s59 bitop3:0x7e
    v_bitop3_b32 v130, v85, v87, s59 bitop3:0x7e
    v_bitop3_b32 v129, v89, v129, s59 bitop3:0xde
    v_bitop3_b32 v130, v91, v130, s59 bitop3:0xde
    v_bitop3_b32 v129, v93, v129, s59 bitop3:0xde
    v_bitop3_b32 v130, v95, v130, s59 bitop3:0xde
    v_or_b32 v129, v129, v130
    v_cmp_ne_u32 vcc, 0, v129
    s_cbranch_vccnz Lrt_178
    s_branch Lck_177
Lrt_180:
    s_sub_u32 s58, s58, 1
    s_cbranch_scc1 L_exit
    s_mov_b64 exec, vcc
    buffer_load_dwordx4 v[96:99], v1, s[20:23], s98 offen offset:2048 sc1
    buffer_load_dwordx4 v[100:103], v1, s[20:23], s98 offen offset:3072 sc1
    s_mov_b64 exec, -1
    s_waitcnt vmcnt(0)
    v_bitop3_b32 v104, v98, v102, s59 bitop3:0x7e
    v_bitop3_b32 v104, v99, v104, s59 bitop3:0xde
    v_bitop3_b32 v104, v103, v104, s59 bitop3:0xde
    v_cmp_ne_u32 vcc, 0, v104
    s_cbranch_vccnz Lrt_180
    s_branch Lck_179
Lzr_214:
    s_sub_u32 s58, s58, 1
    s_cbranch_scc1 L_exit
    s_add_u32 m0, s87, 1024
    s_add_u32 s57, s66, 5769216
    buffer_load_dwordx4 v1, s[20:23], s57 offen sc1 lds
    s_add_u32 m0, s87, 2048
    s_add_u32 s57, s67, 5769216
    buffer_load_dwordx4 v1, s[20:23], s57 offen sc1 lds
    s_waitcnt vmcnt(0)
    ds_read2st64_b32 v[46:47], v50 offset0:4 offset1:8
    s_waitcnt lgkmcnt(0)
    v_max_u32 v46, v46, v47
    v_cmp_eq_u32 vcc, -1, v46
    s_cbranch_vccnz Lzr_214
    s_branch Lzc_213
Lzr_216:
    s_sub_u32 s58, s58, 1
    s_cbranch_scc1 L_exit
    s_add_u32 m0, s87, 3072
    s_add_u32 s57, s68, 5769216
    buffer_load_dwordx4 v1, s[20:23], s57 offen sc1 lds
    s_add_u32 m0, s87, 4096
    s_add_u32 s57, s69, 5769216
    buffer_load_dwordx4 v1, s[20:23], s57 offen sc1 lds
    s_add_u32 m0, s87, 5120
    s_add_u32 s57, s70, 5769216
    buffer_load_dwordx4 v1, s[20:23], s57 offen sc1 lds
    s_add_u32 m0, s87, 6144
    s_add_u32 s57, s71, 5769216
    buffer_load_dwordx4 v1, s[20:23], s57 offen sc1 lds
    s_waitcnt vmcnt(0)
    ds_read2st64_b32 v[46:47], v50 offset0:12 offset1:16
    ds_read2st64_b32 v[48:49], v50 offset0:20 offset1:24
    s_waitcnt lgkmcnt(0)
    v_max3_u32 v47, v47, v48, v49
    v_max_u32 v46, v46, v47
    v_cmp_eq_u32 vcc, -1, v46
    s_cbranch_vccnz Lzr_216
    s_branch Lzc_215
Lzr_218:
    s_sub_u32 s58, s58, 1
    s_cbranch_scc1 L_exit
    s_add_u32 m0, s87, 9216
    s_add_u32 s57, s66, 5770240
    buffer_load_dwordx4 v1, s[20:23], s57 offen sc1 lds
    s_add_u32 m0, s87, 10240
    s_add_u32 s57, s67, 5770240
    buffer_load_dwordx4 v1, s[20:23], s57 offen sc1 lds
    s_add_u32 m0, s87, 11264
    s_add_u32 s57, s68, 5770240
    buffer_load_dwordx4 v1, s[20:23], s57 offen sc1 lds
    s_add_u32 m0, s87, 12288
    s_add_u32 s57, s69, 5770240
    buffer_load_dwordx4 v1, s[20:23], s57 offen sc1 lds
    s_add_u32 m0, s87, 13312
    s_add_u32 s57, s70, 5770240
    buffer_load_dwordx4 v1, s[20:23], s57 offen sc1 lds
    s_add_u32 m0, s87, 14336
    s_add_u32 s57, s71, 5770240
    buffer_load_dwordx4 v1, s[20:23], s57 offen sc1 lds
    s_waitcnt vmcnt(0)
    ds_read2st64_b32 v[40:41], v50 offset0:36 offset1:40
    ds_read2st64_b32 v[42:43], v50 offset0:44 offset1:48
    ds_read2st64_b32 v[44:45], v50 offset0:52 offset1:56
    s_waitcnt lgkmcnt(0)
    v_max3_u32 v41, v41, v42, v43
    v_max3_u32 v40, v40, v44, v45
    v_max_u32 v40, v40, v41
    v_cmp_eq_u32 vcc, -1, v40
    s_cbranch_vccnz Lzr_218
    s_branch Lzc_217
Lrt_220:
    s_sub_u32 s58, s58, 1
    s_cbranch_scc1 L_exit
    buffer_load_dword v0, v3, s[20:23], s88 offen offset:64 sc1
    s_waitcnt vmcnt(0)
    v_cmp_ne_u32 vcc, s59, v0
    s_cbranch_vccnz Lrt_220
    s_branch Lck_219
Lrt_222:
    s_sub_u32 s58, s58, 1
    s_cbranch_scc1 L_exit
    buffer_load_dword v0, v3, s[20:23], s88 offen offset:96 sc1
    s_waitcnt vmcnt(0)
    v_cmp_ne_u32 vcc, s59, v0
    s_cbranch_vccnz Lrt_222
    s_branch Lck_221
Lrt_224:
    s_sub_u32 s58, s58, 1
    s_cbranch_scc1 L_exit
    buffer_load_dword v0, v3, s[20:23], s88 offen offset:128 sc1
    s_waitcnt vmcnt(0)
    v_cmp_ne_u32 vcc, s59, v0
    s_cbranch_vccnz Lrt_224
    s_branch Lck_223
Lrt_226:
    s_sub_u32 s58, s58, 1
    s_cbranch_scc1 L_exit
    buffer_load_dword v0, v3, s[20:23], s88 offen offset:160 sc1
    s_waitcnt vmcnt(0)
    v_cmp_ne_u32 vcc, s59, v0
    s_cbranch_vccnz Lrt_226
    s_branch Lck_225
Lrt_228:
    s_sub_u32 s58, s58, 1
    s_cbranch_scc1 L_exit
    buffer_load_dwordx2 v[144:145], v1, s[20:23], s98 offen offset:0 sc1
    buffer_load_dwordx2 v[146:147], v1, s[20:23], s98 offen offset:1024 sc1
    s_waitcnt vmcnt(0)
    v_bitop3_b32 v148, v145, v147, s83 bitop3:0x7e
    v_cmp_ne_u32 vcc, 0, v148
    s_cbranch_vccnz Lrt_228
    s_branch Lck_227
Lzr_299:
    s_sub_u32 s58, s58, 1
    s_cbranch_scc1 L_exit
    s_add_u32 m0, s87, 1024
    s_add_u32 s57, s66, 4289200128
    buffer_load_dwordx4 v1, s[20:23], s57 offen sc1 lds
    s_add_u32 m0, s87, 2048
    s_add_u32 s57, s67, 4289200128
    buffer_load_dwordx4 v1, s[20:23], s57 offen sc1 lds
    s_waitcnt vmcnt(0)
    ds_read2st64_b32 v[46:47], v38 offset0:4 offset1:8
    s_waitcnt lgkmcnt(0)
    v_max_u32 v46, v46, v47
    v_cmp_eq_u32 vcc, -1, v46
    s_cbranch_vccnz Lzr_299
    s_branch Lzc_298
Lrt_301:
    s_sub_u32 s58, s58, 1
    s_cbranch_scc1 L_exit
    buffer_load_dwordx2 v[80:81], v1, s[20:23], s98 offen offset:8 sc1
    buffer_load_dwordx2 v[82:83], v1, s[20:23], s98 offen offset:1032 sc1
    s_waitcnt vmcnt(0)
    v_bitop3_b32 v84, v81, v83, s83 bitop3:0x7e
    v_cmp_ne_u32 vcc, 0, v84
    s_cbranch_vccnz Lrt_301
    s_branch Lck_300
Lrt_303:
    s_sub_u32 s58, s58, 1
    s_cbranch_scc1 L_exit
    buffer_load_dwordx2 v[112:113], v1, s[20:23], s98 offen offset:2048 sc1
    buffer_load_dwordx2 v[114:115], v1, s[20:23], s98 offen offset:3072 sc1
    s_waitcnt vmcnt(0)
    v_bitop3_b32 v116, v113, v115, s83 bitop3:0x7e
    v_cmp_ne_u32 vcc, 0, v116
    s_cbranch_vccnz Lrt_303
    s_branch Lck_302
Lrt_305:
    s_sub_u32 s58, s58, 1
    s_cbranch_scc1 L_exit
    buffer_load_dwordx2 v[80:81], v1, s[20:23], s98 offen offset:2056 sc1
    buffer_load_dwordx2 v[82:83], v1, s[20:23], s98 offen offset:3080 sc1
    s_waitcnt vmcnt(0)
    v_bitop3_b32 v84, v81, v83, s83 bitop3:0x7e
    v_cmp_ne_u32 vcc, 0, v84
    s_cbranch_vccnz Lrt_305
    s_branch Lck_304
Lzr_307:
    s_sub_u32 s58, s58, 1
    s_cbranch_scc1 L_exit
    s_add_u32 m0, s87, 3072
    s_add_u32 s57, s68, 4289200128
    buffer_load_dwordx4 v1, s[20:23], s57 offen sc1 lds
    s_add_u32 m0, s87, 4096
    s_add_u32 s57, s69, 4289200128
    buffer_load_dwordx4 v1, s[20:23], s57 offen sc1 lds
    s_add_u32 m0, s87, 5120
    s_add_u32 s57, s70, 4289200128
    buffer_load_dwordx4 v1, s[20:23], s57 offen sc1 lds
    s_add_u32 m0, s87, 6144
    s_add_u32 s57, s71, 4289200128
    buffer_load_dwordx4 v1, s[20:23], s57 offen sc1 lds
    s_waitcnt vmcnt(0)
    ds_read2st64_b32 v[46:47], v38 offset0:12 offset1:16
    ds_read2st64_b32 v[48:49], v38 offset0:20 offset1:24
    s_waitcnt lgkmcnt(0)
    v_max3_u32 v47, v47, v48, v49
    v_max_u32 v46, v46, v47
    v_cmp_eq_u32 vcc, -1, v46
    s_cbranch_vccnz Lzr_307
    s_branch Lzc_306
Lzr_309:
    s_sub_u32 s58, s58, 1
    s_cbranch_scc1 L_exit
    s_add_u32 m0, s87, 9216
    s_add_u32 s57, s66, 4289201152
    buffer_load_dwordx4 v1, s[20:23], s57 offen sc1 lds
    s_add_u32 m0, s87, 10240
    s_add_u32 s57, s67, 4289201152
    buffer_load_dwordx4 v1, s[20:23], s57 offen sc1 lds
    s_waitcnt vmcnt(0)
    ds_read2st64_b32 v[46:47], v38 offset0:36 offset1:40
    s_waitcnt lgkmcnt(0)
    v_max_u32 v46, v46, v47
    v_cmp_eq_u32 vcc, -1, v46
    s_cbranch_vccnz Lzr_309
    s_branch Lzc_308
Lzr_311:
    s_sub_u32 s58, s58, 1
    s_cbranch_scc1 L_exit
    s_add_u32 m0, s87, 11264
    s_add_u32 s57, s68, 4289201152
    buffer_load_dwordx4 v1, s[20:23], s57 offen sc1 lds
    s_add_u32 m0, s87, 12288
    s_add_u32 s57, s69, 4289201152
    buffer_load_dwordx4 v1, s[20:23], s57 offen sc1 lds
    s_add_u32 m0, s87, 13312
    s_add_u32 s57, s70, 4289201152
    buffer_load_dwordx4 v1, s[20:23], s57 offen sc1 lds
    s_add_u32 m0, s87, 14336
    s_add_u32 s57, s71, 4289201152
    buffer_load_dwordx4 v1, s[20:23], s57 offen sc1 lds
    s_waitcnt vmcnt(0)
    ds_read2st64_b32 v[46:47], v38 offset0:44 offset1:48
    ds_read2st64_b32 v[48:49], v38 offset0:52 offset1:56
    s_waitcnt lgkmcnt(0)
    v_max3_u32 v47, v47, v48, v49
    v_max_u32 v46, v46, v47
    v_cmp_eq_u32 vcc, -1, v46
    s_cbranch_vccnz Lzr_311
    s_branch Lzc_310
Lrt_313:
    s_sub_u32 s58, s58, 1
    s_cbranch_scc1 L_exit
    buffer_load_dword v0, v3, s[20:23], s88 offen offset:256 sc1
    s_waitcnt vmcnt(0)
    v_cmp_ne_u32 vcc, s59, v0
    s_cbranch_vccnz Lrt_313
    s_branch Lck_312
Lrt_315:
    s_sub_u32 s58, s58, 1
    s_cbranch_scc1 L_exit
    buffer_load_dword v0, v3, s[20:23], s88 offen offset:288 sc1
    s_waitcnt vmcnt(0)
    v_cmp_ne_u32 vcc, s59, v0
    s_cbranch_vccnz Lrt_315
    s_branch Lck_314
Lrt_317:
    s_sub_u32 s58, s58, 1
    s_cbranch_scc1 L_exit
    buffer_load_dword v0, v3, s[20:23], s88 offen offset:320 sc1
    s_waitcnt vmcnt(0)
    v_cmp_ne_u32 vcc, s59, v0
    s_cbranch_vccnz Lrt_317
    s_branch Lck_316
Lrt_319:
    s_sub_u32 s58, s58, 1
    s_cbranch_scc1 L_exit
    buffer_load_dword v0, v3, s[20:23], s88 offen offset:352 sc1
    s_waitcnt vmcnt(0)
    v_cmp_ne_u32 vcc, s59, v0
    s_cbranch_vccnz Lrt_319
    s_branch Lck_318
L_exit:
    s_waitcnt vmcnt(0) lgkmcnt(0)
    s_endpgm
.section .rodata,"a"
.p2align 6
.amdhsa_kernel interleave_layers__ssm_conv_h3__mixer_channel_mlp__prompt_kernel
  .amdhsa_next_free_vgpr 512
  .amdhsa_next_free_sgpr 102
  .amdhsa_accum_offset 256
  .amdhsa_group_segment_fixed_size 0
  .amdhsa_kernarg_size 112
  .amdhsa_user_sgpr_count 2
  .amdhsa_user_sgpr_kernarg_segment_ptr 1
  .amdhsa_system_sgpr_workgroup_id_x 1
.end_amdhsa_kernel
```
